```python
import torch

def _softmax(x, axis=-1):
    return torch.softmax(x, dim=axis)
def _gelu(x):
    return torch.nn.functional.gelu(x, approximate="tanh")
def _silu(x):
    return torch.nn.functional.silu(x)
def _sigmoid(x):
    return torch.sigmoid(x)
def _layernorm(x, axis=-1, eps=1e-5):
    m = x.mean(dim=axis, keepdim=True)
    v = x.var(dim=axis, keepdim=True, unbiased=False)
    return (x - m) / torch.sqrt(v + eps)
def _scatter_add(tgt, idx, src, axis=0):
    return tgt.clone().index_add_(axis, idx, src)
def _segment_sum(src, seg, n):
    out = torch.zeros((n,) + src.shape[1:], dtype=src.dtype)
    return out.index_add_(0, seg, src)
def _pad(x, pw):
    flat = tuple(v for pair in reversed(pw) for v in pair)
    return torch.nn.functional.pad(x, flat)

kernel_name = 'concat_heads__mha_block_cached__gqa_block_cached__near_ridge'

def setup_inputs():

    _w = (lambda a: (lambda t: t.to(torch.bfloat16) if t.is_floating_point() else t)(torch.as_tensor(a)))
    def _A_setup():
        B, Sq, D = 16, 192, 448
        H, Sk, Dh = 16, 512, 256
        return {
            "x": _w((lambda *s: torch.randn(*s, dtype=torch.bfloat16) * 0.8)(B, Sq, D)),
            "k_cache": _w((lambda *s: torch.randn(*s, dtype=torch.bfloat16) * 0.8)(B, H, Sk, Dh)),
            "v_cache": _w((lambda *s: torch.randn(*s, dtype=torch.bfloat16) * 0.05)(B, H, Sk, Dh)),
            "wq": _w((lambda *s: torch.randn(*s, dtype=torch.bfloat16) * 0.8)(D, H * Dh) * (D ** -0.5)),
            "wo": _w((lambda *s: torch.randn(*s, dtype=torch.bfloat16) * 0.05)(H * Dh, D) * ((H * Dh) ** -0.5)),
        }
    _A_in = _A_setup()

    def _B_setup():
        B, Sq, D = 16, 192, 448
        Hq, Hkv, Sk, Dh = 16, 16, 512, 256
        assert Hq % Hkv == 0, (Hq, Hkv)
        return {
            "x": _w((lambda *s: torch.randn(*s, dtype=torch.bfloat16) * 0.8)(B, Sq, D)),
            "k_cache": _w((lambda *s: torch.randn(*s, dtype=torch.bfloat16) * 0.8)(B, Hkv, Sk, Dh)),
            "v_cache": _w((lambda *s: torch.randn(*s, dtype=torch.bfloat16) * 0.05)(B, Hkv, Sk, Dh)),
            "wq": _w((lambda *s: torch.randn(*s, dtype=torch.bfloat16) * 0.8)(D, Hq * Dh) * (D ** -0.5)),
            "wo": _w((lambda *s: torch.randn(*s, dtype=torch.bfloat16) * 0.05)(Hq * Dh, D) * ((Hq * Dh) ** -0.5)),
        }
    _B_in = _B_setup()

    return {
        "A_x": _A_in["x"],
        "A_k_cache": _A_in["k_cache"],
        "A_v_cache": _A_in["v_cache"],
        "A_wq": _A_in["wq"],
        "A_wo": _A_in["wo"],
        "B_x": _B_in["x"],
        "B_k_cache": _B_in["k_cache"],
        "B_v_cache": _B_in["v_cache"],
        "B_wq": _B_in["wq"],
        "B_wo": _B_in["wo"],
    }

def reference(A_x, A_k_cache, A_v_cache, A_wq, A_wo, B_x, B_k_cache, B_v_cache, B_wq, B_wo):
    def _A_ref(x, k_cache, v_cache, wq, wo):
        B, Sq, D = x.shape
        H, Dh = 16, 256
        q = (lambda x, *d: x.permute(*d))((x @ wq).reshape(B, Sq, H, Dh), 0, 2, 1, 3)
        scores = torch.einsum("bhqd,bhkd->bhqk", q, k_cache) * (Dh ** -0.5)
        p = _softmax(scores, axis=-1)
        o = torch.einsum("bhqk,bhkd->bhqd", p, v_cache)
        return (lambda x, *d: x.permute(*d))(o, 0, 2, 1, 3).reshape(B, Sq, H * Dh) @ wo

    def _B_ref(x, k_cache, v_cache, wq, wo):
        B, Sq, D = x.shape
        Hq, Dh = 16, 256
        Hkv = k_cache.shape[1]
        rep = Hq // Hkv
        q = (lambda x, *d: x.permute(*d))((x @ wq).reshape(B, Sq, Hq, Dh), 0, 2, 1, 3)
        k = (lambda x, n, axis: torch.repeat_interleave(x, n, dim=axis))(k_cache, rep, axis=1)
        v = (lambda x, n, axis: torch.repeat_interleave(x, n, dim=axis))(v_cache, rep, axis=1)
        scores = torch.einsum("bhqd,bhkd->bhqk", q, k) * (Dh ** -0.5)
        p = _softmax(scores, axis=-1)
        o = torch.einsum("bhqk,bhkd->bhqd", p, v)
        return (lambda x, *d: x.permute(*d))(o, 0, 2, 1, 3).reshape(B, Sq, Hq * Dh) @ wo

    a = _A_ref(A_x, A_k_cache, A_v_cache, A_wq, A_wo)
    b = _B_ref(B_x, B_k_cache, B_v_cache, B_wq, B_wo)
    return torch.concatenate([a, b], axis=-1)
```

```asm
; @launch grid=(256,1,1) block=(256,1,1) lds=163840
.amdgcn_target "amdgcn-amd-amdhsa--gfx950"
.text
.globl concat_heads__mha_block_cached__gqa_block_cached__near_ridge_kernel
.p2align 8
.type concat_heads__mha_block_cached__gqa_block_cached__near_ridge_kernel,@function
concat_heads__mha_block_cached__gqa_block_cached__near_ridge_kernel:
    s_cmp_ge_u32 s2, 256
    s_cbranch_scc1 L_exit
    s_load_dwordx16 s[64:79], s[0:1], 0
    s_load_dwordx4 s[80:83], s[0:1], 64
    s_load_dwordx2 s[4:5], s[0:1], 96
    s_load_dwordx2 s[94:95], s[0:1], 88
    v_lshrrev_b32 v1, 6, v0
    v_and_b32 v248, 63, v0
    v_readfirstlane_b32 s52, v1
    s_and_b32 s3, s2, 7
    s_lshr_b32 s6, s2, 3
    s_lshr_b32 s53, s3, 2
    s_bfe_u32 s7, s3, 0x10001
    s_and_b32 s3, s3, 1
    s_lshl_b32 s3, s3, 3
    s_lshl_b32 s7, s7, 2
    s_lshr_b32 s54, s6, 3
    s_add_u32 s7, s7, s54
    s_and_b32 s6, s6, 7
    s_mov_b32 s90, s6
    s_mov_b32 s91, s54
    s_add_u32 s6, s6, s3
    s_mov_b32 s3, s7
    s_lshl_b32 s49, s3, 1
    s_mov_b32 s98, 0
    s_lshl_b32 s32, s52, 12
    s_mul_i32 s46, s6, 172032
    s_lshl_b32 s7, s6, 4
    s_add_u32 s7, s7, s49
    s_lshl_b32 s37, s7, 18
    s_nop 0
    s_mov_b32 s38, s37
    s_add_u32 s63, s49, s98
    s_lshl_b32 s63, s63, 9
    s_mov_b32 s42, 114688
    s_mov_b32 s43, 0xfffac080
    s_lshl_b32 s7, s53, 4
    s_add_u32 s7, s7, s6
    s_mov_b32 s92, s7
    s_lshl_b32 s7, s7, 3
    s_add_u32 s7, s7, s3
    s_mul_i32 s48, s7, 172032
    s_mul_i32 s3, s52, 43008
    s_add_u32 s48, s48, s3
    s_mul_i32 s47, s2, 98304
    s_mul_i32 s3, s52, 24576
    s_add_u32 s47, s47, s3
    s_add_u32 s47, s47, 50331648
    s_mov_b32 s40, 0x3db8aa3b
    s_mov_b32 s41, 0x3db8aa3b
    s_mov_b32 s51, 0x41200000
    s_mov_b32 s33, 0
    s_mov_b32 s34, 0
    s_mov_b32 s35, 0
    s_mov_b32 s36, 0
    s_mov_b32 s30, 0
    v_lshrrev_b32 v252, 4, v248
    v_and_b32 v253, 15, v248
    v_xor_b32 v253, v253, v252
    v_lshlrev_b32 v253, 4, v253
    s_mul_i32 s54, s52, 48
    v_add_u32 v252, s54, v252
    v_mul_u32_u24 v252, 896, v252
    v_xor_b32 v244, 0, v253
    v_add_u32 v244, v244, v252
    v_xor_b32 v245, 64, v253
    v_add_u32 v245, v245, v252
    v_add_u32 v245, 2560, v245
    v_xor_b32 v246, 128, v253
    v_add_u32 v246, v246, v252
    v_add_u32 v246, 5120, v246
    v_xor_b32 v247, 192, v253
    v_add_u32 v247, v247, v252
    v_add_u32 v247, 7680, v247
    v_lshrrev_b32 v252, 5, v248
    v_and_b32 v253, 31, v248
    v_lshlrev_b32 v254, 1, v252
    v_xor_b32 v253, v253, v254
    v_lshlrev_b32 v253, 4, v253
    v_lshlrev_b32 v252, 13, v252
    s_and_b32 s54, s52, 1
    s_lshl_b32 s54, s54, 17
    s_lshr_b32 s55, s52, 1
    s_lshl_b32 s55, s55, 15
    s_add_u32 s54, s54, s55
    v_add_u32 v252, s54, v252
    v_xor_b32 v240, 0, v253
    v_add_u32 v240, v240, v252
    v_xor_b32 v241, 64, v253
    v_add_u32 v241, v241, v252
    v_add_u32 v241, 15360, v241
    v_xor_b32 v242, 128, v253
    v_add_u32 v242, v242, v252
    v_add_u32 v242, 63488, v242
    v_xor_b32 v243, 192, v253
    v_add_u32 v243, v243, v252
    v_add_u32 v243, 78848, v243
    s_waitcnt lgkmcnt(0)
    s_cmp_eq_u32 s53, 0
    s_cselect_b32 s20, s64, s74
    s_cselect_b32 s21, s65, s75
    s_cselect_b32 s8, s66, s76
    s_cselect_b32 s9, s67, s77
    s_cselect_b32 s12, s68, s78
    s_cselect_b32 s13, s69, s79
    s_cselect_b32 s16, s70, s80
    s_cselect_b32 s17, s71, s81
    s_cselect_b32 s44, s72, s82
    s_cselect_b32 s45, s73, s83
    s_mov_b32 s22, 2752512
    s_mov_b32 s23, 0x00020000
    s_mov_b32 s10, 67108864
    s_mov_b32 s11, 0x00020000
    s_mov_b32 s14, 67108864
    s_mov_b32 s15, 0x00020000
    s_mov_b32 s18, 3670016
    s_mov_b32 s19, 0x00020000
    s_mov_b32 s24, s4
    s_mov_b32 s25, s5
    s_mov_b32 s26, 288620544
    s_mov_b32 s27, 0x00020000
    s_mov_b32 s81, s90
    s_mov_b32 s82, s91
    s_mov_b32 s74, s92
    s_mov_b32 s3, s98
    s_mov_b32 s6, 0
    s_mov_b32 s7, 0
    s_getpc_b64 s[88:89]
L_pc:
    s_and_b32 s88, s88, 0xffffff00
    s_mov_b32 s90, L_codeend-L_pc
    s_mov_b32 s91, 0x00020000
    s_lshr_b32 s92, s2, 3
    s_lshl_b32 s92, s92, 2
    s_add_u32 s92, s92, s52
    s_mul_hi_u32 s54, s92, 429496730
    s_mul_i32 s54, s54, 10
    s_sub_u32 s92, s92, s54
    s_lshl_b32 s92, s92, 13
    v_lshlrev_b32 v249, 7, v248
    s_lshl_b32 s93, s74, 2
    s_lshl_b32 s75, s74, 8
    s_add_u32 s75, s75, 104857600
    s_or_b32 s99, s49, s52
    s_cmp_eq_u32 s99, 0
    s_cselect_b32 s99, 0, 0x7f000000
    v_mov_b32 v252, 0x7f000000
    v_mov_b32 v253, s99
    v_cmp_eq_u32 vcc, 0, v248
    s_nop 1
    v_cndmask_b32 v254, v252, v253, vcc
    v_mov_b32 v253, 0
    buffer_store_dword v253, v254, s[24:27], s75 offen sc1
    s_mov_b32 s76, s94
    s_mov_b32 s77, s95
    s_mov_b32 s78, 256
    s_mov_b32 s79, 0x00020000
    s_add_u32 s64, s46, 0
    s_add_u32 s65, s46, 14336
    s_add_u32 s66, s46, 28672
    s_add_u32 s67, s63, 0
    s_add_u32 s68, s63, 262144
    s_add_u32 s69, s46, 256
    s_add_u32 s70, s46, 14592
    s_add_u32 s71, s46, 28928
    s_add_u32 m0, s33, s32
    s_nop 0
    buffer_load_dwordx4 v244, s[20:23], s64 offen offset:0 lds
    buffer_load_dwordx4 v245, s[20:23], s64 offen offset:1024 lds
    buffer_load_dwordx4 v246, s[20:23], s64 offen offset:2048 lds
    buffer_load_dwordx4 v247, s[20:23], s64 offen offset:3072 lds
    s_add_u32 s33, s33, 16384
    s_cmp_eq_u32 s33, 163840
    s_cselect_b32 s33, 0, s33
    s_add_u32 m0, s33, s32
    s_nop 0
    buffer_load_dwordx4 v244, s[20:23], s65 offen offset:0 lds
    buffer_load_dwordx4 v245, s[20:23], s65 offen offset:1024 lds
    buffer_load_dwordx4 v246, s[20:23], s65 offen offset:2048 lds
    buffer_load_dwordx4 v247, s[20:23], s65 offen offset:3072 lds
    s_add_u32 s33, s33, 16384
    s_cmp_eq_u32 s33, 163840
    s_cselect_b32 s33, 0, s33
    s_add_u32 m0, s33, s32
    s_nop 0
    buffer_load_dwordx4 v244, s[20:23], s66 offen offset:0 lds
    buffer_load_dwordx4 v245, s[20:23], s66 offen offset:1024 lds
    buffer_load_dwordx4 v246, s[20:23], s66 offen offset:2048 lds
    buffer_load_dwordx4 v247, s[20:23], s66 offen offset:3072 lds
    s_add_u32 s33, s33, 16384
    s_cmp_eq_u32 s33, 163840
    s_cselect_b32 s33, 0, s33
    s_add_u32 m0, s33, s32
    s_nop 0
    buffer_load_dwordx4 v240, s[16:19], s67 offen offset:0 lds
    buffer_load_dwordx4 v241, s[16:19], s67 offen offset:1024 lds
    buffer_load_dwordx4 v242, s[16:19], s67 offen offset:2048 lds
    buffer_load_dwordx4 v243, s[16:19], s67 offen offset:3072 lds
    s_add_u32 s33, s33, 16384
    s_cmp_eq_u32 s33, 163840
    s_cselect_b32 s33, 0, s33
    buffer_load_dword a254, v249, s[88:91], s92 offen
    s_lshl_b32 s54, s81, 2
    s_add_u32 s54, s54, s52
    s_mul_i32 s54, s54, 14
    v_lshrrev_b32 v252, 2, v248
    v_min_u32 v252, 13, v252
    v_add_u32 v252, s54, v252
    v_lshlrev_b32 v252, 13, v252
    v_and_b32 v254, 3, v248
    v_lshlrev_b32 v254, 7, v254
    v_add_u32 v252, v252, v254
    s_mov_b32 s83, s63
    s_lshl_b32 s54, s82, 2
    s_add_u32 s54, s54, s52
    s_mul_i32 s54, s54, 10752
    s_add_u32 s73, s46, s54
    v_lshlrev_b32 v253, 7, v248
    buffer_load_dword a252, v252, s[16:19], s83 offen
    buffer_load_dword a253, v253, s[20:23], s73 offen
    s_add_u32 s73, s73, 8192
    v_lshrrev_b32 v252, 2, v248
    v_and_b32 v253, 7, v252
    v_lshlrev_b32 v253, 1, v253
    v_bfe_u32 v254, v248, 1, 1
    v_xor_b32 v253, v253, v254
    v_lshlrev_b32 v253, 4, v253
    v_lshlrev_b32 v252, 9, v252
    v_add_u32 v252, v252, v253
    v_and_b32 v253, 1, v248
    v_lshlrev_b32 v253, 3, v253
    v_add_u32 v252, v252, v253
    v_xor_b32 v224, 0, v252
    v_xor_b32 v225, 32, v252
    v_xor_b32 v226, 64, v252
    v_xor_b32 v227, 96, v252
    v_xor_b32 v228, 128, v252
    v_xor_b32 v229, 160, v252
    v_xor_b32 v230, 192, v252
    v_xor_b32 v231, 224, v252
    v_and_b32 v252, 15, v248
    v_and_b32 v253, 7, v252
    v_lshlrev_b32 v253, 1, v253
    v_lshrrev_b32 v254, 4, v248
    v_xor_b32 v253, v253, v254
    v_lshlrev_b32 v253, 4, v253
    v_lshlrev_b32 v252, 9, v252
    v_add_u32 v252, v252, v253
    v_xor_b32 v232, 0, v252
    v_xor_b32 v233, 64, v252
    v_xor_b32 v234, 128, v252
    v_xor_b32 v235, 192, v252
    v_lshrrev_b32 v252, 5, v248
    v_and_b32 v253, 31, v248
    v_lshlrev_b32 v254, 1, v252
    v_xor_b32 v253, v253, v254
    v_lshlrev_b32 v253, 4, v253
    v_lshlrev_b32 v252, 9, v252
    v_add_u32 v252, v252, v253
    v_add_u32 v252, s32, v252
    v_xor_b32 v236, 0, v252
    v_xor_b32 v237, 64, v252
    v_xor_b32 v238, 128, v252
    v_xor_b32 v239, 192, v252
    v_and_b32 v252, 15, v248
    v_lshrrev_b32 v253, 4, v248
    v_xor_b32 v253, v253, v252
    v_lshlrev_b32 v253, 4, v253
    v_lshlrev_b32 v252, 8, v252
    v_add_u32 v252, v252, v253
    v_add_u32 v249, s32, v252
    v_lshlrev_b32 v250, 4, v248
    v_mov_b32 v252, 0x3f803f80
    v_accvgpr_write_b32 a204, v252
    v_accvgpr_write_b32 a205, v252
    v_accvgpr_write_b32 a206, v252
    v_accvgpr_write_b32 a207, v252
L_unit:
    s_mov_b32 s30, s6
    s_mov_b32 s60, s34
    s_add_u32 s34, s34, 16384
    s_cmp_eq_u32 s34, 163840
    s_cselect_b32 s34, 0, s34
    s_mov_b32 s61, s34
    s_add_u32 s34, s34, 16384
    s_cmp_eq_u32 s34, 163840
    s_cselect_b32 s34, 0, s34
    s_mov_b32 s62, s34
    s_add_u32 s34, s34, 16384
    s_cmp_eq_u32 s34, 163840
    s_cselect_b32 s34, 0, s34
    s_sub_u32 s50, s34, s35
    s_mov_b32 s35, s34
    v_add_u32 v224, s50, v224
    v_add_u32 v225, s50, v225
    v_add_u32 v226, s50, v226
    v_add_u32 v227, s50, v227
    v_add_u32 v228, s50, v228
    v_add_u32 v229, s50, v229
    v_add_u32 v230, s50, v230
    v_add_u32 v231, s50, v231
    s_waitcnt vmcnt(3)
    s_barrier
    v_add_u32 v252, s60, v249
    ds_read_b128 a[0:3], v252
    v_add_u32 v252, s61, v249
    ds_read_b128 a[4:7], v252
    v_add_u32 v252, s62, v249
    ds_read_b128 a[8:11], v252
    ds_read_b64_tr_b16 v[192:193], v224 offset:0
    ds_read_b64_tr_b16 v[194:195], v224 offset:8192
    ds_read_b64_tr_b16 v[196:197], v225 offset:0
    ds_read_b64_tr_b16 v[198:199], v225 offset:8192
    ds_read_b64_tr_b16 v[200:201], v226 offset:0
    ds_read_b64_tr_b16 v[202:203], v226 offset:8192
    ds_read_b64_tr_b16 v[204:205], v227 offset:0
    ds_read_b64_tr_b16 v[206:207], v227 offset:8192
    s_waitcnt lgkmcnt(6)
    s_cmp_eq_u32 s30, 0
    s_cbranch_scc0 L_q0b
    v_mfma_f32_16x16x32_bf16 v[0:3], v[192:195], a[0:3], 0
    s_add_u32 s34, s34, 16384
    s_cmp_eq_u32 s34, 163840
    s_cselect_b32 s34, 0, s34
    ds_read_b64_tr_b16 v[208:209], v228 offset:0
    v_add_u32 v252, s60, v249
    v_mfma_f32_16x16x32_bf16 v[8:11], v[192:195], a[4:7], 0
    s_sub_u32 s50, s34, s35
    ds_read_b64_tr_b16 v[210:211], v228 offset:8192
    v_xor_b32 v253, 64, v252
    v_mfma_f32_16x16x32_bf16 v[16:19], v[192:195], a[8:11], 0
    s_waitcnt lgkmcnt(6)
    ds_read_b128 a[12:15], v253
    v_xor_b32 v253, 128, v252
    v_mfma_f32_16x16x32_bf16 v[4:7], v[196:199], a[0:3], 0
    s_mov_b32 s35, s34
    ds_read_b64_tr_b16 v[212:213], v229 offset:0
    ds_read_b128 a[24:27], v253
    v_mfma_f32_16x16x32_bf16 v[12:15], v[196:199], a[4:7], 0
    s_add_u32 m0, s33, s32
    ds_read_b64_tr_b16 v[214:215], v229 offset:8192
    v_xor_b32 v253, 192, v252
    v_mfma_f32_16x16x32_bf16 v[20:23], v[196:199], a[8:11], 0
    s_waitcnt lgkmcnt(8)
    ds_read_b128 a[36:39], v253
    v_add_u32 v252, s61, v249
    v_mfma_f32_16x16x32_bf16 v[24:27], v[200:203], a[0:3], 0
    ds_read_b64_tr_b16 v[216:217], v230 offset:0
    v_xor_b32 v253, 64, v252
    v_mfma_f32_16x16x32_bf16 v[32:35], v[200:203], a[4:7], 0
    ds_read_b64_tr_b16 v[218:219], v230 offset:8192
    ds_read_b128 a[16:19], v253
    v_mfma_f32_16x16x32_bf16 v[40:43], v[200:203], a[8:11], 0
    s_waitcnt lgkmcnt(10)
    v_xor_b32 v253, 128, v252
    ds_read_b128 a[28:31], v253
    v_mfma_f32_16x16x32_bf16 v[28:31], v[204:207], a[0:3], 0
    ds_read_b64_tr_b16 v[220:221], v231 offset:0
    v_xor_b32 v253, 192, v252
    v_mfma_f32_16x16x32_bf16 v[36:39], v[204:207], a[4:7], 0
    ds_read_b64_tr_b16 v[222:223], v231 offset:8192
    ds_read_b128 a[40:43], v253
    v_mfma_f32_16x16x32_bf16 v[44:47], v[204:207], a[8:11], 0
    s_waitcnt lgkmcnt(12)
    v_add_u32 v252, s62, v249
    v_xor_b32 v253, 64, v252
    v_mfma_f32_16x16x32_bf16 v[48:51], v[208:211], a[0:3], 0
    ds_read_b64_tr_b16 v[192:193], v224 offset:256
    ds_read_b128 a[20:23], v253
    v_mfma_f32_16x16x32_bf16 v[56:59], v[208:211], a[4:7], 0
    ds_read_b64_tr_b16 v[194:195], v224 offset:8448
    v_add_u32 v224, s50, v224
    v_mfma_f32_16x16x32_bf16 v[64:67], v[208:211], a[8:11], 0
    s_waitcnt lgkmcnt(11)
    v_xor_b32 v253, 128, v252
    ds_read_b128 a[32:35], v253
    v_mfma_f32_16x16x32_bf16 v[52:55], v[212:215], a[0:3], 0
    ds_read_b64_tr_b16 v[196:197], v225 offset:256
    v_xor_b32 v253, 192, v252
    v_mfma_f32_16x16x32_bf16 v[60:63], v[212:215], a[4:7], 0
    ds_read_b64_tr_b16 v[198:199], v225 offset:8448
    v_add_u32 v225, s50, v225
    v_mfma_f32_16x16x32_bf16 v[68:71], v[212:215], a[8:11], 0
    s_waitcnt lgkmcnt(11)
    ds_read_b128 a[44:47], v253
    v_mfma_f32_16x16x32_bf16 v[72:75], v[216:219], a[0:3], 0
    ds_read_b64_tr_b16 v[200:201], v226 offset:256
    v_mfma_f32_16x16x32_bf16 v[80:83], v[216:219], a[4:7], 0
    ds_read_b64_tr_b16 v[202:203], v226 offset:8448
    v_add_u32 v226, s50, v226
    v_mfma_f32_16x16x32_bf16 v[88:91], v[216:219], a[8:11], 0
    s_waitcnt lgkmcnt(10)
    buffer_load_dwordx4 v240, s[16:19], s68 offen offset:0 lds
    v_mfma_f32_16x16x32_bf16 v[76:79], v[220:223], a[0:3], 0
    ds_read_b64_tr_b16 v[204:205], v227 offset:256
    v_mfma_f32_16x16x32_bf16 v[84:87], v[220:223], a[4:7], 0
    ds_read_b64_tr_b16 v[206:207], v227 offset:8448
    v_add_u32 v227, s50, v227
    v_mfma_f32_16x16x32_bf16 v[92:95], v[220:223], a[8:11], 0
    s_waitcnt lgkmcnt(8)
    buffer_load_dwordx4 v241, s[16:19], s68 offen offset:1024 lds
    v_mfma_f32_16x16x32_bf16 v[96:99], v[192:195], a[0:3], 0
    ds_read_b64_tr_b16 v[208:209], v228 offset:256
    v_mfma_f32_16x16x32_bf16 v[104:107], v[192:195], a[4:7], 0
    ds_read_b64_tr_b16 v[210:211], v228 offset:8448
    v_add_u32 v228, s50, v228
    v_mfma_f32_16x16x32_bf16 v[112:115], v[192:195], a[8:11], 0
    s_waitcnt lgkmcnt(7)
    buffer_load_dwordx4 v242, s[16:19], s68 offen offset:2048 lds
    v_mfma_f32_16x16x32_bf16 v[100:103], v[196:199], a[0:3], 0
    ds_read_b64_tr_b16 v[212:213], v229 offset:256
    v_mfma_f32_16x16x32_bf16 v[108:111], v[196:199], a[4:7], 0
    ds_read_b64_tr_b16 v[214:215], v229 offset:8448
    v_add_u32 v229, s50, v229
    v_mfma_f32_16x16x32_bf16 v[116:119], v[196:199], a[8:11], 0
    s_waitcnt lgkmcnt(6)
    buffer_load_dwordx4 v243, s[16:19], s68 offen offset:3072 lds
    v_mfma_f32_16x16x32_bf16 v[120:123], v[200:203], a[0:3], 0
    s_add_u32 s33, s33, 16384
    s_cmp_eq_u32 s33, 163840
    s_cselect_b32 s33, 0, s33
    ds_read_b64_tr_b16 v[216:217], v230 offset:256
    v_mfma_f32_16x16x32_bf16 v[128:131], v[200:203], a[4:7], 0
    s_add_u32 m0, s33, s32
    ds_read_b64_tr_b16 v[218:219], v230 offset:8448
    v_add_u32 v230, s50, v230
    v_mfma_f32_16x16x32_bf16 v[136:139], v[200:203], a[8:11], 0
    s_waitcnt lgkmcnt(6)
    buffer_load_dwordx4 v244, s[20:23], s69 offen offset:0 lds
    v_mfma_f32_16x16x32_bf16 v[124:127], v[204:207], a[0:3], 0
    ds_read_b64_tr_b16 v[220:221], v231 offset:256
    v_mfma_f32_16x16x32_bf16 v[132:135], v[204:207], a[4:7], 0
    ds_read_b64_tr_b16 v[222:223], v231 offset:8448
    v_add_u32 v231, s50, v231
    v_mfma_f32_16x16x32_bf16 v[140:143], v[204:207], a[8:11], 0
    s_waitcnt lgkmcnt(6)
    s_waitcnt lgkmcnt(12)
    s_waitcnt vmcnt(1)
    s_barrier
    buffer_load_dwordx4 v245, s[20:23], s69 offen offset:1024 lds
    v_mfma_f32_16x16x32_bf16 v[144:147], v[208:211], a[0:3], 0
    ds_read_b64_tr_b16 v[192:193], v224 offset:0
    v_mfma_f32_16x16x32_bf16 v[152:155], v[208:211], a[4:7], 0
    ds_read_b64_tr_b16 v[194:195], v224 offset:8192
    v_mfma_f32_16x16x32_bf16 v[160:163], v[208:211], a[8:11], 0
    s_waitcnt lgkmcnt(6)
    buffer_load_dwordx4 v246, s[20:23], s69 offen offset:2048 lds
    v_mfma_f32_16x16x32_bf16 v[148:151], v[212:215], a[0:3], 0
    ds_read_b64_tr_b16 v[196:197], v225 offset:0
    v_mfma_f32_16x16x32_bf16 v[156:159], v[212:215], a[4:7], 0
    ds_read_b64_tr_b16 v[198:199], v225 offset:8192
    v_mfma_f32_16x16x32_bf16 v[164:167], v[212:215], a[8:11], 0
    s_waitcnt lgkmcnt(6)
    buffer_load_dwordx4 v247, s[20:23], s69 offen offset:3072 lds
    v_mfma_f32_16x16x32_bf16 v[168:171], v[216:219], a[0:3], 0
    s_add_u32 s33, s33, 16384
    s_cmp_eq_u32 s33, 163840
    s_cselect_b32 s33, 0, s33
    ds_read_b64_tr_b16 v[200:201], v226 offset:0
    v_mfma_f32_16x16x32_bf16 v[176:179], v[216:219], a[4:7], 0
    s_add_u32 m0, s33, s32
    ds_read_b64_tr_b16 v[202:203], v226 offset:8192
    v_mfma_f32_16x16x32_bf16 v[184:187], v[216:219], a[8:11], 0
    s_waitcnt lgkmcnt(6)
    buffer_load_dwordx4 v244, s[20:23], s70 offen offset:0 lds
    v_mfma_f32_16x16x32_bf16 v[172:175], v[220:223], a[0:3], 0
    ds_read_b64_tr_b16 v[204:205], v227 offset:0
    v_mfma_f32_16x16x32_bf16 v[180:183], v[220:223], a[4:7], 0
    ds_read_b64_tr_b16 v[206:207], v227 offset:8192
    v_mfma_f32_16x16x32_bf16 v[188:191], v[220:223], a[8:11], 0
    s_waitcnt lgkmcnt(6)
    buffer_load_dwordx4 v245, s[20:23], s70 offen offset:1024 lds
    buffer_load_dwordx4 v246, s[20:23], s70 offen offset:2048 lds
    buffer_load_dwordx4 v247, s[20:23], s70 offen offset:3072 lds
    s_add_u32 s33, s33, 16384
    s_cmp_eq_u32 s33, 163840
    s_cselect_b32 s33, 0, s33
    s_add_u32 m0, s33, s32
    buffer_load_dwordx4 v244, s[20:23], s71 offen offset:0 lds
    buffer_load_dwordx4 v245, s[20:23], s71 offen offset:1024 lds
    buffer_load_dwordx4 v246, s[20:23], s71 offen offset:2048 lds
    buffer_load_dwordx4 v247, s[20:23], s71 offen offset:3072 lds
    s_add_u32 s33, s33, 16384
    s_cmp_eq_u32 s33, 163840
    s_cselect_b32 s33, 0, s33
    s_add_u32 m0, s33, s32
    s_add_u32 s72, s63, 524288
    buffer_load_dwordx4 v240, s[16:19], s72 offen offset:0 lds
    buffer_load_dwordx4 v241, s[16:19], s72 offen offset:1024 lds
    buffer_load_dwordx4 v242, s[16:19], s72 offen offset:2048 lds
    buffer_load_dwordx4 v243, s[16:19], s72 offen offset:3072 lds
    s_add_u32 s33, s33, 16384
    s_cmp_eq_u32 s33, 163840
    s_cselect_b32 s33, 0, s33
    s_add_u32 m0, s33, s32
    s_add_u32 s72, s63, 786432
    buffer_load_dwordx4 v240, s[16:19], s72 offen offset:0 lds
    buffer_load_dwordx4 v241, s[16:19], s72 offen offset:1024 lds
    buffer_load_dwordx4 v242, s[16:19], s72 offen offset:2048 lds
    buffer_load_dwordx4 v243, s[16:19], s72 offen offset:3072 lds
    s_add_u32 s33, s33, 16384
    s_cmp_eq_u32 s33, 163840
    s_cselect_b32 s33, 0, s33
    s_branch L_q0e
L_q0b:
    v_mfma_f32_16x16x32_bf16 v[0:3], v[192:195], a[0:3], 0
    s_add_u32 s34, s34, 16384
    s_cmp_eq_u32 s34, 163840
    s_cselect_b32 s34, 0, s34
    ds_read_b64_tr_b16 v[208:209], v228 offset:0
    v_add_u32 v252, s60, v249
    v_mfma_f32_16x16x32_bf16 v[8:11], v[192:195], a[4:7], 0
    s_sub_u32 s50, s34, s35
    ds_read_b64_tr_b16 v[210:211], v228 offset:8192
    v_xor_b32 v253, 64, v252
    v_mfma_f32_16x16x32_bf16 v[16:19], v[192:195], a[8:11], 0
    s_waitcnt lgkmcnt(6)
    ds_read_b128 a[12:15], v253
    v_xor_b32 v253, 128, v252
    v_mfma_f32_16x16x32_bf16 v[4:7], v[196:199], a[0:3], 0
    s_mov_b32 s35, s34
    ds_read_b64_tr_b16 v[212:213], v229 offset:0
    ds_read_b128 a[24:27], v253
    v_mfma_f32_16x16x32_bf16 v[12:15], v[196:199], a[4:7], 0
    s_add_u32 m0, s33, s32
    s_add_u32 s72, s63, 524288
    ds_read_b64_tr_b16 v[214:215], v229 offset:8192
    v_xor_b32 v253, 192, v252
    v_mfma_f32_16x16x32_bf16 v[20:23], v[196:199], a[8:11], 0
    s_waitcnt lgkmcnt(8)
    ds_read_b128 a[36:39], v253
    v_add_u32 v252, s61, v249
    v_mfma_f32_16x16x32_bf16 v[24:27], v[200:203], a[0:3], 0
    ds_read_b64_tr_b16 v[216:217], v230 offset:0
    v_xor_b32 v253, 64, v252
    v_mfma_f32_16x16x32_bf16 v[32:35], v[200:203], a[4:7], 0
    ds_read_b64_tr_b16 v[218:219], v230 offset:8192
    ds_read_b128 a[16:19], v253
    v_mfma_f32_16x16x32_bf16 v[40:43], v[200:203], a[8:11], 0
    s_waitcnt lgkmcnt(10)
    v_xor_b32 v253, 128, v252
    ds_read_b128 a[28:31], v253
    v_mfma_f32_16x16x32_bf16 v[28:31], v[204:207], a[0:3], 0
    ds_read_b64_tr_b16 v[220:221], v231 offset:0
    v_xor_b32 v253, 192, v252
    v_mfma_f32_16x16x32_bf16 v[36:39], v[204:207], a[4:7], 0
    ds_read_b64_tr_b16 v[222:223], v231 offset:8192
    ds_read_b128 a[40:43], v253
    v_mfma_f32_16x16x32_bf16 v[44:47], v[204:207], a[8:11], 0
    s_waitcnt lgkmcnt(12)
    v_add_u32 v252, s62, v249
    v_xor_b32 v253, 64, v252
    v_mfma_f32_16x16x32_bf16 v[48:51], v[208:211], a[0:3], 0
    ds_read_b64_tr_b16 v[192:193], v224 offset:256
    ds_read_b128 a[20:23], v253
    v_mfma_f32_16x16x32_bf16 v[56:59], v[208:211], a[4:7], 0
    ds_read_b64_tr_b16 v[194:195], v224 offset:8448
    v_add_u32 v224, s50, v224
    v_mfma_f32_16x16x32_bf16 v[64:67], v[208:211], a[8:11], 0
    s_waitcnt lgkmcnt(11)
    v_xor_b32 v253, 128, v252
    ds_read_b128 a[32:35], v253
    v_mfma_f32_16x16x32_bf16 v[52:55], v[212:215], a[0:3], 0
    ds_read_b64_tr_b16 v[196:197], v225 offset:256
    v_xor_b32 v253, 192, v252
    v_mfma_f32_16x16x32_bf16 v[60:63], v[212:215], a[4:7], 0
    ds_read_b64_tr_b16 v[198:199], v225 offset:8448
    v_add_u32 v225, s50, v225
    v_mfma_f32_16x16x32_bf16 v[68:71], v[212:215], a[8:11], 0
    s_waitcnt lgkmcnt(11)
    ds_read_b128 a[44:47], v253
    v_mfma_f32_16x16x32_bf16 v[72:75], v[216:219], a[0:3], 0
    ds_read_b64_tr_b16 v[200:201], v226 offset:256
    v_mfma_f32_16x16x32_bf16 v[80:83], v[216:219], a[4:7], 0
    ds_read_b64_tr_b16 v[202:203], v226 offset:8448
    v_add_u32 v226, s50, v226
    v_mfma_f32_16x16x32_bf16 v[88:91], v[216:219], a[8:11], 0
    s_waitcnt lgkmcnt(10)
    buffer_load_dwordx4 v240, s[16:19], s72 offen offset:0 lds
    v_mfma_f32_16x16x32_bf16 v[76:79], v[220:223], a[0:3], 0
    ds_read_b64_tr_b16 v[204:205], v227 offset:256
    v_mfma_f32_16x16x32_bf16 v[84:87], v[220:223], a[4:7], 0
    ds_read_b64_tr_b16 v[206:207], v227 offset:8448
    v_add_u32 v227, s50, v227
    v_mfma_f32_16x16x32_bf16 v[92:95], v[220:223], a[8:11], 0
    s_waitcnt lgkmcnt(8)
    buffer_load_dwordx4 v241, s[16:19], s72 offen offset:1024 lds
    v_mfma_f32_16x16x32_bf16 v[96:99], v[192:195], a[0:3], 0
    ds_read_b64_tr_b16 v[208:209], v228 offset:256
    v_mfma_f32_16x16x32_bf16 v[104:107], v[192:195], a[4:7], 0
    ds_read_b64_tr_b16 v[210:211], v228 offset:8448
    v_add_u32 v228, s50, v228
    v_mfma_f32_16x16x32_bf16 v[112:115], v[192:195], a[8:11], 0
    s_waitcnt lgkmcnt(7)
    buffer_load_dwordx4 v242, s[16:19], s72 offen offset:2048 lds
    v_mfma_f32_16x16x32_bf16 v[100:103], v[196:199], a[0:3], 0
    ds_read_b64_tr_b16 v[212:213], v229 offset:256
    v_mfma_f32_16x16x32_bf16 v[108:111], v[196:199], a[4:7], 0
    ds_read_b64_tr_b16 v[214:215], v229 offset:8448
    v_add_u32 v229, s50, v229
    v_mfma_f32_16x16x32_bf16 v[116:119], v[196:199], a[8:11], 0
    s_waitcnt lgkmcnt(6)
    buffer_load_dwordx4 v243, s[16:19], s72 offen offset:3072 lds
    v_mfma_f32_16x16x32_bf16 v[120:123], v[200:203], a[0:3], 0
    s_add_u32 s33, s33, 16384
    s_cmp_eq_u32 s33, 163840
    s_cselect_b32 s33, 0, s33
    ds_read_b64_tr_b16 v[216:217], v230 offset:256
    v_mfma_f32_16x16x32_bf16 v[128:131], v[200:203], a[4:7], 0
    s_add_u32 m0, s33, s32
    s_add_u32 s72, s63, 786432
    ds_read_b64_tr_b16 v[218:219], v230 offset:8448
    v_add_u32 v230, s50, v230
    v_mfma_f32_16x16x32_bf16 v[136:139], v[200:203], a[8:11], 0
    s_waitcnt lgkmcnt(6)
    buffer_load_dwordx4 v240, s[16:19], s72 offen offset:0 lds
    v_mfma_f32_16x16x32_bf16 v[124:127], v[204:207], a[0:3], 0
    ds_read_b64_tr_b16 v[220:221], v231 offset:256
    v_mfma_f32_16x16x32_bf16 v[132:135], v[204:207], a[4:7], 0
    ds_read_b64_tr_b16 v[222:223], v231 offset:8448
    v_add_u32 v231, s50, v231
    v_mfma_f32_16x16x32_bf16 v[140:143], v[204:207], a[8:11], 0
    s_waitcnt lgkmcnt(6)
    s_waitcnt lgkmcnt(12)
    s_waitcnt vmcnt(30)
    s_barrier
    buffer_load_dwordx4 v241, s[16:19], s72 offen offset:1024 lds
    v_mfma_f32_16x16x32_bf16 v[144:147], v[208:211], a[0:3], 0
    ds_read_b64_tr_b16 v[192:193], v224 offset:0
    v_mfma_f32_16x16x32_bf16 v[152:155], v[208:211], a[4:7], 0
    ds_read_b64_tr_b16 v[194:195], v224 offset:8192
    v_mfma_f32_16x16x32_bf16 v[160:163], v[208:211], a[8:11], 0
    s_waitcnt lgkmcnt(6)
    buffer_load_dwordx4 v242, s[16:19], s72 offen offset:2048 lds
    v_mfma_f32_16x16x32_bf16 v[148:151], v[212:215], a[0:3], 0
    ds_read_b64_tr_b16 v[196:197], v225 offset:0
    v_mfma_f32_16x16x32_bf16 v[156:159], v[212:215], a[4:7], 0
    ds_read_b64_tr_b16 v[198:199], v225 offset:8192
    v_mfma_f32_16x16x32_bf16 v[164:167], v[212:215], a[8:11], 0
    s_waitcnt lgkmcnt(6)
    buffer_load_dwordx4 v243, s[16:19], s72 offen offset:3072 lds
    v_mfma_f32_16x16x32_bf16 v[168:171], v[216:219], a[0:3], 0
    s_add_u32 s33, s33, 16384
    s_cmp_eq_u32 s33, 163840
    s_cselect_b32 s33, 0, s33
    ds_read_b64_tr_b16 v[200:201], v226 offset:0
    v_mfma_f32_16x16x32_bf16 v[176:179], v[216:219], a[4:7], 0
    ds_read_b64_tr_b16 v[202:203], v226 offset:8192
    v_mfma_f32_16x16x32_bf16 v[184:187], v[216:219], a[8:11], 0
    s_waitcnt lgkmcnt(6)
    v_mfma_f32_16x16x32_bf16 v[172:175], v[220:223], a[0:3], 0
    ds_read_b64_tr_b16 v[204:205], v227 offset:0
    v_mfma_f32_16x16x32_bf16 v[180:183], v[220:223], a[4:7], 0
    ds_read_b64_tr_b16 v[206:207], v227 offset:8192
    v_mfma_f32_16x16x32_bf16 v[188:191], v[220:223], a[8:11], 0
    s_waitcnt lgkmcnt(6)
L_q0e:
    v_mfma_f32_16x16x32_bf16 v[0:3], v[192:195], a[12:15], v[0:3]
    s_add_u32 s34, s34, 16384
    s_cmp_eq_u32 s34, 163840
    s_cselect_b32 s34, 0, s34
    ds_read_b64_tr_b16 v[208:209], v228 offset:0
    v_mfma_f32_16x16x32_bf16 v[8:11], v[192:195], a[16:19], v[8:11]
    s_mov_b32 s60, s34
    ds_read_b64_tr_b16 v[210:211], v228 offset:8192
    v_mfma_f32_16x16x32_bf16 v[16:19], v[192:195], a[20:23], v[16:19]
    s_waitcnt lgkmcnt(6)
    v_mfma_f32_16x16x32_bf16 v[4:7], v[196:199], a[12:15], v[4:7]
    s_add_u32 s34, s34, 16384
    s_cmp_eq_u32 s34, 163840
    s_cselect_b32 s34, 0, s34
    ds_read_b64_tr_b16 v[212:213], v229 offset:0
    v_mfma_f32_16x16x32_bf16 v[12:15], v[196:199], a[16:19], v[12:15]
    s_mov_b32 s61, s34
    ds_read_b64_tr_b16 v[214:215], v229 offset:8192
    v_mfma_f32_16x16x32_bf16 v[20:23], v[196:199], a[20:23], v[20:23]
    s_waitcnt lgkmcnt(6)
    v_mfma_f32_16x16x32_bf16 v[24:27], v[200:203], a[12:15], v[24:27]
    s_add_u32 s34, s34, 16384
    s_cmp_eq_u32 s34, 163840
    s_cselect_b32 s34, 0, s34
    ds_read_b64_tr_b16 v[216:217], v230 offset:0
    v_mfma_f32_16x16x32_bf16 v[32:35], v[200:203], a[16:19], v[32:35]
    s_mov_b32 s62, s34
    ds_read_b64_tr_b16 v[218:219], v230 offset:8192
    v_mfma_f32_16x16x32_bf16 v[40:43], v[200:203], a[20:23], v[40:43]
    s_waitcnt lgkmcnt(6)
    v_mfma_f32_16x16x32_bf16 v[28:31], v[204:207], a[12:15], v[28:31]
    s_add_u32 s34, s34, 16384
    s_cmp_eq_u32 s34, 163840
    s_cselect_b32 s34, 0, s34
    ds_read_b64_tr_b16 v[220:221], v231 offset:0
    v_mfma_f32_16x16x32_bf16 v[36:39], v[204:207], a[16:19], v[36:39]
    s_sub_u32 s50, s34, s35
    ds_read_b64_tr_b16 v[222:223], v231 offset:8192
    v_mfma_f32_16x16x32_bf16 v[44:47], v[204:207], a[20:23], v[44:47]
    s_waitcnt lgkmcnt(6)
    v_mfma_f32_16x16x32_bf16 v[48:51], v[208:211], a[12:15], v[48:51]
    s_mov_b32 s35, s34
    ds_read_b64_tr_b16 v[192:193], v224 offset:256
    v_mfma_f32_16x16x32_bf16 v[56:59], v[208:211], a[16:19], v[56:59]
    s_add_u32 m0, s33, s32
    s_add_u32 s72, s46, 512
    ds_read_b64_tr_b16 v[194:195], v224 offset:8448
    v_add_u32 v224, s50, v224
    v_mfma_f32_16x16x32_bf16 v[64:67], v[208:211], a[20:23], v[64:67]
    s_waitcnt lgkmcnt(6)
    buffer_load_dwordx4 v244, s[20:23], s72 offen offset:0 lds
    v_mfma_f32_16x16x32_bf16 v[52:55], v[212:215], a[12:15], v[52:55]
    ds_read_b64_tr_b16 v[196:197], v225 offset:256
    v_mfma_f32_16x16x32_bf16 v[60:63], v[212:215], a[16:19], v[60:63]
    ds_read_b64_tr_b16 v[198:199], v225 offset:8448
    v_add_u32 v225, s50, v225
    v_mfma_f32_16x16x32_bf16 v[68:71], v[212:215], a[20:23], v[68:71]
    s_waitcnt lgkmcnt(6)
    buffer_load_dwordx4 v245, s[20:23], s72 offen offset:1024 lds
    v_mfma_f32_16x16x32_bf16 v[72:75], v[216:219], a[12:15], v[72:75]
    ds_read_b64_tr_b16 v[200:201], v226 offset:256
    v_mfma_f32_16x16x32_bf16 v[80:83], v[216:219], a[16:19], v[80:83]
    ds_read_b64_tr_b16 v[202:203], v226 offset:8448
    v_add_u32 v226, s50, v226
    v_mfma_f32_16x16x32_bf16 v[88:91], v[216:219], a[20:23], v[88:91]
    s_waitcnt lgkmcnt(6)
    buffer_load_dwordx4 v246, s[20:23], s72 offen offset:2048 lds
    v_mfma_f32_16x16x32_bf16 v[76:79], v[220:223], a[12:15], v[76:79]
    ds_read_b64_tr_b16 v[204:205], v227 offset:256
    v_mfma_f32_16x16x32_bf16 v[84:87], v[220:223], a[16:19], v[84:87]
    ds_read_b64_tr_b16 v[206:207], v227 offset:8448
    v_add_u32 v227, s50, v227
    v_mfma_f32_16x16x32_bf16 v[92:95], v[220:223], a[20:23], v[92:95]
    s_waitcnt lgkmcnt(6)
    buffer_load_dwordx4 v247, s[20:23], s72 offen offset:3072 lds
    v_mfma_f32_16x16x32_bf16 v[96:99], v[192:195], a[12:15], v[96:99]
    s_add_u32 s33, s33, 16384
    s_cmp_eq_u32 s33, 163840
    s_cselect_b32 s33, 0, s33
    ds_read_b64_tr_b16 v[208:209], v228 offset:256
    v_mfma_f32_16x16x32_bf16 v[104:107], v[192:195], a[16:19], v[104:107]
    s_add_u32 m0, s33, s32
    s_add_u32 s72, s46, 14848
    ds_read_b64_tr_b16 v[210:211], v228 offset:8448
    v_add_u32 v228, s50, v228
    v_mfma_f32_16x16x32_bf16 v[112:115], v[192:195], a[20:23], v[112:115]
    s_waitcnt lgkmcnt(6)
    buffer_load_dwordx4 v244, s[20:23], s72 offen offset:0 lds
    v_mfma_f32_16x16x32_bf16 v[100:103], v[196:199], a[12:15], v[100:103]
    ds_read_b64_tr_b16 v[212:213], v229 offset:256
    v_mfma_f32_16x16x32_bf16 v[108:111], v[196:199], a[16:19], v[108:111]
    ds_read_b64_tr_b16 v[214:215], v229 offset:8448
    v_add_u32 v229, s50, v229
    v_mfma_f32_16x16x32_bf16 v[116:119], v[196:199], a[20:23], v[116:119]
    s_waitcnt lgkmcnt(6)
    buffer_load_dwordx4 v245, s[20:23], s72 offen offset:1024 lds
    v_mfma_f32_16x16x32_bf16 v[120:123], v[200:203], a[12:15], v[120:123]
    ds_read_b64_tr_b16 v[216:217], v230 offset:256
    v_mfma_f32_16x16x32_bf16 v[128:131], v[200:203], a[16:19], v[128:131]
    ds_read_b64_tr_b16 v[218:219], v230 offset:8448
    v_add_u32 v230, s50, v230
    v_mfma_f32_16x16x32_bf16 v[136:139], v[200:203], a[20:23], v[136:139]
    s_waitcnt lgkmcnt(6)
    buffer_load_dwordx4 v246, s[20:23], s72 offen offset:2048 lds
    v_mfma_f32_16x16x32_bf16 v[124:127], v[204:207], a[12:15], v[124:127]
    ds_read_b64_tr_b16 v[220:221], v231 offset:256
    v_mfma_f32_16x16x32_bf16 v[132:135], v[204:207], a[16:19], v[132:135]
    ds_read_b64_tr_b16 v[222:223], v231 offset:8448
    v_add_u32 v231, s50, v231
    v_mfma_f32_16x16x32_bf16 v[140:143], v[204:207], a[20:23], v[140:143]
    s_waitcnt lgkmcnt(6)
    s_waitcnt vmcnt(11)
    s_barrier
    buffer_load_dwordx4 v247, s[20:23], s72 offen offset:3072 lds
    v_mfma_f32_16x16x32_bf16 v[144:147], v[208:211], a[12:15], v[144:147]
    s_add_u32 s33, s33, 16384
    s_cmp_eq_u32 s33, 163840
    s_cselect_b32 s33, 0, s33
    ds_read_b64_tr_b16 v[192:193], v224 offset:0
    v_mfma_f32_16x16x32_bf16 v[152:155], v[208:211], a[16:19], v[152:155]
    s_add_u32 m0, s33, s32
    s_add_u32 s72, s46, 29184
    ds_read_b64_tr_b16 v[194:195], v224 offset:8192
    v_mfma_f32_16x16x32_bf16 v[160:163], v[208:211], a[20:23], v[160:163]
    s_waitcnt lgkmcnt(6)
    buffer_load_dwordx4 v244, s[20:23], s72 offen offset:0 lds
    v_mfma_f32_16x16x32_bf16 v[148:151], v[212:215], a[12:15], v[148:151]
    ds_read_b64_tr_b16 v[196:197], v225 offset:0
    v_mfma_f32_16x16x32_bf16 v[156:159], v[212:215], a[16:19], v[156:159]
    ds_read_b64_tr_b16 v[198:199], v225 offset:8192
    v_mfma_f32_16x16x32_bf16 v[164:167], v[212:215], a[20:23], v[164:167]
    s_waitcnt lgkmcnt(6)
    buffer_load_dwordx4 v245, s[20:23], s72 offen offset:1024 lds
    v_mfma_f32_16x16x32_bf16 v[168:171], v[216:219], a[12:15], v[168:171]
    ds_read_b64_tr_b16 v[200:201], v226 offset:0
    v_mfma_f32_16x16x32_bf16 v[176:179], v[216:219], a[16:19], v[176:179]
    ds_read_b64_tr_b16 v[202:203], v226 offset:8192
    v_mfma_f32_16x16x32_bf16 v[184:187], v[216:219], a[20:23], v[184:187]
    s_waitcnt lgkmcnt(6)
    buffer_load_dwordx4 v246, s[20:23], s72 offen offset:2048 lds
    v_mfma_f32_16x16x32_bf16 v[172:175], v[220:223], a[12:15], v[172:175]
    ds_read_b64_tr_b16 v[204:205], v227 offset:0
    v_mfma_f32_16x16x32_bf16 v[180:183], v[220:223], a[16:19], v[180:183]
    ds_read_b64_tr_b16 v[206:207], v227 offset:8192
    v_mfma_f32_16x16x32_bf16 v[188:191], v[220:223], a[20:23], v[188:191]
    s_waitcnt lgkmcnt(6)
    buffer_load_dwordx4 v247, s[20:23], s72 offen offset:3072 lds
    s_add_u32 s33, s33, 16384
    s_cmp_eq_u32 s33, 163840
    s_cselect_b32 s33, 0, s33
    v_mfma_f32_16x16x32_bf16 v[0:3], v[192:195], a[24:27], v[0:3]
    s_add_u32 s34, s34, 16384
    s_cmp_eq_u32 s34, 163840
    s_cselect_b32 s34, 0, s34
    ds_read_b64_tr_b16 v[208:209], v228 offset:0
    v_add_u32 v252, s60, v249
    v_mfma_f32_16x16x32_bf16 v[8:11], v[192:195], a[28:31], v[8:11]
    s_sub_u32 s50, s34, s35
    ds_read_b64_tr_b16 v[210:211], v228 offset:8192
    ds_read_b128 a[48:51], v252
    v_mfma_f32_16x16x32_bf16 v[16:19], v[192:195], a[32:35], v[16:19]
    s_waitcnt lgkmcnt(7)
    v_xor_b32 v253, 64, v252
    ds_read_b128 a[60:63], v253
    v_mfma_f32_16x16x32_bf16 v[4:7], v[196:199], a[24:27], v[4:7]
    s_mov_b32 s35, s34
    ds_read_b64_tr_b16 v[212:213], v229 offset:0
    v_xor_b32 v253, 128, v252
    v_mfma_f32_16x16x32_bf16 v[12:15], v[196:199], a[28:31], v[12:15]
    s_add_u32 m0, s33, s32
    s_add_u32 s72, s63, 1048576
    ds_read_b64_tr_b16 v[214:215], v229 offset:8192
    ds_read_b128 a[72:75], v253
    v_mfma_f32_16x16x32_bf16 v[20:23], v[196:199], a[32:35], v[20:23]
    s_waitcnt lgkmcnt(9)
    v_xor_b32 v253, 192, v252
    ds_read_b128 a[84:87], v253
    v_mfma_f32_16x16x32_bf16 v[24:27], v[200:203], a[24:27], v[24:27]
    ds_read_b64_tr_b16 v[216:217], v230 offset:0
    v_add_u32 v252, s61, v249
    v_mfma_f32_16x16x32_bf16 v[32:35], v[200:203], a[28:31], v[32:35]
    ds_read_b64_tr_b16 v[218:219], v230 offset:8192
    ds_read_b128 a[52:55], v252
    v_mfma_f32_16x16x32_bf16 v[40:43], v[200:203], a[32:35], v[40:43]
    s_waitcnt lgkmcnt(11)
    v_xor_b32 v253, 64, v252
    ds_read_b128 a[64:67], v253
    v_mfma_f32_16x16x32_bf16 v[28:31], v[204:207], a[24:27], v[28:31]
    ds_read_b64_tr_b16 v[220:221], v231 offset:0
    v_xor_b32 v253, 128, v252
    v_mfma_f32_16x16x32_bf16 v[36:39], v[204:207], a[28:31], v[36:39]
    ds_read_b64_tr_b16 v[222:223], v231 offset:8192
    ds_read_b128 a[76:79], v253
    v_mfma_f32_16x16x32_bf16 v[44:47], v[204:207], a[32:35], v[44:47]
    s_waitcnt lgkmcnt(13)
    v_xor_b32 v253, 192, v252
    ds_read_b128 a[88:91], v253
    v_mfma_f32_16x16x32_bf16 v[48:51], v[208:211], a[24:27], v[48:51]
    ds_read_b64_tr_b16 v[192:193], v224 offset:256
    v_add_u32 v252, s62, v249
    v_mfma_f32_16x16x32_bf16 v[56:59], v[208:211], a[28:31], v[56:59]
    ds_read_b64_tr_b16 v[194:195], v224 offset:8448
    v_add_u32 v224, s50, v224
    v_mfma_f32_16x16x32_bf16 v[64:67], v[208:211], a[32:35], v[64:67]
    s_waitcnt lgkmcnt(12)
    ds_read_b128 a[56:59], v252
    v_xor_b32 v253, 64, v252
    v_mfma_f32_16x16x32_bf16 v[52:55], v[212:215], a[24:27], v[52:55]
    ds_read_b64_tr_b16 v[196:197], v225 offset:256
    ds_read_b128 a[68:71], v253
    v_mfma_f32_16x16x32_bf16 v[60:63], v[212:215], a[28:31], v[60:63]
    ds_read_b64_tr_b16 v[198:199], v225 offset:8448
    v_add_u32 v225, s50, v225
    v_mfma_f32_16x16x32_bf16 v[68:71], v[212:215], a[32:35], v[68:71]
    s_waitcnt lgkmcnt(12)
    v_xor_b32 v253, 128, v252
    ds_read_b128 a[80:83], v253
    v_mfma_f32_16x16x32_bf16 v[72:75], v[216:219], a[24:27], v[72:75]
    ds_read_b64_tr_b16 v[200:201], v226 offset:256
    v_xor_b32 v253, 192, v252
    v_mfma_f32_16x16x32_bf16 v[80:83], v[216:219], a[28:31], v[80:83]
    ds_read_b64_tr_b16 v[202:203], v226 offset:8448
    v_add_u32 v226, s50, v226
    v_mfma_f32_16x16x32_bf16 v[88:91], v[216:219], a[32:35], v[88:91]
    s_waitcnt lgkmcnt(11)
    ds_read_b128 a[92:95], v253
    v_mfma_f32_16x16x32_bf16 v[76:79], v[220:223], a[24:27], v[76:79]
    ds_read_b64_tr_b16 v[204:205], v227 offset:256
    v_mfma_f32_16x16x32_bf16 v[84:87], v[220:223], a[28:31], v[84:87]
    ds_read_b64_tr_b16 v[206:207], v227 offset:8448
    v_add_u32 v227, s50, v227
    v_mfma_f32_16x16x32_bf16 v[92:95], v[220:223], a[32:35], v[92:95]
    s_waitcnt lgkmcnt(10)
    buffer_load_dwordx4 v240, s[16:19], s72 offen offset:0 lds
    v_mfma_f32_16x16x32_bf16 v[96:99], v[192:195], a[24:27], v[96:99]
    ds_read_b64_tr_b16 v[208:209], v228 offset:256
    v_mfma_f32_16x16x32_bf16 v[104:107], v[192:195], a[28:31], v[104:107]
    ds_read_b64_tr_b16 v[210:211], v228 offset:8448
    v_add_u32 v228, s50, v228
    v_mfma_f32_16x16x32_bf16 v[112:115], v[192:195], a[32:35], v[112:115]
    s_waitcnt lgkmcnt(8)
    buffer_load_dwordx4 v241, s[16:19], s72 offen offset:1024 lds
    v_mfma_f32_16x16x32_bf16 v[100:103], v[196:199], a[24:27], v[100:103]
    ds_read_b64_tr_b16 v[212:213], v229 offset:256
    v_mfma_f32_16x16x32_bf16 v[108:111], v[196:199], a[28:31], v[108:111]
    ds_read_b64_tr_b16 v[214:215], v229 offset:8448
    v_add_u32 v229, s50, v229
    v_mfma_f32_16x16x32_bf16 v[116:119], v[196:199], a[32:35], v[116:119]
    s_waitcnt lgkmcnt(7)
    buffer_load_dwordx4 v242, s[16:19], s72 offen offset:2048 lds
    v_mfma_f32_16x16x32_bf16 v[120:123], v[200:203], a[24:27], v[120:123]
    ds_read_b64_tr_b16 v[216:217], v230 offset:256
    v_mfma_f32_16x16x32_bf16 v[128:131], v[200:203], a[28:31], v[128:131]
    ds_read_b64_tr_b16 v[218:219], v230 offset:8448
    v_add_u32 v230, s50, v230
    v_mfma_f32_16x16x32_bf16 v[136:139], v[200:203], a[32:35], v[136:139]
    s_waitcnt lgkmcnt(6)
    v_mfma_f32_16x16x32_bf16 v[124:127], v[204:207], a[24:27], v[124:127]
    ds_read_b64_tr_b16 v[220:221], v231 offset:256
    v_mfma_f32_16x16x32_bf16 v[132:135], v[204:207], a[28:31], v[132:135]
    ds_read_b64_tr_b16 v[222:223], v231 offset:8448
    v_add_u32 v231, s50, v231
    v_mfma_f32_16x16x32_bf16 v[140:143], v[204:207], a[32:35], v[140:143]
    s_waitcnt lgkmcnt(6)
    s_waitcnt lgkmcnt(10)
    s_waitcnt vmcnt(15)
    s_barrier
    buffer_load_dwordx4 v243, s[16:19], s72 offen offset:3072 lds
    v_mfma_f32_16x16x32_bf16 v[144:147], v[208:211], a[24:27], v[144:147]
    s_add_u32 s33, s33, 16384
    s_cmp_eq_u32 s33, 163840
    s_cselect_b32 s33, 0, s33
    ds_read_b64_tr_b16 v[192:193], v224 offset:0
    v_mfma_f32_16x16x32_bf16 v[152:155], v[208:211], a[28:31], v[152:155]
    ds_read_b64_tr_b16 v[194:195], v224 offset:8192
    v_mfma_f32_16x16x32_bf16 v[160:163], v[208:211], a[32:35], v[160:163]
    s_waitcnt lgkmcnt(6)
    v_mfma_f32_16x16x32_bf16 v[148:151], v[212:215], a[24:27], v[148:151]
    ds_read_b64_tr_b16 v[196:197], v225 offset:0
    v_mfma_f32_16x16x32_bf16 v[156:159], v[212:215], a[28:31], v[156:159]
    ds_read_b64_tr_b16 v[198:199], v225 offset:8192
    v_mfma_f32_16x16x32_bf16 v[164:167], v[212:215], a[32:35], v[164:167]
    s_waitcnt lgkmcnt(6)
    v_mfma_f32_16x16x32_bf16 v[168:171], v[216:219], a[24:27], v[168:171]
    ds_read_b64_tr_b16 v[200:201], v226 offset:0
    v_mfma_f32_16x16x32_bf16 v[176:179], v[216:219], a[28:31], v[176:179]
    ds_read_b64_tr_b16 v[202:203], v226 offset:8192
    v_mfma_f32_16x16x32_bf16 v[184:187], v[216:219], a[32:35], v[184:187]
    s_waitcnt lgkmcnt(6)
    v_mfma_f32_16x16x32_bf16 v[172:175], v[220:223], a[24:27], v[172:175]
    ds_read_b64_tr_b16 v[204:205], v227 offset:0
    v_mfma_f32_16x16x32_bf16 v[180:183], v[220:223], a[28:31], v[180:183]
    ds_read_b64_tr_b16 v[206:207], v227 offset:8192
    v_mfma_f32_16x16x32_bf16 v[188:191], v[220:223], a[32:35], v[188:191]
    s_waitcnt lgkmcnt(6)
    v_mfma_f32_16x16x32_bf16 v[0:3], v[192:195], a[36:39], v[0:3]
    s_add_u32 s34, s34, 16384
    s_cmp_eq_u32 s34, 163840
    s_cselect_b32 s34, 0, s34
    ds_read_b64_tr_b16 v[208:209], v228 offset:0
    v_mfma_f32_16x16x32_bf16 v[8:11], v[192:195], a[40:43], v[8:11]
    s_mov_b32 s60, s34
    ds_read_b64_tr_b16 v[210:211], v228 offset:8192
    v_mfma_f32_16x16x32_bf16 v[16:19], v[192:195], a[44:47], v[16:19]
    s_waitcnt lgkmcnt(6)
    v_mfma_f32_16x16x32_bf16 v[4:7], v[196:199], a[36:39], v[4:7]
    s_add_u32 s34, s34, 16384
    s_cmp_eq_u32 s34, 163840
    s_cselect_b32 s34, 0, s34
    ds_read_b64_tr_b16 v[212:213], v229 offset:0
    v_mfma_f32_16x16x32_bf16 v[12:15], v[196:199], a[40:43], v[12:15]
    s_mov_b32 s61, s34
    ds_read_b64_tr_b16 v[214:215], v229 offset:8192
    v_mfma_f32_16x16x32_bf16 v[20:23], v[196:199], a[44:47], v[20:23]
    s_waitcnt lgkmcnt(6)
    v_mfma_f32_16x16x32_bf16 v[24:27], v[200:203], a[36:39], v[24:27]
    s_add_u32 s34, s34, 16384
    s_cmp_eq_u32 s34, 163840
    s_cselect_b32 s34, 0, s34
    ds_read_b64_tr_b16 v[216:217], v230 offset:0
    v_mfma_f32_16x16x32_bf16 v[32:35], v[200:203], a[40:43], v[32:35]
    s_mov_b32 s62, s34
    ds_read_b64_tr_b16 v[218:219], v230 offset:8192
    v_mfma_f32_16x16x32_bf16 v[40:43], v[200:203], a[44:47], v[40:43]
    s_waitcnt lgkmcnt(6)
    v_mfma_f32_16x16x32_bf16 v[28:31], v[204:207], a[36:39], v[28:31]
    s_add_u32 s34, s34, 16384
    s_cmp_eq_u32 s34, 163840
    s_cselect_b32 s34, 0, s34
    ds_read_b64_tr_b16 v[220:221], v231 offset:0
    v_mfma_f32_16x16x32_bf16 v[36:39], v[204:207], a[40:43], v[36:39]
    s_sub_u32 s50, s34, s35
    ds_read_b64_tr_b16 v[222:223], v231 offset:8192
    v_mfma_f32_16x16x32_bf16 v[44:47], v[204:207], a[44:47], v[44:47]
    s_waitcnt lgkmcnt(6)
    v_mfma_f32_16x16x32_bf16 v[48:51], v[208:211], a[36:39], v[48:51]
    s_mov_b32 s35, s34
    ds_read_b64_tr_b16 v[192:193], v224 offset:256
    v_mfma_f32_16x16x32_bf16 v[56:59], v[208:211], a[40:43], v[56:59]
    s_add_u32 m0, s33, s32
    s_add_u32 s72, s63, 1310720
    ds_read_b64_tr_b16 v[194:195], v224 offset:8448
    v_add_u32 v224, s50, v224
    v_mfma_f32_16x16x32_bf16 v[64:67], v[208:211], a[44:47], v[64:67]
    s_waitcnt lgkmcnt(6)
    buffer_load_dwordx4 v240, s[16:19], s72 offen offset:0 lds
    v_mfma_f32_16x16x32_bf16 v[52:55], v[212:215], a[36:39], v[52:55]
    ds_read_b64_tr_b16 v[196:197], v225 offset:256
    v_mfma_f32_16x16x32_bf16 v[60:63], v[212:215], a[40:43], v[60:63]
    ds_read_b64_tr_b16 v[198:199], v225 offset:8448
    v_add_u32 v225, s50, v225
    v_mfma_f32_16x16x32_bf16 v[68:71], v[212:215], a[44:47], v[68:71]
    s_waitcnt lgkmcnt(6)
    buffer_load_dwordx4 v241, s[16:19], s72 offen offset:1024 lds
    v_mfma_f32_16x16x32_bf16 v[72:75], v[216:219], a[36:39], v[72:75]
    ds_read_b64_tr_b16 v[200:201], v226 offset:256
    v_mfma_f32_16x16x32_bf16 v[80:83], v[216:219], a[40:43], v[80:83]
    ds_read_b64_tr_b16 v[202:203], v226 offset:8448
    v_add_u32 v226, s50, v226
    v_mfma_f32_16x16x32_bf16 v[88:91], v[216:219], a[44:47], v[88:91]
    s_waitcnt lgkmcnt(6)
    buffer_load_dwordx4 v242, s[16:19], s72 offen offset:2048 lds
    v_mfma_f32_16x16x32_bf16 v[76:79], v[220:223], a[36:39], v[76:79]
    ds_read_b64_tr_b16 v[204:205], v227 offset:256
    v_mfma_f32_16x16x32_bf16 v[84:87], v[220:223], a[40:43], v[84:87]
    ds_read_b64_tr_b16 v[206:207], v227 offset:8448
    v_add_u32 v227, s50, v227
    v_mfma_f32_16x16x32_bf16 v[92:95], v[220:223], a[44:47], v[92:95]
    s_waitcnt lgkmcnt(6)
    buffer_load_dwordx4 v243, s[16:19], s72 offen offset:3072 lds
    v_mfma_f32_16x16x32_bf16 v[96:99], v[192:195], a[36:39], v[96:99]
    s_add_u32 s33, s33, 16384
    s_cmp_eq_u32 s33, 163840
    s_cselect_b32 s33, 0, s33
    ds_read_b64_tr_b16 v[208:209], v228 offset:256
    v_mfma_f32_16x16x32_bf16 v[104:107], v[192:195], a[40:43], v[104:107]
    s_add_u32 m0, s33, s32
    s_add_u32 s72, s46, 768
    ds_read_b64_tr_b16 v[210:211], v228 offset:8448
    v_add_u32 v228, s50, v228
    v_mfma_f32_16x16x32_bf16 v[112:115], v[192:195], a[44:47], v[112:115]
    s_waitcnt lgkmcnt(6)
    buffer_load_dwordx4 v244, s[20:23], s72 offen offset:0 lds
    v_mfma_f32_16x16x32_bf16 v[100:103], v[196:199], a[36:39], v[100:103]
    ds_read_b64_tr_b16 v[212:213], v229 offset:256
    v_mfma_f32_16x16x32_bf16 v[108:111], v[196:199], a[40:43], v[108:111]
    ds_read_b64_tr_b16 v[214:215], v229 offset:8448
    v_add_u32 v229, s50, v229
    v_mfma_f32_16x16x32_bf16 v[116:119], v[196:199], a[44:47], v[116:119]
    s_waitcnt lgkmcnt(6)
    buffer_load_dwordx4 v245, s[20:23], s72 offen offset:1024 lds
    v_mfma_f32_16x16x32_bf16 v[120:123], v[200:203], a[36:39], v[120:123]
    ds_read_b64_tr_b16 v[216:217], v230 offset:256
    v_mfma_f32_16x16x32_bf16 v[128:131], v[200:203], a[40:43], v[128:131]
    ds_read_b64_tr_b16 v[218:219], v230 offset:8448
    v_add_u32 v230, s50, v230
    v_mfma_f32_16x16x32_bf16 v[136:139], v[200:203], a[44:47], v[136:139]
    s_waitcnt lgkmcnt(6)
    buffer_load_dwordx4 v246, s[20:23], s72 offen offset:2048 lds
    v_mfma_f32_16x16x32_bf16 v[124:127], v[204:207], a[36:39], v[124:127]
    ds_read_b64_tr_b16 v[220:221], v231 offset:256
    v_mfma_f32_16x16x32_bf16 v[132:135], v[204:207], a[40:43], v[132:135]
    ds_read_b64_tr_b16 v[222:223], v231 offset:8448
    v_add_u32 v231, s50, v231
    v_mfma_f32_16x16x32_bf16 v[140:143], v[204:207], a[44:47], v[140:143]
    s_waitcnt lgkmcnt(6)
    s_waitcnt vmcnt(7)
    s_barrier
    buffer_load_dwordx4 v247, s[20:23], s72 offen offset:3072 lds
    v_mfma_f32_16x16x32_bf16 v[144:147], v[208:211], a[36:39], v[144:147]
    s_add_u32 s33, s33, 16384
    s_cmp_eq_u32 s33, 163840
    s_cselect_b32 s33, 0, s33
    ds_read_b64_tr_b16 v[192:193], v224 offset:0
    v_mfma_f32_16x16x32_bf16 v[152:155], v[208:211], a[40:43], v[152:155]
    s_add_u32 m0, s33, s32
    s_add_u32 s72, s46, 15104
    ds_read_b64_tr_b16 v[194:195], v224 offset:8192
    v_mfma_f32_16x16x32_bf16 v[160:163], v[208:211], a[44:47], v[160:163]
    s_waitcnt lgkmcnt(6)
    buffer_load_dwordx4 v244, s[20:23], s72 offen offset:0 lds
    v_mfma_f32_16x16x32_bf16 v[148:151], v[212:215], a[36:39], v[148:151]
    ds_read_b64_tr_b16 v[196:197], v225 offset:0
    v_mfma_f32_16x16x32_bf16 v[156:159], v[212:215], a[40:43], v[156:159]
    ds_read_b64_tr_b16 v[198:199], v225 offset:8192
    v_mfma_f32_16x16x32_bf16 v[164:167], v[212:215], a[44:47], v[164:167]
    s_waitcnt lgkmcnt(6)
    buffer_load_dwordx4 v245, s[20:23], s72 offen offset:1024 lds
    v_mfma_f32_16x16x32_bf16 v[168:171], v[216:219], a[36:39], v[168:171]
    ds_read_b64_tr_b16 v[200:201], v226 offset:0
    v_mfma_f32_16x16x32_bf16 v[176:179], v[216:219], a[40:43], v[176:179]
    ds_read_b64_tr_b16 v[202:203], v226 offset:8192
    v_mfma_f32_16x16x32_bf16 v[184:187], v[216:219], a[44:47], v[184:187]
    s_waitcnt lgkmcnt(6)
    buffer_load_dwordx4 v246, s[20:23], s72 offen offset:2048 lds
    v_mfma_f32_16x16x32_bf16 v[172:175], v[220:223], a[36:39], v[172:175]
    ds_read_b64_tr_b16 v[204:205], v227 offset:0
    v_mfma_f32_16x16x32_bf16 v[180:183], v[220:223], a[40:43], v[180:183]
    ds_read_b64_tr_b16 v[206:207], v227 offset:8192
    v_mfma_f32_16x16x32_bf16 v[188:191], v[220:223], a[44:47], v[188:191]
    s_waitcnt lgkmcnt(6)
    buffer_load_dwordx4 v247, s[20:23], s72 offen offset:3072 lds
    s_add_u32 s33, s33, 16384
    s_cmp_eq_u32 s33, 163840
    s_cselect_b32 s33, 0, s33
    v_mfma_f32_16x16x32_bf16 v[0:3], v[192:195], a[48:51], v[0:3]
    s_add_u32 s34, s34, 16384
    s_cmp_eq_u32 s34, 163840
    s_cselect_b32 s34, 0, s34
    ds_read_b64_tr_b16 v[208:209], v228 offset:0
    v_add_u32 v252, s60, v249
    v_mfma_f32_16x16x32_bf16 v[8:11], v[192:195], a[52:55], v[8:11]
    s_sub_u32 s50, s34, s35
    ds_read_b64_tr_b16 v[210:211], v228 offset:8192
    ds_read_b128 a[96:99], v252
    v_mfma_f32_16x16x32_bf16 v[16:19], v[192:195], a[56:59], v[16:19]
    s_waitcnt lgkmcnt(7)
    v_xor_b32 v253, 64, v252
    ds_read_b128 a[108:111], v253
    v_mfma_f32_16x16x32_bf16 v[4:7], v[196:199], a[48:51], v[4:7]
    s_mov_b32 s35, s34
    ds_read_b64_tr_b16 v[212:213], v229 offset:0
    v_xor_b32 v253, 128, v252
    v_mfma_f32_16x16x32_bf16 v[12:15], v[196:199], a[52:55], v[12:15]
    s_add_u32 m0, s33, s32
    s_add_u32 s72, s46, 29440
    ds_read_b64_tr_b16 v[214:215], v229 offset:8192
    ds_read_b128 a[120:123], v253
    v_mfma_f32_16x16x32_bf16 v[20:23], v[196:199], a[56:59], v[20:23]
    s_waitcnt lgkmcnt(9)
    v_xor_b32 v253, 192, v252
    ds_read_b128 a[132:135], v253
    v_mfma_f32_16x16x32_bf16 v[24:27], v[200:203], a[48:51], v[24:27]
    ds_read_b64_tr_b16 v[216:217], v230 offset:0
    v_add_u32 v252, s61, v249
    v_mfma_f32_16x16x32_bf16 v[32:35], v[200:203], a[52:55], v[32:35]
    ds_read_b64_tr_b16 v[218:219], v230 offset:8192
    ds_read_b128 a[100:103], v252
    v_mfma_f32_16x16x32_bf16 v[40:43], v[200:203], a[56:59], v[40:43]
    s_waitcnt lgkmcnt(11)
    v_xor_b32 v253, 64, v252
    ds_read_b128 a[112:115], v253
    v_mfma_f32_16x16x32_bf16 v[28:31], v[204:207], a[48:51], v[28:31]
    ds_read_b64_tr_b16 v[220:221], v231 offset:0
    v_xor_b32 v253, 128, v252
    v_mfma_f32_16x16x32_bf16 v[36:39], v[204:207], a[52:55], v[36:39]
    ds_read_b64_tr_b16 v[222:223], v231 offset:8192
    ds_read_b128 a[124:127], v253
    v_mfma_f32_16x16x32_bf16 v[44:47], v[204:207], a[56:59], v[44:47]
    s_waitcnt lgkmcnt(13)
    v_xor_b32 v253, 192, v252
    ds_read_b128 a[136:139], v253
    v_mfma_f32_16x16x32_bf16 v[48:51], v[208:211], a[48:51], v[48:51]
    ds_read_b64_tr_b16 v[192:193], v224 offset:256
    v_add_u32 v252, s62, v249
    v_mfma_f32_16x16x32_bf16 v[56:59], v[208:211], a[52:55], v[56:59]
    ds_read_b64_tr_b16 v[194:195], v224 offset:8448
    v_add_u32 v224, s50, v224
    v_mfma_f32_16x16x32_bf16 v[64:67], v[208:211], a[56:59], v[64:67]
    s_waitcnt lgkmcnt(12)
    ds_read_b128 a[104:107], v252
    v_xor_b32 v253, 64, v252
    v_mfma_f32_16x16x32_bf16 v[52:55], v[212:215], a[48:51], v[52:55]
    ds_read_b64_tr_b16 v[196:197], v225 offset:256
    ds_read_b128 a[116:119], v253
    v_mfma_f32_16x16x32_bf16 v[60:63], v[212:215], a[52:55], v[60:63]
    ds_read_b64_tr_b16 v[198:199], v225 offset:8448
    v_add_u32 v225, s50, v225
    v_mfma_f32_16x16x32_bf16 v[68:71], v[212:215], a[56:59], v[68:71]
    s_waitcnt lgkmcnt(12)
    v_xor_b32 v253, 128, v252
    ds_read_b128 a[128:131], v253
    v_mfma_f32_16x16x32_bf16 v[72:75], v[216:219], a[48:51], v[72:75]
    ds_read_b64_tr_b16 v[200:201], v226 offset:256
    v_xor_b32 v253, 192, v252
    v_mfma_f32_16x16x32_bf16 v[80:83], v[216:219], a[52:55], v[80:83]
    ds_read_b64_tr_b16 v[202:203], v226 offset:8448
    v_add_u32 v226, s50, v226
    v_mfma_f32_16x16x32_bf16 v[88:91], v[216:219], a[56:59], v[88:91]
    s_waitcnt lgkmcnt(11)
    ds_read_b128 a[140:143], v253
    v_mfma_f32_16x16x32_bf16 v[76:79], v[220:223], a[48:51], v[76:79]
    ds_read_b64_tr_b16 v[204:205], v227 offset:256
    v_mfma_f32_16x16x32_bf16 v[84:87], v[220:223], a[52:55], v[84:87]
    ds_read_b64_tr_b16 v[206:207], v227 offset:8448
    v_add_u32 v227, s50, v227
    v_mfma_f32_16x16x32_bf16 v[92:95], v[220:223], a[56:59], v[92:95]
    s_waitcnt lgkmcnt(10)
    buffer_load_dwordx4 v244, s[20:23], s72 offen offset:0 lds
    v_mfma_f32_16x16x32_bf16 v[96:99], v[192:195], a[48:51], v[96:99]
    ds_read_b64_tr_b16 v[208:209], v228 offset:256
    v_mfma_f32_16x16x32_bf16 v[104:107], v[192:195], a[52:55], v[104:107]
    ds_read_b64_tr_b16 v[210:211], v228 offset:8448
    v_add_u32 v228, s50, v228
    v_mfma_f32_16x16x32_bf16 v[112:115], v[192:195], a[56:59], v[112:115]
    s_waitcnt lgkmcnt(8)
    buffer_load_dwordx4 v245, s[20:23], s72 offen offset:1024 lds
    v_mfma_f32_16x16x32_bf16 v[100:103], v[196:199], a[48:51], v[100:103]
    ds_read_b64_tr_b16 v[212:213], v229 offset:256
    v_mfma_f32_16x16x32_bf16 v[108:111], v[196:199], a[52:55], v[108:111]
    ds_read_b64_tr_b16 v[214:215], v229 offset:8448
    v_add_u32 v229, s50, v229
    v_mfma_f32_16x16x32_bf16 v[116:119], v[196:199], a[56:59], v[116:119]
    s_waitcnt lgkmcnt(7)
    buffer_load_dwordx4 v246, s[20:23], s72 offen offset:2048 lds
    v_mfma_f32_16x16x32_bf16 v[120:123], v[200:203], a[48:51], v[120:123]
    ds_read_b64_tr_b16 v[216:217], v230 offset:256
    v_mfma_f32_16x16x32_bf16 v[128:131], v[200:203], a[52:55], v[128:131]
    ds_read_b64_tr_b16 v[218:219], v230 offset:8448
    v_add_u32 v230, s50, v230
    v_mfma_f32_16x16x32_bf16 v[136:139], v[200:203], a[56:59], v[136:139]
    s_waitcnt lgkmcnt(6)
    buffer_load_dwordx4 v247, s[20:23], s72 offen offset:3072 lds
    v_mfma_f32_16x16x32_bf16 v[124:127], v[204:207], a[48:51], v[124:127]
    s_add_u32 s33, s33, 16384
    s_cmp_eq_u32 s33, 163840
    s_cselect_b32 s33, 0, s33
    ds_read_b64_tr_b16 v[220:221], v231 offset:256
    v_mfma_f32_16x16x32_bf16 v[132:135], v[204:207], a[52:55], v[132:135]
    s_add_u32 m0, s33, s32
    s_add_u32 s72, s63, 1572864
    ds_read_b64_tr_b16 v[222:223], v231 offset:8448
    v_add_u32 v231, s50, v231
    v_mfma_f32_16x16x32_bf16 v[140:143], v[204:207], a[56:59], v[140:143]
    s_waitcnt lgkmcnt(6)
    s_waitcnt lgkmcnt(10)
    s_waitcnt vmcnt(12)
    s_barrier
    buffer_load_dwordx4 v240, s[16:19], s72 offen offset:0 lds
    v_mfma_f32_16x16x32_bf16 v[144:147], v[208:211], a[48:51], v[144:147]
    ds_read_b64_tr_b16 v[192:193], v224 offset:0
    v_mfma_f32_16x16x32_bf16 v[152:155], v[208:211], a[52:55], v[152:155]
    ds_read_b64_tr_b16 v[194:195], v224 offset:8192
    v_min_u32 v254, 1, v248
    v_mfma_f32_16x16x32_bf16 v[160:163], v[208:211], a[56:59], v[160:163]
    s_waitcnt lgkmcnt(6)
    buffer_load_dwordx4 v241, s[16:19], s72 offen offset:1024 lds
    v_mfma_f32_16x16x32_bf16 v[148:151], v[212:215], a[48:51], v[148:151]
    ds_read_b64_tr_b16 v[196:197], v225 offset:0
    v_mfma_f32_16x16x32_bf16 v[156:159], v[212:215], a[52:55], v[156:159]
    ds_read_b64_tr_b16 v[198:199], v225 offset:8192
    v_lshlrev_b32 v254, 30, v254
    v_mfma_f32_16x16x32_bf16 v[164:167], v[212:215], a[56:59], v[164:167]
    s_waitcnt lgkmcnt(6)
    buffer_load_dwordx4 v242, s[16:19], s72 offen offset:2048 lds
    v_mfma_f32_16x16x32_bf16 v[168:171], v[216:219], a[48:51], v[168:171]
    ds_read_b64_tr_b16 v[200:201], v226 offset:0
    v_mfma_f32_16x16x32_bf16 v[176:179], v[216:219], a[52:55], v[176:179]
    ds_read_b64_tr_b16 v[202:203], v226 offset:8192
    v_or_b32 v254, s99, v254
    v_mfma_f32_16x16x32_bf16 v[184:187], v[216:219], a[56:59], v[184:187]
    s_waitcnt lgkmcnt(6)
    buffer_load_dwordx4 v243, s[16:19], s72 offen offset:3072 lds
    v_mfma_f32_16x16x32_bf16 v[172:175], v[220:223], a[48:51], v[172:175]
    s_add_u32 s33, s33, 16384
    s_cmp_eq_u32 s33, 163840
    s_cselect_b32 s33, 0, s33
    ds_read_b64_tr_b16 v[204:205], v227 offset:0
    v_mfma_f32_16x16x32_bf16 v[180:183], v[220:223], a[52:55], v[180:183]
    ds_read_b64_tr_b16 v[206:207], v227 offset:8192
    buffer_store_dword a204, v254, s[76:79], s93 offen sc1
    v_mfma_f32_16x16x32_bf16 v[188:191], v[220:223], a[56:59], v[188:191]
    s_waitcnt lgkmcnt(6)
    v_mfma_f32_16x16x32_bf16 v[0:3], v[192:195], a[60:63], v[0:3]
    s_add_u32 s34, s34, 16384
    s_cmp_eq_u32 s34, 163840
    s_cselect_b32 s34, 0, s34
    ds_read_b64_tr_b16 v[208:209], v228 offset:0
    v_mfma_f32_16x16x32_bf16 v[8:11], v[192:195], a[64:67], v[8:11]
    s_mov_b32 s60, s34
    ds_read_b64_tr_b16 v[210:211], v228 offset:8192
    v_mfma_f32_16x16x32_bf16 v[16:19], v[192:195], a[68:71], v[16:19]
    s_waitcnt lgkmcnt(6)
    v_mfma_f32_16x16x32_bf16 v[4:7], v[196:199], a[60:63], v[4:7]
    s_add_u32 s34, s34, 16384
    s_cmp_eq_u32 s34, 163840
    s_cselect_b32 s34, 0, s34
    ds_read_b64_tr_b16 v[212:213], v229 offset:0
    v_mfma_f32_16x16x32_bf16 v[12:15], v[196:199], a[64:67], v[12:15]
    s_mov_b32 s61, s34
    ds_read_b64_tr_b16 v[214:215], v229 offset:8192
    v_mfma_f32_16x16x32_bf16 v[20:23], v[196:199], a[68:71], v[20:23]
    s_waitcnt lgkmcnt(6)
    v_mfma_f32_16x16x32_bf16 v[24:27], v[200:203], a[60:63], v[24:27]
    s_add_u32 s34, s34, 16384
    s_cmp_eq_u32 s34, 163840
    s_cselect_b32 s34, 0, s34
    ds_read_b64_tr_b16 v[216:217], v230 offset:0
    v_mfma_f32_16x16x32_bf16 v[32:35], v[200:203], a[64:67], v[32:35]
    s_mov_b32 s62, s34
    ds_read_b64_tr_b16 v[218:219], v230 offset:8192
    v_mfma_f32_16x16x32_bf16 v[40:43], v[200:203], a[68:71], v[40:43]
    s_waitcnt lgkmcnt(6)
    v_mfma_f32_16x16x32_bf16 v[28:31], v[204:207], a[60:63], v[28:31]
    s_add_u32 s34, s34, 16384
    s_cmp_eq_u32 s34, 163840
    s_cselect_b32 s34, 0, s34
    ds_read_b64_tr_b16 v[220:221], v231 offset:0
    v_mfma_f32_16x16x32_bf16 v[36:39], v[204:207], a[64:67], v[36:39]
    s_sub_u32 s50, s34, s35
    ds_read_b64_tr_b16 v[222:223], v231 offset:8192
    v_mfma_f32_16x16x32_bf16 v[44:47], v[204:207], a[68:71], v[44:47]
    s_waitcnt lgkmcnt(6)
    v_mfma_f32_16x16x32_bf16 v[48:51], v[208:211], a[60:63], v[48:51]
    s_mov_b32 s35, s34
    ds_read_b64_tr_b16 v[192:193], v224 offset:256
    v_mfma_f32_16x16x32_bf16 v[56:59], v[208:211], a[64:67], v[56:59]
    s_add_u32 m0, s33, s32
    s_add_u32 s72, s63, 1835008
    ds_read_b64_tr_b16 v[194:195], v224 offset:8448
    v_add_u32 v224, s50, v224
    v_mfma_f32_16x16x32_bf16 v[64:67], v[208:211], a[68:71], v[64:67]
    s_waitcnt lgkmcnt(6)
    buffer_load_dwordx4 v240, s[16:19], s72 offen offset:0 lds
    v_mfma_f32_16x16x32_bf16 v[52:55], v[212:215], a[60:63], v[52:55]
    ds_read_b64_tr_b16 v[196:197], v225 offset:256
    v_mfma_f32_16x16x32_bf16 v[60:63], v[212:215], a[64:67], v[60:63]
    ds_read_b64_tr_b16 v[198:199], v225 offset:8448
    v_add_u32 v225, s50, v225
    v_mfma_f32_16x16x32_bf16 v[68:71], v[212:215], a[68:71], v[68:71]
    s_waitcnt lgkmcnt(6)
    buffer_load_dwordx4 v241, s[16:19], s72 offen offset:1024 lds
    v_mfma_f32_16x16x32_bf16 v[72:75], v[216:219], a[60:63], v[72:75]
    ds_read_b64_tr_b16 v[200:201], v226 offset:256
    v_mfma_f32_16x16x32_bf16 v[80:83], v[216:219], a[64:67], v[80:83]
    ds_read_b64_tr_b16 v[202:203], v226 offset:8448
    v_add_u32 v226, s50, v226
    v_mfma_f32_16x16x32_bf16 v[88:91], v[216:219], a[68:71], v[88:91]
    s_waitcnt lgkmcnt(6)
    buffer_load_dwordx4 v242, s[16:19], s72 offen offset:2048 lds
    v_mfma_f32_16x16x32_bf16 v[76:79], v[220:223], a[60:63], v[76:79]
    ds_read_b64_tr_b16 v[204:205], v227 offset:256
    v_mfma_f32_16x16x32_bf16 v[84:87], v[220:223], a[64:67], v[84:87]
    ds_read_b64_tr_b16 v[206:207], v227 offset:8448
    v_add_u32 v227, s50, v227
    v_mfma_f32_16x16x32_bf16 v[92:95], v[220:223], a[68:71], v[92:95]
    s_waitcnt lgkmcnt(6)
    buffer_load_dwordx4 v243, s[16:19], s72 offen offset:3072 lds
    v_mfma_f32_16x16x32_bf16 v[96:99], v[192:195], a[60:63], v[96:99]
    s_add_u32 s33, s33, 16384
    s_cmp_eq_u32 s33, 163840
    s_cselect_b32 s33, 0, s33
    ds_read_b64_tr_b16 v[208:209], v228 offset:256
    v_mfma_f32_16x16x32_bf16 v[104:107], v[192:195], a[64:67], v[104:107]
    s_add_u32 m0, s33, s32
    s_add_u32 s72, s63, 2097152
    ds_read_b64_tr_b16 v[210:211], v228 offset:8448
    v_add_u32 v228, s50, v228
    v_mfma_f32_16x16x32_bf16 v[112:115], v[192:195], a[68:71], v[112:115]
    s_waitcnt lgkmcnt(6)
    buffer_load_dwordx4 v240, s[16:19], s72 offen offset:0 lds
    v_mfma_f32_16x16x32_bf16 v[100:103], v[196:199], a[60:63], v[100:103]
    ds_read_b64_tr_b16 v[212:213], v229 offset:256
    v_mfma_f32_16x16x32_bf16 v[108:111], v[196:199], a[64:67], v[108:111]
    ds_read_b64_tr_b16 v[214:215], v229 offset:8448
    v_add_u32 v229, s50, v229
    v_mfma_f32_16x16x32_bf16 v[116:119], v[196:199], a[68:71], v[116:119]
    s_waitcnt lgkmcnt(6)
    buffer_load_dwordx4 v241, s[16:19], s72 offen offset:1024 lds
    v_mfma_f32_16x16x32_bf16 v[120:123], v[200:203], a[60:63], v[120:123]
    ds_read_b64_tr_b16 v[216:217], v230 offset:256
    v_mfma_f32_16x16x32_bf16 v[128:131], v[200:203], a[64:67], v[128:131]
    ds_read_b64_tr_b16 v[218:219], v230 offset:8448
    v_add_u32 v230, s50, v230
    v_mfma_f32_16x16x32_bf16 v[136:139], v[200:203], a[68:71], v[136:139]
    s_waitcnt lgkmcnt(6)
    buffer_load_dwordx4 v242, s[16:19], s72 offen offset:2048 lds
    v_mfma_f32_16x16x32_bf16 v[124:127], v[204:207], a[60:63], v[124:127]
    ds_read_b64_tr_b16 v[220:221], v231 offset:256
    v_mfma_f32_16x16x32_bf16 v[132:135], v[204:207], a[64:67], v[132:135]
    ds_read_b64_tr_b16 v[222:223], v231 offset:8448
    v_add_u32 v231, s50, v231
    v_mfma_f32_16x16x32_bf16 v[140:143], v[204:207], a[68:71], v[140:143]
    s_waitcnt lgkmcnt(6)
    s_waitcnt vmcnt(8)
    s_barrier
    buffer_load_dwordx4 v243, s[16:19], s72 offen offset:3072 lds
    v_mfma_f32_16x16x32_bf16 v[144:147], v[208:211], a[60:63], v[144:147]
    s_add_u32 s33, s33, 16384
    s_cmp_eq_u32 s33, 163840
    s_cselect_b32 s33, 0, s33
    ds_read_b64_tr_b16 v[192:193], v224 offset:0
    v_mfma_f32_16x16x32_bf16 v[152:155], v[208:211], a[64:67], v[152:155]
    s_add_u32 m0, s33, s32
    s_add_u32 s72, s63, 2359296
    ds_read_b64_tr_b16 v[194:195], v224 offset:8192
    v_mfma_f32_16x16x32_bf16 v[160:163], v[208:211], a[68:71], v[160:163]
    s_waitcnt lgkmcnt(6)
    buffer_load_dwordx4 v240, s[16:19], s72 offen offset:0 lds
    v_mfma_f32_16x16x32_bf16 v[148:151], v[212:215], a[60:63], v[148:151]
    ds_read_b64_tr_b16 v[196:197], v225 offset:0
    v_mfma_f32_16x16x32_bf16 v[156:159], v[212:215], a[64:67], v[156:159]
    ds_read_b64_tr_b16 v[198:199], v225 offset:8192
    v_mfma_f32_16x16x32_bf16 v[164:167], v[212:215], a[68:71], v[164:167]
    s_waitcnt lgkmcnt(6)
    buffer_load_dwordx4 v241, s[16:19], s72 offen offset:1024 lds
    v_mfma_f32_16x16x32_bf16 v[168:171], v[216:219], a[60:63], v[168:171]
    ds_read_b64_tr_b16 v[200:201], v226 offset:0
    v_mfma_f32_16x16x32_bf16 v[176:179], v[216:219], a[64:67], v[176:179]
    ds_read_b64_tr_b16 v[202:203], v226 offset:8192
    v_mfma_f32_16x16x32_bf16 v[184:187], v[216:219], a[68:71], v[184:187]
    s_waitcnt lgkmcnt(6)
    buffer_load_dwordx4 v242, s[16:19], s72 offen offset:2048 lds
    v_mfma_f32_16x16x32_bf16 v[172:175], v[220:223], a[60:63], v[172:175]
    ds_read_b64_tr_b16 v[204:205], v227 offset:0
    v_mfma_f32_16x16x32_bf16 v[180:183], v[220:223], a[64:67], v[180:183]
    ds_read_b64_tr_b16 v[206:207], v227 offset:8192
    v_mfma_f32_16x16x32_bf16 v[188:191], v[220:223], a[68:71], v[188:191]
    s_waitcnt lgkmcnt(6)
    buffer_load_dwordx4 v243, s[16:19], s72 offen offset:3072 lds
    s_add_u32 s33, s33, 16384
    s_cmp_eq_u32 s33, 163840
    s_cselect_b32 s33, 0, s33
    v_mfma_f32_16x16x32_bf16 v[0:3], v[192:195], a[72:75], v[0:3]
    s_add_u32 s34, s34, 16384
    s_cmp_eq_u32 s34, 163840
    s_cselect_b32 s34, 0, s34
    ds_read_b64_tr_b16 v[208:209], v228 offset:0
    v_add_u32 v252, s60, v249
    v_mfma_f32_16x16x32_bf16 v[8:11], v[192:195], a[76:79], v[8:11]
    s_sub_u32 s50, s34, s35
    ds_read_b64_tr_b16 v[210:211], v228 offset:8192
    ds_read_b128 a[144:147], v252
    v_mfma_f32_16x16x32_bf16 v[16:19], v[192:195], a[80:83], v[16:19]
    s_waitcnt lgkmcnt(7)
    v_xor_b32 v253, 64, v252
    ds_read_b128 a[156:159], v253
    v_mfma_f32_16x16x32_bf16 v[4:7], v[196:199], a[72:75], v[4:7]
    s_mov_b32 s35, s34
    ds_read_b64_tr_b16 v[212:213], v229 offset:0
    v_add_u32 v252, s61, v249
    v_mfma_f32_16x16x32_bf16 v[12:15], v[196:199], a[76:79], v[12:15]
    s_add_u32 m0, s33, s32
    s_add_u32 s72, s63, 2621440
    ds_read_b64_tr_b16 v[214:215], v229 offset:8192
    ds_read_b128 a[148:151], v252
    v_mfma_f32_16x16x32_bf16 v[20:23], v[196:199], a[80:83], v[20:23]
    s_waitcnt lgkmcnt(9)
    v_xor_b32 v253, 64, v252
    ds_read_b128 a[160:163], v253
    v_mfma_f32_16x16x32_bf16 v[24:27], v[200:203], a[72:75], v[24:27]
    ds_read_b64_tr_b16 v[216:217], v230 offset:0
    v_add_u32 v252, s62, v249
    v_mfma_f32_16x16x32_bf16 v[32:35], v[200:203], a[76:79], v[32:35]
    ds_read_b64_tr_b16 v[218:219], v230 offset:8192
    ds_read_b128 a[152:155], v252
    v_mfma_f32_16x16x32_bf16 v[40:43], v[200:203], a[80:83], v[40:43]
    s_waitcnt lgkmcnt(11)
    v_xor_b32 v253, 64, v252
    ds_read_b128 a[164:167], v253
    v_mfma_f32_16x16x32_bf16 v[28:31], v[204:207], a[72:75], v[28:31]
    ds_read_b64_tr_b16 v[220:221], v231 offset:0
    v_mfma_f32_16x16x32_bf16 v[36:39], v[204:207], a[76:79], v[36:39]
    ds_read_b64_tr_b16 v[222:223], v231 offset:8192
    v_mfma_f32_16x16x32_bf16 v[44:47], v[204:207], a[80:83], v[44:47]
    s_waitcnt lgkmcnt(12)
    buffer_load_dwordx4 v240, s[16:19], s72 offen offset:0 lds
    v_mfma_f32_16x16x32_bf16 v[48:51], v[208:211], a[72:75], v[48:51]
    ds_read_b64_tr_b16 v[192:193], v224 offset:256
    v_mfma_f32_16x16x32_bf16 v[56:59], v[208:211], a[76:79], v[56:59]
    ds_read_b64_tr_b16 v[194:195], v224 offset:8448
    v_add_u32 v224, s50, v224
    v_mfma_f32_16x16x32_bf16 v[64:67], v[208:211], a[80:83], v[64:67]
    s_waitcnt lgkmcnt(10)
    buffer_load_dwordx4 v241, s[16:19], s72 offen offset:1024 lds
    v_mfma_f32_16x16x32_bf16 v[52:55], v[212:215], a[72:75], v[52:55]
    ds_read_b64_tr_b16 v[196:197], v225 offset:256
    v_mfma_f32_16x16x32_bf16 v[60:63], v[212:215], a[76:79], v[60:63]
    ds_read_b64_tr_b16 v[198:199], v225 offset:8448
    v_add_u32 v225, s50, v225
    v_mfma_f32_16x16x32_bf16 v[68:71], v[212:215], a[80:83], v[68:71]
    s_waitcnt lgkmcnt(8)
    buffer_load_dwordx4 v242, s[16:19], s72 offen offset:2048 lds
    v_mfma_f32_16x16x32_bf16 v[72:75], v[216:219], a[72:75], v[72:75]
    ds_read_b64_tr_b16 v[200:201], v226 offset:256
    v_mfma_f32_16x16x32_bf16 v[80:83], v[216:219], a[76:79], v[80:83]
    ds_read_b64_tr_b16 v[202:203], v226 offset:8448
    v_add_u32 v226, s50, v226
    v_mfma_f32_16x16x32_bf16 v[88:91], v[216:219], a[80:83], v[88:91]
    s_waitcnt lgkmcnt(6)
    buffer_load_dwordx4 v243, s[16:19], s72 offen offset:3072 lds
    v_mfma_f32_16x16x32_bf16 v[76:79], v[220:223], a[72:75], v[76:79]
    s_add_u32 s33, s33, 16384
    s_cmp_eq_u32 s33, 163840
    s_cselect_b32 s33, 0, s33
    ds_read_b64_tr_b16 v[204:205], v227 offset:256
    v_mfma_f32_16x16x32_bf16 v[84:87], v[220:223], a[76:79], v[84:87]
    ds_read_b64_tr_b16 v[206:207], v227 offset:8448
    v_add_u32 v227, s50, v227
    v_mfma_f32_16x16x32_bf16 v[92:95], v[220:223], a[80:83], v[92:95]
    s_waitcnt lgkmcnt(6)
    v_mfma_f32_16x16x32_bf16 v[96:99], v[192:195], a[72:75], v[96:99]
    s_add_u32 m0, s33, s32
    s_add_u32 s72, s63, 2883584
    ds_read_b64_tr_b16 v[208:209], v228 offset:256
    v_mfma_f32_16x16x32_bf16 v[104:107], v[192:195], a[76:79], v[104:107]
    ds_read_b64_tr_b16 v[210:211], v228 offset:8448
    v_add_u32 v228, s50, v228
    v_mfma_f32_16x16x32_bf16 v[112:115], v[192:195], a[80:83], v[112:115]
    s_waitcnt lgkmcnt(6)
    buffer_load_dwordx4 v240, s[16:19], s72 offen offset:0 lds
    v_mfma_f32_16x16x32_bf16 v[100:103], v[196:199], a[72:75], v[100:103]
    ds_read_b64_tr_b16 v[212:213], v229 offset:256
    v_mfma_f32_16x16x32_bf16 v[108:111], v[196:199], a[76:79], v[108:111]
    ds_read_b64_tr_b16 v[214:215], v229 offset:8448
    v_add_u32 v229, s50, v229
    v_mfma_f32_16x16x32_bf16 v[116:119], v[196:199], a[80:83], v[116:119]
    s_waitcnt lgkmcnt(6)
    buffer_load_dwordx4 v241, s[16:19], s72 offen offset:1024 lds
    v_mfma_f32_16x16x32_bf16 v[120:123], v[200:203], a[72:75], v[120:123]
    ds_read_b64_tr_b16 v[216:217], v230 offset:256
    v_mfma_f32_16x16x32_bf16 v[128:131], v[200:203], a[76:79], v[128:131]
    ds_read_b64_tr_b16 v[218:219], v230 offset:8448
    v_add_u32 v230, s50, v230
    v_mfma_f32_16x16x32_bf16 v[136:139], v[200:203], a[80:83], v[136:139]
    s_waitcnt lgkmcnt(6)
    v_mfma_f32_16x16x32_bf16 v[124:127], v[204:207], a[72:75], v[124:127]
    ds_read_b64_tr_b16 v[220:221], v231 offset:256
    v_mfma_f32_16x16x32_bf16 v[132:135], v[204:207], a[76:79], v[132:135]
    ds_read_b64_tr_b16 v[222:223], v231 offset:8448
    v_add_u32 v231, s50, v231
    v_mfma_f32_16x16x32_bf16 v[140:143], v[204:207], a[80:83], v[140:143]
    s_waitcnt lgkmcnt(6)
    s_waitcnt lgkmcnt(15)
    s_waitcnt vmcnt(14)
    s_barrier
    buffer_load_dwordx4 v242, s[16:19], s72 offen offset:2048 lds
    v_mfma_f32_16x16x32_bf16 v[144:147], v[208:211], a[72:75], v[144:147]
    ds_read_b64_tr_b16 v[192:193], v224 offset:0
    v_mfma_f32_16x16x32_bf16 v[152:155], v[208:211], a[76:79], v[152:155]
    ds_read_b64_tr_b16 v[194:195], v224 offset:8192
    v_mfma_f32_16x16x32_bf16 v[160:163], v[208:211], a[80:83], v[160:163]
    s_waitcnt lgkmcnt(6)
    v_mfma_f32_16x16x32_bf16 v[148:151], v[212:215], a[72:75], v[148:151]
    ds_read_b64_tr_b16 v[196:197], v225 offset:0
    v_mfma_f32_16x16x32_bf16 v[156:159], v[212:215], a[76:79], v[156:159]
    ds_read_b64_tr_b16 v[198:199], v225 offset:8192
    v_mfma_f32_16x16x32_bf16 v[164:167], v[212:215], a[80:83], v[164:167]
    s_waitcnt lgkmcnt(6)
    buffer_load_dwordx4 v243, s[16:19], s72 offen offset:3072 lds
    v_mfma_f32_16x16x32_bf16 v[168:171], v[216:219], a[72:75], v[168:171]
    s_add_u32 s33, s33, 16384
    s_cmp_eq_u32 s33, 163840
    s_cselect_b32 s33, 0, s33
    ds_read_b64_tr_b16 v[200:201], v226 offset:0
    v_mfma_f32_16x16x32_bf16 v[176:179], v[216:219], a[76:79], v[176:179]
    ds_read_b64_tr_b16 v[202:203], v226 offset:8192
    v_mfma_f32_16x16x32_bf16 v[184:187], v[216:219], a[80:83], v[184:187]
    s_waitcnt lgkmcnt(6)
    v_mfma_f32_16x16x32_bf16 v[172:175], v[220:223], a[72:75], v[172:175]
    ds_read_b64_tr_b16 v[204:205], v227 offset:0
    v_mfma_f32_16x16x32_bf16 v[180:183], v[220:223], a[76:79], v[180:183]
    ds_read_b64_tr_b16 v[206:207], v227 offset:8192
    v_mfma_f32_16x16x32_bf16 v[188:191], v[220:223], a[80:83], v[188:191]
    s_waitcnt lgkmcnt(6)
    v_mfma_f32_16x16x32_bf16 v[0:3], v[192:195], a[84:87], v[0:3]
    s_add_u32 s34, s34, 16384
    s_cmp_eq_u32 s34, 163840
    s_cselect_b32 s34, 0, s34
    ds_read_b64_tr_b16 v[208:209], v228 offset:0
    v_mfma_f32_16x16x32_bf16 v[8:11], v[192:195], a[88:91], v[8:11]
    s_sub_u32 s50, s34, s35
    ds_read_b64_tr_b16 v[210:211], v228 offset:8192
    v_mfma_f32_16x16x32_bf16 v[16:19], v[192:195], a[92:95], v[16:19]
    s_waitcnt lgkmcnt(6)
    v_mfma_f32_16x16x32_bf16 v[4:7], v[196:199], a[84:87], v[4:7]
    s_mov_b32 s35, s34
    ds_read_b64_tr_b16 v[212:213], v229 offset:0
    v_mfma_f32_16x16x32_bf16 v[12:15], v[196:199], a[88:91], v[12:15]
    s_add_u32 m0, s33, s32
    s_add_u32 s72, s63, 3145728
    ds_read_b64_tr_b16 v[214:215], v229 offset:8192
    v_mfma_f32_16x16x32_bf16 v[20:23], v[196:199], a[92:95], v[20:23]
    s_waitcnt lgkmcnt(6)
    buffer_load_dwordx4 v240, s[16:19], s72 offen offset:0 lds
    v_mfma_f32_16x16x32_bf16 v[24:27], v[200:203], a[84:87], v[24:27]
    ds_read_b64_tr_b16 v[216:217], v230 offset:0
    v_mfma_f32_16x16x32_bf16 v[32:35], v[200:203], a[88:91], v[32:35]
    ds_read_b64_tr_b16 v[218:219], v230 offset:8192
    v_mfma_f32_16x16x32_bf16 v[40:43], v[200:203], a[92:95], v[40:43]
    s_waitcnt lgkmcnt(6)
    buffer_load_dwordx4 v241, s[16:19], s72 offen offset:1024 lds
    v_mfma_f32_16x16x32_bf16 v[28:31], v[204:207], a[84:87], v[28:31]
    ds_read_b64_tr_b16 v[220:221], v231 offset:0
    v_mfma_f32_16x16x32_bf16 v[36:39], v[204:207], a[88:91], v[36:39]
    ds_read_b64_tr_b16 v[222:223], v231 offset:8192
    v_mfma_f32_16x16x32_bf16 v[44:47], v[204:207], a[92:95], v[44:47]
    s_waitcnt lgkmcnt(6)
    buffer_load_dwordx4 v242, s[16:19], s72 offen offset:2048 lds
    v_mfma_f32_16x16x32_bf16 v[48:51], v[208:211], a[84:87], v[48:51]
    ds_read_b64_tr_b16 v[192:193], v224 offset:256
    v_mfma_f32_16x16x32_bf16 v[56:59], v[208:211], a[88:91], v[56:59]
    ds_read_b64_tr_b16 v[194:195], v224 offset:8448
    v_add_u32 v224, s50, v224
    v_mfma_f32_16x16x32_bf16 v[64:67], v[208:211], a[92:95], v[64:67]
    s_waitcnt lgkmcnt(6)
    buffer_load_dwordx4 v243, s[16:19], s72 offen offset:3072 lds
    v_mfma_f32_16x16x32_bf16 v[52:55], v[212:215], a[84:87], v[52:55]
    s_add_u32 s33, s33, 16384
    s_cmp_eq_u32 s33, 163840
    s_cselect_b32 s33, 0, s33
    ds_read_b64_tr_b16 v[196:197], v225 offset:256
    v_mfma_f32_16x16x32_bf16 v[60:63], v[212:215], a[88:91], v[60:63]
    s_add_u32 m0, s33, s32
    s_add_u32 s72, s63, 3407872
    ds_read_b64_tr_b16 v[198:199], v225 offset:8448
    v_add_u32 v225, s50, v225
    v_mfma_f32_16x16x32_bf16 v[68:71], v[212:215], a[92:95], v[68:71]
    s_waitcnt lgkmcnt(6)
    buffer_load_dwordx4 v240, s[16:19], s72 offen offset:0 lds
    v_mfma_f32_16x16x32_bf16 v[72:75], v[216:219], a[84:87], v[72:75]
    ds_read_b64_tr_b16 v[200:201], v226 offset:256
    v_mfma_f32_16x16x32_bf16 v[80:83], v[216:219], a[88:91], v[80:83]
    ds_read_b64_tr_b16 v[202:203], v226 offset:8448
    v_add_u32 v226, s50, v226
    v_mfma_f32_16x16x32_bf16 v[88:91], v[216:219], a[92:95], v[88:91]
    s_waitcnt lgkmcnt(6)
    buffer_load_dwordx4 v241, s[16:19], s72 offen offset:1024 lds
    v_mfma_f32_16x16x32_bf16 v[76:79], v[220:223], a[84:87], v[76:79]
    ds_read_b64_tr_b16 v[204:205], v227 offset:256
    v_mfma_f32_16x16x32_bf16 v[84:87], v[220:223], a[88:91], v[84:87]
    ds_read_b64_tr_b16 v[206:207], v227 offset:8448
    v_add_u32 v227, s50, v227
    v_mfma_f32_16x16x32_bf16 v[92:95], v[220:223], a[92:95], v[92:95]
    s_waitcnt lgkmcnt(6)
    buffer_load_dwordx4 v242, s[16:19], s72 offen offset:2048 lds
    v_mfma_f32_16x16x32_bf16 v[96:99], v[192:195], a[84:87], v[96:99]
    ds_read_b64_tr_b16 v[208:209], v228 offset:256
    v_mfma_f32_16x16x32_bf16 v[104:107], v[192:195], a[88:91], v[104:107]
    ds_read_b64_tr_b16 v[210:211], v228 offset:8448
    v_add_u32 v228, s50, v228
    v_mfma_f32_16x16x32_bf16 v[112:115], v[192:195], a[92:95], v[112:115]
    s_waitcnt lgkmcnt(6)
    buffer_load_dwordx4 v243, s[16:19], s72 offen offset:3072 lds
    v_mfma_f32_16x16x32_bf16 v[100:103], v[196:199], a[84:87], v[100:103]
    s_add_u32 s33, s33, 16384
    s_cmp_eq_u32 s33, 163840
    s_cselect_b32 s33, 0, s33
    ds_read_b64_tr_b16 v[212:213], v229 offset:256
    v_mfma_f32_16x16x32_bf16 v[108:111], v[196:199], a[88:91], v[108:111]
    ds_read_b64_tr_b16 v[214:215], v229 offset:8448
    v_add_u32 v229, s50, v229
    v_mfma_f32_16x16x32_bf16 v[116:119], v[196:199], a[92:95], v[116:119]
    s_waitcnt lgkmcnt(6)
    v_mfma_f32_16x16x32_bf16 v[120:123], v[200:203], a[84:87], v[120:123]
    s_add_u32 m0, s33, s32
    ds_read_b64_tr_b16 v[216:217], v230 offset:256
    v_mfma_f32_16x16x32_bf16 v[128:131], v[200:203], a[88:91], v[128:131]
    ds_read_b64_tr_b16 v[218:219], v230 offset:8448
    v_add_u32 v230, s50, v230
    v_mfma_f32_16x16x32_bf16 v[136:139], v[200:203], a[92:95], v[136:139]
    s_waitcnt lgkmcnt(6)
    buffer_load_dwordx4 v236, s[8:11], s37 offen offset:0 sc1 nt lds
    v_mfma_f32_16x16x32_bf16 v[124:127], v[204:207], a[84:87], v[124:127]
    ds_read_b64_tr_b16 v[220:221], v231 offset:256
    v_mfma_f32_16x16x32_bf16 v[132:135], v[204:207], a[88:91], v[132:135]
    ds_read_b64_tr_b16 v[222:223], v231 offset:8448
    v_add_u32 v231, s50, v231
    v_mfma_f32_16x16x32_bf16 v[140:143], v[204:207], a[92:95], v[140:143]
    s_waitcnt lgkmcnt(6)
    s_waitcnt vmcnt(21)
    s_barrier
    buffer_load_dwordx4 v237, s[8:11], s37 offen offset:1024 sc1 nt lds
    v_mfma_f32_16x16x32_bf16 v[144:147], v[208:211], a[84:87], v[144:147]
    ds_read_b64_tr_b16 v[192:193], v224 offset:0
    v_mfma_f32_16x16x32_bf16 v[152:155], v[208:211], a[88:91], v[152:155]
    ds_read_b64_tr_b16 v[194:195], v224 offset:8192
    v_mfma_f32_16x16x32_bf16 v[160:163], v[208:211], a[92:95], v[160:163]
    s_waitcnt lgkmcnt(6)
    buffer_load_dwordx4 v238, s[8:11], s37 offen offset:2048 sc1 nt lds
    v_mfma_f32_16x16x32_bf16 v[148:151], v[212:215], a[84:87], v[148:151]
    ds_read_b64_tr_b16 v[196:197], v225 offset:0
    v_mfma_f32_16x16x32_bf16 v[156:159], v[212:215], a[88:91], v[156:159]
    ds_read_b64_tr_b16 v[198:199], v225 offset:8192
    v_mfma_f32_16x16x32_bf16 v[164:167], v[212:215], a[92:95], v[164:167]
    s_waitcnt lgkmcnt(6)
    buffer_load_dwordx4 v239, s[8:11], s37 offen offset:3072 sc1 nt lds
    v_mfma_f32_16x16x32_bf16 v[168:171], v[216:219], a[84:87], v[168:171]
    s_add_u32 s33, s33, 16384
    s_cmp_eq_u32 s33, 163840
    s_cselect_b32 s33, 0, s33
    ds_read_b64_tr_b16 v[200:201], v226 offset:0
    v_mfma_f32_16x16x32_bf16 v[176:179], v[216:219], a[88:91], v[176:179]
    s_add_u32 s37, s37, 16384
    ds_read_b64_tr_b16 v[202:203], v226 offset:8192
    v_mfma_f32_16x16x32_bf16 v[184:187], v[216:219], a[92:95], v[184:187]
    s_waitcnt lgkmcnt(6)
    v_mfma_f32_16x16x32_bf16 v[172:175], v[220:223], a[84:87], v[172:175]
    ds_read_b64_tr_b16 v[204:205], v227 offset:0
    v_mfma_f32_16x16x32_bf16 v[180:183], v[220:223], a[88:91], v[180:183]
    ds_read_b64_tr_b16 v[206:207], v227 offset:8192
    v_mfma_f32_16x16x32_bf16 v[188:191], v[220:223], a[92:95], v[188:191]
    s_waitcnt lgkmcnt(6)
    s_cmp_eq_u32 s30, 0
    s_cbranch_scc0 L_wsw1
    s_cmp_eq_u32 s3, 0
    s_cbranch_scc0 L_wsw2
    s_add_u32 s63, s63, 512
    s_add_u32 s64, s46, 0
    s_add_u32 s65, s46, 14336
    s_add_u32 s66, s46, 28672
    s_add_u32 s67, s63, 0
    s_add_u32 s68, s63, 262144
    s_add_u32 s69, s46, 256
    s_add_u32 s70, s46, 14592
    s_add_u32 s71, s46, 28928
    s_lshl_b32 s54, s81, 2
    s_add_u32 s54, s54, s52
    s_mul_i32 s54, s54, 14
    v_lshrrev_b32 v252, 2, v248
    v_min_u32 v252, 13, v252
    v_add_u32 v252, s54, v252
    v_lshlrev_b32 v252, 13, v252
    v_and_b32 v254, 3, v248
    v_lshlrev_b32 v254, 7, v254
    v_add_u32 v252, v252, v254
    s_mov_b32 s83, s63
    s_lshl_b32 s54, s82, 2
    s_add_u32 s54, s54, s52
    s_mul_i32 s54, s54, 10752
    s_add_u32 s73, s46, s54
    v_lshlrev_b32 v253, 7, v248
    s_branch L_wsw2
L_wsw1:
    s_cmp_eq_u32 s3, 0
    s_cbranch_scc0 L_wsw3
    s_mov_b32 s16, s44
    s_mov_b32 s17, s45
    s_mov_b32 s20, s44
    s_mov_b32 s21, s45
    s_mov_b32 s22, 3670016
    s_mov_b32 s18, 3670016
    s_mul_i32 s39, s49, 229376
    s_add_u32 s64, s39, 0
    s_add_u32 s65, s39, 114688
    s_add_u32 s66, s39, 229376
    s_add_u32 s67, s39, 344064
    s_add_u32 s68, s39, 128
    s_add_u32 s69, s39, 114816
    s_add_u32 s70, s39, 229504
    s_add_u32 s71, s39, 344192
    s_add_u32 s39, s39, 256
    v_lshrrev_b32 v252, 3, v248
    s_lshl_b32 s54, s52, 5
    v_add_u32 v252, s54, v252
    v_mul_u32_u24 v252, 896, v252
    v_lshrrev_b32 v253, 4, v248
    v_lshlrev_b32 v253, 1, v253
    v_and_b32 v254, 7, v248
    v_xor_b32 v253, v253, v254
    v_lshlrev_b32 v253, 4, v253
    v_add_u32 v240, v252, v253
    v_add_u32 v241, 6144, v240
    v_add_u32 v242, 12288, v240
    v_add_u32 v243, 18432, v240
    v_mov_b32 v244, v240
    v_mov_b32 v245, v241
    v_mov_b32 v246, v242
    v_mov_b32 v247, v243
    s_lshl_b32 s54, s81, 2
    s_add_u32 s54, s54, s52
    s_mul_i32 s54, s54, 14336
    s_mul_i32 s83, s49, 229376
    s_add_u32 s83, s83, s54
    s_add_u32 s73, s83, 8192
    v_lshlrev_b32 v252, 7, v248
    v_lshlrev_b32 v253, 7, v248
    s_branch L_wsw2
L_wsw3:
    s_mov_b32 s22, 0
    s_mov_b32 s18, 0
L_wsw2:
    v_mfma_f32_16x16x32_bf16 v[0:3], v[192:195], a[96:99], v[0:3]
    s_add_u32 s34, s34, 16384
    s_cmp_eq_u32 s34, 163840
    s_cselect_b32 s34, 0, s34
    ds_read_b64_tr_b16 v[208:209], v228 offset:0
    v_mfma_f32_16x16x32_bf16 v[8:11], v[192:195], a[100:103], v[8:11]
    s_sub_u32 s50, s34, s35
    ds_read_b64_tr_b16 v[210:211], v228 offset:8192
    v_mfma_f32_16x16x32_bf16 v[16:19], v[192:195], a[104:107], v[16:19]
    s_waitcnt lgkmcnt(6)
    v_mfma_f32_16x16x32_bf16 v[4:7], v[196:199], a[96:99], v[4:7]
    s_mov_b32 s35, s34
    ds_read_b64_tr_b16 v[212:213], v229 offset:0
    v_mfma_f32_16x16x32_bf16 v[12:15], v[196:199], a[100:103], v[12:15]
    s_add_u32 m0, s33, s32
    ds_read_b64_tr_b16 v[214:215], v229 offset:8192
    v_mfma_f32_16x16x32_bf16 v[20:23], v[196:199], a[104:107], v[20:23]
    s_waitcnt lgkmcnt(6)
    buffer_load_dwordx4 v236, s[8:11], s37 offen offset:0 sc1 nt lds
    v_mfma_f32_16x16x32_bf16 v[24:27], v[200:203], a[96:99], v[24:27]
    ds_read_b64_tr_b16 v[216:217], v230 offset:0
    v_mfma_f32_16x16x32_bf16 v[32:35], v[200:203], a[100:103], v[32:35]
    ds_read_b64_tr_b16 v[218:219], v230 offset:8192
    v_mfma_f32_16x16x32_bf16 v[40:43], v[200:203], a[104:107], v[40:43]
    s_waitcnt lgkmcnt(6)
    v_mfma_f32_16x16x32_bf16 v[28:31], v[204:207], a[96:99], v[28:31]
    ds_read_b64_tr_b16 v[220:221], v231 offset:0
    v_mfma_f32_16x16x32_bf16 v[36:39], v[204:207], a[100:103], v[36:39]
    ds_read_b64_tr_b16 v[222:223], v231 offset:8192
    v_mfma_f32_16x16x32_bf16 v[44:47], v[204:207], a[104:107], v[44:47]
    s_waitcnt lgkmcnt(6)
    buffer_load_dwordx4 v237, s[8:11], s37 offen offset:1024 sc1 nt lds
    v_mfma_f32_16x16x32_bf16 v[48:51], v[208:211], a[96:99], v[48:51]
    ds_read_b64_tr_b16 v[192:193], v224 offset:256
    v_mfma_f32_16x16x32_bf16 v[56:59], v[208:211], a[100:103], v[56:59]
    ds_read_b64_tr_b16 v[194:195], v224 offset:8448
    v_add_u32 v224, s50, v224
    v_mfma_f32_16x16x32_bf16 v[64:67], v[208:211], a[104:107], v[64:67]
    s_waitcnt lgkmcnt(6)
    buffer_load_dwordx4 v238, s[8:11], s37 offen offset:2048 sc1 nt lds
    v_mfma_f32_16x16x32_bf16 v[52:55], v[212:215], a[96:99], v[52:55]
    ds_read_b64_tr_b16 v[196:197], v225 offset:256
    v_mfma_f32_16x16x32_bf16 v[60:63], v[212:215], a[100:103], v[60:63]
    ds_read_b64_tr_b16 v[198:199], v225 offset:8448
    v_add_u32 v225, s50, v225
    v_mfma_f32_16x16x32_bf16 v[68:71], v[212:215], a[104:107], v[68:71]
    s_waitcnt lgkmcnt(6)
    v_mfma_f32_16x16x32_bf16 v[72:75], v[216:219], a[96:99], v[72:75]
    ds_read_b64_tr_b16 v[200:201], v226 offset:256
    v_mfma_f32_16x16x32_bf16 v[80:83], v[216:219], a[100:103], v[80:83]
    ds_read_b64_tr_b16 v[202:203], v226 offset:8448
    v_add_u32 v226, s50, v226
    v_mfma_f32_16x16x32_bf16 v[88:91], v[216:219], a[104:107], v[88:91]
    s_waitcnt lgkmcnt(6)
    buffer_load_dwordx4 v239, s[8:11], s37 offen offset:3072 sc1 nt lds
    v_mfma_f32_16x16x32_bf16 v[76:79], v[220:223], a[96:99], v[76:79]
    s_add_u32 s33, s33, 16384
    s_cmp_eq_u32 s33, 163840
    s_cselect_b32 s33, 0, s33
    ds_read_b64_tr_b16 v[204:205], v227 offset:256
    v_mfma_f32_16x16x32_bf16 v[84:87], v[220:223], a[100:103], v[84:87]
    s_add_u32 s37, s37, 16384
    ds_read_b64_tr_b16 v[206:207], v227 offset:8448
    v_add_u32 v227, s50, v227
    v_mfma_f32_16x16x32_bf16 v[92:95], v[220:223], a[104:107], v[92:95]
    s_waitcnt lgkmcnt(6)
    v_mfma_f32_16x16x32_bf16 v[96:99], v[192:195], a[96:99], v[96:99]
    s_add_u32 m0, s33, s32
    ds_read_b64_tr_b16 v[208:209], v228 offset:256
    v_mfma_f32_16x16x32_bf16 v[104:107], v[192:195], a[100:103], v[104:107]
    ds_read_b64_tr_b16 v[210:211], v228 offset:8448
    v_add_u32 v228, s50, v228
    v_mfma_f32_16x16x32_bf16 v[112:115], v[192:195], a[104:107], v[112:115]
    s_waitcnt lgkmcnt(6)
    buffer_load_dwordx4 v236, s[12:15], s38 offen offset:0 sc1 nt lds
    v_mfma_f32_16x16x32_bf16 v[100:103], v[196:199], a[96:99], v[100:103]
    ds_read_b64_tr_b16 v[212:213], v229 offset:256
    v_mfma_f32_16x16x32_bf16 v[108:111], v[196:199], a[100:103], v[108:111]
    ds_read_b64_tr_b16 v[214:215], v229 offset:8448
    v_add_u32 v229, s50, v229
    v_mfma_f32_16x16x32_bf16 v[116:119], v[196:199], a[104:107], v[116:119]
    s_waitcnt lgkmcnt(6)
    buffer_load_dwordx4 v237, s[12:15], s38 offen offset:1024 sc1 nt lds
    v_mfma_f32_16x16x32_bf16 v[120:123], v[200:203], a[96:99], v[120:123]
    ds_read_b64_tr_b16 v[216:217], v230 offset:256
    v_mfma_f32_16x16x32_bf16 v[128:131], v[200:203], a[100:103], v[128:131]
    ds_read_b64_tr_b16 v[218:219], v230 offset:8448
    v_add_u32 v230, s50, v230
    v_mfma_f32_16x16x32_bf16 v[136:139], v[200:203], a[104:107], v[136:139]
    s_waitcnt lgkmcnt(6)
    v_mfma_f32_16x16x32_bf16 v[124:127], v[204:207], a[96:99], v[124:127]
    ds_read_b64_tr_b16 v[220:221], v231 offset:256
    v_mfma_f32_16x16x32_bf16 v[132:135], v[204:207], a[100:103], v[132:135]
    ds_read_b64_tr_b16 v[222:223], v231 offset:8448
    v_add_u32 v231, s50, v231
    v_mfma_f32_16x16x32_bf16 v[140:143], v[204:207], a[104:107], v[140:143]
    s_waitcnt lgkmcnt(6)
    s_waitcnt vmcnt(26)
    s_barrier
    buffer_load_dwordx4 v238, s[12:15], s38 offen offset:2048 sc1 nt lds
    v_mfma_f32_16x16x32_bf16 v[144:147], v[208:211], a[96:99], v[144:147]
    ds_read_b64_tr_b16 v[192:193], v224 offset:0
    v_mfma_f32_16x16x32_bf16 v[152:155], v[208:211], a[100:103], v[152:155]
    ds_read_b64_tr_b16 v[194:195], v224 offset:8192
    v_mfma_f32_16x16x32_bf16 v[160:163], v[208:211], a[104:107], v[160:163]
    s_waitcnt lgkmcnt(6)
    v_mfma_f32_16x16x32_bf16 v[148:151], v[212:215], a[96:99], v[148:151]
    ds_read_b64_tr_b16 v[196:197], v225 offset:0
    v_mfma_f32_16x16x32_bf16 v[156:159], v[212:215], a[100:103], v[156:159]
    ds_read_b64_tr_b16 v[198:199], v225 offset:8192
    v_mfma_f32_16x16x32_bf16 v[164:167], v[212:215], a[104:107], v[164:167]
    s_waitcnt lgkmcnt(6)
    buffer_load_dwordx4 v239, s[12:15], s38 offen offset:3072 sc1 nt lds
    v_mfma_f32_16x16x32_bf16 v[168:171], v[216:219], a[96:99], v[168:171]
    s_add_u32 s33, s33, 16384
    s_cmp_eq_u32 s33, 163840
    s_cselect_b32 s33, 0, s33
    ds_read_b64_tr_b16 v[200:201], v226 offset:0
    v_mfma_f32_16x16x32_bf16 v[176:179], v[216:219], a[100:103], v[176:179]
    s_add_u32 s38, s38, 16384
    ds_read_b64_tr_b16 v[202:203], v226 offset:8192
    v_mfma_f32_16x16x32_bf16 v[184:187], v[216:219], a[104:107], v[184:187]
    s_waitcnt lgkmcnt(6)
    v_mfma_f32_16x16x32_bf16 v[172:175], v[220:223], a[96:99], v[172:175]
    ds_read_b64_tr_b16 v[204:205], v227 offset:0
    v_mfma_f32_16x16x32_bf16 v[180:183], v[220:223], a[100:103], v[180:183]
    ds_read_b64_tr_b16 v[206:207], v227 offset:8192
    v_mfma_f32_16x16x32_bf16 v[188:191], v[220:223], a[104:107], v[188:191]
    s_waitcnt lgkmcnt(6)
    v_mfma_f32_16x16x32_bf16 v[0:3], v[192:195], a[108:111], v[0:3]
    s_add_u32 s34, s34, 16384
    s_cmp_eq_u32 s34, 163840
    s_cselect_b32 s34, 0, s34
    ds_read_b64_tr_b16 v[208:209], v228 offset:0
    v_mfma_f32_16x16x32_bf16 v[8:11], v[192:195], a[112:115], v[8:11]
    s_sub_u32 s50, s34, s35
    ds_read_b64_tr_b16 v[210:211], v228 offset:8192
    v_mfma_f32_16x16x32_bf16 v[16:19], v[192:195], a[116:119], v[16:19]
    s_waitcnt lgkmcnt(6)
    v_mfma_f32_16x16x32_bf16 v[4:7], v[196:199], a[108:111], v[4:7]
    s_mov_b32 s35, s34
    ds_read_b64_tr_b16 v[212:213], v229 offset:0
    v_mfma_f32_16x16x32_bf16 v[12:15], v[196:199], a[112:115], v[12:15]
    s_add_u32 m0, s33, s32
    ds_read_b64_tr_b16 v[214:215], v229 offset:8192
    v_mfma_f32_16x16x32_bf16 v[20:23], v[196:199], a[116:119], v[20:23]
    s_waitcnt lgkmcnt(6)
    buffer_load_dwordx4 v236, s[8:11], s37 offen offset:0 sc1 nt lds
    v_mfma_f32_16x16x32_bf16 v[24:27], v[200:203], a[108:111], v[24:27]
    ds_read_b64_tr_b16 v[216:217], v230 offset:0
    v_mfma_f32_16x16x32_bf16 v[32:35], v[200:203], a[112:115], v[32:35]
    ds_read_b64_tr_b16 v[218:219], v230 offset:8192
    v_mfma_f32_16x16x32_bf16 v[40:43], v[200:203], a[116:119], v[40:43]
    s_waitcnt lgkmcnt(6)
    v_mfma_f32_16x16x32_bf16 v[28:31], v[204:207], a[108:111], v[28:31]
    ds_read_b64_tr_b16 v[220:221], v231 offset:0
    v_mfma_f32_16x16x32_bf16 v[36:39], v[204:207], a[112:115], v[36:39]
    ds_read_b64_tr_b16 v[222:223], v231 offset:8192
    v_mfma_f32_16x16x32_bf16 v[44:47], v[204:207], a[116:119], v[44:47]
    s_waitcnt lgkmcnt(6)
    v_mfma_f32_16x16x32_bf16 v[48:51], v[208:211], a[108:111], v[48:51]
    ds_read_b64_tr_b16 v[192:193], v224 offset:256
    v_mfma_f32_16x16x32_bf16 v[56:59], v[208:211], a[112:115], v[56:59]
    ds_read_b64_tr_b16 v[194:195], v224 offset:8448
    v_add_u32 v224, s50, v224
    v_mfma_f32_16x16x32_bf16 v[64:67], v[208:211], a[116:119], v[64:67]
    s_waitcnt lgkmcnt(6)
    buffer_load_dwordx4 v237, s[8:11], s37 offen offset:1024 sc1 nt lds
    v_mfma_f32_16x16x32_bf16 v[52:55], v[212:215], a[108:111], v[52:55]
    ds_read_b64_tr_b16 v[196:197], v225 offset:256
    v_mfma_f32_16x16x32_bf16 v[60:63], v[212:215], a[112:115], v[60:63]
    ds_read_b64_tr_b16 v[198:199], v225 offset:8448
    v_add_u32 v225, s50, v225
    v_mfma_f32_16x16x32_bf16 v[68:71], v[212:215], a[116:119], v[68:71]
    s_waitcnt lgkmcnt(6)
    v_mfma_f32_16x16x32_bf16 v[72:75], v[216:219], a[108:111], v[72:75]
    ds_read_b64_tr_b16 v[200:201], v226 offset:256
    v_mfma_f32_16x16x32_bf16 v[80:83], v[216:219], a[112:115], v[80:83]
    ds_read_b64_tr_b16 v[202:203], v226 offset:8448
    v_add_u32 v226, s50, v226
    v_mfma_f32_16x16x32_bf16 v[88:91], v[216:219], a[116:119], v[88:91]
    s_waitcnt lgkmcnt(6)
    v_mfma_f32_16x16x32_bf16 v[76:79], v[220:223], a[108:111], v[76:79]
    ds_read_b64_tr_b16 v[204:205], v227 offset:256
    v_mfma_f32_16x16x32_bf16 v[84:87], v[220:223], a[112:115], v[84:87]
    ds_read_b64_tr_b16 v[206:207], v227 offset:8448
    v_add_u32 v227, s50, v227
    v_mfma_f32_16x16x32_bf16 v[92:95], v[220:223], a[116:119], v[92:95]
    s_waitcnt lgkmcnt(6)
    v_mfma_f32_16x16x32_bf16 v[96:99], v[192:195], a[108:111], v[96:99]
    ds_read_b64_tr_b16 v[208:209], v228 offset:256
    v_mfma_f32_16x16x32_bf16 v[104:107], v[192:195], a[112:115], v[104:107]
    ds_read_b64_tr_b16 v[210:211], v228 offset:8448
    v_add_u32 v228, s50, v228
    v_mfma_f32_16x16x32_bf16 v[112:115], v[192:195], a[116:119], v[112:115]
    s_waitcnt lgkmcnt(6)
    buffer_load_dwordx4 v238, s[8:11], s37 offen offset:2048 sc1 nt lds
    v_mfma_f32_16x16x32_bf16 v[100:103], v[196:199], a[108:111], v[100:103]
    ds_read_b64_tr_b16 v[212:213], v229 offset:256
    v_mfma_f32_16x16x32_bf16 v[108:111], v[196:199], a[112:115], v[108:111]
    ds_read_b64_tr_b16 v[214:215], v229 offset:8448
    v_add_u32 v229, s50, v229
    v_mfma_f32_16x16x32_bf16 v[116:119], v[196:199], a[116:119], v[116:119]
    s_waitcnt lgkmcnt(6)
    v_mfma_f32_16x16x32_bf16 v[120:123], v[200:203], a[108:111], v[120:123]
    ds_read_b64_tr_b16 v[216:217], v230 offset:256
    v_mfma_f32_16x16x32_bf16 v[128:131], v[200:203], a[112:115], v[128:131]
    ds_read_b64_tr_b16 v[218:219], v230 offset:8448
    v_add_u32 v230, s50, v230
    v_mfma_f32_16x16x32_bf16 v[136:139], v[200:203], a[116:119], v[136:139]
    s_waitcnt lgkmcnt(6)
    v_mfma_f32_16x16x32_bf16 v[124:127], v[204:207], a[108:111], v[124:127]
    ds_read_b64_tr_b16 v[220:221], v231 offset:256
    v_mfma_f32_16x16x32_bf16 v[132:135], v[204:207], a[112:115], v[132:135]
    ds_read_b64_tr_b16 v[222:223], v231 offset:8448
    v_add_u32 v231, s50, v231
    v_mfma_f32_16x16x32_bf16 v[140:143], v[204:207], a[116:119], v[140:143]
    s_waitcnt lgkmcnt(6)
    s_waitcnt vmcnt(27)
    s_barrier
    buffer_load_dwordx4 v239, s[8:11], s37 offen offset:3072 sc1 nt lds
    v_mfma_f32_16x16x32_bf16 v[144:147], v[208:211], a[108:111], v[144:147]
    s_add_u32 s33, s33, 16384
    s_cmp_eq_u32 s33, 163840
    s_cselect_b32 s33, 0, s33
    ds_read_b64_tr_b16 v[192:193], v224 offset:0
    v_mfma_f32_16x16x32_bf16 v[152:155], v[208:211], a[112:115], v[152:155]
    s_add_u32 s37, s37, 16384
    ds_read_b64_tr_b16 v[194:195], v224 offset:8192
    v_mfma_f32_16x16x32_bf16 v[160:163], v[208:211], a[116:119], v[160:163]
    s_waitcnt lgkmcnt(6)
    v_mfma_f32_16x16x32_bf16 v[148:151], v[212:215], a[108:111], v[148:151]
    ds_read_b64_tr_b16 v[196:197], v225 offset:0
    v_mfma_f32_16x16x32_bf16 v[156:159], v[212:215], a[112:115], v[156:159]
    ds_read_b64_tr_b16 v[198:199], v225 offset:8192
    v_mfma_f32_16x16x32_bf16 v[164:167], v[212:215], a[116:119], v[164:167]
    s_waitcnt lgkmcnt(6)
    v_mfma_f32_16x16x32_bf16 v[168:171], v[216:219], a[108:111], v[168:171]
    ds_read_b64_tr_b16 v[200:201], v226 offset:0
    v_mfma_f32_16x16x32_bf16 v[176:179], v[216:219], a[112:115], v[176:179]
    ds_read_b64_tr_b16 v[202:203], v226 offset:8192
    v_mfma_f32_16x16x32_bf16 v[184:187], v[216:219], a[116:119], v[184:187]
    s_waitcnt lgkmcnt(6)
    v_mfma_f32_16x16x32_bf16 v[172:175], v[220:223], a[108:111], v[172:175]
    ds_read_b64_tr_b16 v[204:205], v227 offset:0
    v_mfma_f32_16x16x32_bf16 v[180:183], v[220:223], a[112:115], v[180:183]
    ds_read_b64_tr_b16 v[206:207], v227 offset:8192
    v_mfma_f32_16x16x32_bf16 v[188:191], v[220:223], a[116:119], v[188:191]
    s_waitcnt lgkmcnt(6)
    v_mfma_f32_16x16x32_bf16 v[0:3], v[192:195], a[120:123], v[0:3]
    s_add_u32 s34, s34, 16384
    s_cmp_eq_u32 s34, 163840
    s_cselect_b32 s34, 0, s34
    ds_read_b64_tr_b16 v[208:209], v228 offset:0
    v_mfma_f32_16x16x32_bf16 v[8:11], v[192:195], a[124:127], v[8:11]
    s_sub_u32 s50, s34, s35
    ds_read_b64_tr_b16 v[210:211], v228 offset:8192
    v_mfma_f32_16x16x32_bf16 v[16:19], v[192:195], a[128:131], v[16:19]
    s_waitcnt lgkmcnt(6)
    v_mfma_f32_16x16x32_bf16 v[4:7], v[196:199], a[120:123], v[4:7]
    s_mov_b32 s35, s34
    ds_read_b64_tr_b16 v[212:213], v229 offset:0
    v_mfma_f32_16x16x32_bf16 v[12:15], v[196:199], a[124:127], v[12:15]
    s_add_u32 m0, s33, s32
    ds_read_b64_tr_b16 v[214:215], v229 offset:8192
    v_mfma_f32_16x16x32_bf16 v[20:23], v[196:199], a[128:131], v[20:23]
    s_waitcnt lgkmcnt(6)
    buffer_load_dwordx4 v236, s[12:15], s38 offen offset:0 sc1 nt lds
    v_mfma_f32_16x16x32_bf16 v[24:27], v[200:203], a[120:123], v[24:27]
    ds_read_b64_tr_b16 v[216:217], v230 offset:0
    v_mfma_f32_16x16x32_bf16 v[32:35], v[200:203], a[124:127], v[32:35]
    ds_read_b64_tr_b16 v[218:219], v230 offset:8192
    v_mfma_f32_16x16x32_bf16 v[40:43], v[200:203], a[128:131], v[40:43]
    s_waitcnt lgkmcnt(6)
    v_mfma_f32_16x16x32_bf16 v[28:31], v[204:207], a[120:123], v[28:31]
    ds_read_b64_tr_b16 v[220:221], v231 offset:0
    v_mfma_f32_16x16x32_bf16 v[36:39], v[204:207], a[124:127], v[36:39]
    ds_read_b64_tr_b16 v[222:223], v231 offset:8192
    v_mfma_f32_16x16x32_bf16 v[44:47], v[204:207], a[128:131], v[44:47]
    s_waitcnt lgkmcnt(6)
    v_mfma_f32_16x16x32_bf16 v[48:51], v[208:211], a[120:123], v[48:51]
    ds_read_b64_tr_b16 v[192:193], v224 offset:256
    v_mfma_f32_16x16x32_bf16 v[56:59], v[208:211], a[124:127], v[56:59]
    ds_read_b64_tr_b16 v[194:195], v224 offset:8448
    v_add_u32 v224, s50, v224
    v_mfma_f32_16x16x32_bf16 v[64:67], v[208:211], a[128:131], v[64:67]
    s_waitcnt lgkmcnt(6)
    buffer_load_dwordx4 v237, s[12:15], s38 offen offset:1024 sc1 nt lds
    v_mfma_f32_16x16x32_bf16 v[52:55], v[212:215], a[120:123], v[52:55]
    ds_read_b64_tr_b16 v[196:197], v225 offset:256
    v_mfma_f32_16x16x32_bf16 v[60:63], v[212:215], a[124:127], v[60:63]
    ds_read_b64_tr_b16 v[198:199], v225 offset:8448
    v_add_u32 v225, s50, v225
    v_mfma_f32_16x16x32_bf16 v[68:71], v[212:215], a[128:131], v[68:71]
    s_waitcnt lgkmcnt(6)
    v_mfma_f32_16x16x32_bf16 v[72:75], v[216:219], a[120:123], v[72:75]
    ds_read_b64_tr_b16 v[200:201], v226 offset:256
    v_mfma_f32_16x16x32_bf16 v[80:83], v[216:219], a[124:127], v[80:83]
    ds_read_b64_tr_b16 v[202:203], v226 offset:8448
    v_add_u32 v226, s50, v226
    v_mfma_f32_16x16x32_bf16 v[88:91], v[216:219], a[128:131], v[88:91]
    s_waitcnt lgkmcnt(6)
    v_mfma_f32_16x16x32_bf16 v[76:79], v[220:223], a[120:123], v[76:79]
    ds_read_b64_tr_b16 v[204:205], v227 offset:256
    v_mfma_f32_16x16x32_bf16 v[84:87], v[220:223], a[124:127], v[84:87]
    ds_read_b64_tr_b16 v[206:207], v227 offset:8448
    v_add_u32 v227, s50, v227
    v_mfma_f32_16x16x32_bf16 v[92:95], v[220:223], a[128:131], v[92:95]
    s_waitcnt lgkmcnt(6)
    v_mfma_f32_16x16x32_bf16 v[96:99], v[192:195], a[120:123], v[96:99]
    ds_read_b64_tr_b16 v[208:209], v228 offset:256
    v_mfma_f32_16x16x32_bf16 v[104:107], v[192:195], a[124:127], v[104:107]
    ds_read_b64_tr_b16 v[210:211], v228 offset:8448
    v_add_u32 v228, s50, v228
    v_mfma_f32_16x16x32_bf16 v[112:115], v[192:195], a[128:131], v[112:115]
    s_waitcnt lgkmcnt(6)
    buffer_load_dwordx4 v238, s[12:15], s38 offen offset:2048 sc1 nt lds
    v_mfma_f32_16x16x32_bf16 v[100:103], v[196:199], a[120:123], v[100:103]
    ds_read_b64_tr_b16 v[212:213], v229 offset:256
    v_mfma_f32_16x16x32_bf16 v[108:111], v[196:199], a[124:127], v[108:111]
    ds_read_b64_tr_b16 v[214:215], v229 offset:8448
    v_add_u32 v229, s50, v229
    v_mfma_f32_16x16x32_bf16 v[116:119], v[196:199], a[128:131], v[116:119]
    s_waitcnt lgkmcnt(6)
    v_mfma_f32_16x16x32_bf16 v[120:123], v[200:203], a[120:123], v[120:123]
    ds_read_b64_tr_b16 v[216:217], v230 offset:256
    v_mfma_f32_16x16x32_bf16 v[128:131], v[200:203], a[124:127], v[128:131]
    ds_read_b64_tr_b16 v[218:219], v230 offset:8448
    v_add_u32 v230, s50, v230
    v_mfma_f32_16x16x32_bf16 v[136:139], v[200:203], a[128:131], v[136:139]
    s_waitcnt lgkmcnt(6)
    v_mfma_f32_16x16x32_bf16 v[124:127], v[204:207], a[120:123], v[124:127]
    ds_read_b64_tr_b16 v[220:221], v231 offset:256
    v_mfma_f32_16x16x32_bf16 v[132:135], v[204:207], a[124:127], v[132:135]
    ds_read_b64_tr_b16 v[222:223], v231 offset:8448
    v_add_u32 v231, s50, v231
    v_mfma_f32_16x16x32_bf16 v[140:143], v[204:207], a[128:131], v[140:143]
    s_waitcnt lgkmcnt(6)
    s_waitcnt vmcnt(27)
    s_barrier
    buffer_load_dwordx4 v239, s[12:15], s38 offen offset:3072 sc1 nt lds
    v_mfma_f32_16x16x32_bf16 v[144:147], v[208:211], a[120:123], v[144:147]
    s_add_u32 s33, s33, 16384
    s_cmp_eq_u32 s33, 163840
    s_cselect_b32 s33, 0, s33
    ds_read_b64_tr_b16 v[192:193], v224 offset:0
    v_mfma_f32_16x16x32_bf16 v[152:155], v[208:211], a[124:127], v[152:155]
    s_add_u32 s38, s38, 16384
    ds_read_b64_tr_b16 v[194:195], v224 offset:8192
    v_mfma_f32_16x16x32_bf16 v[160:163], v[208:211], a[128:131], v[160:163]
    s_waitcnt lgkmcnt(6)
    v_mfma_f32_16x16x32_bf16 v[148:151], v[212:215], a[120:123], v[148:151]
    ds_read_b64_tr_b16 v[196:197], v225 offset:0
    v_mfma_f32_16x16x32_bf16 v[156:159], v[212:215], a[124:127], v[156:159]
    ds_read_b64_tr_b16 v[198:199], v225 offset:8192
    v_mfma_f32_16x16x32_bf16 v[164:167], v[212:215], a[128:131], v[164:167]
    s_waitcnt lgkmcnt(6)
    v_mfma_f32_16x16x32_bf16 v[168:171], v[216:219], a[120:123], v[168:171]
    ds_read_b64_tr_b16 v[200:201], v226 offset:0
    v_mfma_f32_16x16x32_bf16 v[176:179], v[216:219], a[124:127], v[176:179]
    ds_read_b64_tr_b16 v[202:203], v226 offset:8192
    v_mfma_f32_16x16x32_bf16 v[184:187], v[216:219], a[128:131], v[184:187]
    s_waitcnt lgkmcnt(6)
    v_mfma_f32_16x16x32_bf16 v[172:175], v[220:223], a[120:123], v[172:175]
    ds_read_b64_tr_b16 v[204:205], v227 offset:0
    v_mfma_f32_16x16x32_bf16 v[180:183], v[220:223], a[124:127], v[180:183]
    ds_read_b64_tr_b16 v[206:207], v227 offset:8192
    v_mfma_f32_16x16x32_bf16 v[188:191], v[220:223], a[128:131], v[188:191]
    s_waitcnt lgkmcnt(6)
    v_mfma_f32_16x16x32_bf16 v[0:3], v[192:195], a[132:135], v[0:3]
    s_add_u32 s34, s34, 16384
    s_cmp_eq_u32 s34, 163840
    s_cselect_b32 s34, 0, s34
    ds_read_b64_tr_b16 v[208:209], v228 offset:0
    v_mfma_f32_16x16x32_bf16 v[8:11], v[192:195], a[136:139], v[8:11]
    s_sub_u32 s50, s34, s35
    ds_read_b64_tr_b16 v[210:211], v228 offset:8192
    v_mfma_f32_16x16x32_bf16 v[16:19], v[192:195], a[140:143], v[16:19]
    s_waitcnt lgkmcnt(6)
    v_mfma_f32_16x16x32_bf16 v[4:7], v[196:199], a[132:135], v[4:7]
    s_mov_b32 s35, s34
    ds_read_b64_tr_b16 v[212:213], v229 offset:0
    v_mfma_f32_16x16x32_bf16 v[12:15], v[196:199], a[136:139], v[12:15]
    s_add_u32 m0, s33, s32
    ds_read_b64_tr_b16 v[214:215], v229 offset:8192
    v_mfma_f32_16x16x32_bf16 v[20:23], v[196:199], a[140:143], v[20:23]
    s_waitcnt lgkmcnt(6)
    buffer_load_dwordx4 v236, s[8:11], s37 offen offset:0 sc1 nt lds
    v_mfma_f32_16x16x32_bf16 v[24:27], v[200:203], a[132:135], v[24:27]
    ds_read_b64_tr_b16 v[216:217], v230 offset:0
    v_mfma_f32_16x16x32_bf16 v[32:35], v[200:203], a[136:139], v[32:35]
    ds_read_b64_tr_b16 v[218:219], v230 offset:8192
    v_mfma_f32_16x16x32_bf16 v[40:43], v[200:203], a[140:143], v[40:43]
    s_waitcnt lgkmcnt(6)
    v_mfma_f32_16x16x32_bf16 v[28:31], v[204:207], a[132:135], v[28:31]
    ds_read_b64_tr_b16 v[220:221], v231 offset:0
    v_mfma_f32_16x16x32_bf16 v[36:39], v[204:207], a[136:139], v[36:39]
    ds_read_b64_tr_b16 v[222:223], v231 offset:8192
    v_mfma_f32_16x16x32_bf16 v[44:47], v[204:207], a[140:143], v[44:47]
    s_waitcnt lgkmcnt(6)
    v_mfma_f32_16x16x32_bf16 v[48:51], v[208:211], a[132:135], v[48:51]
    ds_read_b64_tr_b16 v[192:193], v224 offset:256
    v_mfma_f32_16x16x32_bf16 v[56:59], v[208:211], a[136:139], v[56:59]
    ds_read_b64_tr_b16 v[194:195], v224 offset:8448
    v_add_u32 v224, s50, v224
    v_mfma_f32_16x16x32_bf16 v[64:67], v[208:211], a[140:143], v[64:67]
    s_waitcnt lgkmcnt(6)
    buffer_load_dwordx4 v237, s[8:11], s37 offen offset:1024 sc1 nt lds
    v_mfma_f32_16x16x32_bf16 v[52:55], v[212:215], a[132:135], v[52:55]
    ds_read_b64_tr_b16 v[196:197], v225 offset:256
    v_mfma_f32_16x16x32_bf16 v[60:63], v[212:215], a[136:139], v[60:63]
    ds_read_b64_tr_b16 v[198:199], v225 offset:8448
    v_add_u32 v225, s50, v225
    v_mfma_f32_16x16x32_bf16 v[68:71], v[212:215], a[140:143], v[68:71]
    s_waitcnt lgkmcnt(6)
    v_mfma_f32_16x16x32_bf16 v[72:75], v[216:219], a[132:135], v[72:75]
    ds_read_b64_tr_b16 v[200:201], v226 offset:256
    v_mfma_f32_16x16x32_bf16 v[80:83], v[216:219], a[136:139], v[80:83]
    ds_read_b64_tr_b16 v[202:203], v226 offset:8448
    v_add_u32 v226, s50, v226
    v_mfma_f32_16x16x32_bf16 v[88:91], v[216:219], a[140:143], v[88:91]
    s_waitcnt lgkmcnt(6)
    v_mfma_f32_16x16x32_bf16 v[76:79], v[220:223], a[132:135], v[76:79]
    ds_read_b64_tr_b16 v[204:205], v227 offset:256
    v_mfma_f32_16x16x32_bf16 v[84:87], v[220:223], a[136:139], v[84:87]
    ds_read_b64_tr_b16 v[206:207], v227 offset:8448
    v_add_u32 v227, s50, v227
    v_mfma_f32_16x16x32_bf16 v[92:95], v[220:223], a[140:143], v[92:95]
    s_waitcnt lgkmcnt(6)
    v_mfma_f32_16x16x32_bf16 v[96:99], v[192:195], a[132:135], v[96:99]
    ds_read_b64_tr_b16 v[208:209], v228 offset:256
    v_mfma_f32_16x16x32_bf16 v[104:107], v[192:195], a[136:139], v[104:107]
    ds_read_b64_tr_b16 v[210:211], v228 offset:8448
    v_add_u32 v228, s50, v228
    v_mfma_f32_16x16x32_bf16 v[112:115], v[192:195], a[140:143], v[112:115]
    s_waitcnt lgkmcnt(6)
    buffer_load_dwordx4 v238, s[8:11], s37 offen offset:2048 sc1 nt lds
    v_mfma_f32_16x16x32_bf16 v[100:103], v[196:199], a[132:135], v[100:103]
    ds_read_b64_tr_b16 v[212:213], v229 offset:256
    v_mfma_f32_16x16x32_bf16 v[108:111], v[196:199], a[136:139], v[108:111]
    ds_read_b64_tr_b16 v[214:215], v229 offset:8448
    v_add_u32 v229, s50, v229
    v_mfma_f32_16x16x32_bf16 v[116:119], v[196:199], a[140:143], v[116:119]
    s_waitcnt lgkmcnt(6)
    v_mfma_f32_16x16x32_bf16 v[120:123], v[200:203], a[132:135], v[120:123]
    ds_read_b64_tr_b16 v[216:217], v230 offset:256
    v_mfma_f32_16x16x32_bf16 v[128:131], v[200:203], a[136:139], v[128:131]
    ds_read_b64_tr_b16 v[218:219], v230 offset:8448
    v_add_u32 v230, s50, v230
    v_mfma_f32_16x16x32_bf16 v[136:139], v[200:203], a[140:143], v[136:139]
    s_waitcnt lgkmcnt(6)
    v_mfma_f32_16x16x32_bf16 v[124:127], v[204:207], a[132:135], v[124:127]
    ds_read_b64_tr_b16 v[220:221], v231 offset:256
    v_mfma_f32_16x16x32_bf16 v[132:135], v[204:207], a[136:139], v[132:135]
    ds_read_b64_tr_b16 v[222:223], v231 offset:8448
    v_add_u32 v231, s50, v231
    v_mfma_f32_16x16x32_bf16 v[140:143], v[204:207], a[140:143], v[140:143]
    s_waitcnt lgkmcnt(6)
    s_waitcnt vmcnt(27)
    s_barrier
    buffer_load_dwordx4 v239, s[8:11], s37 offen offset:3072 sc1 nt lds
    v_mfma_f32_16x16x32_bf16 v[144:147], v[208:211], a[132:135], v[144:147]
    s_add_u32 s33, s33, 16384
    s_cmp_eq_u32 s33, 163840
    s_cselect_b32 s33, 0, s33
    ds_read_b64_tr_b16 v[192:193], v224 offset:0
    v_mfma_f32_16x16x32_bf16 v[152:155], v[208:211], a[136:139], v[152:155]
    s_add_u32 s37, s37, 16384
    ds_read_b64_tr_b16 v[194:195], v224 offset:8192
    v_mfma_f32_16x16x32_bf16 v[160:163], v[208:211], a[140:143], v[160:163]
    s_waitcnt lgkmcnt(6)
    v_mfma_f32_16x16x32_bf16 v[148:151], v[212:215], a[132:135], v[148:151]
    ds_read_b64_tr_b16 v[196:197], v225 offset:0
    v_mfma_f32_16x16x32_bf16 v[156:159], v[212:215], a[136:139], v[156:159]
    ds_read_b64_tr_b16 v[198:199], v225 offset:8192
    v_mfma_f32_16x16x32_bf16 v[164:167], v[212:215], a[140:143], v[164:167]
    s_waitcnt lgkmcnt(6)
    v_mfma_f32_16x16x32_bf16 v[168:171], v[216:219], a[132:135], v[168:171]
    ds_read_b64_tr_b16 v[200:201], v226 offset:0
    v_mfma_f32_16x16x32_bf16 v[176:179], v[216:219], a[136:139], v[176:179]
    ds_read_b64_tr_b16 v[202:203], v226 offset:8192
    v_mfma_f32_16x16x32_bf16 v[184:187], v[216:219], a[140:143], v[184:187]
    s_waitcnt lgkmcnt(6)
    v_mfma_f32_16x16x32_bf16 v[172:175], v[220:223], a[132:135], v[172:175]
    ds_read_b64_tr_b16 v[204:205], v227 offset:0
    v_mfma_f32_16x16x32_bf16 v[180:183], v[220:223], a[136:139], v[180:183]
    ds_read_b64_tr_b16 v[206:207], v227 offset:8192
    v_mfma_f32_16x16x32_bf16 v[188:191], v[220:223], a[140:143], v[188:191]
    s_waitcnt lgkmcnt(6)
    v_mfma_f32_16x16x32_bf16 v[0:3], v[192:195], a[144:147], v[0:3]
    s_add_u32 s34, s34, 16384
    s_cmp_eq_u32 s34, 163840
    s_cselect_b32 s34, 0, s34
    ds_read_b64_tr_b16 v[208:209], v228 offset:0
    v_mfma_f32_16x16x32_bf16 v[8:11], v[192:195], a[148:151], v[8:11]
    s_sub_u32 s50, s34, s35
    ds_read_b64_tr_b16 v[210:211], v228 offset:8192
    v_mfma_f32_16x16x32_bf16 v[16:19], v[192:195], a[152:155], v[16:19]
    s_waitcnt lgkmcnt(6)
    v_mfma_f32_16x16x32_bf16 v[4:7], v[196:199], a[144:147], v[4:7]
    s_mov_b32 s35, s34
    ds_read_b64_tr_b16 v[212:213], v229 offset:0
    v_mfma_f32_16x16x32_bf16 v[12:15], v[196:199], a[148:151], v[12:15]
    s_add_u32 m0, s33, s32
    ds_read_b64_tr_b16 v[214:215], v229 offset:8192
    v_mfma_f32_16x16x32_bf16 v[20:23], v[196:199], a[152:155], v[20:23]
    s_waitcnt lgkmcnt(6)
    buffer_load_dwordx4 v236, s[12:15], s38 offen offset:0 sc1 nt lds
    v_mfma_f32_16x16x32_bf16 v[24:27], v[200:203], a[144:147], v[24:27]
    ds_read_b64_tr_b16 v[216:217], v230 offset:0
    v_mfma_f32_16x16x32_bf16 v[32:35], v[200:203], a[148:151], v[32:35]
    ds_read_b64_tr_b16 v[218:219], v230 offset:8192
    v_mfma_f32_16x16x32_bf16 v[40:43], v[200:203], a[152:155], v[40:43]
    s_waitcnt lgkmcnt(6)
    v_mfma_f32_16x16x32_bf16 v[28:31], v[204:207], a[144:147], v[28:31]
    ds_read_b64_tr_b16 v[220:221], v231 offset:0
    v_mfma_f32_16x16x32_bf16 v[36:39], v[204:207], a[148:151], v[36:39]
    ds_read_b64_tr_b16 v[222:223], v231 offset:8192
    v_mfma_f32_16x16x32_bf16 v[44:47], v[204:207], a[152:155], v[44:47]
    s_waitcnt lgkmcnt(6)
    v_mfma_f32_16x16x32_bf16 v[48:51], v[208:211], a[144:147], v[48:51]
    ds_read_b64_tr_b16 v[192:193], v224 offset:256
    v_mfma_f32_16x16x32_bf16 v[56:59], v[208:211], a[148:151], v[56:59]
    ds_read_b64_tr_b16 v[194:195], v224 offset:8448
    v_add_u32 v224, s50, v224
    v_mfma_f32_16x16x32_bf16 v[64:67], v[208:211], a[152:155], v[64:67]
    s_waitcnt lgkmcnt(6)
    buffer_load_dwordx4 v237, s[12:15], s38 offen offset:1024 sc1 nt lds
    v_mfma_f32_16x16x32_bf16 v[52:55], v[212:215], a[144:147], v[52:55]
    ds_read_b64_tr_b16 v[196:197], v225 offset:256
    v_mfma_f32_16x16x32_bf16 v[60:63], v[212:215], a[148:151], v[60:63]
    ds_read_b64_tr_b16 v[198:199], v225 offset:8448
    v_add_u32 v225, s50, v225
    v_mfma_f32_16x16x32_bf16 v[68:71], v[212:215], a[152:155], v[68:71]
    s_waitcnt lgkmcnt(6)
    v_mfma_f32_16x16x32_bf16 v[72:75], v[216:219], a[144:147], v[72:75]
    ds_read_b64_tr_b16 v[200:201], v226 offset:256
    v_mfma_f32_16x16x32_bf16 v[80:83], v[216:219], a[148:151], v[80:83]
    ds_read_b64_tr_b16 v[202:203], v226 offset:8448
    v_add_u32 v226, s50, v226
    v_mfma_f32_16x16x32_bf16 v[88:91], v[216:219], a[152:155], v[88:91]
    s_waitcnt lgkmcnt(6)
    v_mfma_f32_16x16x32_bf16 v[76:79], v[220:223], a[144:147], v[76:79]
    ds_read_b64_tr_b16 v[204:205], v227 offset:256
    v_mfma_f32_16x16x32_bf16 v[84:87], v[220:223], a[148:151], v[84:87]
    ds_read_b64_tr_b16 v[206:207], v227 offset:8448
    v_add_u32 v227, s50, v227
    v_mfma_f32_16x16x32_bf16 v[92:95], v[220:223], a[152:155], v[92:95]
    s_waitcnt lgkmcnt(6)
    v_mfma_f32_16x16x32_bf16 v[96:99], v[192:195], a[144:147], v[96:99]
    ds_read_b64_tr_b16 v[208:209], v228 offset:256
    v_mfma_f32_16x16x32_bf16 v[104:107], v[192:195], a[148:151], v[104:107]
    ds_read_b64_tr_b16 v[210:211], v228 offset:8448
    v_add_u32 v228, s50, v228
    v_mfma_f32_16x16x32_bf16 v[112:115], v[192:195], a[152:155], v[112:115]
    s_waitcnt lgkmcnt(6)
    buffer_load_dwordx4 v238, s[12:15], s38 offen offset:2048 sc1 nt lds
    v_mfma_f32_16x16x32_bf16 v[100:103], v[196:199], a[144:147], v[100:103]
    ds_read_b64_tr_b16 v[212:213], v229 offset:256
    v_mfma_f32_16x16x32_bf16 v[108:111], v[196:199], a[148:151], v[108:111]
    ds_read_b64_tr_b16 v[214:215], v229 offset:8448
    v_add_u32 v229, s50, v229
    v_mfma_f32_16x16x32_bf16 v[116:119], v[196:199], a[152:155], v[116:119]
    s_waitcnt lgkmcnt(6)
    v_mfma_f32_16x16x32_bf16 v[120:123], v[200:203], a[144:147], v[120:123]
    ds_read_b64_tr_b16 v[216:217], v230 offset:256
    v_mfma_f32_16x16x32_bf16 v[128:131], v[200:203], a[148:151], v[128:131]
    ds_read_b64_tr_b16 v[218:219], v230 offset:8448
    v_add_u32 v230, s50, v230
    v_mfma_f32_16x16x32_bf16 v[136:139], v[200:203], a[152:155], v[136:139]
    s_waitcnt lgkmcnt(6)
    v_mfma_f32_16x16x32_bf16 v[124:127], v[204:207], a[144:147], v[124:127]
    ds_read_b64_tr_b16 v[220:221], v231 offset:256
    v_mfma_f32_16x16x32_bf16 v[132:135], v[204:207], a[148:151], v[132:135]
    ds_read_b64_tr_b16 v[222:223], v231 offset:8448
    v_add_u32 v231, s50, v231
    v_mfma_f32_16x16x32_bf16 v[140:143], v[204:207], a[152:155], v[140:143]
    s_waitcnt lgkmcnt(6)
    s_waitcnt vmcnt(27)
    s_barrier
    buffer_load_dwordx4 v239, s[12:15], s38 offen offset:3072 sc1 nt lds
    v_mfma_f32_16x16x32_bf16 v[144:147], v[208:211], a[144:147], v[144:147]
    s_add_u32 s33, s33, 16384
    s_cmp_eq_u32 s33, 163840
    s_cselect_b32 s33, 0, s33
    ds_read_b64_tr_b16 v[192:193], v224 offset:0
    v_mfma_f32_16x16x32_bf16 v[152:155], v[208:211], a[148:151], v[152:155]
    s_add_u32 s38, s38, 16384
    ds_read_b64_tr_b16 v[194:195], v224 offset:8192
    v_mfma_f32_16x16x32_bf16 v[160:163], v[208:211], a[152:155], v[160:163]
    s_waitcnt lgkmcnt(6)
    v_mfma_f32_16x16x32_bf16 v[148:151], v[212:215], a[144:147], v[148:151]
    ds_read_b64_tr_b16 v[196:197], v225 offset:0
    v_mfma_f32_16x16x32_bf16 v[156:159], v[212:215], a[148:151], v[156:159]
    ds_read_b64_tr_b16 v[198:199], v225 offset:8192
    v_mfma_f32_16x16x32_bf16 v[164:167], v[212:215], a[152:155], v[164:167]
    s_waitcnt lgkmcnt(6)
    v_mfma_f32_16x16x32_bf16 v[168:171], v[216:219], a[144:147], v[168:171]
    ds_read_b64_tr_b16 v[200:201], v226 offset:0
    v_mfma_f32_16x16x32_bf16 v[176:179], v[216:219], a[148:151], v[176:179]
    ds_read_b64_tr_b16 v[202:203], v226 offset:8192
    v_mfma_f32_16x16x32_bf16 v[184:187], v[216:219], a[152:155], v[184:187]
    s_waitcnt lgkmcnt(6)
    v_mfma_f32_16x16x32_bf16 v[172:175], v[220:223], a[144:147], v[172:175]
    ds_read_b64_tr_b16 v[204:205], v227 offset:0
    v_mfma_f32_16x16x32_bf16 v[180:183], v[220:223], a[148:151], v[180:183]
    ds_read_b64_tr_b16 v[206:207], v227 offset:8192
    v_mfma_f32_16x16x32_bf16 v[188:191], v[220:223], a[152:155], v[188:191]
    s_waitcnt lgkmcnt(6)
    v_mfma_f32_16x16x32_bf16 v[0:3], v[192:195], a[156:159], v[0:3]
    s_add_u32 s34, s34, 16384
    s_cmp_eq_u32 s34, 163840
    s_cselect_b32 s34, 0, s34
    ds_read_b64_tr_b16 v[208:209], v228 offset:0
    v_mfma_f32_16x16x32_bf16 v[8:11], v[192:195], a[160:163], v[8:11]
    s_sub_u32 s50, s34, s36
    ds_read_b64_tr_b16 v[210:211], v228 offset:8192
    v_mfma_f32_16x16x32_bf16 v[16:19], v[192:195], a[164:167], v[16:19]
    s_waitcnt lgkmcnt(6)
    v_mfma_f32_16x16x32_bf16 v[4:7], v[196:199], a[156:159], v[4:7]
    s_mov_b32 s36, s34
    ds_read_b64_tr_b16 v[212:213], v229 offset:0
    v_mfma_f32_16x16x32_bf16 v[12:15], v[196:199], a[160:163], v[12:15]
    s_add_u32 m0, s33, s32
    ds_read_b64_tr_b16 v[214:215], v229 offset:8192
    v_add_u32 v232, s50, v232
    v_mfma_f32_16x16x32_bf16 v[20:23], v[196:199], a[164:167], v[20:23]
    s_waitcnt lgkmcnt(6)
    v_add_u32 v233, s50, v233
    v_add_u32 v234, s50, v234
    v_mfma_f32_16x16x32_bf16 v[24:27], v[200:203], a[156:159], v[24:27]
    ds_read_b64_tr_b16 v[216:217], v230 offset:0
    v_add_u32 v235, s50, v235
    v_mfma_f32_16x16x32_bf16 v[32:35], v[200:203], a[160:163], v[32:35]
    ds_read_b64_tr_b16 v[218:219], v230 offset:8192
    v_mfma_f32_16x16x32_bf16 v[40:43], v[200:203], a[164:167], v[40:43]
    s_waitcnt lgkmcnt(6)
    buffer_load_dwordx4 v236, s[8:11], s37 offen offset:0 sc1 nt lds
    v_mfma_f32_16x16x32_bf16 v[28:31], v[204:207], a[156:159], v[28:31]
    ds_read_b64_tr_b16 v[220:221], v231 offset:0
    v_mfma_f32_16x16x32_bf16 v[36:39], v[204:207], a[160:163], v[36:39]
    ds_read_b64_tr_b16 v[222:223], v231 offset:8192
    v_mfma_f32_16x16x32_bf16 v[44:47], v[204:207], a[164:167], v[44:47]
    s_waitcnt lgkmcnt(6)
    v_mfma_f32_16x16x32_bf16 v[48:51], v[208:211], a[156:159], v[48:51]
    ds_read_b64_tr_b16 v[192:193], v224 offset:256
    v_mfma_f32_16x16x32_bf16 v[56:59], v[208:211], a[160:163], v[56:59]
    ds_read_b64_tr_b16 v[194:195], v224 offset:8448
    v_mfma_f32_16x16x32_bf16 v[64:67], v[208:211], a[164:167], v[64:67]
    s_waitcnt lgkmcnt(6)
    buffer_load_dwordx4 v237, s[8:11], s37 offen offset:1024 sc1 nt lds
    v_mfma_f32_16x16x32_bf16 v[52:55], v[212:215], a[156:159], v[52:55]
    ds_read_b64_tr_b16 v[196:197], v225 offset:256
    v_mfma_f32_16x16x32_bf16 v[60:63], v[212:215], a[160:163], v[60:63]
    ds_read_b64_tr_b16 v[198:199], v225 offset:8448
    v_mfma_f32_16x16x32_bf16 v[68:71], v[212:215], a[164:167], v[68:71]
    s_waitcnt lgkmcnt(6)
    v_mfma_f32_16x16x32_bf16 v[72:75], v[216:219], a[156:159], v[72:75]
    ds_read_b64_tr_b16 v[200:201], v226 offset:256
    v_mfma_f32_16x16x32_bf16 v[80:83], v[216:219], a[160:163], v[80:83]
    ds_read_b64_tr_b16 v[202:203], v226 offset:8448
    v_mfma_f32_16x16x32_bf16 v[88:91], v[216:219], a[164:167], v[88:91]
    s_waitcnt lgkmcnt(6)
    v_mfma_f32_16x16x32_bf16 v[76:79], v[220:223], a[156:159], v[76:79]
    ds_read_b64_tr_b16 v[204:205], v227 offset:256
    v_mfma_f32_16x16x32_bf16 v[84:87], v[220:223], a[160:163], v[84:87]
    ds_read_b64_tr_b16 v[206:207], v227 offset:8448
    v_mfma_f32_16x16x32_bf16 v[92:95], v[220:223], a[164:167], v[92:95]
    s_waitcnt lgkmcnt(6)
    v_mfma_f32_16x16x32_bf16 v[96:99], v[192:195], a[156:159], v[96:99]
    ds_read_b64_tr_b16 v[208:209], v228 offset:256
    v_mfma_f32_16x16x32_bf16 v[104:107], v[192:195], a[160:163], v[104:107]
    ds_read_b64_tr_b16 v[210:211], v228 offset:8448
    v_mfma_f32_16x16x32_bf16 v[112:115], v[192:195], a[164:167], v[112:115]
    s_waitcnt lgkmcnt(6)
    buffer_load_dwordx4 v238, s[8:11], s37 offen offset:2048 sc1 nt lds
    v_mfma_f32_16x16x32_bf16 v[100:103], v[196:199], a[156:159], v[100:103]
    ds_read_b64_tr_b16 v[212:213], v229 offset:256
    v_mfma_f32_16x16x32_bf16 v[108:111], v[196:199], a[160:163], v[108:111]
    ds_read_b64_tr_b16 v[214:215], v229 offset:8448
    v_mfma_f32_16x16x32_bf16 v[116:119], v[196:199], a[164:167], v[116:119]
    s_waitcnt lgkmcnt(6)
    v_mfma_f32_16x16x32_bf16 v[120:123], v[200:203], a[156:159], v[120:123]
    ds_read_b64_tr_b16 v[216:217], v230 offset:256
    v_mfma_f32_16x16x32_bf16 v[128:131], v[200:203], a[160:163], v[128:131]
    ds_read_b64_tr_b16 v[218:219], v230 offset:8448
    v_mfma_f32_16x16x32_bf16 v[136:139], v[200:203], a[164:167], v[136:139]
    s_waitcnt lgkmcnt(6)
    v_mfma_f32_16x16x32_bf16 v[124:127], v[204:207], a[156:159], v[124:127]
    ds_read_b64_tr_b16 v[220:221], v231 offset:256
    v_mfma_f32_16x16x32_bf16 v[132:135], v[204:207], a[160:163], v[132:135]
    ds_read_b64_tr_b16 v[222:223], v231 offset:8448
    v_mfma_f32_16x16x32_bf16 v[140:143], v[204:207], a[164:167], v[140:143]
    s_waitcnt lgkmcnt(6)
    buffer_load_dwordx4 v239, s[8:11], s37 offen offset:3072 sc1 nt lds
    v_mfma_f32_16x16x32_bf16 v[144:147], v[208:211], a[156:159], v[144:147]
    s_add_u32 s33, s33, 16384
    s_cmp_eq_u32 s33, 163840
    s_cselect_b32 s33, 0, s33
    v_mfma_f32_16x16x32_bf16 v[152:155], v[208:211], a[160:163], v[152:155]
    s_add_u32 s37, s37, 16384
    v_mfma_f32_16x16x32_bf16 v[160:163], v[208:211], a[164:167], v[160:163]
    s_waitcnt lgkmcnt(4)
    v_mfma_f32_16x16x32_bf16 v[148:151], v[212:215], a[156:159], v[148:151]
    v_mfma_f32_16x16x32_bf16 v[156:159], v[212:215], a[160:163], v[156:159]
    v_mfma_f32_16x16x32_bf16 v[164:167], v[212:215], a[164:167], v[164:167]
    s_waitcnt lgkmcnt(2)
    v_mfma_f32_16x16x32_bf16 v[168:171], v[216:219], a[156:159], v[168:171]
    v_mfma_f32_16x16x32_bf16 v[176:179], v[216:219], a[160:163], v[176:179]
    v_mfma_f32_16x16x32_bf16 v[184:187], v[216:219], a[164:167], v[184:187]
    s_waitcnt lgkmcnt(0)
    v_mfma_f32_16x16x32_bf16 v[172:175], v[220:223], a[156:159], v[172:175]
    v_mfma_f32_16x16x32_bf16 v[180:183], v[220:223], a[160:163], v[180:183]
    v_mfma_f32_16x16x32_bf16 v[188:191], v[220:223], a[164:167], v[188:191]
    s_nop 7
    .p2align 3
    v_pk_mul_f32 v[0:1], v[0:1], s[40:41]
    v_pk_mul_f32 v[2:3], v[2:3], s[40:41]
    v_pk_mul_f32 v[4:5], v[4:5], s[40:41]
    v_pk_mul_f32 v[6:7], v[6:7], s[40:41]
    v_cvt_pk_bf16_f32 v0, v0, v1
    v_cvt_pk_bf16_f32 v1, v2, v3
    v_cvt_pk_bf16_f32 v2, v4, v5
    v_cvt_pk_bf16_f32 v3, v6, v7
    v_pk_mul_f32 v[8:9], v[8:9], s[40:41]
    v_pk_mul_f32 v[10:11], v[10:11], s[40:41]
    v_pk_mul_f32 v[12:13], v[12:13], s[40:41]
    v_pk_mul_f32 v[14:15], v[14:15], s[40:41]
    v_cvt_pk_bf16_f32 v4, v8, v9
    v_cvt_pk_bf16_f32 v5, v10, v11
    v_cvt_pk_bf16_f32 v6, v12, v13
    v_cvt_pk_bf16_f32 v7, v14, v15
    v_permlane32_swap_b32 v0, v2
    v_permlane32_swap_b32 v1, v3
    v_pk_mul_f32 v[16:17], v[16:17], s[40:41]
    v_pk_mul_f32 v[18:19], v[18:19], s[40:41]
    v_pk_mul_f32 v[20:21], v[20:21], s[40:41]
    v_pk_mul_f32 v[22:23], v[22:23], s[40:41]
    v_cvt_pk_bf16_f32 v8, v16, v17
    v_cvt_pk_bf16_f32 v9, v18, v19
    v_cvt_pk_bf16_f32 v10, v20, v21
    v_cvt_pk_bf16_f32 v11, v22, v23
    v_permlane32_swap_b32 v4, v6
    v_permlane32_swap_b32 v5, v7
    v_permlane16_swap_b32 v0, v2
    v_permlane16_swap_b32 v1, v3
    v_pk_mul_f32 v[24:25], v[24:25], s[40:41]
    v_pk_mul_f32 v[26:27], v[26:27], s[40:41]
    v_pk_mul_f32 v[28:29], v[28:29], s[40:41]
    v_pk_mul_f32 v[30:31], v[30:31], s[40:41]
    v_cvt_pk_bf16_f32 v12, v24, v25
    v_cvt_pk_bf16_f32 v13, v26, v27
    v_cvt_pk_bf16_f32 v14, v28, v29
    v_cvt_pk_bf16_f32 v15, v30, v31
    v_permlane32_swap_b32 v8, v10
    v_permlane32_swap_b32 v9, v11
    v_permlane16_swap_b32 v4, v6
    v_permlane16_swap_b32 v5, v7
    v_pk_mul_f32 v[32:33], v[32:33], s[40:41]
    v_pk_mul_f32 v[34:35], v[34:35], s[40:41]
    v_pk_mul_f32 v[36:37], v[36:37], s[40:41]
    v_pk_mul_f32 v[38:39], v[38:39], s[40:41]
    v_cvt_pk_bf16_f32 v16, v32, v33
    v_cvt_pk_bf16_f32 v17, v34, v35
    v_cvt_pk_bf16_f32 v18, v36, v37
    v_cvt_pk_bf16_f32 v19, v38, v39
    v_permlane32_swap_b32 v12, v14
    v_permlane32_swap_b32 v13, v15
    v_permlane16_swap_b32 v8, v10
    v_permlane16_swap_b32 v9, v11
    v_pk_mul_f32 v[40:41], v[40:41], s[40:41]
    v_pk_mul_f32 v[42:43], v[42:43], s[40:41]
    v_pk_mul_f32 v[44:45], v[44:45], s[40:41]
    v_pk_mul_f32 v[46:47], v[46:47], s[40:41]
    v_cvt_pk_bf16_f32 v20, v40, v41
    v_cvt_pk_bf16_f32 v21, v42, v43
    v_cvt_pk_bf16_f32 v22, v44, v45
    v_cvt_pk_bf16_f32 v23, v46, v47
    v_permlane32_swap_b32 v16, v18
    v_permlane32_swap_b32 v17, v19
    v_permlane16_swap_b32 v12, v14
    v_permlane16_swap_b32 v13, v15
    v_pk_mul_f32 v[48:49], v[48:49], s[40:41]
    v_pk_mul_f32 v[50:51], v[50:51], s[40:41]
    v_pk_mul_f32 v[52:53], v[52:53], s[40:41]
    v_pk_mul_f32 v[54:55], v[54:55], s[40:41]
    v_cvt_pk_bf16_f32 v24, v48, v49
    v_cvt_pk_bf16_f32 v25, v50, v51
    v_cvt_pk_bf16_f32 v26, v52, v53
    v_cvt_pk_bf16_f32 v27, v54, v55
    v_permlane32_swap_b32 v20, v22
    v_permlane32_swap_b32 v21, v23
    v_permlane16_swap_b32 v16, v18
    v_permlane16_swap_b32 v17, v19
    v_pk_mul_f32 v[56:57], v[56:57], s[40:41]
    v_pk_mul_f32 v[58:59], v[58:59], s[40:41]
    v_pk_mul_f32 v[60:61], v[60:61], s[40:41]
    v_pk_mul_f32 v[62:63], v[62:63], s[40:41]
    v_cvt_pk_bf16_f32 v28, v56, v57
    v_cvt_pk_bf16_f32 v29, v58, v59
    v_cvt_pk_bf16_f32 v30, v60, v61
    v_cvt_pk_bf16_f32 v31, v62, v63
    v_permlane32_swap_b32 v24, v26
    v_permlane32_swap_b32 v25, v27
    v_permlane16_swap_b32 v20, v22
    v_permlane16_swap_b32 v21, v23
    v_pk_mul_f32 v[64:65], v[64:65], s[40:41]
    v_pk_mul_f32 v[66:67], v[66:67], s[40:41]
    v_pk_mul_f32 v[68:69], v[68:69], s[40:41]
    v_pk_mul_f32 v[70:71], v[70:71], s[40:41]
    v_cvt_pk_bf16_f32 v32, v64, v65
    v_cvt_pk_bf16_f32 v33, v66, v67
    v_cvt_pk_bf16_f32 v34, v68, v69
    v_cvt_pk_bf16_f32 v35, v70, v71
    v_permlane32_swap_b32 v28, v30
    v_permlane32_swap_b32 v29, v31
    v_permlane16_swap_b32 v24, v26
    v_permlane16_swap_b32 v25, v27
    v_pk_mul_f32 v[72:73], v[72:73], s[40:41]
    v_pk_mul_f32 v[74:75], v[74:75], s[40:41]
    v_pk_mul_f32 v[76:77], v[76:77], s[40:41]
    v_pk_mul_f32 v[78:79], v[78:79], s[40:41]
    v_cvt_pk_bf16_f32 v36, v72, v73
    v_cvt_pk_bf16_f32 v37, v74, v75
    v_cvt_pk_bf16_f32 v38, v76, v77
    v_cvt_pk_bf16_f32 v39, v78, v79
    v_permlane32_swap_b32 v32, v34
    v_permlane32_swap_b32 v33, v35
    v_permlane16_swap_b32 v28, v30
    v_permlane16_swap_b32 v29, v31
    v_pk_mul_f32 v[80:81], v[80:81], s[40:41]
    v_pk_mul_f32 v[82:83], v[82:83], s[40:41]
    v_pk_mul_f32 v[84:85], v[84:85], s[40:41]
    v_pk_mul_f32 v[86:87], v[86:87], s[40:41]
    v_cvt_pk_bf16_f32 v40, v80, v81
    v_cvt_pk_bf16_f32 v41, v82, v83
    v_cvt_pk_bf16_f32 v42, v84, v85
    v_cvt_pk_bf16_f32 v43, v86, v87
    v_permlane32_swap_b32 v36, v38
    v_permlane32_swap_b32 v37, v39
    v_permlane16_swap_b32 v32, v34
    v_permlane16_swap_b32 v33, v35
    v_pk_mul_f32 v[88:89], v[88:89], s[40:41]
    v_pk_mul_f32 v[90:91], v[90:91], s[40:41]
    v_pk_mul_f32 v[92:93], v[92:93], s[40:41]
    v_pk_mul_f32 v[94:95], v[94:95], s[40:41]
    v_cvt_pk_bf16_f32 v44, v88, v89
    v_cvt_pk_bf16_f32 v45, v90, v91
    v_cvt_pk_bf16_f32 v46, v92, v93
    v_cvt_pk_bf16_f32 v47, v94, v95
    v_permlane32_swap_b32 v40, v42
    v_permlane32_swap_b32 v41, v43
    v_permlane16_swap_b32 v36, v38
    v_permlane16_swap_b32 v37, v39
    v_pk_mul_f32 v[96:97], v[96:97], s[40:41]
    v_pk_mul_f32 v[98:99], v[98:99], s[40:41]
    v_pk_mul_f32 v[100:101], v[100:101], s[40:41]
    v_pk_mul_f32 v[102:103], v[102:103], s[40:41]
    v_cvt_pk_bf16_f32 v48, v96, v97
    v_cvt_pk_bf16_f32 v49, v98, v99
    v_cvt_pk_bf16_f32 v50, v100, v101
    v_cvt_pk_bf16_f32 v51, v102, v103
    v_permlane32_swap_b32 v44, v46
    v_permlane32_swap_b32 v45, v47
    v_permlane16_swap_b32 v40, v42
    v_permlane16_swap_b32 v41, v43
    v_pk_mul_f32 v[104:105], v[104:105], s[40:41]
    v_pk_mul_f32 v[106:107], v[106:107], s[40:41]
    v_pk_mul_f32 v[108:109], v[108:109], s[40:41]
    v_pk_mul_f32 v[110:111], v[110:111], s[40:41]
    v_cvt_pk_bf16_f32 v52, v104, v105
    v_cvt_pk_bf16_f32 v53, v106, v107
    v_cvt_pk_bf16_f32 v54, v108, v109
    v_cvt_pk_bf16_f32 v55, v110, v111
    v_permlane32_swap_b32 v48, v50
    v_permlane32_swap_b32 v49, v51
    v_permlane16_swap_b32 v44, v46
    v_permlane16_swap_b32 v45, v47
    v_pk_mul_f32 v[112:113], v[112:113], s[40:41]
    v_pk_mul_f32 v[114:115], v[114:115], s[40:41]
    v_pk_mul_f32 v[116:117], v[116:117], s[40:41]
    v_pk_mul_f32 v[118:119], v[118:119], s[40:41]
    v_cvt_pk_bf16_f32 v56, v112, v113
    v_cvt_pk_bf16_f32 v57, v114, v115
    v_cvt_pk_bf16_f32 v58, v116, v117
    v_cvt_pk_bf16_f32 v59, v118, v119
    v_permlane32_swap_b32 v52, v54
    v_permlane32_swap_b32 v53, v55
    v_permlane16_swap_b32 v48, v50
    v_permlane16_swap_b32 v49, v51
    v_pk_mul_f32 v[120:121], v[120:121], s[40:41]
    v_pk_mul_f32 v[122:123], v[122:123], s[40:41]
    v_pk_mul_f32 v[124:125], v[124:125], s[40:41]
    v_pk_mul_f32 v[126:127], v[126:127], s[40:41]
    v_cvt_pk_bf16_f32 v60, v120, v121
    v_cvt_pk_bf16_f32 v61, v122, v123
    v_cvt_pk_bf16_f32 v62, v124, v125
    v_cvt_pk_bf16_f32 v63, v126, v127
    v_permlane32_swap_b32 v56, v58
    v_permlane32_swap_b32 v57, v59
    v_permlane16_swap_b32 v52, v54
    v_permlane16_swap_b32 v53, v55
    v_pk_mul_f32 v[128:129], v[128:129], s[40:41]
    v_pk_mul_f32 v[130:131], v[130:131], s[40:41]
    v_pk_mul_f32 v[132:133], v[132:133], s[40:41]
    v_pk_mul_f32 v[134:135], v[134:135], s[40:41]
    v_cvt_pk_bf16_f32 v64, v128, v129
    v_cvt_pk_bf16_f32 v65, v130, v131
    v_cvt_pk_bf16_f32 v66, v132, v133
    v_cvt_pk_bf16_f32 v67, v134, v135
    v_permlane32_swap_b32 v60, v62
    v_permlane32_swap_b32 v61, v63
    v_permlane16_swap_b32 v56, v58
    v_permlane16_swap_b32 v57, v59
    v_pk_mul_f32 v[136:137], v[136:137], s[40:41]
    v_pk_mul_f32 v[138:139], v[138:139], s[40:41]
    v_pk_mul_f32 v[140:141], v[140:141], s[40:41]
    v_pk_mul_f32 v[142:143], v[142:143], s[40:41]
    v_cvt_pk_bf16_f32 v68, v136, v137
    v_cvt_pk_bf16_f32 v69, v138, v139
    v_cvt_pk_bf16_f32 v70, v140, v141
    v_cvt_pk_bf16_f32 v71, v142, v143
    v_permlane32_swap_b32 v64, v66
    v_permlane32_swap_b32 v65, v67
    v_permlane16_swap_b32 v60, v62
    v_permlane16_swap_b32 v61, v63
    v_pk_mul_f32 v[144:145], v[144:145], s[40:41]
    v_pk_mul_f32 v[146:147], v[146:147], s[40:41]
    v_pk_mul_f32 v[148:149], v[148:149], s[40:41]
    v_pk_mul_f32 v[150:151], v[150:151], s[40:41]
    v_cvt_pk_bf16_f32 v72, v144, v145
    v_cvt_pk_bf16_f32 v73, v146, v147
    v_cvt_pk_bf16_f32 v74, v148, v149
    v_cvt_pk_bf16_f32 v75, v150, v151
    v_permlane32_swap_b32 v68, v70
    v_permlane32_swap_b32 v69, v71
    v_permlane16_swap_b32 v64, v66
    v_permlane16_swap_b32 v65, v67
    v_pk_mul_f32 v[152:153], v[152:153], s[40:41]
    v_pk_mul_f32 v[154:155], v[154:155], s[40:41]
    v_pk_mul_f32 v[156:157], v[156:157], s[40:41]
    v_pk_mul_f32 v[158:159], v[158:159], s[40:41]
    v_cvt_pk_bf16_f32 v76, v152, v153
    v_cvt_pk_bf16_f32 v77, v154, v155
    v_cvt_pk_bf16_f32 v78, v156, v157
    v_cvt_pk_bf16_f32 v79, v158, v159
    v_permlane32_swap_b32 v72, v74
    v_permlane32_swap_b32 v73, v75
    v_permlane16_swap_b32 v68, v70
    v_permlane16_swap_b32 v69, v71
    v_pk_mul_f32 v[160:161], v[160:161], s[40:41]
    v_pk_mul_f32 v[162:163], v[162:163], s[40:41]
    v_pk_mul_f32 v[164:165], v[164:165], s[40:41]
    v_pk_mul_f32 v[166:167], v[166:167], s[40:41]
    v_cvt_pk_bf16_f32 v80, v160, v161
    v_cvt_pk_bf16_f32 v81, v162, v163
    v_cvt_pk_bf16_f32 v82, v164, v165
    v_cvt_pk_bf16_f32 v83, v166, v167
    v_permlane32_swap_b32 v76, v78
    v_permlane32_swap_b32 v77, v79
    v_permlane16_swap_b32 v72, v74
    v_permlane16_swap_b32 v73, v75
    v_pk_mul_f32 v[168:169], v[168:169], s[40:41]
    v_pk_mul_f32 v[170:171], v[170:171], s[40:41]
    v_pk_mul_f32 v[172:173], v[172:173], s[40:41]
    v_pk_mul_f32 v[174:175], v[174:175], s[40:41]
    v_cvt_pk_bf16_f32 v84, v168, v169
    v_cvt_pk_bf16_f32 v85, v170, v171
    v_cvt_pk_bf16_f32 v86, v172, v173
    v_cvt_pk_bf16_f32 v87, v174, v175
    v_permlane32_swap_b32 v80, v82
    v_permlane32_swap_b32 v81, v83
    v_permlane16_swap_b32 v76, v78
    v_permlane16_swap_b32 v77, v79
    v_pk_mul_f32 v[176:177], v[176:177], s[40:41]
    v_pk_mul_f32 v[178:179], v[178:179], s[40:41]
    v_pk_mul_f32 v[180:181], v[180:181], s[40:41]
    v_pk_mul_f32 v[182:183], v[182:183], s[40:41]
    v_cvt_pk_bf16_f32 v88, v176, v177
    v_cvt_pk_bf16_f32 v89, v178, v179
    v_cvt_pk_bf16_f32 v90, v180, v181
    v_cvt_pk_bf16_f32 v91, v182, v183
    v_permlane32_swap_b32 v84, v86
    v_permlane32_swap_b32 v85, v87
    v_permlane16_swap_b32 v80, v82
    v_permlane16_swap_b32 v81, v83
    v_pk_mul_f32 v[184:185], v[184:185], s[40:41]
    v_pk_mul_f32 v[186:187], v[186:187], s[40:41]
    v_pk_mul_f32 v[188:189], v[188:189], s[40:41]
    v_pk_mul_f32 v[190:191], v[190:191], s[40:41]
    v_cvt_pk_bf16_f32 v92, v184, v185
    v_cvt_pk_bf16_f32 v93, v186, v187
    v_cvt_pk_bf16_f32 v94, v188, v189
    v_cvt_pk_bf16_f32 v95, v190, v191
    v_permlane32_swap_b32 v88, v90
    v_permlane32_swap_b32 v89, v91
    v_permlane16_swap_b32 v84, v86
    v_permlane16_swap_b32 v85, v87
    s_nop 1
    v_permlane32_swap_b32 v92, v94
    v_permlane32_swap_b32 v93, v95
    v_permlane16_swap_b32 v88, v90
    v_permlane16_swap_b32 v89, v91
    s_nop 1
    v_permlane16_swap_b32 v92, v94
    v_permlane16_swap_b32 v93, v95
    s_nop 1
L_at:
    s_mov_b32 s30, s7
    s_waitcnt vmcnt(28)
    s_barrier
    ds_read_b128 v[192:195], v232 offset:0
    ds_read_b128 v[196:199], v233 offset:0
    ds_read_b128 v[200:203], v234 offset:0
    ds_read_b128 v[204:207], v235 offset:0
    s_waitcnt lgkmcnt(3)
    v_mfma_f32_16x16x32_bf16 v[96:99], v[192:195], v[0:3], 0
    s_add_u32 s34, s34, 16384
    s_cmp_eq_u32 s34, 163840
    s_cselect_b32 s34, 0, s34
    ds_read_b128 v[208:211], v232 offset:256
    v_mfma_f32_16x16x32_bf16 v[100:103], v[192:195], v[4:7], 0
    s_sub_u32 s50, s34, s36
    v_mfma_f32_16x16x32_bf16 v[104:107], v[192:195], v[8:11], 0
    s_waitcnt lgkmcnt(3)
    v_mfma_f32_16x16x32_bf16 v[96:99], v[196:199], v[12:15], v[96:99]
    s_mov_b32 s36, s34
    ds_read_b128 v[212:215], v233 offset:256
    v_mfma_f32_16x16x32_bf16 v[100:103], v[196:199], v[16:19], v[100:103]
    s_add_u32 m0, s33, s32
    buffer_load_dwordx4 v236, s[12:15], s38 offen offset:0 sc1 nt lds
    v_mfma_f32_16x16x32_bf16 v[104:107], v[196:199], v[20:23], v[104:107]
    s_waitcnt lgkmcnt(3)
    v_mfma_f32_16x16x32_bf16 v[96:99], v[200:203], v[24:27], v[96:99]
    ds_read_b128 v[216:219], v234 offset:256
    v_mfma_f32_16x16x32_bf16 v[100:103], v[200:203], v[28:31], v[100:103]
    v_mfma_f32_16x16x32_bf16 v[104:107], v[200:203], v[32:35], v[104:107]
    s_waitcnt lgkmcnt(3)
    v_mfma_f32_16x16x32_bf16 v[96:99], v[204:207], v[36:39], v[96:99]
    ds_read_b128 v[220:223], v235 offset:256
    v_mfma_f32_16x16x32_bf16 v[100:103], v[204:207], v[40:43], v[100:103]
    v_mfma_f32_16x16x32_bf16 v[104:107], v[204:207], v[44:47], v[104:107]
    s_waitcnt lgkmcnt(3)
    v_mfma_f32_16x16x32_bf16 v[96:99], v[208:211], v[48:51], v[96:99]
    ds_read_b128 v[192:195], v232 offset:8192
    v_mfma_f32_16x16x32_bf16 v[100:103], v[208:211], v[52:55], v[100:103]
    v_mfma_f32_16x16x32_bf16 v[104:107], v[208:211], v[56:59], v[104:107]
    s_waitcnt lgkmcnt(3)
    buffer_load_dwordx4 v237, s[12:15], s38 offen offset:1024 sc1 nt lds
    v_mfma_f32_16x16x32_bf16 v[96:99], v[212:215], v[60:63], v[96:99]
    ds_read_b128 v[196:199], v233 offset:8192
    v_mfma_f32_16x16x32_bf16 v[100:103], v[212:215], v[64:67], v[100:103]
    v_mfma_f32_16x16x32_bf16 v[104:107], v[212:215], v[68:71], v[104:107]
    s_waitcnt lgkmcnt(3)
    v_mfma_f32_16x16x32_bf16 v[96:99], v[216:219], v[72:75], v[96:99]
    ds_read_b128 v[200:203], v234 offset:8192
    v_mfma_f32_16x16x32_bf16 v[100:103], v[216:219], v[76:79], v[100:103]
    v_mfma_f32_16x16x32_bf16 v[104:107], v[216:219], v[80:83], v[104:107]
    s_waitcnt lgkmcnt(3)
    v_mfma_f32_16x16x32_bf16 v[96:99], v[220:223], v[84:87], v[96:99]
    ds_read_b128 v[204:207], v235 offset:8192
    v_mfma_f32_16x16x32_bf16 v[100:103], v[220:223], v[88:91], v[100:103]
    v_mfma_f32_16x16x32_bf16 v[104:107], v[220:223], v[92:95], v[104:107]
    s_waitcnt lgkmcnt(3)
    v_mfma_f32_16x16x32_bf16 v[108:111], v[192:195], v[0:3], 0
    ds_read_b128 v[208:211], v232 offset:8448
    v_mfma_f32_16x16x32_bf16 v[112:115], v[192:195], v[4:7], 0
    v_add_u32 v232, s50, v232
    v_mfma_f32_16x16x32_bf16 v[116:119], v[192:195], v[8:11], 0
    s_waitcnt lgkmcnt(3)
    buffer_load_dwordx4 v238, s[12:15], s38 offen offset:2048 sc1 nt lds
    v_mfma_f32_16x16x32_bf16 v[108:111], v[196:199], v[12:15], v[108:111]
    ds_read_b128 v[212:215], v233 offset:8448
    v_mfma_f32_16x16x32_bf16 v[112:115], v[196:199], v[16:19], v[112:115]
    v_add_u32 v233, s50, v233
    v_mfma_f32_16x16x32_bf16 v[116:119], v[196:199], v[20:23], v[116:119]
    s_waitcnt lgkmcnt(3)
    v_mfma_f32_16x16x32_bf16 v[108:111], v[200:203], v[24:27], v[108:111]
    ds_read_b128 v[216:219], v234 offset:8448
    v_mfma_f32_16x16x32_bf16 v[112:115], v[200:203], v[28:31], v[112:115]
    v_add_u32 v234, s50, v234
    v_mfma_f32_16x16x32_bf16 v[116:119], v[200:203], v[32:35], v[116:119]
    s_waitcnt lgkmcnt(3)
    v_mfma_f32_16x16x32_bf16 v[108:111], v[204:207], v[36:39], v[108:111]
    ds_read_b128 v[220:223], v235 offset:8448
    v_mfma_f32_16x16x32_bf16 v[112:115], v[204:207], v[40:43], v[112:115]
    v_add_u32 v235, s50, v235
    v_mfma_f32_16x16x32_bf16 v[116:119], v[204:207], v[44:47], v[116:119]
    s_waitcnt lgkmcnt(3)
    s_waitcnt vmcnt(27)
    s_barrier
    buffer_load_dwordx4 v239, s[12:15], s38 offen offset:3072 sc1 nt lds
    v_mfma_f32_16x16x32_bf16 v[108:111], v[208:211], v[48:51], v[108:111]
    s_add_u32 s33, s33, 16384
    s_cmp_eq_u32 s33, 163840
    s_cselect_b32 s33, 0, s33
    ds_read_b128 v[192:195], v232 offset:0
    v_mfma_f32_16x16x32_bf16 v[112:115], v[208:211], v[52:55], v[112:115]
    s_add_u32 s38, s38, 16384
    v_mfma_f32_16x16x32_bf16 v[116:119], v[208:211], v[56:59], v[116:119]
    s_waitcnt lgkmcnt(3)
    v_mfma_f32_16x16x32_bf16 v[108:111], v[212:215], v[60:63], v[108:111]
    ds_read_b128 v[196:199], v233 offset:0
    v_mfma_f32_16x16x32_bf16 v[112:115], v[212:215], v[64:67], v[112:115]
    v_mfma_f32_16x16x32_bf16 v[116:119], v[212:215], v[68:71], v[116:119]
    s_waitcnt lgkmcnt(3)
    v_mfma_f32_16x16x32_bf16 v[108:111], v[216:219], v[72:75], v[108:111]
    ds_read_b128 v[200:203], v234 offset:0
    v_mfma_f32_16x16x32_bf16 v[112:115], v[216:219], v[76:79], v[112:115]
    v_mfma_f32_16x16x32_bf16 v[116:119], v[216:219], v[80:83], v[116:119]
    s_waitcnt lgkmcnt(3)
    v_mfma_f32_16x16x32_bf16 v[108:111], v[220:223], v[84:87], v[108:111]
    ds_read_b128 v[204:207], v235 offset:0
    v_mfma_f32_16x16x32_bf16 v[112:115], v[220:223], v[88:91], v[112:115]
    v_mfma_f32_16x16x32_bf16 v[116:119], v[220:223], v[92:95], v[116:119]
    s_waitcnt lgkmcnt(3)
    s_nop 7
    v_max3_f32 v168, v96, v97, v98
    v_max3_f32 v170, v100, v101, v102
    v_max3_f32 v172, v104, v105, v106
    v_max3_f32 v168, v168, v99, v108
    v_max3_f32 v170, v170, v103, v112
    v_max3_f32 v172, v172, v107, v116
    v_max3_f32 v168, v168, v109, v110
    v_max3_f32 v170, v170, v113, v114
    v_max3_f32 v172, v172, v117, v118
    v_max_f32 v168, v168, v111
    v_max_f32 v170, v170, v115
    v_max_f32 v172, v172, v119
    v_mov_b32 v169, v168
    v_mov_b32 v171, v170
    v_mov_b32 v173, v172
    v_permlane32_swap_b32 v168, v169
    v_permlane32_swap_b32 v170, v171
    v_permlane32_swap_b32 v172, v173
    v_max_f32 v168, v168, v169
    v_max_f32 v170, v170, v171
    v_max_f32 v172, v172, v173
    v_mov_b32 v169, v168
    v_mov_b32 v171, v170
    v_mov_b32 v173, v172
    v_permlane16_swap_b32 v168, v169
    v_permlane16_swap_b32 v170, v171
    v_permlane16_swap_b32 v172, v173
    v_max_f32 v168, v168, v169
    v_max_f32 v170, v170, v171
    v_max_f32 v172, v172, v173
    v_add_f32 v168, s51, v168
    v_add_f32 v170, s51, v170
    v_add_f32 v172, s51, v172
    v_sub_f32 v176, 0, v168
    v_sub_f32 v177, 0, v168
    v_sub_f32 v178, 0, v168
    v_sub_f32 v179, 0, v168
    v_sub_f32 v96, v96, v168
    v_sub_f32 v97, v97, v168
    v_sub_f32 v98, v98, v168
    v_sub_f32 v99, v99, v168
    v_sub_f32 v108, v108, v168
    v_sub_f32 v109, v109, v168
    v_sub_f32 v110, v110, v168
    v_sub_f32 v111, v111, v168
    v_sub_f32 v180, 0, v170
    v_sub_f32 v181, 0, v170
    v_sub_f32 v182, 0, v170
    v_sub_f32 v183, 0, v170
    v_sub_f32 v100, v100, v170
    v_sub_f32 v101, v101, v170
    v_sub_f32 v102, v102, v170
    v_sub_f32 v103, v103, v170
    v_sub_f32 v112, v112, v170
    v_sub_f32 v113, v113, v170
    v_sub_f32 v114, v114, v170
    v_sub_f32 v115, v115, v170
    v_sub_f32 v184, 0, v172
    v_sub_f32 v185, 0, v172
    v_sub_f32 v186, 0, v172
    v_sub_f32 v187, 0, v172
    v_sub_f32 v104, v104, v172
    v_sub_f32 v105, v105, v172
    v_sub_f32 v106, v106, v172
    v_sub_f32 v107, v107, v172
    v_sub_f32 v116, v116, v172
    v_sub_f32 v117, v117, v172
    v_sub_f32 v118, v118, v172
    v_sub_f32 v119, v119, v172
    s_nop 1
    v_mfma_f32_16x16x32_bf16 v[120:123], v[192:195], v[0:3], v[176:179]
    s_add_u32 s34, s34, 16384
    s_cmp_eq_u32 s34, 163840
    s_cselect_b32 s34, 0, s34
    ds_read_b128 v[208:211], v232 offset:256
    v_mfma_f32_16x16x32_bf16 v[124:127], v[192:195], v[4:7], v[180:183]
    s_sub_u32 s50, s34, s35
    v_exp_f32 v168, v96
    v_mfma_f32_16x16x32_bf16 v[128:131], v[192:195], v[8:11], v[184:187]
    s_waitcnt lgkmcnt(3)
    v_exp_f32 v169, v97
    v_mfma_f32_16x16x32_bf16 v[120:123], v[196:199], v[12:15], v[120:123]
    s_mov_b32 s35, s34
    ds_read_b128 v[212:215], v233 offset:256
    v_mfma_f32_16x16x32_bf16 v[124:127], v[196:199], v[16:19], v[124:127]
    s_add_u32 m0, s33, s32
    v_add_u32 v224, s50, v224
    v_add_u32 v225, s50, v225
    v_mfma_f32_16x16x32_bf16 v[128:131], v[196:199], v[20:23], v[128:131]
    s_waitcnt lgkmcnt(3)
    v_add_u32 v226, s50, v226
    v_add_u32 v227, s50, v227
    v_mfma_f32_16x16x32_bf16 v[120:123], v[200:203], v[24:27], v[120:123]
    ds_read_b128 v[216:219], v234 offset:256
    v_add_u32 v228, s50, v228
    v_mfma_f32_16x16x32_bf16 v[124:127], v[200:203], v[28:31], v[124:127]
    v_add_u32 v229, s50, v229
    v_add_u32 v230, s50, v230
    v_mfma_f32_16x16x32_bf16 v[128:131], v[200:203], v[32:35], v[128:131]
    s_waitcnt lgkmcnt(3)
    v_add_u32 v231, s50, v231
    v_mfma_f32_16x16x32_bf16 v[120:123], v[204:207], v[36:39], v[120:123]
    ds_read_b128 v[220:223], v235 offset:256
    v_mfma_f32_16x16x32_bf16 v[124:127], v[204:207], v[40:43], v[124:127]
    buffer_load_dwordx4 v236, s[8:11], s37 offen offset:0 sc1 nt lds
    v_mfma_f32_16x16x32_bf16 v[128:131], v[204:207], v[44:47], v[128:131]
    s_waitcnt lgkmcnt(3)
    v_exp_f32 v170, v98
    v_mfma_f32_16x16x32_bf16 v[120:123], v[208:211], v[48:51], v[120:123]
    ds_read_b128 v[192:195], v232 offset:8192
    v_cvt_pk_bf16_f32 v144, v168, v169
    v_mfma_f32_16x16x32_bf16 v[124:127], v[208:211], v[52:55], v[124:127]
    v_exp_f32 v171, v99
    v_mfma_f32_16x16x32_bf16 v[128:131], v[208:211], v[56:59], v[128:131]
    s_waitcnt lgkmcnt(3)
    buffer_load_dwordx4 v237, s[8:11], s37 offen offset:1024 sc1 nt lds
    v_mfma_f32_16x16x32_bf16 v[120:123], v[212:215], v[60:63], v[120:123]
    ds_read_b128 v[196:199], v233 offset:8192
    v_mfma_f32_16x16x32_bf16 v[124:127], v[212:215], v[64:67], v[124:127]
    v_exp_f32 v172, v100
    v_mfma_f32_16x16x32_bf16 v[128:131], v[212:215], v[68:71], v[128:131]
    s_waitcnt lgkmcnt(3)
    v_cvt_pk_bf16_f32 v145, v170, v171
    v_mfma_f32_16x16x32_bf16 v[120:123], v[216:219], v[72:75], v[120:123]
    ds_read_b128 v[200:203], v234 offset:8192
    v_mfma_f32_16x16x32_bf16 v[124:127], v[216:219], v[76:79], v[124:127]
    v_exp_f32 v173, v101
    v_mfma_f32_16x16x32_bf16 v[128:131], v[216:219], v[80:83], v[128:131]
    s_waitcnt lgkmcnt(3)
    v_exp_f32 v174, v102
    v_mfma_f32_16x16x32_bf16 v[120:123], v[220:223], v[84:87], v[120:123]
    ds_read_b128 v[204:207], v235 offset:8192
    v_cvt_pk_bf16_f32 v148, v172, v173
    v_mfma_f32_16x16x32_bf16 v[124:127], v[220:223], v[88:91], v[124:127]
    v_exp_f32 v175, v103
    v_mfma_f32_16x16x32_bf16 v[128:131], v[220:223], v[92:95], v[128:131]
    s_waitcnt lgkmcnt(3)
    v_exp_f32 v168, v104
    v_mfma_f32_16x16x32_bf16 v[132:135], v[192:195], v[0:3], v[176:179]
    ds_read_b128 v[208:211], v232 offset:8448
    v_cvt_pk_bf16_f32 v149, v174, v175
    v_mfma_f32_16x16x32_bf16 v[136:139], v[192:195], v[4:7], v[180:183]
    buffer_load_dwordx4 v238, s[8:11], s37 offen offset:2048 sc1 nt lds
    v_mfma_f32_16x16x32_bf16 v[140:143], v[192:195], v[8:11], v[184:187]
    s_waitcnt lgkmcnt(3)
    v_exp_f32 v169, v105
    v_mfma_f32_16x16x32_bf16 v[132:135], v[196:199], v[12:15], v[132:135]
    ds_read_b128 v[212:215], v233 offset:8448
    v_mfma_f32_16x16x32_bf16 v[136:139], v[196:199], v[16:19], v[136:139]
    v_exp_f32 v170, v106
    v_mfma_f32_16x16x32_bf16 v[140:143], v[196:199], v[20:23], v[140:143]
    s_waitcnt lgkmcnt(3)
    v_cvt_pk_bf16_f32 v152, v168, v169
    v_mfma_f32_16x16x32_bf16 v[132:135], v[200:203], v[24:27], v[132:135]
    ds_read_b128 v[216:219], v234 offset:8448
    v_mfma_f32_16x16x32_bf16 v[136:139], v[200:203], v[28:31], v[136:139]
    v_exp_f32 v171, v107
    v_mfma_f32_16x16x32_bf16 v[140:143], v[200:203], v[32:35], v[140:143]
    s_waitcnt lgkmcnt(3)
    v_exp_f32 v172, v108
    v_mfma_f32_16x16x32_bf16 v[132:135], v[204:207], v[36:39], v[132:135]
    ds_read_b128 v[220:223], v235 offset:8448
    v_cvt_pk_bf16_f32 v153, v170, v171
    v_mfma_f32_16x16x32_bf16 v[136:139], v[204:207], v[40:43], v[136:139]
    buffer_load_dwordx4 v239, s[8:11], s37 offen offset:3072 sc1 nt lds
    v_mfma_f32_16x16x32_bf16 v[140:143], v[204:207], v[44:47], v[140:143]
    s_waitcnt lgkmcnt(3)
    s_waitcnt vmcnt(28)
    s_barrier
    v_exp_f32 v173, v109
    v_mfma_f32_16x16x32_bf16 v[132:135], v[208:211], v[48:51], v[132:135]
    s_add_u32 s33, s33, 16384
    s_cmp_eq_u32 s33, 163840
    s_cselect_b32 s33, 0, s33
    ds_read_b64_tr_b16 v[192:193], v224 offset:0
    ds_read_b64_tr_b16 v[194:195], v224 offset:8192
    v_mfma_f32_16x16x32_bf16 v[136:139], v[208:211], v[52:55], v[136:139]
    s_add_u32 s37, s37, 16384
    v_exp_f32 v174, v110
    v_mfma_f32_16x16x32_bf16 v[140:143], v[208:211], v[56:59], v[140:143]
    s_waitcnt lgkmcnt(4)
    v_cvt_pk_bf16_f32 v146, v172, v173
    v_mfma_f32_16x16x32_bf16 v[132:135], v[212:215], v[60:63], v[132:135]
    ds_read_b64_tr_b16 v[196:197], v225 offset:0
    ds_read_b64_tr_b16 v[198:199], v225 offset:8192
    v_mfma_f32_16x16x32_bf16 v[136:139], v[212:215], v[64:67], v[136:139]
    v_exp_f32 v175, v111
    v_mfma_f32_16x16x32_bf16 v[140:143], v[212:215], v[68:71], v[140:143]
    s_waitcnt lgkmcnt(5)
    v_exp_f32 v168, v112
    v_mfma_f32_16x16x32_bf16 v[132:135], v[216:219], v[72:75], v[132:135]
    ds_read_b64_tr_b16 v[200:201], v226 offset:0
    ds_read_b64_tr_b16 v[202:203], v226 offset:8192
    v_mfma_f32_16x16x32_bf16 v[136:139], v[216:219], v[76:79], v[136:139]
    v_cvt_pk_bf16_f32 v147, v174, v175
    v_mfma_f32_16x16x32_bf16 v[140:143], v[216:219], v[80:83], v[140:143]
    s_waitcnt lgkmcnt(6)
    v_exp_f32 v169, v113
    v_mfma_f32_16x16x32_bf16 v[132:135], v[220:223], v[84:87], v[132:135]
    ds_read_b64_tr_b16 v[204:205], v227 offset:0
    ds_read_b64_tr_b16 v[206:207], v227 offset:8192
    v_mfma_f32_16x16x32_bf16 v[136:139], v[220:223], v[88:91], v[136:139]
    v_exp_f32 v170, v114
    v_mfma_f32_16x16x32_bf16 v[140:143], v[220:223], v[92:95], v[140:143]
    s_waitcnt lgkmcnt(6)
    v_cvt_pk_bf16_f32 v150, v168, v169
    v_exp_f32 v171, v115
    v_exp_f32 v172, v116
    v_cvt_pk_bf16_f32 v151, v170, v171
    v_exp_f32 v173, v117
    v_exp_f32 v174, v118
    v_cvt_pk_bf16_f32 v154, v172, v173
    v_exp_f32 v175, v119
    v_or3_b32 v188, v144, v145, v148
    v_cvt_pk_bf16_f32 v155, v174, v175
    v_or3_b32 v188, v188, v149, v152
    v_or3_b32 v188, v188, v153, v146
    v_or3_b32 v188, v188, v147, v150
    v_or3_b32 v188, v188, v151, v154
    v_or_b32 v188, v188, v155
    v_and_b32 v188, 0x40004000, v188
    v_cmp_ne_u32 vcc, 0, v188
    v_mfma_f32_16x16x32_bf16 a[192:195], a[204:207], v[144:147], 0
    v_mfma_f32_16x16x32_bf16 a[196:199], a[204:207], v[148:151], 0
    v_mfma_f32_16x16x32_bf16 a[200:203], a[204:207], v[152:155], 0
    v_mfma_f32_16x16x32_bf16 a[0:3], v[192:195], v[144:147], 0
    s_add_u32 s34, s34, 16384
    s_cmp_eq_u32 s34, 163840
    s_cselect_b32 s34, 0, s34
    ds_read_b64_tr_b16 v[208:209], v228 offset:0
    ds_read_b64_tr_b16 v[210:211], v228 offset:8192
    v_mfma_f32_16x16x32_bf16 a[4:7], v[192:195], v[148:151], 0
    s_sub_u32 s50, s34, s36
    v_exp_f32 v168, v120
    v_mfma_f32_16x16x32_bf16 a[8:11], v[192:195], v[152:155], 0
    s_waitcnt lgkmcnt(6)
    v_exp_f32 v169, v121
    v_mfma_f32_16x16x32_bf16 a[12:15], v[196:199], v[144:147], 0
    s_mov_b32 s36, s34
    ds_read_b64_tr_b16 v[212:213], v229 offset:0
    ds_read_b64_tr_b16 v[214:215], v229 offset:8192
    v_mfma_f32_16x16x32_bf16 a[16:19], v[196:199], v[148:151], 0
    s_add_u32 m0, s33, s32
    v_add_u32 v232, s50, v232
    v_add_u32 v233, s50, v233
    v_mfma_f32_16x16x32_bf16 a[20:23], v[196:199], v[152:155], 0
    s_waitcnt lgkmcnt(6)
    v_add_u32 v234, s50, v234
    v_add_u32 v235, s50, v235
    v_mfma_f32_16x16x32_bf16 a[24:27], v[200:203], v[144:147], 0
    ds_read_b64_tr_b16 v[216:217], v230 offset:0
    ds_read_b64_tr_b16 v[218:219], v230 offset:8192
    v_mfma_f32_16x16x32_bf16 a[28:31], v[200:203], v[148:151], 0
    buffer_load_dwordx4 v236, s[12:15], s38 offen offset:0 sc1 nt lds
    v_mfma_f32_16x16x32_bf16 a[32:35], v[200:203], v[152:155], 0
    s_waitcnt lgkmcnt(6)
    v_exp_f32 v170, v122
    v_mfma_f32_16x16x32_bf16 a[36:39], v[204:207], v[144:147], 0
    ds_read_b64_tr_b16 v[220:221], v231 offset:0
    ds_read_b64_tr_b16 v[222:223], v231 offset:8192
    v_mfma_f32_16x16x32_bf16 a[40:43], v[204:207], v[148:151], 0
    v_cvt_pk_bf16_f32 v156, v168, v169
    v_mfma_f32_16x16x32_bf16 a[44:47], v[204:207], v[152:155], 0
    s_waitcnt lgkmcnt(6)
    v_exp_f32 v171, v123
    v_mfma_f32_16x16x32_bf16 a[48:51], v[208:211], v[144:147], 0
    ds_read_b64_tr_b16 v[192:193], v224 offset:256
    ds_read_b64_tr_b16 v[194:195], v224 offset:8448
    v_mfma_f32_16x16x32_bf16 a[52:55], v[208:211], v[148:151], 0
    v_exp_f32 v172, v124
    v_mfma_f32_16x16x32_bf16 a[56:59], v[208:211], v[152:155], 0
    s_waitcnt lgkmcnt(6)
    buffer_load_dwordx4 v237, s[12:15], s38 offen offset:1024 sc1 nt lds
    v_mfma_f32_16x16x32_bf16 a[60:63], v[212:215], v[144:147], 0
    ds_read_b64_tr_b16 v[196:197], v225 offset:256
    ds_read_b64_tr_b16 v[198:199], v225 offset:8448
    v_mfma_f32_16x16x32_bf16 a[64:67], v[212:215], v[148:151], 0
    v_cvt_pk_bf16_f32 v157, v170, v171
    v_mfma_f32_16x16x32_bf16 a[68:71], v[212:215], v[152:155], 0
    s_waitcnt lgkmcnt(6)
    v_exp_f32 v173, v125
    v_mfma_f32_16x16x32_bf16 a[72:75], v[216:219], v[144:147], 0
    ds_read_b64_tr_b16 v[200:201], v226 offset:256
    ds_read_b64_tr_b16 v[202:203], v226 offset:8448
    v_mfma_f32_16x16x32_bf16 a[76:79], v[216:219], v[148:151], 0
    v_exp_f32 v174, v126
    v_mfma_f32_16x16x32_bf16 a[80:83], v[216:219], v[152:155], 0
    s_waitcnt lgkmcnt(6)
    v_cvt_pk_bf16_f32 v160, v172, v173
    v_mfma_f32_16x16x32_bf16 a[84:87], v[220:223], v[144:147], 0
    ds_read_b64_tr_b16 v[204:205], v227 offset:256
    ds_read_b64_tr_b16 v[206:207], v227 offset:8448
    v_mfma_f32_16x16x32_bf16 a[88:91], v[220:223], v[148:151], 0
    v_exp_f32 v175, v127
    v_mfma_f32_16x16x32_bf16 a[92:95], v[220:223], v[152:155], 0
    s_waitcnt lgkmcnt(6)
    v_exp_f32 v168, v128
    v_mfma_f32_16x16x32_bf16 a[96:99], v[192:195], v[144:147], 0
    ds_read_b64_tr_b16 v[208:209], v228 offset:256
    ds_read_b64_tr_b16 v[210:211], v228 offset:8448
    v_mfma_f32_16x16x32_bf16 a[100:103], v[192:195], v[148:151], 0
    buffer_load_dwordx4 v238, s[12:15], s38 offen offset:2048 sc1 nt lds
    v_mfma_f32_16x16x32_bf16 a[104:107], v[192:195], v[152:155], 0
    s_waitcnt lgkmcnt(6)
    v_cvt_pk_bf16_f32 v161, v174, v175
    v_mfma_f32_16x16x32_bf16 a[108:111], v[196:199], v[144:147], 0
    ds_read_b64_tr_b16 v[212:213], v229 offset:256
    ds_read_b64_tr_b16 v[214:215], v229 offset:8448
    v_mfma_f32_16x16x32_bf16 a[112:115], v[196:199], v[148:151], 0
    v_exp_f32 v169, v129
    v_mfma_f32_16x16x32_bf16 a[116:119], v[196:199], v[152:155], 0
    s_waitcnt lgkmcnt(6)
    v_exp_f32 v170, v130
    v_mfma_f32_16x16x32_bf16 a[120:123], v[200:203], v[144:147], 0
    ds_read_b64_tr_b16 v[216:217], v230 offset:256
    ds_read_b64_tr_b16 v[218:219], v230 offset:8448
    v_mfma_f32_16x16x32_bf16 a[124:127], v[200:203], v[148:151], 0
    v_cvt_pk_bf16_f32 v164, v168, v169
    v_mfma_f32_16x16x32_bf16 a[128:131], v[200:203], v[152:155], 0
    s_waitcnt lgkmcnt(6)
    v_exp_f32 v171, v131
    v_mfma_f32_16x16x32_bf16 a[132:135], v[204:207], v[144:147], 0
    ds_read_b64_tr_b16 v[220:221], v231 offset:256
    ds_read_b64_tr_b16 v[222:223], v231 offset:8448
    v_mfma_f32_16x16x32_bf16 a[136:139], v[204:207], v[148:151], 0
    buffer_load_dwordx4 v239, s[12:15], s38 offen offset:3072 sc1 nt lds
    v_mfma_f32_16x16x32_bf16 a[140:143], v[204:207], v[152:155], 0
    s_waitcnt lgkmcnt(6)
    s_waitcnt vmcnt(28)
    s_barrier
    v_exp_f32 v172, v132
    v_mfma_f32_16x16x32_bf16 a[144:147], v[208:211], v[144:147], 0
    s_add_u32 s33, s33, 16384
    s_cmp_eq_u32 s33, 163840
    s_cselect_b32 s33, 0, s33
    ds_read_b128 v[192:195], v232 offset:0
    v_cvt_pk_bf16_f32 v165, v170, v171
    v_mfma_f32_16x16x32_bf16 a[148:151], v[208:211], v[148:151], 0
    s_add_u32 s38, s38, 16384
    v_exp_f32 v173, v133
    v_mfma_f32_16x16x32_bf16 a[152:155], v[208:211], v[152:155], 0
    s_waitcnt lgkmcnt(5)
    v_exp_f32 v174, v134
    v_mfma_f32_16x16x32_bf16 a[156:159], v[212:215], v[144:147], 0
    ds_read_b128 v[196:199], v233 offset:0
    v_cvt_pk_bf16_f32 v158, v172, v173
    v_mfma_f32_16x16x32_bf16 a[160:163], v[212:215], v[148:151], 0
    v_exp_f32 v175, v135
    v_mfma_f32_16x16x32_bf16 a[164:167], v[212:215], v[152:155], 0
    s_waitcnt lgkmcnt(4)
    v_exp_f32 v168, v136
    v_mfma_f32_16x16x32_bf16 a[168:171], v[216:219], v[144:147], 0
    ds_read_b128 v[200:203], v234 offset:0
    v_cvt_pk_bf16_f32 v159, v174, v175
    v_mfma_f32_16x16x32_bf16 a[172:175], v[216:219], v[148:151], 0
    v_exp_f32 v169, v137
    v_mfma_f32_16x16x32_bf16 a[176:179], v[216:219], v[152:155], 0
    s_waitcnt lgkmcnt(3)
    v_exp_f32 v170, v138
    v_mfma_f32_16x16x32_bf16 a[180:183], v[220:223], v[144:147], 0
    ds_read_b128 v[204:207], v235 offset:0
    v_cvt_pk_bf16_f32 v162, v168, v169
    v_mfma_f32_16x16x32_bf16 a[184:187], v[220:223], v[148:151], 0
    v_exp_f32 v171, v139
    v_mfma_f32_16x16x32_bf16 a[188:191], v[220:223], v[152:155], 0
    s_waitcnt lgkmcnt(3)
    v_exp_f32 v172, v140
    v_mfma_f32_16x16x32_bf16 v[96:99], v[192:195], v[0:3], v[176:179]
    s_add_u32 s34, s34, 16384
    s_cmp_eq_u32 s34, 163840
    s_cselect_b32 s34, 0, s34
    ds_read_b128 v[208:211], v232 offset:256
    v_cvt_pk_bf16_f32 v163, v170, v171
    v_mfma_f32_16x16x32_bf16 v[100:103], v[192:195], v[4:7], v[180:183]
    s_sub_u32 s50, s34, s35
    v_exp_f32 v173, v141
    v_mfma_f32_16x16x32_bf16 v[104:107], v[192:195], v[8:11], v[184:187]
    s_waitcnt lgkmcnt(3)
    v_exp_f32 v174, v142
    v_mfma_f32_16x16x32_bf16 v[96:99], v[196:199], v[12:15], v[96:99]
    s_mov_b32 s35, s34
    ds_read_b128 v[212:215], v233 offset:256
    v_cvt_pk_bf16_f32 v166, v172, v173
    v_mfma_f32_16x16x32_bf16 v[100:103], v[196:199], v[16:19], v[100:103]
    s_add_u32 m0, s33, s32
    v_add_u32 v224, s50, v224
    v_add_u32 v225, s50, v225
    v_mfma_f32_16x16x32_bf16 v[104:107], v[196:199], v[20:23], v[104:107]
    s_waitcnt lgkmcnt(3)
    v_add_u32 v226, s50, v226
    v_add_u32 v227, s50, v227
    v_mfma_f32_16x16x32_bf16 v[96:99], v[200:203], v[24:27], v[96:99]
    ds_read_b128 v[216:219], v234 offset:256
    v_add_u32 v228, s50, v228
    v_mfma_f32_16x16x32_bf16 v[100:103], v[200:203], v[28:31], v[100:103]
    v_add_u32 v229, s50, v229
    v_add_u32 v230, s50, v230
    v_mfma_f32_16x16x32_bf16 v[104:107], v[200:203], v[32:35], v[104:107]
    s_waitcnt lgkmcnt(3)
    v_add_u32 v231, s50, v231
    v_mfma_f32_16x16x32_bf16 v[96:99], v[204:207], v[36:39], v[96:99]
    ds_read_b128 v[220:223], v235 offset:256
    v_mfma_f32_16x16x32_bf16 v[100:103], v[204:207], v[40:43], v[100:103]
    buffer_load_dwordx4 v236, s[8:11], s37 offen offset:0 sc1 nt lds
    v_mfma_f32_16x16x32_bf16 v[104:107], v[204:207], v[44:47], v[104:107]
    s_waitcnt lgkmcnt(3)
    v_exp_f32 v175, v143
    v_mfma_f32_16x16x32_bf16 v[96:99], v[208:211], v[48:51], v[96:99]
    ds_read_b128 v[192:195], v232 offset:8192
    v_or3_b32 v188, v156, v157, v160
    v_mfma_f32_16x16x32_bf16 v[100:103], v[208:211], v[52:55], v[100:103]
    v_cvt_pk_bf16_f32 v167, v174, v175
    v_or3_b32 v188, v188, v161, v164
    v_mfma_f32_16x16x32_bf16 v[104:107], v[208:211], v[56:59], v[104:107]
    s_waitcnt lgkmcnt(3)
    buffer_load_dwordx4 v237, s[8:11], s37 offen offset:1024 sc1 nt lds
    v_mfma_f32_16x16x32_bf16 v[96:99], v[212:215], v[60:63], v[96:99]
    ds_read_b128 v[196:199], v233 offset:8192
    v_or3_b32 v188, v188, v165, v158
    v_mfma_f32_16x16x32_bf16 v[100:103], v[212:215], v[64:67], v[100:103]
    v_or3_b32 v188, v188, v159, v162
    v_or3_b32 v188, v188, v163, v166
    v_mfma_f32_16x16x32_bf16 v[104:107], v[212:215], v[68:71], v[104:107]
    s_waitcnt lgkmcnt(3)
    v_or_b32 v188, v188, v167
    v_and_b32 v188, 0x40004000, v188
    v_mfma_f32_16x16x32_bf16 v[96:99], v[216:219], v[72:75], v[96:99]
    ds_read_b128 v[200:203], v234 offset:8192
    v_cmp_ne_u32 vcc, 0, v188
    v_mfma_f32_16x16x32_bf16 v[100:103], v[216:219], v[76:79], v[100:103]
    v_mfma_f32_16x16x32_bf16 v[104:107], v[216:219], v[80:83], v[104:107]
    s_waitcnt lgkmcnt(3)
    v_mfma_f32_16x16x32_bf16 v[96:99], v[220:223], v[84:87], v[96:99]
    ds_read_b128 v[204:207], v235 offset:8192
    v_mfma_f32_16x16x32_bf16 v[100:103], v[220:223], v[88:91], v[100:103]
    v_mfma_f32_16x16x32_bf16 v[104:107], v[220:223], v[92:95], v[104:107]
    s_waitcnt lgkmcnt(3)
    v_mfma_f32_16x16x32_bf16 v[108:111], v[192:195], v[0:3], v[176:179]
    ds_read_b128 v[208:211], v232 offset:8448
    v_mfma_f32_16x16x32_bf16 v[112:115], v[192:195], v[4:7], v[180:183]
    buffer_load_dwordx4 v238, s[8:11], s37 offen offset:2048 sc1 nt lds
    v_mfma_f32_16x16x32_bf16 v[116:119], v[192:195], v[8:11], v[184:187]
    s_waitcnt lgkmcnt(3)
    v_mfma_f32_16x16x32_bf16 v[108:111], v[196:199], v[12:15], v[108:111]
    ds_read_b128 v[212:215], v233 offset:8448
    v_mfma_f32_16x16x32_bf16 v[112:115], v[196:199], v[16:19], v[112:115]
    v_mfma_f32_16x16x32_bf16 v[116:119], v[196:199], v[20:23], v[116:119]
    s_waitcnt lgkmcnt(3)
    v_mfma_f32_16x16x32_bf16 v[108:111], v[200:203], v[24:27], v[108:111]
    ds_read_b128 v[216:219], v234 offset:8448
    v_mfma_f32_16x16x32_bf16 v[112:115], v[200:203], v[28:31], v[112:115]
    v_mfma_f32_16x16x32_bf16 v[116:119], v[200:203], v[32:35], v[116:119]
    s_waitcnt lgkmcnt(3)
    v_mfma_f32_16x16x32_bf16 v[108:111], v[204:207], v[36:39], v[108:111]
    ds_read_b128 v[220:223], v235 offset:8448
    v_mfma_f32_16x16x32_bf16 v[112:115], v[204:207], v[40:43], v[112:115]
    buffer_load_dwordx4 v239, s[8:11], s37 offen offset:3072 sc1 nt lds
    v_mfma_f32_16x16x32_bf16 v[116:119], v[204:207], v[44:47], v[116:119]
    s_waitcnt lgkmcnt(3)
    s_waitcnt vmcnt(28)
    s_barrier
    v_mfma_f32_16x16x32_bf16 v[108:111], v[208:211], v[48:51], v[108:111]
    s_add_u32 s33, s33, 16384
    s_cmp_eq_u32 s33, 163840
    s_cselect_b32 s33, 0, s33
    ds_read_b64_tr_b16 v[192:193], v224 offset:0
    ds_read_b64_tr_b16 v[194:195], v224 offset:8192
    v_mfma_f32_16x16x32_bf16 v[112:115], v[208:211], v[52:55], v[112:115]
    s_add_u32 s37, s37, 16384
    v_mfma_f32_16x16x32_bf16 v[116:119], v[208:211], v[56:59], v[116:119]
    s_waitcnt lgkmcnt(4)
    v_mfma_f32_16x16x32_bf16 v[108:111], v[212:215], v[60:63], v[108:111]
    ds_read_b64_tr_b16 v[196:197], v225 offset:0
    ds_read_b64_tr_b16 v[198:199], v225 offset:8192
    v_mfma_f32_16x16x32_bf16 v[112:115], v[212:215], v[64:67], v[112:115]
    v_mfma_f32_16x16x32_bf16 v[116:119], v[212:215], v[68:71], v[116:119]
    s_waitcnt lgkmcnt(5)
    v_mfma_f32_16x16x32_bf16 v[108:111], v[216:219], v[72:75], v[108:111]
    ds_read_b64_tr_b16 v[200:201], v226 offset:0
    ds_read_b64_tr_b16 v[202:203], v226 offset:8192
    v_mfma_f32_16x16x32_bf16 v[112:115], v[216:219], v[76:79], v[112:115]
    v_mfma_f32_16x16x32_bf16 v[116:119], v[216:219], v[80:83], v[116:119]
    s_waitcnt lgkmcnt(6)
    v_mfma_f32_16x16x32_bf16 v[108:111], v[220:223], v[84:87], v[108:111]
    ds_read_b64_tr_b16 v[204:205], v227 offset:0
    ds_read_b64_tr_b16 v[206:207], v227 offset:8192
    v_mfma_f32_16x16x32_bf16 v[112:115], v[220:223], v[88:91], v[112:115]
    v_mfma_f32_16x16x32_bf16 v[116:119], v[220:223], v[92:95], v[116:119]
    s_waitcnt lgkmcnt(6)
    s_cbranch_vccnz L_stub0
L_back0:
    s_mov_b32 s31, 4
L_att:
    v_mfma_f32_16x16x32_bf16 a[192:195], a[204:207], v[156:159], a[192:195]
    v_mfma_f32_16x16x32_bf16 a[196:199], a[204:207], v[160:163], a[196:199]
    v_mfma_f32_16x16x32_bf16 a[200:203], a[204:207], v[164:167], a[200:203]
    v_mfma_f32_16x16x32_bf16 a[0:3], v[192:195], v[156:159], a[0:3]
    s_add_u32 s34, s34, 16384
    s_cmp_eq_u32 s34, 163840
    s_cselect_b32 s34, 0, s34
    ds_read_b64_tr_b16 v[208:209], v228 offset:0
    ds_read_b64_tr_b16 v[210:211], v228 offset:8192
    v_mfma_f32_16x16x32_bf16 a[4:7], v[192:195], v[160:163], a[4:7]
    s_sub_u32 s50, s34, s36
    v_exp_f32 v168, v96
    v_mfma_f32_16x16x32_bf16 a[8:11], v[192:195], v[164:167], a[8:11]
    s_waitcnt lgkmcnt(6)
    v_exp_f32 v169, v97
    v_mfma_f32_16x16x32_bf16 a[12:15], v[196:199], v[156:159], a[12:15]
    s_mov_b32 s36, s34
    ds_read_b64_tr_b16 v[212:213], v229 offset:0
    ds_read_b64_tr_b16 v[214:215], v229 offset:8192
    v_mfma_f32_16x16x32_bf16 a[16:19], v[196:199], v[160:163], a[16:19]
    s_add_u32 m0, s33, s32
    v_add_u32 v232, s50, v232
    v_add_u32 v233, s50, v233
    v_mfma_f32_16x16x32_bf16 a[20:23], v[196:199], v[164:167], a[20:23]
    s_waitcnt lgkmcnt(6)
    v_add_u32 v234, s50, v234
    v_add_u32 v235, s50, v235
    v_mfma_f32_16x16x32_bf16 a[24:27], v[200:203], v[156:159], a[24:27]
    ds_read_b64_tr_b16 v[216:217], v230 offset:0
    ds_read_b64_tr_b16 v[218:219], v230 offset:8192
    v_mfma_f32_16x16x32_bf16 a[28:31], v[200:203], v[160:163], a[28:31]
    buffer_load_dwordx4 v236, s[12:15], s38 offen offset:0 sc1 nt lds
    v_mfma_f32_16x16x32_bf16 a[32:35], v[200:203], v[164:167], a[32:35]
    s_waitcnt lgkmcnt(6)
    v_exp_f32 v170, v98
    v_mfma_f32_16x16x32_bf16 a[36:39], v[204:207], v[156:159], a[36:39]
    ds_read_b64_tr_b16 v[220:221], v231 offset:0
    ds_read_b64_tr_b16 v[222:223], v231 offset:8192
    v_mfma_f32_16x16x32_bf16 a[40:43], v[204:207], v[160:163], a[40:43]
    v_cvt_pk_bf16_f32 v144, v168, v169
    v_mfma_f32_16x16x32_bf16 a[44:47], v[204:207], v[164:167], a[44:47]
    s_waitcnt lgkmcnt(6)
    v_exp_f32 v171, v99
    v_mfma_f32_16x16x32_bf16 a[48:51], v[208:211], v[156:159], a[48:51]
    ds_read_b64_tr_b16 v[192:193], v224 offset:256
    ds_read_b64_tr_b16 v[194:195], v224 offset:8448
    v_mfma_f32_16x16x32_bf16 a[52:55], v[208:211], v[160:163], a[52:55]
    v_exp_f32 v172, v100
    v_mfma_f32_16x16x32_bf16 a[56:59], v[208:211], v[164:167], a[56:59]
    s_waitcnt lgkmcnt(6)
    buffer_load_dwordx4 v237, s[12:15], s38 offen offset:1024 sc1 nt lds
    v_mfma_f32_16x16x32_bf16 a[60:63], v[212:215], v[156:159], a[60:63]
    ds_read_b64_tr_b16 v[196:197], v225 offset:256
    ds_read_b64_tr_b16 v[198:199], v225 offset:8448
    v_mfma_f32_16x16x32_bf16 a[64:67], v[212:215], v[160:163], a[64:67]
    v_cvt_pk_bf16_f32 v145, v170, v171
    v_mfma_f32_16x16x32_bf16 a[68:71], v[212:215], v[164:167], a[68:71]
    s_waitcnt lgkmcnt(6)
    v_exp_f32 v173, v101
    v_mfma_f32_16x16x32_bf16 a[72:75], v[216:219], v[156:159], a[72:75]
    ds_read_b64_tr_b16 v[200:201], v226 offset:256
    ds_read_b64_tr_b16 v[202:203], v226 offset:8448
    v_mfma_f32_16x16x32_bf16 a[76:79], v[216:219], v[160:163], a[76:79]
    v_exp_f32 v174, v102
    v_mfma_f32_16x16x32_bf16 a[80:83], v[216:219], v[164:167], a[80:83]
    s_waitcnt lgkmcnt(6)
    v_cvt_pk_bf16_f32 v148, v172, v173
    v_mfma_f32_16x16x32_bf16 a[84:87], v[220:223], v[156:159], a[84:87]
    ds_read_b64_tr_b16 v[204:205], v227 offset:256
    ds_read_b64_tr_b16 v[206:207], v227 offset:8448
    v_mfma_f32_16x16x32_bf16 a[88:91], v[220:223], v[160:163], a[88:91]
    v_exp_f32 v175, v103
    v_mfma_f32_16x16x32_bf16 a[92:95], v[220:223], v[164:167], a[92:95]
    s_waitcnt lgkmcnt(6)
    v_exp_f32 v168, v104
    v_mfma_f32_16x16x32_bf16 a[96:99], v[192:195], v[156:159], a[96:99]
    ds_read_b64_tr_b16 v[208:209], v228 offset:256
    ds_read_b64_tr_b16 v[210:211], v228 offset:8448
    v_mfma_f32_16x16x32_bf16 a[100:103], v[192:195], v[160:163], a[100:103]
    buffer_load_dwordx4 v238, s[12:15], s38 offen offset:2048 sc1 nt lds
    v_mfma_f32_16x16x32_bf16 a[104:107], v[192:195], v[164:167], a[104:107]
    s_waitcnt lgkmcnt(6)
    v_cvt_pk_bf16_f32 v149, v174, v175
    v_mfma_f32_16x16x32_bf16 a[108:111], v[196:199], v[156:159], a[108:111]
    ds_read_b64_tr_b16 v[212:213], v229 offset:256
    ds_read_b64_tr_b16 v[214:215], v229 offset:8448
    v_mfma_f32_16x16x32_bf16 a[112:115], v[196:199], v[160:163], a[112:115]
    v_exp_f32 v169, v105
    v_mfma_f32_16x16x32_bf16 a[116:119], v[196:199], v[164:167], a[116:119]
    s_waitcnt lgkmcnt(6)
    v_exp_f32 v170, v106
    v_mfma_f32_16x16x32_bf16 a[120:123], v[200:203], v[156:159], a[120:123]
    ds_read_b64_tr_b16 v[216:217], v230 offset:256
    ds_read_b64_tr_b16 v[218:219], v230 offset:8448
    v_mfma_f32_16x16x32_bf16 a[124:127], v[200:203], v[160:163], a[124:127]
    v_cvt_pk_bf16_f32 v152, v168, v169
    v_mfma_f32_16x16x32_bf16 a[128:131], v[200:203], v[164:167], a[128:131]
    s_waitcnt lgkmcnt(6)
    v_exp_f32 v171, v107
    v_mfma_f32_16x16x32_bf16 a[132:135], v[204:207], v[156:159], a[132:135]
    ds_read_b64_tr_b16 v[220:221], v231 offset:256
    ds_read_b64_tr_b16 v[222:223], v231 offset:8448
    v_mfma_f32_16x16x32_bf16 a[136:139], v[204:207], v[160:163], a[136:139]
    buffer_load_dwordx4 v239, s[12:15], s38 offen offset:3072 sc1 nt lds
    v_mfma_f32_16x16x32_bf16 a[140:143], v[204:207], v[164:167], a[140:143]
    s_waitcnt lgkmcnt(6)
    s_waitcnt vmcnt(28)
    s_barrier
    v_exp_f32 v172, v108
    v_mfma_f32_16x16x32_bf16 a[144:147], v[208:211], v[156:159], a[144:147]
    s_add_u32 s33, s33, 16384
    s_cmp_eq_u32 s33, 163840
    s_cselect_b32 s33, 0, s33
    ds_read_b128 v[192:195], v232 offset:0
    v_cvt_pk_bf16_f32 v153, v170, v171
    v_mfma_f32_16x16x32_bf16 a[148:151], v[208:211], v[160:163], a[148:151]
    s_add_u32 s38, s38, 16384
    v_exp_f32 v173, v109
    v_mfma_f32_16x16x32_bf16 a[152:155], v[208:211], v[164:167], a[152:155]
    s_waitcnt lgkmcnt(5)
    v_exp_f32 v174, v110
    v_mfma_f32_16x16x32_bf16 a[156:159], v[212:215], v[156:159], a[156:159]
    ds_read_b128 v[196:199], v233 offset:0
    v_cvt_pk_bf16_f32 v146, v172, v173
    v_mfma_f32_16x16x32_bf16 a[160:163], v[212:215], v[160:163], a[160:163]
    v_exp_f32 v175, v111
    v_mfma_f32_16x16x32_bf16 a[164:167], v[212:215], v[164:167], a[164:167]
    s_waitcnt lgkmcnt(4)
    v_exp_f32 v168, v112
    v_mfma_f32_16x16x32_bf16 a[168:171], v[216:219], v[156:159], a[168:171]
    ds_read_b128 v[200:203], v234 offset:0
    v_cvt_pk_bf16_f32 v147, v174, v175
    v_mfma_f32_16x16x32_bf16 a[172:175], v[216:219], v[160:163], a[172:175]
    v_exp_f32 v169, v113
    v_mfma_f32_16x16x32_bf16 a[176:179], v[216:219], v[164:167], a[176:179]
    s_waitcnt lgkmcnt(3)
    v_exp_f32 v170, v114
    v_mfma_f32_16x16x32_bf16 a[180:183], v[220:223], v[156:159], a[180:183]
    ds_read_b128 v[204:207], v235 offset:0
    v_cvt_pk_bf16_f32 v150, v168, v169
    v_mfma_f32_16x16x32_bf16 a[184:187], v[220:223], v[160:163], a[184:187]
    v_exp_f32 v171, v115
    v_mfma_f32_16x16x32_bf16 a[188:191], v[220:223], v[164:167], a[188:191]
    s_waitcnt lgkmcnt(3)
    v_exp_f32 v172, v116
    v_mfma_f32_16x16x32_bf16 v[120:123], v[192:195], v[0:3], v[176:179]
    s_add_u32 s34, s34, 16384
    s_cmp_eq_u32 s34, 163840
    s_cselect_b32 s34, 0, s34
    ds_read_b128 v[208:211], v232 offset:256
    v_cvt_pk_bf16_f32 v151, v170, v171
    v_mfma_f32_16x16x32_bf16 v[124:127], v[192:195], v[4:7], v[180:183]
    s_sub_u32 s50, s34, s35
    v_exp_f32 v173, v117
    v_mfma_f32_16x16x32_bf16 v[128:131], v[192:195], v[8:11], v[184:187]
    s_waitcnt lgkmcnt(3)
    v_exp_f32 v174, v118
    v_mfma_f32_16x16x32_bf16 v[120:123], v[196:199], v[12:15], v[120:123]
    s_mov_b32 s35, s34
    ds_read_b128 v[212:215], v233 offset:256
    v_cvt_pk_bf16_f32 v154, v172, v173
    v_mfma_f32_16x16x32_bf16 v[124:127], v[196:199], v[16:19], v[124:127]
    s_add_u32 m0, s33, s32
    v_add_u32 v224, s50, v224
    v_add_u32 v225, s50, v225
    v_mfma_f32_16x16x32_bf16 v[128:131], v[196:199], v[20:23], v[128:131]
    s_waitcnt lgkmcnt(3)
    v_add_u32 v226, s50, v226
    v_add_u32 v227, s50, v227
    v_mfma_f32_16x16x32_bf16 v[120:123], v[200:203], v[24:27], v[120:123]
    ds_read_b128 v[216:219], v234 offset:256
    v_add_u32 v228, s50, v228
    v_mfma_f32_16x16x32_bf16 v[124:127], v[200:203], v[28:31], v[124:127]
    v_add_u32 v229, s50, v229
    v_add_u32 v230, s50, v230
    v_mfma_f32_16x16x32_bf16 v[128:131], v[200:203], v[32:35], v[128:131]
    s_waitcnt lgkmcnt(3)
    v_add_u32 v231, s50, v231
    v_mfma_f32_16x16x32_bf16 v[120:123], v[204:207], v[36:39], v[120:123]
    ds_read_b128 v[220:223], v235 offset:256
    v_mfma_f32_16x16x32_bf16 v[124:127], v[204:207], v[40:43], v[124:127]
    buffer_load_dwordx4 v236, s[8:11], s37 offen offset:0 sc1 nt lds
    v_mfma_f32_16x16x32_bf16 v[128:131], v[204:207], v[44:47], v[128:131]
    s_waitcnt lgkmcnt(3)
    v_exp_f32 v175, v119
    v_mfma_f32_16x16x32_bf16 v[120:123], v[208:211], v[48:51], v[120:123]
    ds_read_b128 v[192:195], v232 offset:8192
    v_or3_b32 v188, v144, v145, v148
    v_mfma_f32_16x16x32_bf16 v[124:127], v[208:211], v[52:55], v[124:127]
    v_cvt_pk_bf16_f32 v155, v174, v175
    v_or3_b32 v188, v188, v149, v152
    v_mfma_f32_16x16x32_bf16 v[128:131], v[208:211], v[56:59], v[128:131]
    s_waitcnt lgkmcnt(3)
    buffer_load_dwordx4 v237, s[8:11], s37 offen offset:1024 sc1 nt lds
    v_mfma_f32_16x16x32_bf16 v[120:123], v[212:215], v[60:63], v[120:123]
    ds_read_b128 v[196:199], v233 offset:8192
    v_or3_b32 v188, v188, v153, v146
    v_mfma_f32_16x16x32_bf16 v[124:127], v[212:215], v[64:67], v[124:127]
    v_or3_b32 v188, v188, v147, v150
    v_or3_b32 v188, v188, v151, v154
    v_mfma_f32_16x16x32_bf16 v[128:131], v[212:215], v[68:71], v[128:131]
    s_waitcnt lgkmcnt(3)
    v_or_b32 v188, v188, v155
    v_and_b32 v188, 0x40004000, v188
    v_mfma_f32_16x16x32_bf16 v[120:123], v[216:219], v[72:75], v[120:123]
    ds_read_b128 v[200:203], v234 offset:8192
    v_cmp_ne_u32 vcc, 0, v188
    v_mfma_f32_16x16x32_bf16 v[124:127], v[216:219], v[76:79], v[124:127]
    v_mfma_f32_16x16x32_bf16 v[128:131], v[216:219], v[80:83], v[128:131]
    s_waitcnt lgkmcnt(3)
    v_mfma_f32_16x16x32_bf16 v[120:123], v[220:223], v[84:87], v[120:123]
    ds_read_b128 v[204:207], v235 offset:8192
    v_mfma_f32_16x16x32_bf16 v[124:127], v[220:223], v[88:91], v[124:127]
    v_mfma_f32_16x16x32_bf16 v[128:131], v[220:223], v[92:95], v[128:131]
    s_waitcnt lgkmcnt(3)
    v_mfma_f32_16x16x32_bf16 v[132:135], v[192:195], v[0:3], v[176:179]
    ds_read_b128 v[208:211], v232 offset:8448
    v_mfma_f32_16x16x32_bf16 v[136:139], v[192:195], v[4:7], v[180:183]
    buffer_load_dwordx4 v238, s[8:11], s37 offen offset:2048 sc1 nt lds
    v_mfma_f32_16x16x32_bf16 v[140:143], v[192:195], v[8:11], v[184:187]
    s_waitcnt lgkmcnt(3)
    v_mfma_f32_16x16x32_bf16 v[132:135], v[196:199], v[12:15], v[132:135]
    ds_read_b128 v[212:215], v233 offset:8448
    v_mfma_f32_16x16x32_bf16 v[136:139], v[196:199], v[16:19], v[136:139]
    v_mfma_f32_16x16x32_bf16 v[140:143], v[196:199], v[20:23], v[140:143]
    s_waitcnt lgkmcnt(3)
    v_mfma_f32_16x16x32_bf16 v[132:135], v[200:203], v[24:27], v[132:135]
    ds_read_b128 v[216:219], v234 offset:8448
    v_mfma_f32_16x16x32_bf16 v[136:139], v[200:203], v[28:31], v[136:139]
    v_mfma_f32_16x16x32_bf16 v[140:143], v[200:203], v[32:35], v[140:143]
    s_waitcnt lgkmcnt(3)
    v_mfma_f32_16x16x32_bf16 v[132:135], v[204:207], v[36:39], v[132:135]
    ds_read_b128 v[220:223], v235 offset:8448
    v_mfma_f32_16x16x32_bf16 v[136:139], v[204:207], v[40:43], v[136:139]
    buffer_load_dwordx4 v239, s[8:11], s37 offen offset:3072 sc1 nt lds
    v_mfma_f32_16x16x32_bf16 v[140:143], v[204:207], v[44:47], v[140:143]
    s_waitcnt lgkmcnt(3)
    s_waitcnt vmcnt(28)
    s_barrier
    v_mfma_f32_16x16x32_bf16 v[132:135], v[208:211], v[48:51], v[132:135]
    s_add_u32 s33, s33, 16384
    s_cmp_eq_u32 s33, 163840
    s_cselect_b32 s33, 0, s33
    ds_read_b64_tr_b16 v[192:193], v224 offset:0
    ds_read_b64_tr_b16 v[194:195], v224 offset:8192
    v_mfma_f32_16x16x32_bf16 v[136:139], v[208:211], v[52:55], v[136:139]
    s_add_u32 s37, s37, 16384
    v_mfma_f32_16x16x32_bf16 v[140:143], v[208:211], v[56:59], v[140:143]
    s_waitcnt lgkmcnt(4)
    v_mfma_f32_16x16x32_bf16 v[132:135], v[212:215], v[60:63], v[132:135]
    ds_read_b64_tr_b16 v[196:197], v225 offset:0
    ds_read_b64_tr_b16 v[198:199], v225 offset:8192
    v_mfma_f32_16x16x32_bf16 v[136:139], v[212:215], v[64:67], v[136:139]
    v_mfma_f32_16x16x32_bf16 v[140:143], v[212:215], v[68:71], v[140:143]
    s_waitcnt lgkmcnt(5)
    v_mfma_f32_16x16x32_bf16 v[132:135], v[216:219], v[72:75], v[132:135]
    ds_read_b64_tr_b16 v[200:201], v226 offset:0
    ds_read_b64_tr_b16 v[202:203], v226 offset:8192
    v_mfma_f32_16x16x32_bf16 v[136:139], v[216:219], v[76:79], v[136:139]
    v_mfma_f32_16x16x32_bf16 v[140:143], v[216:219], v[80:83], v[140:143]
    s_waitcnt lgkmcnt(6)
    v_mfma_f32_16x16x32_bf16 v[132:135], v[220:223], v[84:87], v[132:135]
    ds_read_b64_tr_b16 v[204:205], v227 offset:0
    ds_read_b64_tr_b16 v[206:207], v227 offset:8192
    v_mfma_f32_16x16x32_bf16 v[136:139], v[220:223], v[88:91], v[136:139]
    v_mfma_f32_16x16x32_bf16 v[140:143], v[220:223], v[92:95], v[140:143]
    s_waitcnt lgkmcnt(6)
    s_cbranch_vccnz L_stub1
L_back1:
    v_mfma_f32_16x16x32_bf16 a[192:195], a[204:207], v[144:147], a[192:195]
    v_mfma_f32_16x16x32_bf16 a[196:199], a[204:207], v[148:151], a[196:199]
    v_mfma_f32_16x16x32_bf16 a[200:203], a[204:207], v[152:155], a[200:203]
    v_mfma_f32_16x16x32_bf16 a[0:3], v[192:195], v[144:147], a[0:3]
    s_add_u32 s34, s34, 16384
    s_cmp_eq_u32 s34, 163840
    s_cselect_b32 s34, 0, s34
    ds_read_b64_tr_b16 v[208:209], v228 offset:0
    ds_read_b64_tr_b16 v[210:211], v228 offset:8192
    v_mfma_f32_16x16x32_bf16 a[4:7], v[192:195], v[148:151], a[4:7]
    s_sub_u32 s50, s34, s36
    v_exp_f32 v168, v120
    v_mfma_f32_16x16x32_bf16 a[8:11], v[192:195], v[152:155], a[8:11]
    s_waitcnt lgkmcnt(6)
    v_exp_f32 v169, v121
    v_mfma_f32_16x16x32_bf16 a[12:15], v[196:199], v[144:147], a[12:15]
    s_mov_b32 s36, s34
    ds_read_b64_tr_b16 v[212:213], v229 offset:0
    ds_read_b64_tr_b16 v[214:215], v229 offset:8192
    v_mfma_f32_16x16x32_bf16 a[16:19], v[196:199], v[148:151], a[16:19]
    s_add_u32 m0, s33, s32
    v_add_u32 v232, s50, v232
    v_add_u32 v233, s50, v233
    v_mfma_f32_16x16x32_bf16 a[20:23], v[196:199], v[152:155], a[20:23]
    s_waitcnt lgkmcnt(6)
    v_add_u32 v234, s50, v234
    v_add_u32 v235, s50, v235
    v_mfma_f32_16x16x32_bf16 a[24:27], v[200:203], v[144:147], a[24:27]
    ds_read_b64_tr_b16 v[216:217], v230 offset:0
    ds_read_b64_tr_b16 v[218:219], v230 offset:8192
    v_mfma_f32_16x16x32_bf16 a[28:31], v[200:203], v[148:151], a[28:31]
    buffer_load_dwordx4 v236, s[12:15], s38 offen offset:0 sc1 nt lds
    v_mfma_f32_16x16x32_bf16 a[32:35], v[200:203], v[152:155], a[32:35]
    s_waitcnt lgkmcnt(6)
    v_exp_f32 v170, v122
    v_mfma_f32_16x16x32_bf16 a[36:39], v[204:207], v[144:147], a[36:39]
    ds_read_b64_tr_b16 v[220:221], v231 offset:0
    ds_read_b64_tr_b16 v[222:223], v231 offset:8192
    v_mfma_f32_16x16x32_bf16 a[40:43], v[204:207], v[148:151], a[40:43]
    v_cvt_pk_bf16_f32 v156, v168, v169
    v_mfma_f32_16x16x32_bf16 a[44:47], v[204:207], v[152:155], a[44:47]
    s_waitcnt lgkmcnt(6)
    v_exp_f32 v171, v123
    v_mfma_f32_16x16x32_bf16 a[48:51], v[208:211], v[144:147], a[48:51]
    ds_read_b64_tr_b16 v[192:193], v224 offset:256
    ds_read_b64_tr_b16 v[194:195], v224 offset:8448
    v_mfma_f32_16x16x32_bf16 a[52:55], v[208:211], v[148:151], a[52:55]
    v_exp_f32 v172, v124
    v_mfma_f32_16x16x32_bf16 a[56:59], v[208:211], v[152:155], a[56:59]
    s_waitcnt lgkmcnt(6)
    buffer_load_dwordx4 v237, s[12:15], s38 offen offset:1024 sc1 nt lds
    v_mfma_f32_16x16x32_bf16 a[60:63], v[212:215], v[144:147], a[60:63]
    ds_read_b64_tr_b16 v[196:197], v225 offset:256
    ds_read_b64_tr_b16 v[198:199], v225 offset:8448
    v_mfma_f32_16x16x32_bf16 a[64:67], v[212:215], v[148:151], a[64:67]
    v_cvt_pk_bf16_f32 v157, v170, v171
    v_mfma_f32_16x16x32_bf16 a[68:71], v[212:215], v[152:155], a[68:71]
    s_waitcnt lgkmcnt(6)
    v_exp_f32 v173, v125
    v_mfma_f32_16x16x32_bf16 a[72:75], v[216:219], v[144:147], a[72:75]
    ds_read_b64_tr_b16 v[200:201], v226 offset:256
    ds_read_b64_tr_b16 v[202:203], v226 offset:8448
    v_mfma_f32_16x16x32_bf16 a[76:79], v[216:219], v[148:151], a[76:79]
    v_exp_f32 v174, v126
    v_mfma_f32_16x16x32_bf16 a[80:83], v[216:219], v[152:155], a[80:83]
    s_waitcnt lgkmcnt(6)
    v_cvt_pk_bf16_f32 v160, v172, v173
    v_mfma_f32_16x16x32_bf16 a[84:87], v[220:223], v[144:147], a[84:87]
    ds_read_b64_tr_b16 v[204:205], v227 offset:256
    ds_read_b64_tr_b16 v[206:207], v227 offset:8448
    v_mfma_f32_16x16x32_bf16 a[88:91], v[220:223], v[148:151], a[88:91]
    v_exp_f32 v175, v127
    v_mfma_f32_16x16x32_bf16 a[92:95], v[220:223], v[152:155], a[92:95]
    s_waitcnt lgkmcnt(6)
    v_exp_f32 v168, v128
    v_mfma_f32_16x16x32_bf16 a[96:99], v[192:195], v[144:147], a[96:99]
    ds_read_b64_tr_b16 v[208:209], v228 offset:256
    ds_read_b64_tr_b16 v[210:211], v228 offset:8448
    v_mfma_f32_16x16x32_bf16 a[100:103], v[192:195], v[148:151], a[100:103]
    buffer_load_dwordx4 v238, s[12:15], s38 offen offset:2048 sc1 nt lds
    v_mfma_f32_16x16x32_bf16 a[104:107], v[192:195], v[152:155], a[104:107]
    s_waitcnt lgkmcnt(6)
    v_cvt_pk_bf16_f32 v161, v174, v175
    v_mfma_f32_16x16x32_bf16 a[108:111], v[196:199], v[144:147], a[108:111]
    ds_read_b64_tr_b16 v[212:213], v229 offset:256
    ds_read_b64_tr_b16 v[214:215], v229 offset:8448
    v_mfma_f32_16x16x32_bf16 a[112:115], v[196:199], v[148:151], a[112:115]
    v_exp_f32 v169, v129
    v_mfma_f32_16x16x32_bf16 a[116:119], v[196:199], v[152:155], a[116:119]
    s_waitcnt lgkmcnt(6)
    v_exp_f32 v170, v130
    v_mfma_f32_16x16x32_bf16 a[120:123], v[200:203], v[144:147], a[120:123]
    ds_read_b64_tr_b16 v[216:217], v230 offset:256
    ds_read_b64_tr_b16 v[218:219], v230 offset:8448
    v_mfma_f32_16x16x32_bf16 a[124:127], v[200:203], v[148:151], a[124:127]
    v_cvt_pk_bf16_f32 v164, v168, v169
    v_mfma_f32_16x16x32_bf16 a[128:131], v[200:203], v[152:155], a[128:131]
    s_waitcnt lgkmcnt(6)
    v_exp_f32 v171, v131
    v_mfma_f32_16x16x32_bf16 a[132:135], v[204:207], v[144:147], a[132:135]
    ds_read_b64_tr_b16 v[220:221], v231 offset:256
    ds_read_b64_tr_b16 v[222:223], v231 offset:8448
    v_mfma_f32_16x16x32_bf16 a[136:139], v[204:207], v[148:151], a[136:139]
    buffer_load_dwordx4 v239, s[12:15], s38 offen offset:3072 sc1 nt lds
    v_mfma_f32_16x16x32_bf16 a[140:143], v[204:207], v[152:155], a[140:143]
    s_waitcnt lgkmcnt(6)
    s_waitcnt vmcnt(28)
    s_barrier
    v_exp_f32 v172, v132
    v_mfma_f32_16x16x32_bf16 a[144:147], v[208:211], v[144:147], a[144:147]
    s_add_u32 s33, s33, 16384
    s_cmp_eq_u32 s33, 163840
    s_cselect_b32 s33, 0, s33
    ds_read_b128 v[192:195], v232 offset:0
    v_cvt_pk_bf16_f32 v165, v170, v171
    v_mfma_f32_16x16x32_bf16 a[148:151], v[208:211], v[148:151], a[148:151]
    s_add_u32 s38, s38, 16384
    v_exp_f32 v173, v133
    v_mfma_f32_16x16x32_bf16 a[152:155], v[208:211], v[152:155], a[152:155]
    s_waitcnt lgkmcnt(5)
    v_exp_f32 v174, v134
    v_mfma_f32_16x16x32_bf16 a[156:159], v[212:215], v[144:147], a[156:159]
    ds_read_b128 v[196:199], v233 offset:0
    v_cvt_pk_bf16_f32 v158, v172, v173
    v_mfma_f32_16x16x32_bf16 a[160:163], v[212:215], v[148:151], a[160:163]
    v_exp_f32 v175, v135
    v_mfma_f32_16x16x32_bf16 a[164:167], v[212:215], v[152:155], a[164:167]
    s_waitcnt lgkmcnt(4)
    v_exp_f32 v168, v136
    v_mfma_f32_16x16x32_bf16 a[168:171], v[216:219], v[144:147], a[168:171]
    ds_read_b128 v[200:203], v234 offset:0
    v_cvt_pk_bf16_f32 v159, v174, v175
    v_mfma_f32_16x16x32_bf16 a[172:175], v[216:219], v[148:151], a[172:175]
    v_exp_f32 v169, v137
    v_mfma_f32_16x16x32_bf16 a[176:179], v[216:219], v[152:155], a[176:179]
    s_waitcnt lgkmcnt(3)
    v_exp_f32 v170, v138
    v_mfma_f32_16x16x32_bf16 a[180:183], v[220:223], v[144:147], a[180:183]
    ds_read_b128 v[204:207], v235 offset:0
    v_cvt_pk_bf16_f32 v162, v168, v169
    v_mfma_f32_16x16x32_bf16 a[184:187], v[220:223], v[148:151], a[184:187]
    v_exp_f32 v171, v139
    v_mfma_f32_16x16x32_bf16 a[188:191], v[220:223], v[152:155], a[188:191]
    s_waitcnt lgkmcnt(3)
    v_exp_f32 v172, v140
    v_mfma_f32_16x16x32_bf16 v[96:99], v[192:195], v[0:3], v[176:179]
    s_add_u32 s34, s34, 16384
    s_cmp_eq_u32 s34, 163840
    s_cselect_b32 s34, 0, s34
    ds_read_b128 v[208:211], v232 offset:256
    v_cvt_pk_bf16_f32 v163, v170, v171
    v_mfma_f32_16x16x32_bf16 v[100:103], v[192:195], v[4:7], v[180:183]
    s_sub_u32 s50, s34, s35
    v_exp_f32 v173, v141
    v_mfma_f32_16x16x32_bf16 v[104:107], v[192:195], v[8:11], v[184:187]
    s_waitcnt lgkmcnt(3)
    v_exp_f32 v174, v142
    v_mfma_f32_16x16x32_bf16 v[96:99], v[196:199], v[12:15], v[96:99]
    s_mov_b32 s35, s34
    ds_read_b128 v[212:215], v233 offset:256
    v_cvt_pk_bf16_f32 v166, v172, v173
    v_mfma_f32_16x16x32_bf16 v[100:103], v[196:199], v[16:19], v[100:103]
    s_add_u32 m0, s33, s32
    v_add_u32 v224, s50, v224
    v_add_u32 v225, s50, v225
    v_mfma_f32_16x16x32_bf16 v[104:107], v[196:199], v[20:23], v[104:107]
    s_waitcnt lgkmcnt(3)
    v_add_u32 v226, s50, v226
    v_add_u32 v227, s50, v227
    v_mfma_f32_16x16x32_bf16 v[96:99], v[200:203], v[24:27], v[96:99]
    ds_read_b128 v[216:219], v234 offset:256
    v_add_u32 v228, s50, v228
    v_mfma_f32_16x16x32_bf16 v[100:103], v[200:203], v[28:31], v[100:103]
    v_add_u32 v229, s50, v229
    v_add_u32 v230, s50, v230
    v_mfma_f32_16x16x32_bf16 v[104:107], v[200:203], v[32:35], v[104:107]
    s_waitcnt lgkmcnt(3)
    v_add_u32 v231, s50, v231
    v_mfma_f32_16x16x32_bf16 v[96:99], v[204:207], v[36:39], v[96:99]
    ds_read_b128 v[220:223], v235 offset:256
    v_mfma_f32_16x16x32_bf16 v[100:103], v[204:207], v[40:43], v[100:103]
    buffer_load_dwordx4 v236, s[8:11], s37 offen offset:0 sc1 nt lds
    v_mfma_f32_16x16x32_bf16 v[104:107], v[204:207], v[44:47], v[104:107]
    s_waitcnt lgkmcnt(3)
    v_exp_f32 v175, v143
    v_mfma_f32_16x16x32_bf16 v[96:99], v[208:211], v[48:51], v[96:99]
    ds_read_b128 v[192:195], v232 offset:8192
    v_or3_b32 v188, v156, v157, v160
    v_mfma_f32_16x16x32_bf16 v[100:103], v[208:211], v[52:55], v[100:103]
    v_cvt_pk_bf16_f32 v167, v174, v175
    v_or3_b32 v188, v188, v161, v164
    v_mfma_f32_16x16x32_bf16 v[104:107], v[208:211], v[56:59], v[104:107]
    s_waitcnt lgkmcnt(3)
    buffer_load_dwordx4 v237, s[8:11], s37 offen offset:1024 sc1 nt lds
    v_mfma_f32_16x16x32_bf16 v[96:99], v[212:215], v[60:63], v[96:99]
    ds_read_b128 v[196:199], v233 offset:8192
    v_or3_b32 v188, v188, v165, v158
    v_mfma_f32_16x16x32_bf16 v[100:103], v[212:215], v[64:67], v[100:103]
    v_or3_b32 v188, v188, v159, v162
    v_or3_b32 v188, v188, v163, v166
    v_mfma_f32_16x16x32_bf16 v[104:107], v[212:215], v[68:71], v[104:107]
    s_waitcnt lgkmcnt(3)
    v_or_b32 v188, v188, v167
    v_and_b32 v188, 0x40004000, v188
    v_mfma_f32_16x16x32_bf16 v[96:99], v[216:219], v[72:75], v[96:99]
    ds_read_b128 v[200:203], v234 offset:8192
    v_cmp_ne_u32 vcc, 0, v188
    v_mfma_f32_16x16x32_bf16 v[100:103], v[216:219], v[76:79], v[100:103]
    v_mfma_f32_16x16x32_bf16 v[104:107], v[216:219], v[80:83], v[104:107]
    s_waitcnt lgkmcnt(3)
    v_mfma_f32_16x16x32_bf16 v[96:99], v[220:223], v[84:87], v[96:99]
    ds_read_b128 v[204:207], v235 offset:8192
    v_mfma_f32_16x16x32_bf16 v[100:103], v[220:223], v[88:91], v[100:103]
    v_mfma_f32_16x16x32_bf16 v[104:107], v[220:223], v[92:95], v[104:107]
    s_waitcnt lgkmcnt(3)
    v_mfma_f32_16x16x32_bf16 v[108:111], v[192:195], v[0:3], v[176:179]
    ds_read_b128 v[208:211], v232 offset:8448
    v_mfma_f32_16x16x32_bf16 v[112:115], v[192:195], v[4:7], v[180:183]
    buffer_load_dwordx4 v238, s[8:11], s37 offen offset:2048 sc1 nt lds
    v_mfma_f32_16x16x32_bf16 v[116:119], v[192:195], v[8:11], v[184:187]
    s_waitcnt lgkmcnt(3)
    v_mfma_f32_16x16x32_bf16 v[108:111], v[196:199], v[12:15], v[108:111]
    ds_read_b128 v[212:215], v233 offset:8448
    v_mfma_f32_16x16x32_bf16 v[112:115], v[196:199], v[16:19], v[112:115]
    v_mfma_f32_16x16x32_bf16 v[116:119], v[196:199], v[20:23], v[116:119]
    s_waitcnt lgkmcnt(3)
    v_mfma_f32_16x16x32_bf16 v[108:111], v[200:203], v[24:27], v[108:111]
    ds_read_b128 v[216:219], v234 offset:8448
    v_mfma_f32_16x16x32_bf16 v[112:115], v[200:203], v[28:31], v[112:115]
    v_mfma_f32_16x16x32_bf16 v[116:119], v[200:203], v[32:35], v[116:119]
    s_waitcnt lgkmcnt(3)
    v_mfma_f32_16x16x32_bf16 v[108:111], v[204:207], v[36:39], v[108:111]
    ds_read_b128 v[220:223], v235 offset:8448
    v_mfma_f32_16x16x32_bf16 v[112:115], v[204:207], v[40:43], v[112:115]
    buffer_load_dwordx4 v239, s[8:11], s37 offen offset:3072 sc1 nt lds
    v_mfma_f32_16x16x32_bf16 v[116:119], v[204:207], v[44:47], v[116:119]
    s_waitcnt lgkmcnt(3)
    s_waitcnt vmcnt(28)
    s_barrier
    v_mfma_f32_16x16x32_bf16 v[108:111], v[208:211], v[48:51], v[108:111]
    s_add_u32 s33, s33, 16384
    s_cmp_eq_u32 s33, 163840
    s_cselect_b32 s33, 0, s33
    ds_read_b64_tr_b16 v[192:193], v224 offset:0
    ds_read_b64_tr_b16 v[194:195], v224 offset:8192
    v_mfma_f32_16x16x32_bf16 v[112:115], v[208:211], v[52:55], v[112:115]
    s_add_u32 s37, s37, 16384
    v_mfma_f32_16x16x32_bf16 v[116:119], v[208:211], v[56:59], v[116:119]
    s_waitcnt lgkmcnt(4)
    v_mfma_f32_16x16x32_bf16 v[108:111], v[212:215], v[60:63], v[108:111]
    ds_read_b64_tr_b16 v[196:197], v225 offset:0
    ds_read_b64_tr_b16 v[198:199], v225 offset:8192
    v_mfma_f32_16x16x32_bf16 v[112:115], v[212:215], v[64:67], v[112:115]
    v_mfma_f32_16x16x32_bf16 v[116:119], v[212:215], v[68:71], v[116:119]
    s_waitcnt lgkmcnt(5)
    v_mfma_f32_16x16x32_bf16 v[108:111], v[216:219], v[72:75], v[108:111]
    ds_read_b64_tr_b16 v[200:201], v226 offset:0
    ds_read_b64_tr_b16 v[202:203], v226 offset:8192
    v_mfma_f32_16x16x32_bf16 v[112:115], v[216:219], v[76:79], v[112:115]
    v_mfma_f32_16x16x32_bf16 v[116:119], v[216:219], v[80:83], v[116:119]
    s_waitcnt lgkmcnt(6)
    v_mfma_f32_16x16x32_bf16 v[108:111], v[220:223], v[84:87], v[108:111]
    ds_read_b64_tr_b16 v[204:205], v227 offset:0
    ds_read_b64_tr_b16 v[206:207], v227 offset:8192
    v_mfma_f32_16x16x32_bf16 v[112:115], v[220:223], v[88:91], v[112:115]
    v_mfma_f32_16x16x32_bf16 v[116:119], v[220:223], v[92:95], v[116:119]
    s_waitcnt lgkmcnt(6)
    s_cbranch_vccnz L_stub2
L_back2:
    s_sub_u32 s31, s31, 1
    s_cmp_lg_u32 s31, 0
    s_cbranch_scc1 L_att
    v_mfma_f32_16x16x32_bf16 a[192:195], a[204:207], v[156:159], a[192:195]
    v_mfma_f32_16x16x32_bf16 a[196:199], a[204:207], v[160:163], a[196:199]
    v_mfma_f32_16x16x32_bf16 a[200:203], a[204:207], v[164:167], a[200:203]
    v_mfma_f32_16x16x32_bf16 a[0:3], v[192:195], v[156:159], a[0:3]
    s_add_u32 s34, s34, 16384
    s_cmp_eq_u32 s34, 163840
    s_cselect_b32 s34, 0, s34
    ds_read_b64_tr_b16 v[208:209], v228 offset:0
    ds_read_b64_tr_b16 v[210:211], v228 offset:8192
    v_mfma_f32_16x16x32_bf16 a[4:7], v[192:195], v[160:163], a[4:7]
    s_sub_u32 s50, s34, s36
    v_exp_f32 v168, v96
    v_mfma_f32_16x16x32_bf16 a[8:11], v[192:195], v[164:167], a[8:11]
    s_waitcnt lgkmcnt(6)
    v_exp_f32 v169, v97
    v_mfma_f32_16x16x32_bf16 a[12:15], v[196:199], v[156:159], a[12:15]
    s_mov_b32 s36, s34
    ds_read_b64_tr_b16 v[212:213], v229 offset:0
    ds_read_b64_tr_b16 v[214:215], v229 offset:8192
    v_mfma_f32_16x16x32_bf16 a[16:19], v[196:199], v[160:163], a[16:19]
    s_add_u32 m0, s33, s32
    v_add_u32 v232, s50, v232
    v_add_u32 v233, s50, v233
    v_mfma_f32_16x16x32_bf16 a[20:23], v[196:199], v[164:167], a[20:23]
    s_waitcnt lgkmcnt(6)
    v_add_u32 v234, s50, v234
    v_add_u32 v235, s50, v235
    v_mfma_f32_16x16x32_bf16 a[24:27], v[200:203], v[156:159], a[24:27]
    ds_read_b64_tr_b16 v[216:217], v230 offset:0
    ds_read_b64_tr_b16 v[218:219], v230 offset:8192
    v_mfma_f32_16x16x32_bf16 a[28:31], v[200:203], v[160:163], a[28:31]
    buffer_load_dwordx4 v236, s[12:15], s38 offen offset:0 sc1 nt lds
    v_mfma_f32_16x16x32_bf16 a[32:35], v[200:203], v[164:167], a[32:35]
    s_waitcnt lgkmcnt(6)
    v_exp_f32 v170, v98
    v_mfma_f32_16x16x32_bf16 a[36:39], v[204:207], v[156:159], a[36:39]
    ds_read_b64_tr_b16 v[220:221], v231 offset:0
    ds_read_b64_tr_b16 v[222:223], v231 offset:8192
    v_mfma_f32_16x16x32_bf16 a[40:43], v[204:207], v[160:163], a[40:43]
    v_cvt_pk_bf16_f32 v144, v168, v169
    v_mfma_f32_16x16x32_bf16 a[44:47], v[204:207], v[164:167], a[44:47]
    s_waitcnt lgkmcnt(6)
    v_exp_f32 v171, v99
    v_mfma_f32_16x16x32_bf16 a[48:51], v[208:211], v[156:159], a[48:51]
    ds_read_b64_tr_b16 v[192:193], v224 offset:256
    ds_read_b64_tr_b16 v[194:195], v224 offset:8448
    v_mfma_f32_16x16x32_bf16 a[52:55], v[208:211], v[160:163], a[52:55]
    v_exp_f32 v172, v100
    v_mfma_f32_16x16x32_bf16 a[56:59], v[208:211], v[164:167], a[56:59]
    s_waitcnt lgkmcnt(6)
    buffer_load_dwordx4 v237, s[12:15], s38 offen offset:1024 sc1 nt lds
    v_mfma_f32_16x16x32_bf16 a[60:63], v[212:215], v[156:159], a[60:63]
    ds_read_b64_tr_b16 v[196:197], v225 offset:256
    ds_read_b64_tr_b16 v[198:199], v225 offset:8448
    v_mfma_f32_16x16x32_bf16 a[64:67], v[212:215], v[160:163], a[64:67]
    v_cvt_pk_bf16_f32 v145, v170, v171
    v_mfma_f32_16x16x32_bf16 a[68:71], v[212:215], v[164:167], a[68:71]
    s_waitcnt lgkmcnt(6)
    v_exp_f32 v173, v101
    v_mfma_f32_16x16x32_bf16 a[72:75], v[216:219], v[156:159], a[72:75]
    ds_read_b64_tr_b16 v[200:201], v226 offset:256
    ds_read_b64_tr_b16 v[202:203], v226 offset:8448
    v_mfma_f32_16x16x32_bf16 a[76:79], v[216:219], v[160:163], a[76:79]
    v_exp_f32 v174, v102
    v_mfma_f32_16x16x32_bf16 a[80:83], v[216:219], v[164:167], a[80:83]
    s_waitcnt lgkmcnt(6)
    v_cvt_pk_bf16_f32 v148, v172, v173
    v_mfma_f32_16x16x32_bf16 a[84:87], v[220:223], v[156:159], a[84:87]
    ds_read_b64_tr_b16 v[204:205], v227 offset:256
    ds_read_b64_tr_b16 v[206:207], v227 offset:8448
    v_mfma_f32_16x16x32_bf16 a[88:91], v[220:223], v[160:163], a[88:91]
    v_exp_f32 v175, v103
    v_mfma_f32_16x16x32_bf16 a[92:95], v[220:223], v[164:167], a[92:95]
    s_waitcnt lgkmcnt(6)
    v_exp_f32 v168, v104
    v_mfma_f32_16x16x32_bf16 a[96:99], v[192:195], v[156:159], a[96:99]
    ds_read_b64_tr_b16 v[208:209], v228 offset:256
    ds_read_b64_tr_b16 v[210:211], v228 offset:8448
    v_mfma_f32_16x16x32_bf16 a[100:103], v[192:195], v[160:163], a[100:103]
    buffer_load_dwordx4 v238, s[12:15], s38 offen offset:2048 sc1 nt lds
    v_mfma_f32_16x16x32_bf16 a[104:107], v[192:195], v[164:167], a[104:107]
    s_waitcnt lgkmcnt(6)
    v_cvt_pk_bf16_f32 v149, v174, v175
    v_mfma_f32_16x16x32_bf16 a[108:111], v[196:199], v[156:159], a[108:111]
    ds_read_b64_tr_b16 v[212:213], v229 offset:256
    ds_read_b64_tr_b16 v[214:215], v229 offset:8448
    v_mfma_f32_16x16x32_bf16 a[112:115], v[196:199], v[160:163], a[112:115]
    v_exp_f32 v169, v105
    v_mfma_f32_16x16x32_bf16 a[116:119], v[196:199], v[164:167], a[116:119]
    s_waitcnt lgkmcnt(6)
    v_exp_f32 v170, v106
    v_mfma_f32_16x16x32_bf16 a[120:123], v[200:203], v[156:159], a[120:123]
    ds_read_b64_tr_b16 v[216:217], v230 offset:256
    ds_read_b64_tr_b16 v[218:219], v230 offset:8448
    v_mfma_f32_16x16x32_bf16 a[124:127], v[200:203], v[160:163], a[124:127]
    v_cvt_pk_bf16_f32 v152, v168, v169
    v_mfma_f32_16x16x32_bf16 a[128:131], v[200:203], v[164:167], a[128:131]
    s_waitcnt lgkmcnt(6)
    v_exp_f32 v171, v107
    v_mfma_f32_16x16x32_bf16 a[132:135], v[204:207], v[156:159], a[132:135]
    ds_read_b64_tr_b16 v[220:221], v231 offset:256
    ds_read_b64_tr_b16 v[222:223], v231 offset:8448
    v_mfma_f32_16x16x32_bf16 a[136:139], v[204:207], v[160:163], a[136:139]
    buffer_load_dwordx4 v239, s[12:15], s38 offen offset:3072 sc1 nt lds
    v_mfma_f32_16x16x32_bf16 a[140:143], v[204:207], v[164:167], a[140:143]
    s_waitcnt lgkmcnt(6)
    s_waitcnt vmcnt(28)
    s_barrier
    v_exp_f32 v172, v108
    v_mfma_f32_16x16x32_bf16 a[144:147], v[208:211], v[156:159], a[144:147]
    s_add_u32 s33, s33, 16384
    s_cmp_eq_u32 s33, 163840
    s_cselect_b32 s33, 0, s33
    ds_read_b128 v[192:195], v232 offset:0
    v_cvt_pk_bf16_f32 v153, v170, v171
    v_mfma_f32_16x16x32_bf16 a[148:151], v[208:211], v[160:163], a[148:151]
    s_add_u32 s38, s38, 16384
    v_exp_f32 v173, v109
    v_mfma_f32_16x16x32_bf16 a[152:155], v[208:211], v[164:167], a[152:155]
    s_waitcnt lgkmcnt(5)
    v_exp_f32 v174, v110
    v_mfma_f32_16x16x32_bf16 a[156:159], v[212:215], v[156:159], a[156:159]
    ds_read_b128 v[196:199], v233 offset:0
    v_cvt_pk_bf16_f32 v146, v172, v173
    v_mfma_f32_16x16x32_bf16 a[160:163], v[212:215], v[160:163], a[160:163]
    v_exp_f32 v175, v111
    v_mfma_f32_16x16x32_bf16 a[164:167], v[212:215], v[164:167], a[164:167]
    s_waitcnt lgkmcnt(4)
    v_exp_f32 v168, v112
    v_mfma_f32_16x16x32_bf16 a[168:171], v[216:219], v[156:159], a[168:171]
    ds_read_b128 v[200:203], v234 offset:0
    v_cvt_pk_bf16_f32 v147, v174, v175
    v_mfma_f32_16x16x32_bf16 a[172:175], v[216:219], v[160:163], a[172:175]
    v_exp_f32 v169, v113
    v_mfma_f32_16x16x32_bf16 a[176:179], v[216:219], v[164:167], a[176:179]
    s_waitcnt lgkmcnt(3)
    v_exp_f32 v170, v114
    v_mfma_f32_16x16x32_bf16 a[180:183], v[220:223], v[156:159], a[180:183]
    ds_read_b128 v[204:207], v235 offset:0
    v_cvt_pk_bf16_f32 v150, v168, v169
    v_mfma_f32_16x16x32_bf16 a[184:187], v[220:223], v[160:163], a[184:187]
    v_exp_f32 v171, v115
    v_mfma_f32_16x16x32_bf16 a[188:191], v[220:223], v[164:167], a[188:191]
    s_waitcnt lgkmcnt(3)
    v_exp_f32 v172, v116
    v_mfma_f32_16x16x32_bf16 v[120:123], v[192:195], v[0:3], v[176:179]
    s_add_u32 s34, s34, 16384
    s_cmp_eq_u32 s34, 163840
    s_cselect_b32 s34, 0, s34
    ds_read_b128 v[208:211], v232 offset:256
    v_cvt_pk_bf16_f32 v151, v170, v171
    v_mfma_f32_16x16x32_bf16 v[124:127], v[192:195], v[4:7], v[180:183]
    s_sub_u32 s50, s34, s35
    v_exp_f32 v173, v117
    v_mfma_f32_16x16x32_bf16 v[128:131], v[192:195], v[8:11], v[184:187]
    s_waitcnt lgkmcnt(3)
    v_exp_f32 v174, v118
    v_mfma_f32_16x16x32_bf16 v[120:123], v[196:199], v[12:15], v[120:123]
    s_mov_b32 s35, s34
    ds_read_b128 v[212:215], v233 offset:256
    v_cvt_pk_bf16_f32 v154, v172, v173
    v_mfma_f32_16x16x32_bf16 v[124:127], v[196:199], v[16:19], v[124:127]
    s_add_u32 m0, s33, s32
    v_add_u32 v224, s50, v224
    v_add_u32 v225, s50, v225
    v_mfma_f32_16x16x32_bf16 v[128:131], v[196:199], v[20:23], v[128:131]
    s_waitcnt lgkmcnt(3)
    v_add_u32 v226, s50, v226
    v_add_u32 v227, s50, v227
    v_mfma_f32_16x16x32_bf16 v[120:123], v[200:203], v[24:27], v[120:123]
    ds_read_b128 v[216:219], v234 offset:256
    v_add_u32 v228, s50, v228
    v_mfma_f32_16x16x32_bf16 v[124:127], v[200:203], v[28:31], v[124:127]
    v_add_u32 v229, s50, v229
    v_add_u32 v230, s50, v230
    v_mfma_f32_16x16x32_bf16 v[128:131], v[200:203], v[32:35], v[128:131]
    s_waitcnt lgkmcnt(3)
    v_add_u32 v231, s50, v231
    v_mfma_f32_16x16x32_bf16 v[120:123], v[204:207], v[36:39], v[120:123]
    ds_read_b128 v[220:223], v235 offset:256
    v_mfma_f32_16x16x32_bf16 v[124:127], v[204:207], v[40:43], v[124:127]
    buffer_load_dwordx4 v236, s[8:11], s37 offen offset:0 sc1 nt lds
    v_mfma_f32_16x16x32_bf16 v[128:131], v[204:207], v[44:47], v[128:131]
    s_waitcnt lgkmcnt(3)
    v_exp_f32 v175, v119
    v_mfma_f32_16x16x32_bf16 v[120:123], v[208:211], v[48:51], v[120:123]
    ds_read_b128 v[192:195], v232 offset:8192
    v_or3_b32 v188, v144, v145, v148
    v_mfma_f32_16x16x32_bf16 v[124:127], v[208:211], v[52:55], v[124:127]
    v_cvt_pk_bf16_f32 v155, v174, v175
    v_or3_b32 v188, v188, v149, v152
    v_mfma_f32_16x16x32_bf16 v[128:131], v[208:211], v[56:59], v[128:131]
    s_waitcnt lgkmcnt(3)
    buffer_load_dwordx4 v237, s[8:11], s37 offen offset:1024 sc1 nt lds
    v_mfma_f32_16x16x32_bf16 v[120:123], v[212:215], v[60:63], v[120:123]
    ds_read_b128 v[196:199], v233 offset:8192
    v_or3_b32 v188, v188, v153, v146
    v_mfma_f32_16x16x32_bf16 v[124:127], v[212:215], v[64:67], v[124:127]
    v_or3_b32 v188, v188, v147, v150
    v_or3_b32 v188, v188, v151, v154
    v_mfma_f32_16x16x32_bf16 v[128:131], v[212:215], v[68:71], v[128:131]
    s_waitcnt lgkmcnt(3)
    v_or_b32 v188, v188, v155
    v_and_b32 v188, 0x40004000, v188
    v_mfma_f32_16x16x32_bf16 v[120:123], v[216:219], v[72:75], v[120:123]
    ds_read_b128 v[200:203], v234 offset:8192
    v_cmp_ne_u32 vcc, 0, v188
    v_mfma_f32_16x16x32_bf16 v[124:127], v[216:219], v[76:79], v[124:127]
    v_mfma_f32_16x16x32_bf16 v[128:131], v[216:219], v[80:83], v[128:131]
    s_waitcnt lgkmcnt(3)
    v_mfma_f32_16x16x32_bf16 v[120:123], v[220:223], v[84:87], v[120:123]
    ds_read_b128 v[204:207], v235 offset:8192
    v_mfma_f32_16x16x32_bf16 v[124:127], v[220:223], v[88:91], v[124:127]
    v_mfma_f32_16x16x32_bf16 v[128:131], v[220:223], v[92:95], v[128:131]
    s_waitcnt lgkmcnt(3)
    v_mfma_f32_16x16x32_bf16 v[132:135], v[192:195], v[0:3], v[176:179]
    ds_read_b128 v[208:211], v232 offset:8448
    v_mfma_f32_16x16x32_bf16 v[136:139], v[192:195], v[4:7], v[180:183]
    buffer_load_dwordx4 v238, s[8:11], s37 offen offset:2048 sc1 nt lds
    v_mfma_f32_16x16x32_bf16 v[140:143], v[192:195], v[8:11], v[184:187]
    s_waitcnt lgkmcnt(3)
    v_mfma_f32_16x16x32_bf16 v[132:135], v[196:199], v[12:15], v[132:135]
    ds_read_b128 v[212:215], v233 offset:8448
    v_mfma_f32_16x16x32_bf16 v[136:139], v[196:199], v[16:19], v[136:139]
    v_mfma_f32_16x16x32_bf16 v[140:143], v[196:199], v[20:23], v[140:143]
    s_waitcnt lgkmcnt(3)
    v_mfma_f32_16x16x32_bf16 v[132:135], v[200:203], v[24:27], v[132:135]
    ds_read_b128 v[216:219], v234 offset:8448
    v_mfma_f32_16x16x32_bf16 v[136:139], v[200:203], v[28:31], v[136:139]
    v_mfma_f32_16x16x32_bf16 v[140:143], v[200:203], v[32:35], v[140:143]
    s_waitcnt lgkmcnt(3)
    v_mfma_f32_16x16x32_bf16 v[132:135], v[204:207], v[36:39], v[132:135]
    ds_read_b128 v[220:223], v235 offset:8448
    v_mfma_f32_16x16x32_bf16 v[136:139], v[204:207], v[40:43], v[136:139]
    buffer_load_dwordx4 v239, s[8:11], s37 offen offset:3072 sc1 nt lds
    v_mfma_f32_16x16x32_bf16 v[140:143], v[204:207], v[44:47], v[140:143]
    s_waitcnt lgkmcnt(3)
    s_waitcnt vmcnt(28)
    s_barrier
    v_mfma_f32_16x16x32_bf16 v[132:135], v[208:211], v[48:51], v[132:135]
    s_add_u32 s33, s33, 16384
    s_cmp_eq_u32 s33, 163840
    s_cselect_b32 s33, 0, s33
    ds_read_b64_tr_b16 v[192:193], v224 offset:0
    ds_read_b64_tr_b16 v[194:195], v224 offset:8192
    v_mfma_f32_16x16x32_bf16 v[136:139], v[208:211], v[52:55], v[136:139]
    s_add_u32 s37, s37, 16384
    v_mfma_f32_16x16x32_bf16 v[140:143], v[208:211], v[56:59], v[140:143]
    s_waitcnt lgkmcnt(4)
    v_mfma_f32_16x16x32_bf16 v[132:135], v[212:215], v[60:63], v[132:135]
    ds_read_b64_tr_b16 v[196:197], v225 offset:0
    ds_read_b64_tr_b16 v[198:199], v225 offset:8192
    v_mfma_f32_16x16x32_bf16 v[136:139], v[212:215], v[64:67], v[136:139]
    v_mfma_f32_16x16x32_bf16 v[140:143], v[212:215], v[68:71], v[140:143]
    s_waitcnt lgkmcnt(5)
    v_mfma_f32_16x16x32_bf16 v[132:135], v[216:219], v[72:75], v[132:135]
    ds_read_b64_tr_b16 v[200:201], v226 offset:0
    ds_read_b64_tr_b16 v[202:203], v226 offset:8192
    v_mfma_f32_16x16x32_bf16 v[136:139], v[216:219], v[76:79], v[136:139]
    v_mfma_f32_16x16x32_bf16 v[140:143], v[216:219], v[80:83], v[140:143]
    s_waitcnt lgkmcnt(6)
    v_mfma_f32_16x16x32_bf16 v[132:135], v[220:223], v[84:87], v[132:135]
    ds_read_b64_tr_b16 v[204:205], v227 offset:0
    ds_read_b64_tr_b16 v[206:207], v227 offset:8192
    v_mfma_f32_16x16x32_bf16 v[136:139], v[220:223], v[88:91], v[136:139]
    v_mfma_f32_16x16x32_bf16 v[140:143], v[220:223], v[92:95], v[140:143]
    s_waitcnt lgkmcnt(6)
    s_cbranch_vccnz L_stub3
L_back3:
    v_mfma_f32_16x16x32_bf16 a[192:195], a[204:207], v[144:147], a[192:195]
    v_mfma_f32_16x16x32_bf16 a[196:199], a[204:207], v[148:151], a[196:199]
    v_mfma_f32_16x16x32_bf16 a[200:203], a[204:207], v[152:155], a[200:203]
    v_mfma_f32_16x16x32_bf16 a[0:3], v[192:195], v[144:147], a[0:3]
    s_add_u32 s34, s34, 16384
    s_cmp_eq_u32 s34, 163840
    s_cselect_b32 s34, 0, s34
    ds_read_b64_tr_b16 v[208:209], v228 offset:0
    ds_read_b64_tr_b16 v[210:211], v228 offset:8192
    v_mfma_f32_16x16x32_bf16 a[4:7], v[192:195], v[148:151], a[4:7]
    s_sub_u32 s50, s34, s36
    v_exp_f32 v168, v120
    v_mfma_f32_16x16x32_bf16 a[8:11], v[192:195], v[152:155], a[8:11]
    s_waitcnt lgkmcnt(6)
    v_exp_f32 v169, v121
    v_mfma_f32_16x16x32_bf16 a[12:15], v[196:199], v[144:147], a[12:15]
    s_mov_b32 s36, s34
    ds_read_b64_tr_b16 v[212:213], v229 offset:0
    ds_read_b64_tr_b16 v[214:215], v229 offset:8192
    v_mfma_f32_16x16x32_bf16 a[16:19], v[196:199], v[148:151], a[16:19]
    s_add_u32 m0, s33, s32
    v_add_u32 v232, s50, v232
    v_add_u32 v233, s50, v233
    v_mfma_f32_16x16x32_bf16 a[20:23], v[196:199], v[152:155], a[20:23]
    s_waitcnt lgkmcnt(6)
    v_add_u32 v234, s50, v234
    v_add_u32 v235, s50, v235
    v_mfma_f32_16x16x32_bf16 a[24:27], v[200:203], v[144:147], a[24:27]
    ds_read_b64_tr_b16 v[216:217], v230 offset:0
    ds_read_b64_tr_b16 v[218:219], v230 offset:8192
    v_mfma_f32_16x16x32_bf16 a[28:31], v[200:203], v[148:151], a[28:31]
    buffer_load_dwordx4 v236, s[12:15], s38 offen offset:0 sc1 nt lds
    v_mfma_f32_16x16x32_bf16 a[32:35], v[200:203], v[152:155], a[32:35]
    s_waitcnt lgkmcnt(6)
    v_exp_f32 v170, v122
    v_mfma_f32_16x16x32_bf16 a[36:39], v[204:207], v[144:147], a[36:39]
    ds_read_b64_tr_b16 v[220:221], v231 offset:0
    ds_read_b64_tr_b16 v[222:223], v231 offset:8192
    v_mfma_f32_16x16x32_bf16 a[40:43], v[204:207], v[148:151], a[40:43]
    v_cvt_pk_bf16_f32 v156, v168, v169
    v_mfma_f32_16x16x32_bf16 a[44:47], v[204:207], v[152:155], a[44:47]
    s_waitcnt lgkmcnt(6)
    v_exp_f32 v171, v123
    v_mfma_f32_16x16x32_bf16 a[48:51], v[208:211], v[144:147], a[48:51]
    ds_read_b64_tr_b16 v[192:193], v224 offset:256
    ds_read_b64_tr_b16 v[194:195], v224 offset:8448
    v_mfma_f32_16x16x32_bf16 a[52:55], v[208:211], v[148:151], a[52:55]
    v_exp_f32 v172, v124
    v_mfma_f32_16x16x32_bf16 a[56:59], v[208:211], v[152:155], a[56:59]
    s_waitcnt lgkmcnt(6)
    buffer_load_dwordx4 v237, s[12:15], s38 offen offset:1024 sc1 nt lds
    v_mfma_f32_16x16x32_bf16 a[60:63], v[212:215], v[144:147], a[60:63]
    ds_read_b64_tr_b16 v[196:197], v225 offset:256
    ds_read_b64_tr_b16 v[198:199], v225 offset:8448
    v_mfma_f32_16x16x32_bf16 a[64:67], v[212:215], v[148:151], a[64:67]
    v_cvt_pk_bf16_f32 v157, v170, v171
    v_mfma_f32_16x16x32_bf16 a[68:71], v[212:215], v[152:155], a[68:71]
    s_waitcnt lgkmcnt(6)
    v_exp_f32 v173, v125
    v_mfma_f32_16x16x32_bf16 a[72:75], v[216:219], v[144:147], a[72:75]
    ds_read_b64_tr_b16 v[200:201], v226 offset:256
    ds_read_b64_tr_b16 v[202:203], v226 offset:8448
    v_mfma_f32_16x16x32_bf16 a[76:79], v[216:219], v[148:151], a[76:79]
    v_exp_f32 v174, v126
    v_mfma_f32_16x16x32_bf16 a[80:83], v[216:219], v[152:155], a[80:83]
    s_waitcnt lgkmcnt(6)
    v_cvt_pk_bf16_f32 v160, v172, v173
    v_mfma_f32_16x16x32_bf16 a[84:87], v[220:223], v[144:147], a[84:87]
    ds_read_b64_tr_b16 v[204:205], v227 offset:256
    ds_read_b64_tr_b16 v[206:207], v227 offset:8448
    v_mfma_f32_16x16x32_bf16 a[88:91], v[220:223], v[148:151], a[88:91]
    v_exp_f32 v175, v127
    v_mfma_f32_16x16x32_bf16 a[92:95], v[220:223], v[152:155], a[92:95]
    s_waitcnt lgkmcnt(6)
    v_exp_f32 v168, v128
    v_mfma_f32_16x16x32_bf16 a[96:99], v[192:195], v[144:147], a[96:99]
    ds_read_b64_tr_b16 v[208:209], v228 offset:256
    ds_read_b64_tr_b16 v[210:211], v228 offset:8448
    v_mfma_f32_16x16x32_bf16 a[100:103], v[192:195], v[148:151], a[100:103]
    buffer_load_dwordx4 v238, s[12:15], s38 offen offset:2048 sc1 nt lds
    v_mfma_f32_16x16x32_bf16 a[104:107], v[192:195], v[152:155], a[104:107]
    s_waitcnt lgkmcnt(6)
    v_cvt_pk_bf16_f32 v161, v174, v175
    v_mfma_f32_16x16x32_bf16 a[108:111], v[196:199], v[144:147], a[108:111]
    ds_read_b64_tr_b16 v[212:213], v229 offset:256
    ds_read_b64_tr_b16 v[214:215], v229 offset:8448
    v_mfma_f32_16x16x32_bf16 a[112:115], v[196:199], v[148:151], a[112:115]
    v_exp_f32 v169, v129
    v_mfma_f32_16x16x32_bf16 a[116:119], v[196:199], v[152:155], a[116:119]
    s_waitcnt lgkmcnt(6)
    v_exp_f32 v170, v130
    v_mfma_f32_16x16x32_bf16 a[120:123], v[200:203], v[144:147], a[120:123]
    ds_read_b64_tr_b16 v[216:217], v230 offset:256
    ds_read_b64_tr_b16 v[218:219], v230 offset:8448
    v_mfma_f32_16x16x32_bf16 a[124:127], v[200:203], v[148:151], a[124:127]
    v_cvt_pk_bf16_f32 v164, v168, v169
    v_mfma_f32_16x16x32_bf16 a[128:131], v[200:203], v[152:155], a[128:131]
    s_waitcnt lgkmcnt(6)
    v_exp_f32 v171, v131
    v_mfma_f32_16x16x32_bf16 a[132:135], v[204:207], v[144:147], a[132:135]
    ds_read_b64_tr_b16 v[220:221], v231 offset:256
    ds_read_b64_tr_b16 v[222:223], v231 offset:8448
    v_mfma_f32_16x16x32_bf16 a[136:139], v[204:207], v[148:151], a[136:139]
    buffer_load_dwordx4 v239, s[12:15], s38 offen offset:3072 sc1 nt lds
    v_mfma_f32_16x16x32_bf16 a[140:143], v[204:207], v[152:155], a[140:143]
    s_waitcnt lgkmcnt(6)
    s_waitcnt vmcnt(28)
    s_barrier
    v_exp_f32 v172, v132
    v_mfma_f32_16x16x32_bf16 a[144:147], v[208:211], v[144:147], a[144:147]
    s_add_u32 s33, s33, 16384
    s_cmp_eq_u32 s33, 163840
    s_cselect_b32 s33, 0, s33
    ds_read_b128 v[192:195], v232 offset:0
    v_cvt_pk_bf16_f32 v165, v170, v171
    v_mfma_f32_16x16x32_bf16 a[148:151], v[208:211], v[148:151], a[148:151]
    s_add_u32 s38, s38, 16384
    v_exp_f32 v173, v133
    v_mfma_f32_16x16x32_bf16 a[152:155], v[208:211], v[152:155], a[152:155]
    s_waitcnt lgkmcnt(5)
    v_exp_f32 v174, v134
    v_mfma_f32_16x16x32_bf16 a[156:159], v[212:215], v[144:147], a[156:159]
    ds_read_b128 v[196:199], v233 offset:0
    v_cvt_pk_bf16_f32 v158, v172, v173
    v_mfma_f32_16x16x32_bf16 a[160:163], v[212:215], v[148:151], a[160:163]
    v_exp_f32 v175, v135
    v_mfma_f32_16x16x32_bf16 a[164:167], v[212:215], v[152:155], a[164:167]
    s_waitcnt lgkmcnt(4)
    v_exp_f32 v168, v136
    v_mfma_f32_16x16x32_bf16 a[168:171], v[216:219], v[144:147], a[168:171]
    ds_read_b128 v[200:203], v234 offset:0
    v_cvt_pk_bf16_f32 v159, v174, v175
    v_mfma_f32_16x16x32_bf16 a[172:175], v[216:219], v[148:151], a[172:175]
    v_exp_f32 v169, v137
    v_mfma_f32_16x16x32_bf16 a[176:179], v[216:219], v[152:155], a[176:179]
    s_waitcnt lgkmcnt(3)
    v_exp_f32 v170, v138
    v_mfma_f32_16x16x32_bf16 a[180:183], v[220:223], v[144:147], a[180:183]
    ds_read_b128 v[204:207], v235 offset:0
    v_cvt_pk_bf16_f32 v162, v168, v169
    v_mfma_f32_16x16x32_bf16 a[184:187], v[220:223], v[148:151], a[184:187]
    v_exp_f32 v171, v139
    v_mfma_f32_16x16x32_bf16 a[188:191], v[220:223], v[152:155], a[188:191]
    s_waitcnt lgkmcnt(3)
    v_exp_f32 v172, v140
    v_mfma_f32_16x16x32_bf16 v[96:99], v[192:195], v[0:3], v[176:179]
    s_add_u32 s34, s34, 16384
    s_cmp_eq_u32 s34, 163840
    s_cselect_b32 s34, 0, s34
    ds_read_b128 v[208:211], v232 offset:256
    v_cvt_pk_bf16_f32 v163, v170, v171
    v_mfma_f32_16x16x32_bf16 v[100:103], v[192:195], v[4:7], v[180:183]
    s_sub_u32 s50, s34, s35
    v_exp_f32 v173, v141
    v_mfma_f32_16x16x32_bf16 v[104:107], v[192:195], v[8:11], v[184:187]
    s_waitcnt lgkmcnt(3)
    v_exp_f32 v174, v142
    v_mfma_f32_16x16x32_bf16 v[96:99], v[196:199], v[12:15], v[96:99]
    s_mov_b32 s35, s34
    ds_read_b128 v[212:215], v233 offset:256
    v_cvt_pk_bf16_f32 v166, v172, v173
    v_mfma_f32_16x16x32_bf16 v[100:103], v[196:199], v[16:19], v[100:103]
    s_add_u32 m0, s33, s32
    v_add_u32 v224, s50, v224
    v_add_u32 v225, s50, v225
    v_mfma_f32_16x16x32_bf16 v[104:107], v[196:199], v[20:23], v[104:107]
    s_waitcnt lgkmcnt(3)
    v_add_u32 v226, s50, v226
    v_add_u32 v227, s50, v227
    v_mfma_f32_16x16x32_bf16 v[96:99], v[200:203], v[24:27], v[96:99]
    ds_read_b128 v[216:219], v234 offset:256
    v_add_u32 v228, s50, v228
    v_mfma_f32_16x16x32_bf16 v[100:103], v[200:203], v[28:31], v[100:103]
    v_add_u32 v229, s50, v229
    v_add_u32 v230, s50, v230
    v_mfma_f32_16x16x32_bf16 v[104:107], v[200:203], v[32:35], v[104:107]
    s_waitcnt lgkmcnt(3)
    v_add_u32 v231, s50, v231
    v_mfma_f32_16x16x32_bf16 v[96:99], v[204:207], v[36:39], v[96:99]
    ds_read_b128 v[220:223], v235 offset:256
    v_mfma_f32_16x16x32_bf16 v[100:103], v[204:207], v[40:43], v[100:103]
    buffer_load_dwordx4 v236, s[12:15], s38 offen offset:0 sc1 nt lds
    v_mfma_f32_16x16x32_bf16 v[104:107], v[204:207], v[44:47], v[104:107]
    s_waitcnt lgkmcnt(3)
    v_exp_f32 v175, v143
    v_mfma_f32_16x16x32_bf16 v[96:99], v[208:211], v[48:51], v[96:99]
    ds_read_b128 v[192:195], v232 offset:8192
    v_or3_b32 v188, v156, v157, v160
    v_mfma_f32_16x16x32_bf16 v[100:103], v[208:211], v[52:55], v[100:103]
    v_cvt_pk_bf16_f32 v167, v174, v175
    v_or3_b32 v188, v188, v161, v164
    v_mfma_f32_16x16x32_bf16 v[104:107], v[208:211], v[56:59], v[104:107]
    s_waitcnt lgkmcnt(3)
    buffer_load_dwordx4 v237, s[12:15], s38 offen offset:1024 sc1 nt lds
    v_mfma_f32_16x16x32_bf16 v[96:99], v[212:215], v[60:63], v[96:99]
    ds_read_b128 v[196:199], v233 offset:8192
    v_or3_b32 v188, v188, v165, v158
    v_mfma_f32_16x16x32_bf16 v[100:103], v[212:215], v[64:67], v[100:103]
    v_or3_b32 v188, v188, v159, v162
    v_or3_b32 v188, v188, v163, v166
    v_mfma_f32_16x16x32_bf16 v[104:107], v[212:215], v[68:71], v[104:107]
    s_waitcnt lgkmcnt(3)
    v_or_b32 v188, v188, v167
    v_and_b32 v188, 0x40004000, v188
    v_mfma_f32_16x16x32_bf16 v[96:99], v[216:219], v[72:75], v[96:99]
    ds_read_b128 v[200:203], v234 offset:8192
    v_cmp_ne_u32 vcc, 0, v188
    v_mfma_f32_16x16x32_bf16 v[100:103], v[216:219], v[76:79], v[100:103]
    v_mfma_f32_16x16x32_bf16 v[104:107], v[216:219], v[80:83], v[104:107]
    s_waitcnt lgkmcnt(3)
    v_mfma_f32_16x16x32_bf16 v[96:99], v[220:223], v[84:87], v[96:99]
    ds_read_b128 v[204:207], v235 offset:8192
    v_mfma_f32_16x16x32_bf16 v[100:103], v[220:223], v[88:91], v[100:103]
    v_mfma_f32_16x16x32_bf16 v[104:107], v[220:223], v[92:95], v[104:107]
    s_waitcnt lgkmcnt(3)
    v_mfma_f32_16x16x32_bf16 v[108:111], v[192:195], v[0:3], v[176:179]
    ds_read_b128 v[208:211], v232 offset:8448
    v_mfma_f32_16x16x32_bf16 v[112:115], v[192:195], v[4:7], v[180:183]
    buffer_load_dwordx4 v238, s[12:15], s38 offen offset:2048 sc1 nt lds
    v_mfma_f32_16x16x32_bf16 v[116:119], v[192:195], v[8:11], v[184:187]
    s_waitcnt lgkmcnt(3)
    v_mfma_f32_16x16x32_bf16 v[108:111], v[196:199], v[12:15], v[108:111]
    ds_read_b128 v[212:215], v233 offset:8448
    v_mfma_f32_16x16x32_bf16 v[112:115], v[196:199], v[16:19], v[112:115]
    v_mfma_f32_16x16x32_bf16 v[116:119], v[196:199], v[20:23], v[116:119]
    s_waitcnt lgkmcnt(3)
    v_mfma_f32_16x16x32_bf16 v[108:111], v[200:203], v[24:27], v[108:111]
    ds_read_b128 v[216:219], v234 offset:8448
    v_mfma_f32_16x16x32_bf16 v[112:115], v[200:203], v[28:31], v[112:115]
    v_mfma_f32_16x16x32_bf16 v[116:119], v[200:203], v[32:35], v[116:119]
    s_waitcnt lgkmcnt(3)
    v_mfma_f32_16x16x32_bf16 v[108:111], v[204:207], v[36:39], v[108:111]
    ds_read_b128 v[220:223], v235 offset:8448
    v_mfma_f32_16x16x32_bf16 v[112:115], v[204:207], v[40:43], v[112:115]
    buffer_load_dwordx4 v239, s[12:15], s38 offen offset:3072 sc1 nt lds
    v_mfma_f32_16x16x32_bf16 v[116:119], v[204:207], v[44:47], v[116:119]
    s_waitcnt lgkmcnt(3)
    s_waitcnt vmcnt(28)
    s_barrier
    v_mfma_f32_16x16x32_bf16 v[108:111], v[208:211], v[48:51], v[108:111]
    s_add_u32 s33, s33, 16384
    s_cmp_eq_u32 s33, 163840
    s_cselect_b32 s33, 0, s33
    ds_read_b64_tr_b16 v[192:193], v224 offset:0
    ds_read_b64_tr_b16 v[194:195], v224 offset:8192
    v_mfma_f32_16x16x32_bf16 v[112:115], v[208:211], v[52:55], v[112:115]
    s_add_u32 s38, s38, 16384
    v_mfma_f32_16x16x32_bf16 v[116:119], v[208:211], v[56:59], v[116:119]
    s_waitcnt lgkmcnt(4)
    v_mfma_f32_16x16x32_bf16 v[108:111], v[212:215], v[60:63], v[108:111]
    ds_read_b64_tr_b16 v[196:197], v225 offset:0
    ds_read_b64_tr_b16 v[198:199], v225 offset:8192
    v_mfma_f32_16x16x32_bf16 v[112:115], v[212:215], v[64:67], v[112:115]
    v_mfma_f32_16x16x32_bf16 v[116:119], v[212:215], v[68:71], v[116:119]
    s_waitcnt lgkmcnt(5)
    v_mfma_f32_16x16x32_bf16 v[108:111], v[216:219], v[72:75], v[108:111]
    ds_read_b64_tr_b16 v[200:201], v226 offset:0
    ds_read_b64_tr_b16 v[202:203], v226 offset:8192
    v_mfma_f32_16x16x32_bf16 v[112:115], v[216:219], v[76:79], v[112:115]
    v_mfma_f32_16x16x32_bf16 v[116:119], v[216:219], v[80:83], v[116:119]
    s_waitcnt lgkmcnt(6)
    v_mfma_f32_16x16x32_bf16 v[108:111], v[220:223], v[84:87], v[108:111]
    ds_read_b64_tr_b16 v[204:205], v227 offset:0
    ds_read_b64_tr_b16 v[206:207], v227 offset:8192
    v_mfma_f32_16x16x32_bf16 v[112:115], v[220:223], v[88:91], v[112:115]
    v_mfma_f32_16x16x32_bf16 v[116:119], v[220:223], v[92:95], v[116:119]
    s_waitcnt lgkmcnt(6)
    s_cbranch_vccnz L_stub4
L_back4:
    v_mfma_f32_16x16x32_bf16 a[192:195], a[204:207], v[156:159], a[192:195]
    v_mfma_f32_16x16x32_bf16 a[196:199], a[204:207], v[160:163], a[196:199]
    v_mfma_f32_16x16x32_bf16 a[200:203], a[204:207], v[164:167], a[200:203]
    v_mfma_f32_16x16x32_bf16 a[0:3], v[192:195], v[156:159], a[0:3]
    s_add_u32 s34, s34, 16384
    s_cmp_eq_u32 s34, 163840
    s_cselect_b32 s34, 0, s34
    ds_read_b64_tr_b16 v[208:209], v228 offset:0
    ds_read_b64_tr_b16 v[210:211], v228 offset:8192
    v_mfma_f32_16x16x32_bf16 a[4:7], v[192:195], v[160:163], a[4:7]
    s_sub_u32 s50, s34, s36
    v_exp_f32 v168, v96
    v_mfma_f32_16x16x32_bf16 a[8:11], v[192:195], v[164:167], a[8:11]
    s_waitcnt lgkmcnt(6)
    v_exp_f32 v169, v97
    v_mfma_f32_16x16x32_bf16 a[12:15], v[196:199], v[156:159], a[12:15]
    s_mov_b32 s36, s34
    ds_read_b64_tr_b16 v[212:213], v229 offset:0
    ds_read_b64_tr_b16 v[214:215], v229 offset:8192
    v_mfma_f32_16x16x32_bf16 a[16:19], v[196:199], v[160:163], a[16:19]
    s_add_u32 m0, s33, s32
    v_add_u32 v232, s50, v232
    v_add_u32 v233, s50, v233
    v_mfma_f32_16x16x32_bf16 a[20:23], v[196:199], v[164:167], a[20:23]
    s_waitcnt lgkmcnt(6)
    v_add_u32 v234, s50, v234
    v_add_u32 v235, s50, v235
    v_mfma_f32_16x16x32_bf16 a[24:27], v[200:203], v[156:159], a[24:27]
    ds_read_b64_tr_b16 v[216:217], v230 offset:0
    ds_read_b64_tr_b16 v[218:219], v230 offset:8192
    v_mfma_f32_16x16x32_bf16 a[28:31], v[200:203], v[160:163], a[28:31]
    buffer_load_dwordx4 v244, s[20:23], s64 offen offset:0 lds
    v_mfma_f32_16x16x32_bf16 a[32:35], v[200:203], v[164:167], a[32:35]
    s_waitcnt lgkmcnt(6)
    v_exp_f32 v170, v98
    v_mfma_f32_16x16x32_bf16 a[36:39], v[204:207], v[156:159], a[36:39]
    ds_read_b64_tr_b16 v[220:221], v231 offset:0
    ds_read_b64_tr_b16 v[222:223], v231 offset:8192
    v_mfma_f32_16x16x32_bf16 a[40:43], v[204:207], v[160:163], a[40:43]
    buffer_load_dword a252, v252, s[16:19], s83 offen
    v_mfma_f32_16x16x32_bf16 a[44:47], v[204:207], v[164:167], a[44:47]
    s_waitcnt lgkmcnt(6)
    v_cvt_pk_bf16_f32 v144, v168, v169
    v_mfma_f32_16x16x32_bf16 a[48:51], v[208:211], v[156:159], a[48:51]
    ds_read_b64_tr_b16 v[192:193], v224 offset:256
    ds_read_b64_tr_b16 v[194:195], v224 offset:8448
    v_mfma_f32_16x16x32_bf16 a[52:55], v[208:211], v[160:163], a[52:55]
    v_exp_f32 v171, v99
    v_mfma_f32_16x16x32_bf16 a[56:59], v[208:211], v[164:167], a[56:59]
    s_waitcnt lgkmcnt(6)
    buffer_load_dwordx4 v245, s[20:23], s64 offen offset:1024 lds
    v_mfma_f32_16x16x32_bf16 a[60:63], v[212:215], v[156:159], a[60:63]
    ds_read_b64_tr_b16 v[196:197], v225 offset:256
    ds_read_b64_tr_b16 v[198:199], v225 offset:8448
    v_mfma_f32_16x16x32_bf16 a[64:67], v[212:215], v[160:163], a[64:67]
    v_exp_f32 v172, v100
    v_mfma_f32_16x16x32_bf16 a[68:71], v[212:215], v[164:167], a[68:71]
    s_waitcnt lgkmcnt(6)
    v_cvt_pk_bf16_f32 v145, v170, v171
    v_mfma_f32_16x16x32_bf16 a[72:75], v[216:219], v[156:159], a[72:75]
    ds_read_b64_tr_b16 v[200:201], v226 offset:256
    ds_read_b64_tr_b16 v[202:203], v226 offset:8448
    v_mfma_f32_16x16x32_bf16 a[76:79], v[216:219], v[160:163], a[76:79]
    v_exp_f32 v173, v101
    v_mfma_f32_16x16x32_bf16 a[80:83], v[216:219], v[164:167], a[80:83]
    s_waitcnt lgkmcnt(6)
    v_exp_f32 v174, v102
    v_mfma_f32_16x16x32_bf16 a[84:87], v[220:223], v[156:159], a[84:87]
    ds_read_b64_tr_b16 v[204:205], v227 offset:256
    ds_read_b64_tr_b16 v[206:207], v227 offset:8448
    v_mfma_f32_16x16x32_bf16 a[88:91], v[220:223], v[160:163], a[88:91]
    v_cvt_pk_bf16_f32 v148, v172, v173
    v_mfma_f32_16x16x32_bf16 a[92:95], v[220:223], v[164:167], a[92:95]
    s_waitcnt lgkmcnt(6)
    v_exp_f32 v175, v103
    v_mfma_f32_16x16x32_bf16 a[96:99], v[192:195], v[156:159], a[96:99]
    ds_read_b64_tr_b16 v[208:209], v228 offset:256
    ds_read_b64_tr_b16 v[210:211], v228 offset:8448
    v_mfma_f32_16x16x32_bf16 a[100:103], v[192:195], v[160:163], a[100:103]
    buffer_load_dwordx4 v246, s[20:23], s64 offen offset:2048 lds
    v_mfma_f32_16x16x32_bf16 a[104:107], v[192:195], v[164:167], a[104:107]
    s_waitcnt lgkmcnt(6)
    v_exp_f32 v168, v104
    v_mfma_f32_16x16x32_bf16 a[108:111], v[196:199], v[156:159], a[108:111]
    ds_read_b64_tr_b16 v[212:213], v229 offset:256
    ds_read_b64_tr_b16 v[214:215], v229 offset:8448
    v_mfma_f32_16x16x32_bf16 a[112:115], v[196:199], v[160:163], a[112:115]
    v_cvt_pk_bf16_f32 v149, v174, v175
    v_mfma_f32_16x16x32_bf16 a[116:119], v[196:199], v[164:167], a[116:119]
    s_waitcnt lgkmcnt(6)
    v_exp_f32 v169, v105
    v_mfma_f32_16x16x32_bf16 a[120:123], v[200:203], v[156:159], a[120:123]
    ds_read_b64_tr_b16 v[216:217], v230 offset:256
    ds_read_b64_tr_b16 v[218:219], v230 offset:8448
    v_mfma_f32_16x16x32_bf16 a[124:127], v[200:203], v[160:163], a[124:127]
    v_exp_f32 v170, v106
    v_mfma_f32_16x16x32_bf16 a[128:131], v[200:203], v[164:167], a[128:131]
    s_waitcnt lgkmcnt(6)
    v_cvt_pk_bf16_f32 v152, v168, v169
    v_mfma_f32_16x16x32_bf16 a[132:135], v[204:207], v[156:159], a[132:135]
    ds_read_b64_tr_b16 v[220:221], v231 offset:256
    ds_read_b64_tr_b16 v[222:223], v231 offset:8448
    v_mfma_f32_16x16x32_bf16 a[136:139], v[204:207], v[160:163], a[136:139]
    buffer_load_dwordx4 v247, s[20:23], s64 offen offset:3072 lds
    v_mfma_f32_16x16x32_bf16 a[140:143], v[204:207], v[164:167], a[140:143]
    s_waitcnt lgkmcnt(6)
    s_waitcnt vmcnt(29)
    s_barrier
    v_exp_f32 v171, v107
    v_mfma_f32_16x16x32_bf16 a[144:147], v[208:211], v[156:159], a[144:147]
    s_add_u32 s33, s33, 16384
    s_cmp_eq_u32 s33, 163840
    s_cselect_b32 s33, 0, s33
    ds_read_b128 v[192:195], v232 offset:0
    v_mfma_f32_16x16x32_bf16 a[148:151], v[208:211], v[160:163], a[148:151]
    v_exp_f32 v172, v108
    v_mfma_f32_16x16x32_bf16 a[152:155], v[208:211], v[164:167], a[152:155]
    s_waitcnt lgkmcnt(5)
    v_cvt_pk_bf16_f32 v153, v170, v171
    v_mfma_f32_16x16x32_bf16 a[156:159], v[212:215], v[156:159], a[156:159]
    ds_read_b128 v[196:199], v233 offset:0
    v_mfma_f32_16x16x32_bf16 a[160:163], v[212:215], v[160:163], a[160:163]
    v_exp_f32 v173, v109
    v_mfma_f32_16x16x32_bf16 a[164:167], v[212:215], v[164:167], a[164:167]
    s_waitcnt lgkmcnt(4)
    v_exp_f32 v174, v110
    v_mfma_f32_16x16x32_bf16 a[168:171], v[216:219], v[156:159], a[168:171]
    ds_read_b128 v[200:203], v234 offset:0
    v_cvt_pk_bf16_f32 v146, v172, v173
    v_mfma_f32_16x16x32_bf16 a[172:175], v[216:219], v[160:163], a[172:175]
    v_exp_f32 v175, v111
    v_mfma_f32_16x16x32_bf16 a[176:179], v[216:219], v[164:167], a[176:179]
    s_waitcnt lgkmcnt(3)
    v_exp_f32 v168, v112
    v_mfma_f32_16x16x32_bf16 a[180:183], v[220:223], v[156:159], a[180:183]
    ds_read_b128 v[204:207], v235 offset:0
    v_cvt_pk_bf16_f32 v147, v174, v175
    v_mfma_f32_16x16x32_bf16 a[184:187], v[220:223], v[160:163], a[184:187]
    v_exp_f32 v169, v113
    v_mfma_f32_16x16x32_bf16 a[188:191], v[220:223], v[164:167], a[188:191]
    s_waitcnt lgkmcnt(3)
    v_exp_f32 v170, v114
    v_mfma_f32_16x16x32_bf16 v[120:123], v[192:195], v[0:3], v[176:179]
    s_add_u32 s34, s34, 16384
    s_cmp_eq_u32 s34, 163840
    s_cselect_b32 s34, 0, s34
    ds_read_b128 v[208:211], v232 offset:256
    v_cvt_pk_bf16_f32 v150, v168, v169
    v_mfma_f32_16x16x32_bf16 v[124:127], v[192:195], v[4:7], v[180:183]
    s_sub_u32 s50, s34, s35
    v_exp_f32 v171, v115
    v_mfma_f32_16x16x32_bf16 v[128:131], v[192:195], v[8:11], v[184:187]
    s_waitcnt lgkmcnt(3)
    v_exp_f32 v172, v116
    v_mfma_f32_16x16x32_bf16 v[120:123], v[196:199], v[12:15], v[120:123]
    s_mov_b32 s35, s34
    ds_read_b128 v[212:215], v233 offset:256
    v_cvt_pk_bf16_f32 v151, v170, v171
    v_mfma_f32_16x16x32_bf16 v[124:127], v[196:199], v[16:19], v[124:127]
    s_add_u32 m0, s33, s32
    v_add_u32 v224, s50, v224
    v_add_u32 v225, s50, v225
    v_mfma_f32_16x16x32_bf16 v[128:131], v[196:199], v[20:23], v[128:131]
    s_waitcnt lgkmcnt(3)
    v_add_u32 v226, s50, v226
    v_add_u32 v227, s50, v227
    v_mfma_f32_16x16x32_bf16 v[120:123], v[200:203], v[24:27], v[120:123]
    ds_read_b128 v[216:219], v234 offset:256
    v_add_u32 v228, s50, v228
    v_mfma_f32_16x16x32_bf16 v[124:127], v[200:203], v[28:31], v[124:127]
    v_add_u32 v229, s50, v229
    v_add_u32 v230, s50, v230
    v_mfma_f32_16x16x32_bf16 v[128:131], v[200:203], v[32:35], v[128:131]
    s_waitcnt lgkmcnt(3)
    v_add_u32 v231, s50, v231
    v_mfma_f32_16x16x32_bf16 v[120:123], v[204:207], v[36:39], v[120:123]
    ds_read_b128 v[220:223], v235 offset:256
    v_mfma_f32_16x16x32_bf16 v[124:127], v[204:207], v[40:43], v[124:127]
    buffer_load_dwordx4 v244, s[20:23], s65 offen offset:0 lds
    v_mfma_f32_16x16x32_bf16 v[128:131], v[204:207], v[44:47], v[128:131]
    s_waitcnt lgkmcnt(3)
    v_exp_f32 v173, v117
    v_mfma_f32_16x16x32_bf16 v[120:123], v[208:211], v[48:51], v[120:123]
    ds_read_b128 v[192:195], v232 offset:8192
    v_mfma_f32_16x16x32_bf16 v[124:127], v[208:211], v[52:55], v[124:127]
    v_exp_f32 v174, v118
    v_mfma_f32_16x16x32_bf16 v[128:131], v[208:211], v[56:59], v[128:131]
    s_waitcnt lgkmcnt(3)
    buffer_load_dwordx4 v245, s[20:23], s65 offen offset:1024 lds
    v_mfma_f32_16x16x32_bf16 v[120:123], v[212:215], v[60:63], v[120:123]
    ds_read_b128 v[196:199], v233 offset:8192
    v_cvt_pk_bf16_f32 v154, v172, v173
    v_mfma_f32_16x16x32_bf16 v[124:127], v[212:215], v[64:67], v[124:127]
    v_exp_f32 v175, v119
    v_mfma_f32_16x16x32_bf16 v[128:131], v[212:215], v[68:71], v[128:131]
    s_waitcnt lgkmcnt(3)
    v_or3_b32 v188, v144, v145, v148
    v_cvt_pk_bf16_f32 v155, v174, v175
    v_mfma_f32_16x16x32_bf16 v[120:123], v[216:219], v[72:75], v[120:123]
    ds_read_b128 v[200:203], v234 offset:8192
    v_or3_b32 v188, v188, v149, v152
    v_mfma_f32_16x16x32_bf16 v[124:127], v[216:219], v[76:79], v[124:127]
    v_or3_b32 v188, v188, v153, v146
    v_or3_b32 v188, v188, v147, v150
    v_mfma_f32_16x16x32_bf16 v[128:131], v[216:219], v[80:83], v[128:131]
    s_waitcnt lgkmcnt(3)
    v_or3_b32 v188, v188, v151, v154
    v_or_b32 v188, v188, v155
    v_mfma_f32_16x16x32_bf16 v[120:123], v[220:223], v[84:87], v[120:123]
    ds_read_b128 v[204:207], v235 offset:8192
    v_and_b32 v188, 0x40004000, v188
    v_mfma_f32_16x16x32_bf16 v[124:127], v[220:223], v[88:91], v[124:127]
    v_cmp_ne_u32 vcc, 0, v188
    v_mfma_f32_16x16x32_bf16 v[128:131], v[220:223], v[92:95], v[128:131]
    s_waitcnt lgkmcnt(3)
    v_mfma_f32_16x16x32_bf16 v[132:135], v[192:195], v[0:3], v[176:179]
    ds_read_b128 v[208:211], v232 offset:8448
    v_mfma_f32_16x16x32_bf16 v[136:139], v[192:195], v[4:7], v[180:183]
    buffer_load_dwordx4 v246, s[20:23], s65 offen offset:2048 lds
    v_mfma_f32_16x16x32_bf16 v[140:143], v[192:195], v[8:11], v[184:187]
    s_waitcnt lgkmcnt(3)
    v_mfma_f32_16x16x32_bf16 v[132:135], v[196:199], v[12:15], v[132:135]
    ds_read_b128 v[212:215], v233 offset:8448
    v_mfma_f32_16x16x32_bf16 v[136:139], v[196:199], v[16:19], v[136:139]
    v_mfma_f32_16x16x32_bf16 v[140:143], v[196:199], v[20:23], v[140:143]
    s_waitcnt lgkmcnt(3)
    v_mfma_f32_16x16x32_bf16 v[132:135], v[200:203], v[24:27], v[132:135]
    ds_read_b128 v[216:219], v234 offset:8448
    v_mfma_f32_16x16x32_bf16 v[136:139], v[200:203], v[28:31], v[136:139]
    v_mfma_f32_16x16x32_bf16 v[140:143], v[200:203], v[32:35], v[140:143]
    s_waitcnt lgkmcnt(3)
    v_mfma_f32_16x16x32_bf16 v[132:135], v[204:207], v[36:39], v[132:135]
    ds_read_b128 v[220:223], v235 offset:8448
    v_mfma_f32_16x16x32_bf16 v[136:139], v[204:207], v[40:43], v[136:139]
    buffer_load_dwordx4 v247, s[20:23], s65 offen offset:3072 lds
    v_mfma_f32_16x16x32_bf16 v[140:143], v[204:207], v[44:47], v[140:143]
    s_waitcnt lgkmcnt(3)
    s_waitcnt vmcnt(29)
    s_barrier
    v_mfma_f32_16x16x32_bf16 v[132:135], v[208:211], v[48:51], v[132:135]
    s_add_u32 s33, s33, 16384
    s_cmp_eq_u32 s33, 163840
    s_cselect_b32 s33, 0, s33
    ds_read_b64_tr_b16 v[192:193], v224 offset:0
    ds_read_b64_tr_b16 v[194:195], v224 offset:8192
    v_mfma_f32_16x16x32_bf16 v[136:139], v[208:211], v[52:55], v[136:139]
    v_mfma_f32_16x16x32_bf16 v[140:143], v[208:211], v[56:59], v[140:143]
    s_waitcnt lgkmcnt(4)
    v_mfma_f32_16x16x32_bf16 v[132:135], v[212:215], v[60:63], v[132:135]
    ds_read_b64_tr_b16 v[196:197], v225 offset:0
    ds_read_b64_tr_b16 v[198:199], v225 offset:8192
    v_mfma_f32_16x16x32_bf16 v[136:139], v[212:215], v[64:67], v[136:139]
    v_mfma_f32_16x16x32_bf16 v[140:143], v[212:215], v[68:71], v[140:143]
    s_waitcnt lgkmcnt(5)
    v_mfma_f32_16x16x32_bf16 v[132:135], v[216:219], v[72:75], v[132:135]
    ds_read_b64_tr_b16 v[200:201], v226 offset:0
    ds_read_b64_tr_b16 v[202:203], v226 offset:8192
    v_mfma_f32_16x16x32_bf16 v[136:139], v[216:219], v[76:79], v[136:139]
    v_mfma_f32_16x16x32_bf16 v[140:143], v[216:219], v[80:83], v[140:143]
    s_waitcnt lgkmcnt(6)
    v_mfma_f32_16x16x32_bf16 v[132:135], v[220:223], v[84:87], v[132:135]
    ds_read_b64_tr_b16 v[204:205], v227 offset:0
    ds_read_b64_tr_b16 v[206:207], v227 offset:8192
    v_mfma_f32_16x16x32_bf16 v[136:139], v[220:223], v[88:91], v[136:139]
    v_mfma_f32_16x16x32_bf16 v[140:143], v[220:223], v[92:95], v[140:143]
    s_waitcnt lgkmcnt(6)
    s_cbranch_vccnz L_stub5
L_back5:
    v_mfma_f32_16x16x32_bf16 a[192:195], a[204:207], v[144:147], a[192:195]
    v_mfma_f32_16x16x32_bf16 a[196:199], a[204:207], v[148:151], a[196:199]
    v_mfma_f32_16x16x32_bf16 a[200:203], a[204:207], v[152:155], a[200:203]
    v_mfma_f32_16x16x32_bf16 a[0:3], v[192:195], v[144:147], a[0:3]
    s_add_u32 s34, s34, 16384
    s_cmp_eq_u32 s34, 163840
    s_cselect_b32 s34, 0, s34
    ds_read_b64_tr_b16 v[208:209], v228 offset:0
    ds_read_b64_tr_b16 v[210:211], v228 offset:8192
    v_mfma_f32_16x16x32_bf16 a[4:7], v[192:195], v[148:151], a[4:7]
    s_sub_u32 s50, s34, s36
    v_exp_f32 v168, v120
    v_mfma_f32_16x16x32_bf16 a[8:11], v[192:195], v[152:155], a[8:11]
    s_waitcnt lgkmcnt(6)
    v_exp_f32 v169, v121
    v_mfma_f32_16x16x32_bf16 a[12:15], v[196:199], v[144:147], a[12:15]
    s_mov_b32 s36, s34
    ds_read_b64_tr_b16 v[212:213], v229 offset:0
    ds_read_b64_tr_b16 v[214:215], v229 offset:8192
    v_mfma_f32_16x16x32_bf16 a[16:19], v[196:199], v[148:151], a[16:19]
    s_add_u32 m0, s33, s32
    v_add_u32 v232, s50, v232
    v_add_u32 v233, s50, v233
    v_mfma_f32_16x16x32_bf16 a[20:23], v[196:199], v[152:155], a[20:23]
    s_waitcnt lgkmcnt(6)
    v_add_u32 v234, s50, v234
    v_add_u32 v235, s50, v235
    v_mfma_f32_16x16x32_bf16 a[24:27], v[200:203], v[144:147], a[24:27]
    ds_read_b64_tr_b16 v[216:217], v230 offset:0
    ds_read_b64_tr_b16 v[218:219], v230 offset:8192
    v_mfma_f32_16x16x32_bf16 a[28:31], v[200:203], v[148:151], a[28:31]
    buffer_load_dwordx4 v244, s[20:23], s66 offen offset:0 lds
    v_mfma_f32_16x16x32_bf16 a[32:35], v[200:203], v[152:155], a[32:35]
    s_waitcnt lgkmcnt(6)
    v_exp_f32 v170, v122
    v_mfma_f32_16x16x32_bf16 a[36:39], v[204:207], v[144:147], a[36:39]
    ds_read_b64_tr_b16 v[220:221], v231 offset:0
    ds_read_b64_tr_b16 v[222:223], v231 offset:8192
    v_mfma_f32_16x16x32_bf16 a[40:43], v[204:207], v[148:151], a[40:43]
    buffer_load_dword a253, v253, s[20:23], s73 offen
    v_mfma_f32_16x16x32_bf16 a[44:47], v[204:207], v[152:155], a[44:47]
    s_waitcnt lgkmcnt(6)
    v_cvt_pk_bf16_f32 v156, v168, v169
    v_mfma_f32_16x16x32_bf16 a[48:51], v[208:211], v[144:147], a[48:51]
    s_add_u32 s73, s73, 8192
    ds_read_b64_tr_b16 v[192:193], v224 offset:256
    ds_read_b64_tr_b16 v[194:195], v224 offset:8448
    v_mfma_f32_16x16x32_bf16 a[52:55], v[208:211], v[148:151], a[52:55]
    v_exp_f32 v171, v123
    v_mfma_f32_16x16x32_bf16 a[56:59], v[208:211], v[152:155], a[56:59]
    s_waitcnt lgkmcnt(6)
    buffer_load_dwordx4 v245, s[20:23], s66 offen offset:1024 lds
    v_mfma_f32_16x16x32_bf16 a[60:63], v[212:215], v[144:147], a[60:63]
    ds_read_b64_tr_b16 v[196:197], v225 offset:256
    ds_read_b64_tr_b16 v[198:199], v225 offset:8448
    v_mfma_f32_16x16x32_bf16 a[64:67], v[212:215], v[148:151], a[64:67]
    v_exp_f32 v172, v124
    v_mfma_f32_16x16x32_bf16 a[68:71], v[212:215], v[152:155], a[68:71]
    s_waitcnt lgkmcnt(6)
    v_cvt_pk_bf16_f32 v157, v170, v171
    v_mfma_f32_16x16x32_bf16 a[72:75], v[216:219], v[144:147], a[72:75]
    ds_read_b64_tr_b16 v[200:201], v226 offset:256
    ds_read_b64_tr_b16 v[202:203], v226 offset:8448
    v_mfma_f32_16x16x32_bf16 a[76:79], v[216:219], v[148:151], a[76:79]
    v_exp_f32 v173, v125
    v_mfma_f32_16x16x32_bf16 a[80:83], v[216:219], v[152:155], a[80:83]
    s_waitcnt lgkmcnt(6)
    v_exp_f32 v174, v126
    v_mfma_f32_16x16x32_bf16 a[84:87], v[220:223], v[144:147], a[84:87]
    ds_read_b64_tr_b16 v[204:205], v227 offset:256
    ds_read_b64_tr_b16 v[206:207], v227 offset:8448
    v_mfma_f32_16x16x32_bf16 a[88:91], v[220:223], v[148:151], a[88:91]
    v_cvt_pk_bf16_f32 v160, v172, v173
    v_mfma_f32_16x16x32_bf16 a[92:95], v[220:223], v[152:155], a[92:95]
    s_waitcnt lgkmcnt(6)
    v_exp_f32 v175, v127
    v_mfma_f32_16x16x32_bf16 a[96:99], v[192:195], v[144:147], a[96:99]
    ds_read_b64_tr_b16 v[208:209], v228 offset:256
    ds_read_b64_tr_b16 v[210:211], v228 offset:8448
    v_mfma_f32_16x16x32_bf16 a[100:103], v[192:195], v[148:151], a[100:103]
    buffer_load_dwordx4 v246, s[20:23], s66 offen offset:2048 lds
    v_mfma_f32_16x16x32_bf16 a[104:107], v[192:195], v[152:155], a[104:107]
    s_waitcnt lgkmcnt(6)
    v_exp_f32 v168, v128
    v_mfma_f32_16x16x32_bf16 a[108:111], v[196:199], v[144:147], a[108:111]
    ds_read_b64_tr_b16 v[212:213], v229 offset:256
    ds_read_b64_tr_b16 v[214:215], v229 offset:8448
    v_mfma_f32_16x16x32_bf16 a[112:115], v[196:199], v[148:151], a[112:115]
    v_cvt_pk_bf16_f32 v161, v174, v175
    v_mfma_f32_16x16x32_bf16 a[116:119], v[196:199], v[152:155], a[116:119]
    s_waitcnt lgkmcnt(6)
    v_exp_f32 v169, v129
    v_mfma_f32_16x16x32_bf16 a[120:123], v[200:203], v[144:147], a[120:123]
    ds_read_b64_tr_b16 v[216:217], v230 offset:256
    ds_read_b64_tr_b16 v[218:219], v230 offset:8448
    v_mfma_f32_16x16x32_bf16 a[124:127], v[200:203], v[148:151], a[124:127]
    v_exp_f32 v170, v130
    v_mfma_f32_16x16x32_bf16 a[128:131], v[200:203], v[152:155], a[128:131]
    s_waitcnt lgkmcnt(6)
    v_cvt_pk_bf16_f32 v164, v168, v169
    v_mfma_f32_16x16x32_bf16 a[132:135], v[204:207], v[144:147], a[132:135]
    ds_read_b64_tr_b16 v[220:221], v231 offset:256
    ds_read_b64_tr_b16 v[222:223], v231 offset:8448
    v_mfma_f32_16x16x32_bf16 a[136:139], v[204:207], v[148:151], a[136:139]
    buffer_load_dwordx4 v247, s[20:23], s66 offen offset:3072 lds
    v_mfma_f32_16x16x32_bf16 a[140:143], v[204:207], v[152:155], a[140:143]
    s_waitcnt lgkmcnt(6)
    s_waitcnt vmcnt(30)
    s_barrier
    v_exp_f32 v171, v131
    v_mfma_f32_16x16x32_bf16 a[144:147], v[208:211], v[144:147], a[144:147]
    s_add_u32 s33, s33, 16384
    s_cmp_eq_u32 s33, 163840
    s_cselect_b32 s33, 0, s33
    ds_read_b128 v[192:195], v232 offset:0
    v_mfma_f32_16x16x32_bf16 a[148:151], v[208:211], v[148:151], a[148:151]
    v_exp_f32 v172, v132
    v_mfma_f32_16x16x32_bf16 a[152:155], v[208:211], v[152:155], a[152:155]
    s_waitcnt lgkmcnt(5)
    v_cvt_pk_bf16_f32 v165, v170, v171
    v_mfma_f32_16x16x32_bf16 a[156:159], v[212:215], v[144:147], a[156:159]
    ds_read_b128 v[196:199], v233 offset:0
    v_mfma_f32_16x16x32_bf16 a[160:163], v[212:215], v[148:151], a[160:163]
    v_exp_f32 v173, v133
    v_mfma_f32_16x16x32_bf16 a[164:167], v[212:215], v[152:155], a[164:167]
    s_waitcnt lgkmcnt(4)
    v_exp_f32 v174, v134
    v_mfma_f32_16x16x32_bf16 a[168:171], v[216:219], v[144:147], a[168:171]
    ds_read_b128 v[200:203], v234 offset:0
    v_cvt_pk_bf16_f32 v158, v172, v173
    v_mfma_f32_16x16x32_bf16 a[172:175], v[216:219], v[148:151], a[172:175]
    v_exp_f32 v175, v135
    v_mfma_f32_16x16x32_bf16 a[176:179], v[216:219], v[152:155], a[176:179]
    s_waitcnt lgkmcnt(3)
    v_exp_f32 v168, v136
    v_mfma_f32_16x16x32_bf16 a[180:183], v[220:223], v[144:147], a[180:183]
    ds_read_b128 v[204:207], v235 offset:0
    v_cvt_pk_bf16_f32 v159, v174, v175
    v_mfma_f32_16x16x32_bf16 a[184:187], v[220:223], v[148:151], a[184:187]
    v_exp_f32 v169, v137
    v_mfma_f32_16x16x32_bf16 a[188:191], v[220:223], v[152:155], a[188:191]
    s_waitcnt lgkmcnt(3)
    v_exp_f32 v170, v138
    v_mfma_f32_16x16x32_bf16 v[96:99], v[192:195], v[0:3], v[176:179]
    s_add_u32 s34, s34, 16384
    s_cmp_eq_u32 s34, 163840
    s_cselect_b32 s34, 0, s34
    ds_read_b128 v[208:211], v232 offset:256
    v_cvt_pk_bf16_f32 v162, v168, v169
    v_mfma_f32_16x16x32_bf16 v[100:103], v[192:195], v[4:7], v[180:183]
    s_sub_u32 s50, s34, s35
    v_exp_f32 v171, v139
    v_mfma_f32_16x16x32_bf16 v[104:107], v[192:195], v[8:11], v[184:187]
    s_waitcnt lgkmcnt(3)
    v_exp_f32 v172, v140
    v_mfma_f32_16x16x32_bf16 v[96:99], v[196:199], v[12:15], v[96:99]
    s_mov_b32 s35, s34
    ds_read_b128 v[212:215], v233 offset:256
    v_cvt_pk_bf16_f32 v163, v170, v171
    v_mfma_f32_16x16x32_bf16 v[100:103], v[196:199], v[16:19], v[100:103]
    s_add_u32 m0, s33, s32
    v_add_u32 v224, s50, v224
    v_add_u32 v225, s50, v225
    v_mfma_f32_16x16x32_bf16 v[104:107], v[196:199], v[20:23], v[104:107]
    s_waitcnt lgkmcnt(3)
    v_add_u32 v226, s50, v226
    v_add_u32 v227, s50, v227
    v_mfma_f32_16x16x32_bf16 v[96:99], v[200:203], v[24:27], v[96:99]
    ds_read_b128 v[216:219], v234 offset:256
    v_add_u32 v228, s50, v228
    v_mfma_f32_16x16x32_bf16 v[100:103], v[200:203], v[28:31], v[100:103]
    v_add_u32 v229, s50, v229
    v_add_u32 v230, s50, v230
    v_mfma_f32_16x16x32_bf16 v[104:107], v[200:203], v[32:35], v[104:107]
    s_waitcnt lgkmcnt(3)
    v_add_u32 v231, s50, v231
    v_mfma_f32_16x16x32_bf16 v[96:99], v[204:207], v[36:39], v[96:99]
    ds_read_b128 v[220:223], v235 offset:256
    v_mfma_f32_16x16x32_bf16 v[100:103], v[204:207], v[40:43], v[100:103]
    buffer_load_dwordx4 v240, s[16:19], s67 offen offset:0 lds
    v_mfma_f32_16x16x32_bf16 v[104:107], v[204:207], v[44:47], v[104:107]
    s_waitcnt lgkmcnt(3)
    v_exp_f32 v173, v141
    v_mfma_f32_16x16x32_bf16 v[96:99], v[208:211], v[48:51], v[96:99]
    ds_read_b128 v[192:195], v232 offset:8192
    v_mfma_f32_16x16x32_bf16 v[100:103], v[208:211], v[52:55], v[100:103]
    v_exp_f32 v174, v142
    v_mfma_f32_16x16x32_bf16 v[104:107], v[208:211], v[56:59], v[104:107]
    s_waitcnt lgkmcnt(3)
    buffer_load_dwordx4 v241, s[16:19], s67 offen offset:1024 lds
    v_mfma_f32_16x16x32_bf16 v[96:99], v[212:215], v[60:63], v[96:99]
    ds_read_b128 v[196:199], v233 offset:8192
    v_cvt_pk_bf16_f32 v166, v172, v173
    v_mfma_f32_16x16x32_bf16 v[100:103], v[212:215], v[64:67], v[100:103]
    v_exp_f32 v175, v143
    v_mfma_f32_16x16x32_bf16 v[104:107], v[212:215], v[68:71], v[104:107]
    s_waitcnt lgkmcnt(3)
    v_or3_b32 v188, v156, v157, v160
    v_cvt_pk_bf16_f32 v167, v174, v175
    v_mfma_f32_16x16x32_bf16 v[96:99], v[216:219], v[72:75], v[96:99]
    ds_read_b128 v[200:203], v234 offset:8192
    v_or3_b32 v188, v188, v161, v164
    v_mfma_f32_16x16x32_bf16 v[100:103], v[216:219], v[76:79], v[100:103]
    v_or3_b32 v188, v188, v165, v158
    v_or3_b32 v188, v188, v159, v162
    v_mfma_f32_16x16x32_bf16 v[104:107], v[216:219], v[80:83], v[104:107]
    s_waitcnt lgkmcnt(3)
    v_or3_b32 v188, v188, v163, v166
    v_or_b32 v188, v188, v167
    v_mfma_f32_16x16x32_bf16 v[96:99], v[220:223], v[84:87], v[96:99]
    ds_read_b128 v[204:207], v235 offset:8192
    v_and_b32 v188, 0x40004000, v188
    v_mfma_f32_16x16x32_bf16 v[100:103], v[220:223], v[88:91], v[100:103]
    v_cmp_ne_u32 vcc, 0, v188
    v_mfma_f32_16x16x32_bf16 v[104:107], v[220:223], v[92:95], v[104:107]
    s_waitcnt lgkmcnt(3)
    v_mfma_f32_16x16x32_bf16 v[108:111], v[192:195], v[0:3], v[176:179]
    ds_read_b128 v[208:211], v232 offset:8448
    v_mfma_f32_16x16x32_bf16 v[112:115], v[192:195], v[4:7], v[180:183]
    buffer_load_dwordx4 v242, s[16:19], s67 offen offset:2048 lds
    v_mfma_f32_16x16x32_bf16 v[116:119], v[192:195], v[8:11], v[184:187]
    s_waitcnt lgkmcnt(3)
    v_mfma_f32_16x16x32_bf16 v[108:111], v[196:199], v[12:15], v[108:111]
    ds_read_b128 v[212:215], v233 offset:8448
    v_mfma_f32_16x16x32_bf16 v[112:115], v[196:199], v[16:19], v[112:115]
    v_mfma_f32_16x16x32_bf16 v[116:119], v[196:199], v[20:23], v[116:119]
    s_waitcnt lgkmcnt(3)
    v_mfma_f32_16x16x32_bf16 v[108:111], v[200:203], v[24:27], v[108:111]
    ds_read_b128 v[216:219], v234 offset:8448
    v_mfma_f32_16x16x32_bf16 v[112:115], v[200:203], v[28:31], v[112:115]
    v_mfma_f32_16x16x32_bf16 v[116:119], v[200:203], v[32:35], v[116:119]
    s_waitcnt lgkmcnt(3)
    v_mfma_f32_16x16x32_bf16 v[108:111], v[204:207], v[36:39], v[108:111]
    ds_read_b128 v[220:223], v235 offset:8448
    v_mfma_f32_16x16x32_bf16 v[112:115], v[204:207], v[40:43], v[112:115]
    buffer_load_dwordx4 v243, s[16:19], s67 offen offset:3072 lds
    v_mfma_f32_16x16x32_bf16 v[116:119], v[204:207], v[44:47], v[116:119]
    s_waitcnt lgkmcnt(3)
    s_waitcnt vmcnt(30)
    s_barrier
    v_mfma_f32_16x16x32_bf16 v[108:111], v[208:211], v[48:51], v[108:111]
    s_add_u32 s33, s33, 16384
    s_cmp_eq_u32 s33, 163840
    s_cselect_b32 s33, 0, s33
    ds_read_b64_tr_b16 v[192:193], v224 offset:0
    ds_read_b64_tr_b16 v[194:195], v224 offset:8192
    v_mfma_f32_16x16x32_bf16 v[112:115], v[208:211], v[52:55], v[112:115]
    v_mfma_f32_16x16x32_bf16 v[116:119], v[208:211], v[56:59], v[116:119]
    s_waitcnt lgkmcnt(4)
    v_mfma_f32_16x16x32_bf16 v[108:111], v[212:215], v[60:63], v[108:111]
    ds_read_b64_tr_b16 v[196:197], v225 offset:0
    ds_read_b64_tr_b16 v[198:199], v225 offset:8192
    v_mfma_f32_16x16x32_bf16 v[112:115], v[212:215], v[64:67], v[112:115]
    v_mfma_f32_16x16x32_bf16 v[116:119], v[212:215], v[68:71], v[116:119]
    s_waitcnt lgkmcnt(5)
    v_mfma_f32_16x16x32_bf16 v[108:111], v[216:219], v[72:75], v[108:111]
    ds_read_b64_tr_b16 v[200:201], v226 offset:0
    ds_read_b64_tr_b16 v[202:203], v226 offset:8192
    v_mfma_f32_16x16x32_bf16 v[112:115], v[216:219], v[76:79], v[112:115]
    v_mfma_f32_16x16x32_bf16 v[116:119], v[216:219], v[80:83], v[116:119]
    s_waitcnt lgkmcnt(6)
    v_mfma_f32_16x16x32_bf16 v[108:111], v[220:223], v[84:87], v[108:111]
    ds_read_b64_tr_b16 v[204:205], v227 offset:0
    ds_read_b64_tr_b16 v[206:207], v227 offset:8192
    v_mfma_f32_16x16x32_bf16 v[112:115], v[220:223], v[88:91], v[112:115]
    v_mfma_f32_16x16x32_bf16 v[116:119], v[220:223], v[92:95], v[116:119]
    s_waitcnt lgkmcnt(6)
    s_cbranch_vccnz L_stub6
L_back6:
    v_mfma_f32_16x16x32_bf16 a[192:195], a[204:207], v[156:159], a[192:195]
    v_mfma_f32_16x16x32_bf16 a[196:199], a[204:207], v[160:163], a[196:199]
    v_mfma_f32_16x16x32_bf16 a[200:203], a[204:207], v[164:167], a[200:203]
    v_mfma_f32_16x16x32_bf16 a[0:3], v[192:195], v[156:159], a[0:3]
    s_add_u32 s34, s34, 16384
    s_cmp_eq_u32 s34, 163840
    s_cselect_b32 s34, 0, s34
    ds_read_b64_tr_b16 v[208:209], v228 offset:0
    ds_read_b64_tr_b16 v[210:211], v228 offset:8192
    v_mfma_f32_16x16x32_bf16 a[4:7], v[192:195], v[160:163], a[4:7]
    s_sub_u32 s50, s34, s36
    v_exp_f32 v168, v96
    v_mfma_f32_16x16x32_bf16 a[8:11], v[192:195], v[164:167], a[8:11]
    s_waitcnt lgkmcnt(6)
    v_exp_f32 v169, v97
    v_mfma_f32_16x16x32_bf16 a[12:15], v[196:199], v[156:159], a[12:15]
    s_mov_b32 s36, s34
    ds_read_b64_tr_b16 v[212:213], v229 offset:0
    ds_read_b64_tr_b16 v[214:215], v229 offset:8192
    v_mfma_f32_16x16x32_bf16 a[16:19], v[196:199], v[160:163], a[16:19]
    s_add_u32 m0, s33, s32
    v_add_u32 v232, s50, v232
    v_add_u32 v233, s50, v233
    v_mfma_f32_16x16x32_bf16 a[20:23], v[196:199], v[164:167], a[20:23]
    s_waitcnt lgkmcnt(6)
    v_add_u32 v234, s50, v234
    v_add_u32 v235, s50, v235
    v_mfma_f32_16x16x32_bf16 a[24:27], v[200:203], v[156:159], a[24:27]
    ds_read_b64_tr_b16 v[216:217], v230 offset:0
    ds_read_b64_tr_b16 v[218:219], v230 offset:8192
    v_mfma_f32_16x16x32_bf16 a[28:31], v[200:203], v[160:163], a[28:31]
    buffer_load_dwordx4 v240, s[16:19], s68 offen offset:0 lds
    v_mfma_f32_16x16x32_bf16 a[32:35], v[200:203], v[164:167], a[32:35]
    s_waitcnt lgkmcnt(6)
    v_exp_f32 v170, v98
    v_mfma_f32_16x16x32_bf16 a[36:39], v[204:207], v[156:159], a[36:39]
    ds_read_b64_tr_b16 v[220:221], v231 offset:0
    ds_read_b64_tr_b16 v[222:223], v231 offset:8192
    v_mfma_f32_16x16x32_bf16 a[40:43], v[204:207], v[160:163], a[40:43]
    v_cvt_pk_bf16_f32 v144, v168, v169
    v_mfma_f32_16x16x32_bf16 a[44:47], v[204:207], v[164:167], a[44:47]
    s_waitcnt lgkmcnt(6)
    v_exp_f32 v171, v99
    v_mfma_f32_16x16x32_bf16 a[48:51], v[208:211], v[156:159], a[48:51]
    ds_read_b64_tr_b16 v[192:193], v224 offset:256
    ds_read_b64_tr_b16 v[194:195], v224 offset:8448
    v_mfma_f32_16x16x32_bf16 a[52:55], v[208:211], v[160:163], a[52:55]
    v_exp_f32 v172, v100
    v_mfma_f32_16x16x32_bf16 a[56:59], v[208:211], v[164:167], a[56:59]
    s_waitcnt lgkmcnt(6)
    buffer_load_dwordx4 v241, s[16:19], s68 offen offset:1024 lds
    v_mfma_f32_16x16x32_bf16 a[60:63], v[212:215], v[156:159], a[60:63]
    ds_read_b64_tr_b16 v[196:197], v225 offset:256
    ds_read_b64_tr_b16 v[198:199], v225 offset:8448
    v_mfma_f32_16x16x32_bf16 a[64:67], v[212:215], v[160:163], a[64:67]
    v_cvt_pk_bf16_f32 v145, v170, v171
    v_mfma_f32_16x16x32_bf16 a[68:71], v[212:215], v[164:167], a[68:71]
    s_waitcnt lgkmcnt(6)
    v_exp_f32 v173, v101
    v_mfma_f32_16x16x32_bf16 a[72:75], v[216:219], v[156:159], a[72:75]
    ds_read_b64_tr_b16 v[200:201], v226 offset:256
    ds_read_b64_tr_b16 v[202:203], v226 offset:8448
    v_mfma_f32_16x16x32_bf16 a[76:79], v[216:219], v[160:163], a[76:79]
    v_exp_f32 v174, v102
    v_mfma_f32_16x16x32_bf16 a[80:83], v[216:219], v[164:167], a[80:83]
    s_waitcnt lgkmcnt(6)
    v_cvt_pk_bf16_f32 v148, v172, v173
    v_mfma_f32_16x16x32_bf16 a[84:87], v[220:223], v[156:159], a[84:87]
    ds_read_b64_tr_b16 v[204:205], v227 offset:256
    ds_read_b64_tr_b16 v[206:207], v227 offset:8448
    v_mfma_f32_16x16x32_bf16 a[88:91], v[220:223], v[160:163], a[88:91]
    v_exp_f32 v175, v103
    v_mfma_f32_16x16x32_bf16 a[92:95], v[220:223], v[164:167], a[92:95]
    s_waitcnt lgkmcnt(6)
    v_exp_f32 v168, v104
    v_mfma_f32_16x16x32_bf16 a[96:99], v[192:195], v[156:159], a[96:99]
    ds_read_b64_tr_b16 v[208:209], v228 offset:256
    ds_read_b64_tr_b16 v[210:211], v228 offset:8448
    v_mfma_f32_16x16x32_bf16 a[100:103], v[192:195], v[160:163], a[100:103]
    buffer_load_dwordx4 v242, s[16:19], s68 offen offset:2048 lds
    v_mfma_f32_16x16x32_bf16 a[104:107], v[192:195], v[164:167], a[104:107]
    s_waitcnt lgkmcnt(6)
    v_cvt_pk_bf16_f32 v149, v174, v175
    v_mfma_f32_16x16x32_bf16 a[108:111], v[196:199], v[156:159], a[108:111]
    ds_read_b64_tr_b16 v[212:213], v229 offset:256
    ds_read_b64_tr_b16 v[214:215], v229 offset:8448
    v_mfma_f32_16x16x32_bf16 a[112:115], v[196:199], v[160:163], a[112:115]
    v_exp_f32 v169, v105
    v_mfma_f32_16x16x32_bf16 a[116:119], v[196:199], v[164:167], a[116:119]
    s_waitcnt lgkmcnt(6)
    v_exp_f32 v170, v106
    v_mfma_f32_16x16x32_bf16 a[120:123], v[200:203], v[156:159], a[120:123]
    ds_read_b64_tr_b16 v[216:217], v230 offset:256
    ds_read_b64_tr_b16 v[218:219], v230 offset:8448
    v_mfma_f32_16x16x32_bf16 a[124:127], v[200:203], v[160:163], a[124:127]
    v_cvt_pk_bf16_f32 v152, v168, v169
    v_mfma_f32_16x16x32_bf16 a[128:131], v[200:203], v[164:167], a[128:131]
    s_waitcnt lgkmcnt(6)
    v_exp_f32 v171, v107
    v_mfma_f32_16x16x32_bf16 a[132:135], v[204:207], v[156:159], a[132:135]
    ds_read_b64_tr_b16 v[220:221], v231 offset:256
    ds_read_b64_tr_b16 v[222:223], v231 offset:8448
    v_mfma_f32_16x16x32_bf16 a[136:139], v[204:207], v[160:163], a[136:139]
    buffer_load_dwordx4 v243, s[16:19], s68 offen offset:3072 lds
    v_mfma_f32_16x16x32_bf16 a[140:143], v[204:207], v[164:167], a[140:143]
    s_waitcnt lgkmcnt(6)
    s_waitcnt vmcnt(30)
    s_barrier
    v_exp_f32 v172, v108
    v_mfma_f32_16x16x32_bf16 a[144:147], v[208:211], v[156:159], a[144:147]
    s_add_u32 s33, s33, 16384
    s_cmp_eq_u32 s33, 163840
    s_cselect_b32 s33, 0, s33
    ds_read_b128 v[192:195], v232 offset:0
    v_cvt_pk_bf16_f32 v153, v170, v171
    v_mfma_f32_16x16x32_bf16 a[148:151], v[208:211], v[160:163], a[148:151]
    v_exp_f32 v173, v109
    v_mfma_f32_16x16x32_bf16 a[152:155], v[208:211], v[164:167], a[152:155]
    s_waitcnt lgkmcnt(5)
    v_exp_f32 v174, v110
    v_mfma_f32_16x16x32_bf16 a[156:159], v[212:215], v[156:159], a[156:159]
    ds_read_b128 v[196:199], v233 offset:0
    v_cvt_pk_bf16_f32 v146, v172, v173
    v_mfma_f32_16x16x32_bf16 a[160:163], v[212:215], v[160:163], a[160:163]
    v_exp_f32 v175, v111
    v_mfma_f32_16x16x32_bf16 a[164:167], v[212:215], v[164:167], a[164:167]
    s_waitcnt lgkmcnt(4)
    v_exp_f32 v168, v112
    v_mfma_f32_16x16x32_bf16 a[168:171], v[216:219], v[156:159], a[168:171]
    ds_read_b128 v[200:203], v234 offset:0
    v_cvt_pk_bf16_f32 v147, v174, v175
    v_mfma_f32_16x16x32_bf16 a[172:175], v[216:219], v[160:163], a[172:175]
    v_exp_f32 v169, v113
    v_mfma_f32_16x16x32_bf16 a[176:179], v[216:219], v[164:167], a[176:179]
    s_waitcnt lgkmcnt(3)
    v_exp_f32 v170, v114
    v_mfma_f32_16x16x32_bf16 a[180:183], v[220:223], v[156:159], a[180:183]
    ds_read_b128 v[204:207], v235 offset:0
    v_cvt_pk_bf16_f32 v150, v168, v169
    v_mfma_f32_16x16x32_bf16 a[184:187], v[220:223], v[160:163], a[184:187]
    v_exp_f32 v171, v115
    v_mfma_f32_16x16x32_bf16 a[188:191], v[220:223], v[164:167], a[188:191]
    s_waitcnt lgkmcnt(3)
    v_exp_f32 v172, v116
    v_mfma_f32_16x16x32_bf16 v[120:123], v[192:195], v[0:3], v[176:179]
    s_add_u32 s34, s34, 16384
    s_cmp_eq_u32 s34, 163840
    s_cselect_b32 s34, 0, s34
    ds_read_b128 v[208:211], v232 offset:256
    v_cvt_pk_bf16_f32 v151, v170, v171
    v_mfma_f32_16x16x32_bf16 v[124:127], v[192:195], v[4:7], v[180:183]
    s_sub_u32 s50, s34, s35
    v_exp_f32 v173, v117
    v_mfma_f32_16x16x32_bf16 v[128:131], v[192:195], v[8:11], v[184:187]
    s_waitcnt lgkmcnt(3)
    v_exp_f32 v174, v118
    v_mfma_f32_16x16x32_bf16 v[120:123], v[196:199], v[12:15], v[120:123]
    s_mov_b32 s35, s34
    ds_read_b128 v[212:215], v233 offset:256
    v_cvt_pk_bf16_f32 v154, v172, v173
    v_mfma_f32_16x16x32_bf16 v[124:127], v[196:199], v[16:19], v[124:127]
    s_add_u32 m0, s33, s32
    v_add_u32 v224, s50, v224
    v_add_u32 v225, s50, v225
    v_mfma_f32_16x16x32_bf16 v[128:131], v[196:199], v[20:23], v[128:131]
    s_waitcnt lgkmcnt(3)
    v_add_u32 v226, s50, v226
    v_add_u32 v227, s50, v227
    v_mfma_f32_16x16x32_bf16 v[120:123], v[200:203], v[24:27], v[120:123]
    ds_read_b128 v[216:219], v234 offset:256
    v_add_u32 v228, s50, v228
    v_mfma_f32_16x16x32_bf16 v[124:127], v[200:203], v[28:31], v[124:127]
    v_add_u32 v229, s50, v229
    v_add_u32 v230, s50, v230
    v_mfma_f32_16x16x32_bf16 v[128:131], v[200:203], v[32:35], v[128:131]
    s_waitcnt lgkmcnt(3)
    v_add_u32 v231, s50, v231
    v_mfma_f32_16x16x32_bf16 v[120:123], v[204:207], v[36:39], v[120:123]
    ds_read_b128 v[220:223], v235 offset:256
    v_mfma_f32_16x16x32_bf16 v[124:127], v[204:207], v[40:43], v[124:127]
    buffer_load_dwordx4 v244, s[20:23], s69 offen offset:0 lds
    v_mfma_f32_16x16x32_bf16 v[128:131], v[204:207], v[44:47], v[128:131]
    s_waitcnt lgkmcnt(3)
    v_exp_f32 v175, v119
    v_mfma_f32_16x16x32_bf16 v[120:123], v[208:211], v[48:51], v[120:123]
    ds_read_b128 v[192:195], v232 offset:8192
    v_or3_b32 v188, v144, v145, v148
    v_mfma_f32_16x16x32_bf16 v[124:127], v[208:211], v[52:55], v[124:127]
    v_cvt_pk_bf16_f32 v155, v174, v175
    v_or3_b32 v188, v188, v149, v152
    v_mfma_f32_16x16x32_bf16 v[128:131], v[208:211], v[56:59], v[128:131]
    s_waitcnt lgkmcnt(3)
    buffer_load_dwordx4 v245, s[20:23], s69 offen offset:1024 lds
    v_mfma_f32_16x16x32_bf16 v[120:123], v[212:215], v[60:63], v[120:123]
    ds_read_b128 v[196:199], v233 offset:8192
    v_or3_b32 v188, v188, v153, v146
    v_mfma_f32_16x16x32_bf16 v[124:127], v[212:215], v[64:67], v[124:127]
    v_or3_b32 v188, v188, v147, v150
    v_or3_b32 v188, v188, v151, v154
    v_mfma_f32_16x16x32_bf16 v[128:131], v[212:215], v[68:71], v[128:131]
    s_waitcnt lgkmcnt(3)
    v_or_b32 v188, v188, v155
    v_and_b32 v188, 0x40004000, v188
    v_mfma_f32_16x16x32_bf16 v[120:123], v[216:219], v[72:75], v[120:123]
    ds_read_b128 v[200:203], v234 offset:8192
    v_cmp_ne_u32 vcc, 0, v188
    v_mfma_f32_16x16x32_bf16 v[124:127], v[216:219], v[76:79], v[124:127]
    v_mfma_f32_16x16x32_bf16 v[128:131], v[216:219], v[80:83], v[128:131]
    s_waitcnt lgkmcnt(3)
    v_mfma_f32_16x16x32_bf16 v[120:123], v[220:223], v[84:87], v[120:123]
    ds_read_b128 v[204:207], v235 offset:8192
    v_mfma_f32_16x16x32_bf16 v[124:127], v[220:223], v[88:91], v[124:127]
    v_mfma_f32_16x16x32_bf16 v[128:131], v[220:223], v[92:95], v[128:131]
    s_waitcnt lgkmcnt(3)
    v_mfma_f32_16x16x32_bf16 v[132:135], v[192:195], v[0:3], v[176:179]
    ds_read_b128 v[208:211], v232 offset:8448
    v_mfma_f32_16x16x32_bf16 v[136:139], v[192:195], v[4:7], v[180:183]
    buffer_load_dwordx4 v246, s[20:23], s69 offen offset:2048 lds
    v_mfma_f32_16x16x32_bf16 v[140:143], v[192:195], v[8:11], v[184:187]
    s_waitcnt lgkmcnt(3)
    v_mfma_f32_16x16x32_bf16 v[132:135], v[196:199], v[12:15], v[132:135]
    ds_read_b128 v[212:215], v233 offset:8448
    v_mfma_f32_16x16x32_bf16 v[136:139], v[196:199], v[16:19], v[136:139]
    v_mfma_f32_16x16x32_bf16 v[140:143], v[196:199], v[20:23], v[140:143]
    s_waitcnt lgkmcnt(3)
    v_mfma_f32_16x16x32_bf16 v[132:135], v[200:203], v[24:27], v[132:135]
    ds_read_b128 v[216:219], v234 offset:8448
    v_mfma_f32_16x16x32_bf16 v[136:139], v[200:203], v[28:31], v[136:139]
    v_mfma_f32_16x16x32_bf16 v[140:143], v[200:203], v[32:35], v[140:143]
    s_waitcnt lgkmcnt(3)
    v_mfma_f32_16x16x32_bf16 v[132:135], v[204:207], v[36:39], v[132:135]
    ds_read_b128 v[220:223], v235 offset:8448
    v_mfma_f32_16x16x32_bf16 v[136:139], v[204:207], v[40:43], v[136:139]
    buffer_load_dwordx4 v247, s[20:23], s69 offen offset:3072 lds
    v_mfma_f32_16x16x32_bf16 v[140:143], v[204:207], v[44:47], v[140:143]
    s_waitcnt lgkmcnt(3)
    s_waitcnt vmcnt(30)
    s_barrier
    v_mfma_f32_16x16x32_bf16 v[132:135], v[208:211], v[48:51], v[132:135]
    s_add_u32 s33, s33, 16384
    s_cmp_eq_u32 s33, 163840
    s_cselect_b32 s33, 0, s33
    ds_read_b64_tr_b16 v[192:193], v224 offset:0
    ds_read_b64_tr_b16 v[194:195], v224 offset:8192
    v_mfma_f32_16x16x32_bf16 v[136:139], v[208:211], v[52:55], v[136:139]
    v_mfma_f32_16x16x32_bf16 v[140:143], v[208:211], v[56:59], v[140:143]
    s_waitcnt lgkmcnt(4)
    v_mfma_f32_16x16x32_bf16 v[132:135], v[212:215], v[60:63], v[132:135]
    ds_read_b64_tr_b16 v[196:197], v225 offset:0
    ds_read_b64_tr_b16 v[198:199], v225 offset:8192
    v_mfma_f32_16x16x32_bf16 v[136:139], v[212:215], v[64:67], v[136:139]
    v_mfma_f32_16x16x32_bf16 v[140:143], v[212:215], v[68:71], v[140:143]
    s_waitcnt lgkmcnt(5)
    v_mfma_f32_16x16x32_bf16 v[132:135], v[216:219], v[72:75], v[132:135]
    ds_read_b64_tr_b16 v[200:201], v226 offset:0
    ds_read_b64_tr_b16 v[202:203], v226 offset:8192
    v_mfma_f32_16x16x32_bf16 v[136:139], v[216:219], v[76:79], v[136:139]
    v_mfma_f32_16x16x32_bf16 v[140:143], v[216:219], v[80:83], v[140:143]
    s_waitcnt lgkmcnt(6)
    v_mfma_f32_16x16x32_bf16 v[132:135], v[220:223], v[84:87], v[132:135]
    ds_read_b64_tr_b16 v[204:205], v227 offset:0
    ds_read_b64_tr_b16 v[206:207], v227 offset:8192
    v_mfma_f32_16x16x32_bf16 v[136:139], v[220:223], v[88:91], v[136:139]
    v_mfma_f32_16x16x32_bf16 v[140:143], v[220:223], v[92:95], v[140:143]
    s_waitcnt lgkmcnt(6)
    s_cbranch_vccnz L_stub7
L_back7:
    v_mfma_f32_16x16x32_bf16 a[192:195], a[204:207], v[144:147], a[192:195]
    v_mfma_f32_16x16x32_bf16 a[196:199], a[204:207], v[148:151], a[196:199]
    v_mfma_f32_16x16x32_bf16 a[200:203], a[204:207], v[152:155], a[200:203]
    v_mfma_f32_16x16x32_bf16 a[0:3], v[192:195], v[144:147], a[0:3]
    s_add_u32 s34, s34, 16384
    s_cmp_eq_u32 s34, 163840
    s_cselect_b32 s34, 0, s34
    ds_read_b64_tr_b16 v[208:209], v228 offset:0
    ds_read_b64_tr_b16 v[210:211], v228 offset:8192
    v_mfma_f32_16x16x32_bf16 a[4:7], v[192:195], v[148:151], a[4:7]
    s_sub_u32 s50, s34, s35
    v_exp_f32 v168, v120
    v_mfma_f32_16x16x32_bf16 a[8:11], v[192:195], v[152:155], a[8:11]
    s_waitcnt lgkmcnt(6)
    v_exp_f32 v169, v121
    v_mfma_f32_16x16x32_bf16 a[12:15], v[196:199], v[144:147], a[12:15]
    s_mov_b32 s35, s34
    ds_read_b64_tr_b16 v[212:213], v229 offset:0
    ds_read_b64_tr_b16 v[214:215], v229 offset:8192
    v_mfma_f32_16x16x32_bf16 a[16:19], v[196:199], v[148:151], a[16:19]
    s_add_u32 m0, s33, s32
    buffer_load_dwordx4 v244, s[20:23], s70 offen offset:0 lds
    v_mfma_f32_16x16x32_bf16 a[20:23], v[196:199], v[152:155], a[20:23]
    s_waitcnt lgkmcnt(6)
    v_exp_f32 v170, v122
    v_mfma_f32_16x16x32_bf16 a[24:27], v[200:203], v[144:147], a[24:27]
    ds_read_b64_tr_b16 v[216:217], v230 offset:0
    ds_read_b64_tr_b16 v[218:219], v230 offset:8192
    v_mfma_f32_16x16x32_bf16 a[28:31], v[200:203], v[148:151], a[28:31]
    v_cvt_pk_bf16_f32 v156, v168, v169
    v_mfma_f32_16x16x32_bf16 a[32:35], v[200:203], v[152:155], a[32:35]
    s_waitcnt lgkmcnt(6)
    v_exp_f32 v171, v123
    v_mfma_f32_16x16x32_bf16 a[36:39], v[204:207], v[144:147], a[36:39]
    ds_read_b64_tr_b16 v[220:221], v231 offset:0
    ds_read_b64_tr_b16 v[222:223], v231 offset:8192
    v_mfma_f32_16x16x32_bf16 a[40:43], v[204:207], v[148:151], a[40:43]
    v_exp_f32 v172, v124
    v_mfma_f32_16x16x32_bf16 a[44:47], v[204:207], v[152:155], a[44:47]
    s_waitcnt lgkmcnt(6)
    v_cvt_pk_bf16_f32 v157, v170, v171
    v_mfma_f32_16x16x32_bf16 a[48:51], v[208:211], v[144:147], a[48:51]
    ds_read_b64_tr_b16 v[192:193], v224 offset:256
    ds_read_b64_tr_b16 v[194:195], v224 offset:8448
    v_mfma_f32_16x16x32_bf16 a[52:55], v[208:211], v[148:151], a[52:55]
    v_add_u32 v224, s50, v224
    v_mfma_f32_16x16x32_bf16 a[56:59], v[208:211], v[152:155], a[56:59]
    s_waitcnt lgkmcnt(6)
    buffer_load_dwordx4 v245, s[20:23], s70 offen offset:1024 lds
    v_mfma_f32_16x16x32_bf16 a[60:63], v[212:215], v[144:147], a[60:63]
    ds_read_b64_tr_b16 v[196:197], v225 offset:256
    ds_read_b64_tr_b16 v[198:199], v225 offset:8448
    v_mfma_f32_16x16x32_bf16 a[64:67], v[212:215], v[148:151], a[64:67]
    v_add_u32 v225, s50, v225
    v_mfma_f32_16x16x32_bf16 a[68:71], v[212:215], v[152:155], a[68:71]
    s_waitcnt lgkmcnt(6)
    v_exp_f32 v173, v125
    v_mfma_f32_16x16x32_bf16 a[72:75], v[216:219], v[144:147], a[72:75]
    ds_read_b64_tr_b16 v[200:201], v226 offset:256
    ds_read_b64_tr_b16 v[202:203], v226 offset:8448
    v_mfma_f32_16x16x32_bf16 a[76:79], v[216:219], v[148:151], a[76:79]
    v_add_u32 v226, s50, v226
    v_mfma_f32_16x16x32_bf16 a[80:83], v[216:219], v[152:155], a[80:83]
    s_waitcnt lgkmcnt(6)
    v_exp_f32 v174, v126
    v_mfma_f32_16x16x32_bf16 a[84:87], v[220:223], v[144:147], a[84:87]
    ds_read_b64_tr_b16 v[204:205], v227 offset:256
    ds_read_b64_tr_b16 v[206:207], v227 offset:8448
    v_mfma_f32_16x16x32_bf16 a[88:91], v[220:223], v[148:151], a[88:91]
    v_add_u32 v227, s50, v227
    v_cvt_pk_bf16_f32 v160, v172, v173
    v_mfma_f32_16x16x32_bf16 a[92:95], v[220:223], v[152:155], a[92:95]
    s_waitcnt lgkmcnt(6)
    v_exp_f32 v175, v127
    v_mfma_f32_16x16x32_bf16 a[96:99], v[192:195], v[144:147], a[96:99]
    ds_read_b64_tr_b16 v[208:209], v228 offset:256
    ds_read_b64_tr_b16 v[210:211], v228 offset:8448
    v_mfma_f32_16x16x32_bf16 a[100:103], v[192:195], v[148:151], a[100:103]
    v_add_u32 v228, s50, v228
    v_mfma_f32_16x16x32_bf16 a[104:107], v[192:195], v[152:155], a[104:107]
    s_waitcnt lgkmcnt(6)
    buffer_load_dwordx4 v246, s[20:23], s70 offen offset:2048 lds
    v_mfma_f32_16x16x32_bf16 a[108:111], v[196:199], v[144:147], a[108:111]
    ds_read_b64_tr_b16 v[212:213], v229 offset:256
    ds_read_b64_tr_b16 v[214:215], v229 offset:8448
    v_mfma_f32_16x16x32_bf16 a[112:115], v[196:199], v[148:151], a[112:115]
    v_add_u32 v229, s50, v229
    v_mfma_f32_16x16x32_bf16 a[116:119], v[196:199], v[152:155], a[116:119]
    s_waitcnt lgkmcnt(6)
    v_exp_f32 v168, v128
    v_mfma_f32_16x16x32_bf16 a[120:123], v[200:203], v[144:147], a[120:123]
    ds_read_b64_tr_b16 v[216:217], v230 offset:256
    ds_read_b64_tr_b16 v[218:219], v230 offset:8448
    v_mfma_f32_16x16x32_bf16 a[124:127], v[200:203], v[148:151], a[124:127]
    v_add_u32 v230, s50, v230
    v_cvt_pk_bf16_f32 v161, v174, v175
    v_mfma_f32_16x16x32_bf16 a[128:131], v[200:203], v[152:155], a[128:131]
    s_waitcnt lgkmcnt(6)
    v_exp_f32 v169, v129
    v_mfma_f32_16x16x32_bf16 a[132:135], v[204:207], v[144:147], a[132:135]
    ds_read_b64_tr_b16 v[220:221], v231 offset:256
    ds_read_b64_tr_b16 v[222:223], v231 offset:8448
    v_mfma_f32_16x16x32_bf16 a[136:139], v[204:207], v[148:151], a[136:139]
    v_add_u32 v231, s50, v231
    v_mfma_f32_16x16x32_bf16 a[140:143], v[204:207], v[152:155], a[140:143]
    s_waitcnt lgkmcnt(6)
    s_waitcnt vmcnt(29)
    s_barrier
    buffer_load_dwordx4 v247, s[20:23], s70 offen offset:3072 lds
    v_mfma_f32_16x16x32_bf16 a[144:147], v[208:211], v[144:147], a[144:147]
    s_add_u32 s33, s33, 16384
    s_cmp_eq_u32 s33, 163840
    s_cselect_b32 s33, 0, s33
    ds_read_b64_tr_b16 v[192:193], v224 offset:0
    ds_read_b64_tr_b16 v[194:195], v224 offset:8192
    v_mfma_f32_16x16x32_bf16 a[148:151], v[208:211], v[148:151], a[148:151]
    v_exp_f32 v170, v130
    v_mfma_f32_16x16x32_bf16 a[152:155], v[208:211], v[152:155], a[152:155]
    s_waitcnt lgkmcnt(6)
    v_cvt_pk_bf16_f32 v164, v168, v169
    v_mfma_f32_16x16x32_bf16 a[156:159], v[212:215], v[144:147], a[156:159]
    ds_read_b64_tr_b16 v[196:197], v225 offset:0
    ds_read_b64_tr_b16 v[198:199], v225 offset:8192
    v_mfma_f32_16x16x32_bf16 a[160:163], v[212:215], v[148:151], a[160:163]
    v_exp_f32 v171, v131
    v_mfma_f32_16x16x32_bf16 a[164:167], v[212:215], v[152:155], a[164:167]
    s_waitcnt lgkmcnt(6)
    v_exp_f32 v172, v132
    v_mfma_f32_16x16x32_bf16 a[168:171], v[216:219], v[144:147], a[168:171]
    ds_read_b64_tr_b16 v[200:201], v226 offset:0
    ds_read_b64_tr_b16 v[202:203], v226 offset:8192
    v_mfma_f32_16x16x32_bf16 a[172:175], v[216:219], v[148:151], a[172:175]
    v_cvt_pk_bf16_f32 v165, v170, v171
    v_mfma_f32_16x16x32_bf16 a[176:179], v[216:219], v[152:155], a[176:179]
    s_waitcnt lgkmcnt(6)
    v_exp_f32 v173, v133
    v_mfma_f32_16x16x32_bf16 a[180:183], v[220:223], v[144:147], a[180:183]
    ds_read_b64_tr_b16 v[204:205], v227 offset:0
    ds_read_b64_tr_b16 v[206:207], v227 offset:8192
    v_mfma_f32_16x16x32_bf16 a[184:187], v[220:223], v[148:151], a[184:187]
    v_exp_f32 v174, v134
    v_mfma_f32_16x16x32_bf16 a[188:191], v[220:223], v[152:155], a[188:191]
    s_waitcnt lgkmcnt(6)
    v_cvt_pk_bf16_f32 v158, v172, v173
    v_exp_f32 v175, v135
    v_exp_f32 v168, v136
    v_cvt_pk_bf16_f32 v159, v174, v175
    v_exp_f32 v169, v137
    v_exp_f32 v170, v138
    v_cvt_pk_bf16_f32 v162, v168, v169
    v_exp_f32 v171, v139
    v_exp_f32 v172, v140
    v_cvt_pk_bf16_f32 v163, v170, v171
    v_exp_f32 v173, v141
    v_exp_f32 v174, v142
    v_cvt_pk_bf16_f32 v166, v172, v173
    v_exp_f32 v175, v143
    v_or3_b32 v188, v156, v157, v160
    v_cvt_pk_bf16_f32 v167, v174, v175
    v_or3_b32 v188, v188, v161, v164
    v_or3_b32 v188, v188, v165, v158
    v_or3_b32 v188, v188, v159, v162
    v_or3_b32 v188, v188, v163, v166
    v_or_b32 v188, v188, v167
    v_and_b32 v188, 0x40004000, v188
    v_cmp_ne_u32 vcc, 0, v188
    s_cbranch_vccnz L_stub8
L_back8:
    s_cmp_eq_u32 s30, 0
    s_cbranch_scc0 L_c15b
    v_mfma_f32_16x16x32_bf16 a[192:195], a[204:207], v[156:159], a[192:195]
    v_mfma_f32_16x16x32_bf16 a[196:199], a[204:207], v[160:163], a[196:199]
    v_mfma_f32_16x16x32_bf16 a[200:203], a[204:207], v[164:167], a[200:203]
    v_mfma_f32_16x16x32_bf16 a[0:3], v[192:195], v[156:159], a[0:3]
    s_add_u32 s34, s34, 16384
    s_cmp_eq_u32 s34, 163840
    s_cselect_b32 s34, 0, s34
    ds_read_b64_tr_b16 v[208:209], v228 offset:0
    ds_read_b64_tr_b16 v[210:211], v228 offset:8192
    v_mfma_f32_16x16x32_bf16 a[4:7], v[192:195], v[160:163], a[4:7]
    v_mfma_f32_16x16x32_bf16 a[8:11], v[192:195], v[164:167], a[8:11]
    s_waitcnt lgkmcnt(6)
    v_mfma_f32_16x16x32_bf16 a[12:15], v[196:199], v[156:159], a[12:15]
    s_add_u32 m0, s33, s32
    ds_read_b64_tr_b16 v[212:213], v229 offset:0
    ds_read_b64_tr_b16 v[214:215], v229 offset:8192
    v_mfma_f32_16x16x32_bf16 a[16:19], v[196:199], v[160:163], a[16:19]
    buffer_load_dwordx4 v244, s[20:23], s71 offen offset:0 lds
    v_mfma_f32_16x16x32_bf16 a[20:23], v[196:199], v[164:167], a[20:23]
    s_waitcnt lgkmcnt(6)
    v_mfma_f32_16x16x32_bf16 a[24:27], v[200:203], v[156:159], a[24:27]
    ds_read_b64_tr_b16 v[216:217], v230 offset:0
    ds_read_b64_tr_b16 v[218:219], v230 offset:8192
    v_mfma_f32_16x16x32_bf16 a[28:31], v[200:203], v[160:163], a[28:31]
    v_mfma_f32_16x16x32_bf16 a[32:35], v[200:203], v[164:167], a[32:35]
    s_waitcnt lgkmcnt(6)
    v_mfma_f32_16x16x32_bf16 a[36:39], v[204:207], v[156:159], a[36:39]
    ds_read_b64_tr_b16 v[220:221], v231 offset:0
    ds_read_b64_tr_b16 v[222:223], v231 offset:8192
    v_mfma_f32_16x16x32_bf16 a[40:43], v[204:207], v[160:163], a[40:43]
    v_mfma_f32_16x16x32_bf16 a[44:47], v[204:207], v[164:167], a[44:47]
    s_waitcnt lgkmcnt(6)
    v_mfma_f32_16x16x32_bf16 a[48:51], v[208:211], v[156:159], a[48:51]
    ds_read_b64_tr_b16 v[192:193], v224 offset:256
    ds_read_b64_tr_b16 v[194:195], v224 offset:8448
    v_mfma_f32_16x16x32_bf16 a[52:55], v[208:211], v[160:163], a[52:55]
    v_mfma_f32_16x16x32_bf16 a[56:59], v[208:211], v[164:167], a[56:59]
    s_waitcnt lgkmcnt(6)
    buffer_load_dwordx4 v245, s[20:23], s71 offen offset:1024 lds
    v_mfma_f32_16x16x32_bf16 a[60:63], v[212:215], v[156:159], a[60:63]
    ds_read_b64_tr_b16 v[196:197], v225 offset:256
    ds_read_b64_tr_b16 v[198:199], v225 offset:8448
    v_mfma_f32_16x16x32_bf16 a[64:67], v[212:215], v[160:163], a[64:67]
    v_mfma_f32_16x16x32_bf16 a[68:71], v[212:215], v[164:167], a[68:71]
    s_waitcnt lgkmcnt(6)
    v_mfma_f32_16x16x32_bf16 a[72:75], v[216:219], v[156:159], a[72:75]
    ds_read_b64_tr_b16 v[200:201], v226 offset:256
    ds_read_b64_tr_b16 v[202:203], v226 offset:8448
    v_mfma_f32_16x16x32_bf16 a[76:79], v[216:219], v[160:163], a[76:79]
    v_mfma_f32_16x16x32_bf16 a[80:83], v[216:219], v[164:167], a[80:83]
    s_waitcnt lgkmcnt(6)
    v_mfma_f32_16x16x32_bf16 a[84:87], v[220:223], v[156:159], a[84:87]
    ds_read_b64_tr_b16 v[204:205], v227 offset:256
    ds_read_b64_tr_b16 v[206:207], v227 offset:8448
    v_mfma_f32_16x16x32_bf16 a[88:91], v[220:223], v[160:163], a[88:91]
    v_mfma_f32_16x16x32_bf16 a[92:95], v[220:223], v[164:167], a[92:95]
    s_waitcnt lgkmcnt(6)
    v_mfma_f32_16x16x32_bf16 a[96:99], v[192:195], v[156:159], a[96:99]
    ds_read_b64_tr_b16 v[208:209], v228 offset:256
    ds_read_b64_tr_b16 v[210:211], v228 offset:8448
    v_mfma_f32_16x16x32_bf16 a[100:103], v[192:195], v[160:163], a[100:103]
    buffer_load_dwordx4 v246, s[20:23], s71 offen offset:2048 lds
    v_mfma_f32_16x16x32_bf16 a[104:107], v[192:195], v[164:167], a[104:107]
    s_waitcnt lgkmcnt(6)
    v_mfma_f32_16x16x32_bf16 a[108:111], v[196:199], v[156:159], a[108:111]
    ds_read_b64_tr_b16 v[212:213], v229 offset:256
    ds_read_b64_tr_b16 v[214:215], v229 offset:8448
    v_mfma_f32_16x16x32_bf16 a[112:115], v[196:199], v[160:163], a[112:115]
    v_mfma_f32_16x16x32_bf16 a[116:119], v[196:199], v[164:167], a[116:119]
    s_waitcnt lgkmcnt(6)
    v_mfma_f32_16x16x32_bf16 a[120:123], v[200:203], v[156:159], a[120:123]
    ds_read_b64_tr_b16 v[216:217], v230 offset:256
    ds_read_b64_tr_b16 v[218:219], v230 offset:8448
    v_mfma_f32_16x16x32_bf16 a[124:127], v[200:203], v[160:163], a[124:127]
    v_mfma_f32_16x16x32_bf16 a[128:131], v[200:203], v[164:167], a[128:131]
    s_waitcnt lgkmcnt(6)
    v_mfma_f32_16x16x32_bf16 a[132:135], v[204:207], v[156:159], a[132:135]
    ds_read_b64_tr_b16 v[220:221], v231 offset:256
    ds_read_b64_tr_b16 v[222:223], v231 offset:8448
    v_mfma_f32_16x16x32_bf16 a[136:139], v[204:207], v[160:163], a[136:139]
    buffer_load_dwordx4 v247, s[20:23], s71 offen offset:3072 lds
    v_mfma_f32_16x16x32_bf16 a[140:143], v[204:207], v[164:167], a[140:143]
    s_waitcnt lgkmcnt(6)
    v_mfma_f32_16x16x32_bf16 a[144:147], v[208:211], v[156:159], a[144:147]
    s_add_u32 s33, s33, 16384
    s_cmp_eq_u32 s33, 163840
    s_cselect_b32 s33, 0, s33
    v_mfma_f32_16x16x32_bf16 a[148:151], v[208:211], v[160:163], a[148:151]
    v_mfma_f32_16x16x32_bf16 a[152:155], v[208:211], v[164:167], a[152:155]
    s_waitcnt lgkmcnt(4)
    v_mfma_f32_16x16x32_bf16 a[156:159], v[212:215], v[156:159], a[156:159]
    v_mfma_f32_16x16x32_bf16 a[160:163], v[212:215], v[160:163], a[160:163]
    v_mfma_f32_16x16x32_bf16 a[164:167], v[212:215], v[164:167], a[164:167]
    s_waitcnt lgkmcnt(2)
    v_mfma_f32_16x16x32_bf16 a[168:171], v[216:219], v[156:159], a[168:171]
    v_mfma_f32_16x16x32_bf16 a[172:175], v[216:219], v[160:163], a[172:175]
    v_mfma_f32_16x16x32_bf16 a[176:179], v[216:219], v[164:167], a[176:179]
    s_waitcnt lgkmcnt(0)
    v_mfma_f32_16x16x32_bf16 a[180:183], v[220:223], v[156:159], a[180:183]
    v_mfma_f32_16x16x32_bf16 a[184:187], v[220:223], v[160:163], a[184:187]
    v_mfma_f32_16x16x32_bf16 a[188:191], v[220:223], v[164:167], a[188:191]
    s_branch L_c15e
L_c15b:
    v_mfma_f32_16x16x32_bf16 a[192:195], a[204:207], v[156:159], a[192:195]
    v_mfma_f32_16x16x32_bf16 a[196:199], a[204:207], v[160:163], a[196:199]
    v_mfma_f32_16x16x32_bf16 a[200:203], a[204:207], v[164:167], a[200:203]
    v_mfma_f32_16x16x32_bf16 a[0:3], v[192:195], v[156:159], a[0:3]
    s_add_u32 s34, s34, 16384
    s_cmp_eq_u32 s34, 163840
    s_cselect_b32 s34, 0, s34
    ds_read_b64_tr_b16 v[208:209], v228 offset:0
    ds_read_b64_tr_b16 v[210:211], v228 offset:8192
    v_mfma_f32_16x16x32_bf16 a[4:7], v[192:195], v[160:163], a[4:7]
    s_add_u32 s56, s47, 8192
    buffer_load_dwordx4 v[44:47], v250, s[24:27], s56 offen offset:3072 sc1 nt
    v_mfma_f32_16x16x32_bf16 a[8:11], v[192:195], v[164:167], a[8:11]
    s_waitcnt lgkmcnt(6)
    v_mfma_f32_16x16x32_bf16 a[12:15], v[196:199], v[156:159], a[12:15]
    s_add_u32 m0, s33, s32
    ds_read_b64_tr_b16 v[212:213], v229 offset:0
    ds_read_b64_tr_b16 v[214:215], v229 offset:8192
    v_mfma_f32_16x16x32_bf16 a[16:19], v[196:199], v[160:163], a[16:19]
    s_add_u32 s56, s47, 12288
    buffer_load_dwordx4 v244, s[20:23], s71 offen offset:0 lds
    v_mfma_f32_16x16x32_bf16 a[20:23], v[196:199], v[164:167], a[20:23]
    s_waitcnt lgkmcnt(6)
    buffer_load_dwordx4 v[48:51], v250, s[24:27], s56 offen offset:0 sc1 nt
    v_mfma_f32_16x16x32_bf16 a[24:27], v[200:203], v[156:159], a[24:27]
    ds_read_b64_tr_b16 v[216:217], v230 offset:0
    ds_read_b64_tr_b16 v[218:219], v230 offset:8192
    v_mfma_f32_16x16x32_bf16 a[28:31], v[200:203], v[160:163], a[28:31]
    buffer_load_dwordx4 v[52:55], v250, s[24:27], s56 offen offset:1024 sc1 nt
    v_mfma_f32_16x16x32_bf16 a[32:35], v[200:203], v[164:167], a[32:35]
    s_waitcnt lgkmcnt(6)
    buffer_load_dwordx4 v[56:59], v250, s[24:27], s56 offen offset:2048 sc1 nt
    v_mfma_f32_16x16x32_bf16 a[36:39], v[204:207], v[156:159], a[36:39]
    ds_read_b64_tr_b16 v[220:221], v231 offset:0
    ds_read_b64_tr_b16 v[222:223], v231 offset:8192
    v_mfma_f32_16x16x32_bf16 a[40:43], v[204:207], v[160:163], a[40:43]
    buffer_load_dwordx4 v[60:63], v250, s[24:27], s56 offen offset:3072 sc1 nt
    v_mfma_f32_16x16x32_bf16 a[44:47], v[204:207], v[164:167], a[44:47]
    s_waitcnt lgkmcnt(6)
    v_mfma_f32_16x16x32_bf16 a[48:51], v[208:211], v[156:159], a[48:51]
    s_add_u32 s56, s47, 16384
    ds_read_b64_tr_b16 v[192:193], v224 offset:256
    ds_read_b64_tr_b16 v[194:195], v224 offset:8448
    v_mfma_f32_16x16x32_bf16 a[52:55], v[208:211], v[160:163], a[52:55]
    buffer_load_dwordx4 v[64:67], v250, s[24:27], s56 offen offset:0 sc1 nt
    v_mfma_f32_16x16x32_bf16 a[56:59], v[208:211], v[164:167], a[56:59]
    s_waitcnt lgkmcnt(6)
    buffer_load_dwordx4 v245, s[20:23], s71 offen offset:1024 lds
    v_mfma_f32_16x16x32_bf16 a[60:63], v[212:215], v[156:159], a[60:63]
    ds_read_b64_tr_b16 v[196:197], v225 offset:256
    ds_read_b64_tr_b16 v[198:199], v225 offset:8448
    v_mfma_f32_16x16x32_bf16 a[64:67], v[212:215], v[160:163], a[64:67]
    buffer_load_dwordx4 v[68:71], v250, s[24:27], s56 offen offset:1024 sc1 nt
    v_mfma_f32_16x16x32_bf16 a[68:71], v[212:215], v[164:167], a[68:71]
    s_waitcnt lgkmcnt(6)
    buffer_load_dwordx4 v[72:75], v250, s[24:27], s56 offen offset:2048 sc1 nt
    v_mfma_f32_16x16x32_bf16 a[72:75], v[216:219], v[156:159], a[72:75]
    ds_read_b64_tr_b16 v[200:201], v226 offset:256
    ds_read_b64_tr_b16 v[202:203], v226 offset:8448
    v_mfma_f32_16x16x32_bf16 a[76:79], v[216:219], v[160:163], a[76:79]
    buffer_load_dwordx4 v[76:79], v250, s[24:27], s56 offen offset:3072 sc1 nt
    v_mfma_f32_16x16x32_bf16 a[80:83], v[216:219], v[164:167], a[80:83]
    s_waitcnt lgkmcnt(6)
    v_mfma_f32_16x16x32_bf16 a[84:87], v[220:223], v[156:159], a[84:87]
    s_add_u32 s56, s47, 20480
    ds_read_b64_tr_b16 v[204:205], v227 offset:256
    ds_read_b64_tr_b16 v[206:207], v227 offset:8448
    v_mfma_f32_16x16x32_bf16 a[88:91], v[220:223], v[160:163], a[88:91]
    buffer_load_dwordx4 v[80:83], v250, s[24:27], s56 offen offset:0 sc1 nt
    v_mfma_f32_16x16x32_bf16 a[92:95], v[220:223], v[164:167], a[92:95]
    s_waitcnt lgkmcnt(6)
    buffer_load_dwordx4 v[84:87], v250, s[24:27], s56 offen offset:1024 sc1 nt
    v_mfma_f32_16x16x32_bf16 a[96:99], v[192:195], v[156:159], a[96:99]
    ds_read_b64_tr_b16 v[208:209], v228 offset:256
    ds_read_b64_tr_b16 v[210:211], v228 offset:8448
    v_mfma_f32_16x16x32_bf16 a[100:103], v[192:195], v[160:163], a[100:103]
    buffer_load_dwordx4 v246, s[20:23], s71 offen offset:2048 lds
    v_mfma_f32_16x16x32_bf16 a[104:107], v[192:195], v[164:167], a[104:107]
    s_waitcnt lgkmcnt(6)
    buffer_load_dwordx4 v[88:91], v250, s[24:27], s56 offen offset:2048 sc1 nt
    v_mfma_f32_16x16x32_bf16 a[108:111], v[196:199], v[156:159], a[108:111]
    ds_read_b64_tr_b16 v[212:213], v229 offset:256
    ds_read_b64_tr_b16 v[214:215], v229 offset:8448
    v_mfma_f32_16x16x32_bf16 a[112:115], v[196:199], v[160:163], a[112:115]
    buffer_load_dwordx4 v[92:95], v250, s[24:27], s56 offen offset:3072 sc1 nt
    v_mfma_f32_16x16x32_bf16 a[116:119], v[196:199], v[164:167], a[116:119]
    s_waitcnt lgkmcnt(6)
    v_mfma_f32_16x16x32_bf16 a[120:123], v[200:203], v[156:159], a[120:123]
    ds_read_b64_tr_b16 v[216:217], v230 offset:256
    ds_read_b64_tr_b16 v[218:219], v230 offset:8448
    v_mfma_f32_16x16x32_bf16 a[124:127], v[200:203], v[160:163], a[124:127]
    v_mfma_f32_16x16x32_bf16 a[128:131], v[200:203], v[164:167], a[128:131]
    s_waitcnt lgkmcnt(6)
    v_mfma_f32_16x16x32_bf16 a[132:135], v[204:207], v[156:159], a[132:135]
    ds_read_b64_tr_b16 v[220:221], v231 offset:256
    ds_read_b64_tr_b16 v[222:223], v231 offset:8448
    v_mfma_f32_16x16x32_bf16 a[136:139], v[204:207], v[160:163], a[136:139]
    buffer_load_dwordx4 v247, s[20:23], s71 offen offset:3072 lds
    v_mfma_f32_16x16x32_bf16 a[140:143], v[204:207], v[164:167], a[140:143]
    s_waitcnt lgkmcnt(6)
    v_mfma_f32_16x16x32_bf16 a[144:147], v[208:211], v[156:159], a[144:147]
    s_add_u32 s33, s33, 16384
    s_cmp_eq_u32 s33, 163840
    s_cselect_b32 s33, 0, s33
    v_mfma_f32_16x16x32_bf16 a[148:151], v[208:211], v[160:163], a[148:151]
    v_mfma_f32_16x16x32_bf16 a[152:155], v[208:211], v[164:167], a[152:155]
    s_waitcnt lgkmcnt(4)
    v_mfma_f32_16x16x32_bf16 a[156:159], v[212:215], v[156:159], a[156:159]
    v_mfma_f32_16x16x32_bf16 a[160:163], v[212:215], v[160:163], a[160:163]
    v_mfma_f32_16x16x32_bf16 a[164:167], v[212:215], v[164:167], a[164:167]
    s_waitcnt lgkmcnt(2)
    v_mfma_f32_16x16x32_bf16 a[168:171], v[216:219], v[156:159], a[168:171]
    v_mfma_f32_16x16x32_bf16 a[172:175], v[216:219], v[160:163], a[172:175]
    v_mfma_f32_16x16x32_bf16 a[176:179], v[216:219], v[164:167], a[176:179]
    s_waitcnt lgkmcnt(0)
    v_mfma_f32_16x16x32_bf16 a[180:183], v[220:223], v[156:159], a[180:183]
    v_mfma_f32_16x16x32_bf16 a[184:187], v[220:223], v[160:163], a[184:187]
    v_mfma_f32_16x16x32_bf16 a[188:191], v[220:223], v[164:167], a[188:191]
L_c15e:
    s_cmp_eq_u32 s30, 1
    s_cbranch_scc1 L_oc1
    s_nop 7
    v_accvgpr_read_b32 v192, a192
    v_accvgpr_read_b32 v194, a196
    v_accvgpr_read_b32 v196, a200
    v_rcp_f32 v192, v192
    v_rcp_f32 v194, v194
    v_rcp_f32 v196, v196
    s_nop 0
    v_mov_b32 v193, v192
    v_mov_b32 v195, v194
    v_mov_b32 v197, v196
    .p2align 3
    v_accvgpr_read_b32 v200, a80
    v_accvgpr_read_b32 v201, a81
    v_accvgpr_read_b32 v202, a82
    v_accvgpr_read_b32 v203, a83
    v_accvgpr_read_b32 v204, a92
    v_accvgpr_read_b32 v205, a93
    v_accvgpr_read_b32 v206, a94
    v_accvgpr_read_b32 v207, a95
    v_pk_mul_f32 v[200:201], v[200:201], v[196:197]
    v_pk_mul_f32 v[202:203], v[202:203], v[196:197]
    v_pk_mul_f32 v[204:205], v[204:205], v[196:197]
    v_pk_mul_f32 v[206:207], v[206:207], v[196:197]
    v_cvt_pk_bf16_f32 v140, v200, v201
    v_cvt_pk_bf16_f32 v141, v202, v203
    v_cvt_pk_bf16_f32 v142, v204, v205
    v_cvt_pk_bf16_f32 v143, v206, v207
    s_add_u32 s56, s47, 8192
    buffer_store_dwordx4 v[140:143], v250, s[24:27], s56 offen offset:3072 nt
    v_accvgpr_read_b32 v208, a96
    v_accvgpr_read_b32 v209, a97
    v_accvgpr_read_b32 v210, a98
    v_accvgpr_read_b32 v211, a99
    v_accvgpr_read_b32 v212, a108
    v_accvgpr_read_b32 v213, a109
    v_accvgpr_read_b32 v214, a110
    v_accvgpr_read_b32 v215, a111
    v_pk_mul_f32 v[208:209], v[208:209], v[192:193]
    v_pk_mul_f32 v[210:211], v[210:211], v[192:193]
    v_pk_mul_f32 v[212:213], v[212:213], v[192:193]
    v_pk_mul_f32 v[214:215], v[214:215], v[192:193]
    v_cvt_pk_bf16_f32 v144, v208, v209
    v_cvt_pk_bf16_f32 v145, v210, v211
    v_cvt_pk_bf16_f32 v146, v212, v213
    v_cvt_pk_bf16_f32 v147, v214, v215
    s_add_u32 s56, s47, 12288
    buffer_store_dwordx4 v[144:147], v250, s[24:27], s56 offen offset:0 nt
    v_accvgpr_read_b32 v216, a100
    v_accvgpr_read_b32 v217, a101
    v_accvgpr_read_b32 v218, a102
    v_accvgpr_read_b32 v219, a103
    v_accvgpr_read_b32 v220, a112
    v_accvgpr_read_b32 v221, a113
    v_accvgpr_read_b32 v222, a114
    v_accvgpr_read_b32 v223, a115
    v_pk_mul_f32 v[216:217], v[216:217], v[194:195]
    v_pk_mul_f32 v[218:219], v[218:219], v[194:195]
    v_pk_mul_f32 v[220:221], v[220:221], v[194:195]
    v_pk_mul_f32 v[222:223], v[222:223], v[194:195]
    v_cvt_pk_bf16_f32 v148, v216, v217
    v_cvt_pk_bf16_f32 v149, v218, v219
    v_cvt_pk_bf16_f32 v150, v220, v221
    v_cvt_pk_bf16_f32 v151, v222, v223
    buffer_store_dwordx4 v[148:151], v250, s[24:27], s56 offen offset:1024 nt
    v_accvgpr_read_b32 v200, a104
    v_accvgpr_read_b32 v201, a105
    v_accvgpr_read_b32 v202, a106
    v_accvgpr_read_b32 v203, a107
    v_accvgpr_read_b32 v204, a116
    v_accvgpr_read_b32 v205, a117
    v_accvgpr_read_b32 v206, a118
    v_accvgpr_read_b32 v207, a119
    v_pk_mul_f32 v[200:201], v[200:201], v[196:197]
    v_pk_mul_f32 v[202:203], v[202:203], v[196:197]
    v_pk_mul_f32 v[204:205], v[204:205], v[196:197]
    v_pk_mul_f32 v[206:207], v[206:207], v[196:197]
    v_cvt_pk_bf16_f32 v152, v200, v201
    v_cvt_pk_bf16_f32 v153, v202, v203
    v_cvt_pk_bf16_f32 v154, v204, v205
    v_cvt_pk_bf16_f32 v155, v206, v207
    buffer_store_dwordx4 v[152:155], v250, s[24:27], s56 offen offset:2048 nt
    v_accvgpr_read_b32 v208, a120
    v_accvgpr_read_b32 v209, a121
    v_accvgpr_read_b32 v210, a122
    v_accvgpr_read_b32 v211, a123
    v_accvgpr_read_b32 v212, a132
    v_accvgpr_read_b32 v213, a133
    v_accvgpr_read_b32 v214, a134
    v_accvgpr_read_b32 v215, a135
    v_pk_mul_f32 v[208:209], v[208:209], v[192:193]
    v_pk_mul_f32 v[210:211], v[210:211], v[192:193]
    v_pk_mul_f32 v[212:213], v[212:213], v[192:193]
    v_pk_mul_f32 v[214:215], v[214:215], v[192:193]
    v_cvt_pk_bf16_f32 v156, v208, v209
    v_cvt_pk_bf16_f32 v157, v210, v211
    v_cvt_pk_bf16_f32 v158, v212, v213
    v_cvt_pk_bf16_f32 v159, v214, v215
    buffer_store_dwordx4 v[156:159], v250, s[24:27], s56 offen offset:3072 nt
    v_accvgpr_read_b32 v216, a124
    v_accvgpr_read_b32 v217, a125
    v_accvgpr_read_b32 v218, a126
    v_accvgpr_read_b32 v219, a127
    v_accvgpr_read_b32 v220, a136
    v_accvgpr_read_b32 v221, a137
    v_accvgpr_read_b32 v222, a138
    v_accvgpr_read_b32 v223, a139
    v_pk_mul_f32 v[216:217], v[216:217], v[194:195]
    v_pk_mul_f32 v[218:219], v[218:219], v[194:195]
    v_pk_mul_f32 v[220:221], v[220:221], v[194:195]
    v_pk_mul_f32 v[222:223], v[222:223], v[194:195]
    v_cvt_pk_bf16_f32 v160, v216, v217
    v_cvt_pk_bf16_f32 v161, v218, v219
    v_cvt_pk_bf16_f32 v162, v220, v221
    v_cvt_pk_bf16_f32 v163, v222, v223
    s_add_u32 s56, s47, 16384
    buffer_store_dwordx4 v[160:163], v250, s[24:27], s56 offen offset:0 nt
    v_accvgpr_read_b32 v200, a128
    v_accvgpr_read_b32 v201, a129
    v_accvgpr_read_b32 v202, a130
    v_accvgpr_read_b32 v203, a131
    v_accvgpr_read_b32 v204, a140
    v_accvgpr_read_b32 v205, a141
    v_accvgpr_read_b32 v206, a142
    v_accvgpr_read_b32 v207, a143
    v_pk_mul_f32 v[200:201], v[200:201], v[196:197]
    v_pk_mul_f32 v[202:203], v[202:203], v[196:197]
    v_pk_mul_f32 v[204:205], v[204:205], v[196:197]
    v_pk_mul_f32 v[206:207], v[206:207], v[196:197]
    v_cvt_pk_bf16_f32 v164, v200, v201
    v_cvt_pk_bf16_f32 v165, v202, v203
    v_cvt_pk_bf16_f32 v166, v204, v205
    v_cvt_pk_bf16_f32 v167, v206, v207
    buffer_store_dwordx4 v[164:167], v250, s[24:27], s56 offen offset:1024 nt
    v_accvgpr_read_b32 v208, a144
    v_accvgpr_read_b32 v209, a145
    v_accvgpr_read_b32 v210, a146
    v_accvgpr_read_b32 v211, a147
    v_accvgpr_read_b32 v212, a156
    v_accvgpr_read_b32 v213, a157
    v_accvgpr_read_b32 v214, a158
    v_accvgpr_read_b32 v215, a159
    v_pk_mul_f32 v[208:209], v[208:209], v[192:193]
    v_pk_mul_f32 v[210:211], v[210:211], v[192:193]
    v_pk_mul_f32 v[212:213], v[212:213], v[192:193]
    v_pk_mul_f32 v[214:215], v[214:215], v[192:193]
    v_cvt_pk_bf16_f32 v168, v208, v209
    v_cvt_pk_bf16_f32 v169, v210, v211
    v_cvt_pk_bf16_f32 v170, v212, v213
    v_cvt_pk_bf16_f32 v171, v214, v215
    buffer_store_dwordx4 v[168:171], v250, s[24:27], s56 offen offset:2048 nt
    v_accvgpr_read_b32 v216, a148
    v_accvgpr_read_b32 v217, a149
    v_accvgpr_read_b32 v218, a150
    v_accvgpr_read_b32 v219, a151
    v_accvgpr_read_b32 v220, a160
    v_accvgpr_read_b32 v221, a161
    v_accvgpr_read_b32 v222, a162
    v_accvgpr_read_b32 v223, a163
    v_pk_mul_f32 v[216:217], v[216:217], v[194:195]
    v_pk_mul_f32 v[218:219], v[218:219], v[194:195]
    v_pk_mul_f32 v[220:221], v[220:221], v[194:195]
    v_pk_mul_f32 v[222:223], v[222:223], v[194:195]
    v_cvt_pk_bf16_f32 v172, v216, v217
    v_cvt_pk_bf16_f32 v173, v218, v219
    v_cvt_pk_bf16_f32 v174, v220, v221
    v_cvt_pk_bf16_f32 v175, v222, v223
    buffer_store_dwordx4 v[172:175], v250, s[24:27], s56 offen offset:3072 nt
    v_accvgpr_read_b32 v200, a152
    v_accvgpr_read_b32 v201, a153
    v_accvgpr_read_b32 v202, a154
    v_accvgpr_read_b32 v203, a155
    v_accvgpr_read_b32 v204, a164
    v_accvgpr_read_b32 v205, a165
    v_accvgpr_read_b32 v206, a166
    v_accvgpr_read_b32 v207, a167
    v_pk_mul_f32 v[200:201], v[200:201], v[196:197]
    v_pk_mul_f32 v[202:203], v[202:203], v[196:197]
    v_pk_mul_f32 v[204:205], v[204:205], v[196:197]
    v_pk_mul_f32 v[206:207], v[206:207], v[196:197]
    v_cvt_pk_bf16_f32 v176, v200, v201
    v_cvt_pk_bf16_f32 v177, v202, v203
    v_cvt_pk_bf16_f32 v178, v204, v205
    v_cvt_pk_bf16_f32 v179, v206, v207
    s_add_u32 s56, s47, 20480
    buffer_store_dwordx4 v[176:179], v250, s[24:27], s56 offen offset:0 nt
    v_accvgpr_read_b32 v208, a168
    v_accvgpr_read_b32 v209, a169
    v_accvgpr_read_b32 v210, a170
    v_accvgpr_read_b32 v211, a171
    v_accvgpr_read_b32 v212, a180
    v_accvgpr_read_b32 v213, a181
    v_accvgpr_read_b32 v214, a182
    v_accvgpr_read_b32 v215, a183
    v_pk_mul_f32 v[208:209], v[208:209], v[192:193]
    v_pk_mul_f32 v[210:211], v[210:211], v[192:193]
    v_pk_mul_f32 v[212:213], v[212:213], v[192:193]
    v_pk_mul_f32 v[214:215], v[214:215], v[192:193]
    v_cvt_pk_bf16_f32 v180, v208, v209
    v_cvt_pk_bf16_f32 v181, v210, v211
    v_cvt_pk_bf16_f32 v182, v212, v213
    v_cvt_pk_bf16_f32 v183, v214, v215
    buffer_store_dwordx4 v[180:183], v250, s[24:27], s56 offen offset:1024 nt
    v_accvgpr_read_b32 v216, a172
    v_accvgpr_read_b32 v217, a173
    v_accvgpr_read_b32 v218, a174
    v_accvgpr_read_b32 v219, a175
    v_accvgpr_read_b32 v220, a184
    v_accvgpr_read_b32 v221, a185
    v_accvgpr_read_b32 v222, a186
    v_accvgpr_read_b32 v223, a187
    v_pk_mul_f32 v[216:217], v[216:217], v[194:195]
    v_pk_mul_f32 v[218:219], v[218:219], v[194:195]
    v_pk_mul_f32 v[220:221], v[220:221], v[194:195]
    v_pk_mul_f32 v[222:223], v[222:223], v[194:195]
    v_cvt_pk_bf16_f32 v184, v216, v217
    v_cvt_pk_bf16_f32 v185, v218, v219
    v_cvt_pk_bf16_f32 v186, v220, v221
    v_cvt_pk_bf16_f32 v187, v222, v223
    buffer_store_dwordx4 v[184:187], v250, s[24:27], s56 offen offset:2048 nt
    v_accvgpr_read_b32 v200, a176
    v_accvgpr_read_b32 v201, a177
    v_accvgpr_read_b32 v202, a178
    v_accvgpr_read_b32 v203, a179
    v_accvgpr_read_b32 v204, a188
    v_accvgpr_read_b32 v205, a189
    v_accvgpr_read_b32 v206, a190
    v_accvgpr_read_b32 v207, a191
    v_pk_mul_f32 v[200:201], v[200:201], v[196:197]
    v_pk_mul_f32 v[202:203], v[202:203], v[196:197]
    v_pk_mul_f32 v[204:205], v[204:205], v[196:197]
    v_pk_mul_f32 v[206:207], v[206:207], v[196:197]
    v_cvt_pk_bf16_f32 v188, v200, v201
    v_cvt_pk_bf16_f32 v189, v202, v203
    v_cvt_pk_bf16_f32 v190, v204, v205
    v_cvt_pk_bf16_f32 v191, v206, v207
    buffer_store_dwordx4 v[188:191], v250, s[24:27], s56 offen offset:3072 nt
    v_accvgpr_read_b32 v208, a0
    v_accvgpr_read_b32 v209, a1
    v_accvgpr_read_b32 v210, a2
    v_accvgpr_read_b32 v211, a3
    v_accvgpr_read_b32 v212, a12
    v_accvgpr_read_b32 v213, a13
    v_accvgpr_read_b32 v214, a14
    v_accvgpr_read_b32 v215, a15
    v_pk_mul_f32 v[208:209], v[208:209], v[192:193]
    v_pk_mul_f32 v[210:211], v[210:211], v[192:193]
    v_pk_mul_f32 v[212:213], v[212:213], v[192:193]
    v_pk_mul_f32 v[214:215], v[214:215], v[192:193]
    v_cvt_pk_bf16_f32 v96, v208, v209
    v_cvt_pk_bf16_f32 v97, v210, v211
    v_cvt_pk_bf16_f32 v98, v212, v213
    v_cvt_pk_bf16_f32 v99, v214, v215
    v_accvgpr_write_b32 a208, v96
    v_accvgpr_write_b32 a209, v97
    v_accvgpr_write_b32 a210, v98
    v_accvgpr_write_b32 a211, v99
    v_accvgpr_read_b32 v216, a4
    v_accvgpr_read_b32 v217, a5
    v_accvgpr_read_b32 v218, a6
    v_accvgpr_read_b32 v219, a7
    v_accvgpr_read_b32 v220, a16
    v_accvgpr_read_b32 v221, a17
    v_accvgpr_read_b32 v222, a18
    v_accvgpr_read_b32 v223, a19
    v_pk_mul_f32 v[216:217], v[216:217], v[194:195]
    v_pk_mul_f32 v[218:219], v[218:219], v[194:195]
    v_pk_mul_f32 v[220:221], v[220:221], v[194:195]
    v_pk_mul_f32 v[222:223], v[222:223], v[194:195]
    v_cvt_pk_bf16_f32 v100, v216, v217
    v_cvt_pk_bf16_f32 v101, v218, v219
    v_cvt_pk_bf16_f32 v102, v220, v221
    v_cvt_pk_bf16_f32 v103, v222, v223
    v_accvgpr_write_b32 a212, v100
    v_accvgpr_write_b32 a213, v101
    v_accvgpr_write_b32 a214, v102
    v_accvgpr_write_b32 a215, v103
    v_accvgpr_read_b32 v200, a8
    v_accvgpr_read_b32 v201, a9
    v_accvgpr_read_b32 v202, a10
    v_accvgpr_read_b32 v203, a11
    v_accvgpr_read_b32 v204, a20
    v_accvgpr_read_b32 v205, a21
    v_accvgpr_read_b32 v206, a22
    v_accvgpr_read_b32 v207, a23
    v_pk_mul_f32 v[200:201], v[200:201], v[196:197]
    v_pk_mul_f32 v[202:203], v[202:203], v[196:197]
    v_pk_mul_f32 v[204:205], v[204:205], v[196:197]
    v_pk_mul_f32 v[206:207], v[206:207], v[196:197]
    v_cvt_pk_bf16_f32 v104, v200, v201
    v_cvt_pk_bf16_f32 v105, v202, v203
    v_cvt_pk_bf16_f32 v106, v204, v205
    v_cvt_pk_bf16_f32 v107, v206, v207
    v_accvgpr_write_b32 a216, v104
    v_accvgpr_write_b32 a217, v105
    v_accvgpr_write_b32 a218, v106
    v_accvgpr_write_b32 a219, v107
    v_accvgpr_read_b32 v208, a24
    v_accvgpr_read_b32 v209, a25
    v_accvgpr_read_b32 v210, a26
    v_accvgpr_read_b32 v211, a27
    v_accvgpr_read_b32 v212, a36
    v_accvgpr_read_b32 v213, a37
    v_accvgpr_read_b32 v214, a38
    v_accvgpr_read_b32 v215, a39
    v_pk_mul_f32 v[208:209], v[208:209], v[192:193]
    v_pk_mul_f32 v[210:211], v[210:211], v[192:193]
    v_pk_mul_f32 v[212:213], v[212:213], v[192:193]
    v_pk_mul_f32 v[214:215], v[214:215], v[192:193]
    v_cvt_pk_bf16_f32 v108, v208, v209
    v_cvt_pk_bf16_f32 v109, v210, v211
    v_cvt_pk_bf16_f32 v110, v212, v213
    v_cvt_pk_bf16_f32 v111, v214, v215
    v_accvgpr_write_b32 a220, v108
    v_accvgpr_write_b32 a221, v109
    v_accvgpr_write_b32 a222, v110
    v_accvgpr_write_b32 a223, v111
    v_accvgpr_read_b32 v216, a28
    v_accvgpr_read_b32 v217, a29
    v_accvgpr_read_b32 v218, a30
    v_accvgpr_read_b32 v219, a31
    v_accvgpr_read_b32 v220, a40
    v_accvgpr_read_b32 v221, a41
    v_accvgpr_read_b32 v222, a42
    v_accvgpr_read_b32 v223, a43
    v_pk_mul_f32 v[216:217], v[216:217], v[194:195]
    v_pk_mul_f32 v[218:219], v[218:219], v[194:195]
    v_pk_mul_f32 v[220:221], v[220:221], v[194:195]
    v_pk_mul_f32 v[222:223], v[222:223], v[194:195]
    v_cvt_pk_bf16_f32 v112, v216, v217
    v_cvt_pk_bf16_f32 v113, v218, v219
    v_cvt_pk_bf16_f32 v114, v220, v221
    v_cvt_pk_bf16_f32 v115, v222, v223
    v_accvgpr_write_b32 a224, v112
    v_accvgpr_write_b32 a225, v113
    v_accvgpr_write_b32 a226, v114
    v_accvgpr_write_b32 a227, v115
    v_accvgpr_read_b32 v200, a32
    v_accvgpr_read_b32 v201, a33
    v_accvgpr_read_b32 v202, a34
    v_accvgpr_read_b32 v203, a35
    v_accvgpr_read_b32 v204, a44
    v_accvgpr_read_b32 v205, a45
    v_accvgpr_read_b32 v206, a46
    v_accvgpr_read_b32 v207, a47
    v_pk_mul_f32 v[200:201], v[200:201], v[196:197]
    v_pk_mul_f32 v[202:203], v[202:203], v[196:197]
    v_pk_mul_f32 v[204:205], v[204:205], v[196:197]
    v_pk_mul_f32 v[206:207], v[206:207], v[196:197]
    v_cvt_pk_bf16_f32 v116, v200, v201
    v_cvt_pk_bf16_f32 v117, v202, v203
    v_cvt_pk_bf16_f32 v118, v204, v205
    v_cvt_pk_bf16_f32 v119, v206, v207
    v_accvgpr_write_b32 a228, v116
    v_accvgpr_write_b32 a229, v117
    v_accvgpr_write_b32 a230, v118
    v_accvgpr_write_b32 a231, v119
    v_accvgpr_read_b32 v208, a48
    v_accvgpr_read_b32 v209, a49
    v_accvgpr_read_b32 v210, a50
    v_accvgpr_read_b32 v211, a51
    v_accvgpr_read_b32 v212, a60
    v_accvgpr_read_b32 v213, a61
    v_accvgpr_read_b32 v214, a62
    v_accvgpr_read_b32 v215, a63
    v_pk_mul_f32 v[208:209], v[208:209], v[192:193]
    v_pk_mul_f32 v[210:211], v[210:211], v[192:193]
    v_pk_mul_f32 v[212:213], v[212:213], v[192:193]
    v_pk_mul_f32 v[214:215], v[214:215], v[192:193]
    v_cvt_pk_bf16_f32 v120, v208, v209
    v_cvt_pk_bf16_f32 v121, v210, v211
    v_cvt_pk_bf16_f32 v122, v212, v213
    v_cvt_pk_bf16_f32 v123, v214, v215
    v_accvgpr_write_b32 a232, v120
    v_accvgpr_write_b32 a233, v121
    v_accvgpr_write_b32 a234, v122
    v_accvgpr_write_b32 a235, v123
    v_accvgpr_read_b32 v216, a52
    v_accvgpr_read_b32 v217, a53
    v_accvgpr_read_b32 v218, a54
    v_accvgpr_read_b32 v219, a55
    v_accvgpr_read_b32 v220, a64
    v_accvgpr_read_b32 v221, a65
    v_accvgpr_read_b32 v222, a66
    v_accvgpr_read_b32 v223, a67
    v_pk_mul_f32 v[216:217], v[216:217], v[194:195]
    v_pk_mul_f32 v[218:219], v[218:219], v[194:195]
    v_pk_mul_f32 v[220:221], v[220:221], v[194:195]
    v_pk_mul_f32 v[222:223], v[222:223], v[194:195]
    v_cvt_pk_bf16_f32 v124, v216, v217
    v_cvt_pk_bf16_f32 v125, v218, v219
    v_cvt_pk_bf16_f32 v126, v220, v221
    v_cvt_pk_bf16_f32 v127, v222, v223
    v_accvgpr_write_b32 a236, v124
    v_accvgpr_write_b32 a237, v125
    v_accvgpr_write_b32 a238, v126
    v_accvgpr_write_b32 a239, v127
    v_accvgpr_read_b32 v200, a56
    v_accvgpr_read_b32 v201, a57
    v_accvgpr_read_b32 v202, a58
    v_accvgpr_read_b32 v203, a59
    v_accvgpr_read_b32 v204, a68
    v_accvgpr_read_b32 v205, a69
    v_accvgpr_read_b32 v206, a70
    v_accvgpr_read_b32 v207, a71
    v_pk_mul_f32 v[200:201], v[200:201], v[196:197]
    v_pk_mul_f32 v[202:203], v[202:203], v[196:197]
    v_pk_mul_f32 v[204:205], v[204:205], v[196:197]
    v_pk_mul_f32 v[206:207], v[206:207], v[196:197]
    v_cvt_pk_bf16_f32 v128, v200, v201
    v_cvt_pk_bf16_f32 v129, v202, v203
    v_cvt_pk_bf16_f32 v130, v204, v205
    v_cvt_pk_bf16_f32 v131, v206, v207
    v_accvgpr_write_b32 a240, v128
    v_accvgpr_write_b32 a241, v129
    v_accvgpr_write_b32 a242, v130
    v_accvgpr_write_b32 a243, v131
    v_accvgpr_read_b32 v208, a72
    v_accvgpr_read_b32 v209, a73
    v_accvgpr_read_b32 v210, a74
    v_accvgpr_read_b32 v211, a75
    v_accvgpr_read_b32 v212, a84
    v_accvgpr_read_b32 v213, a85
    v_accvgpr_read_b32 v214, a86
    v_accvgpr_read_b32 v215, a87
    v_pk_mul_f32 v[208:209], v[208:209], v[192:193]
    v_pk_mul_f32 v[210:211], v[210:211], v[192:193]
    v_pk_mul_f32 v[212:213], v[212:213], v[192:193]
    v_pk_mul_f32 v[214:215], v[214:215], v[192:193]
    v_cvt_pk_bf16_f32 v132, v208, v209
    v_cvt_pk_bf16_f32 v133, v210, v211
    v_cvt_pk_bf16_f32 v134, v212, v213
    v_cvt_pk_bf16_f32 v135, v214, v215
    v_accvgpr_write_b32 a244, v132
    v_accvgpr_write_b32 a245, v133
    v_accvgpr_write_b32 a246, v134
    v_accvgpr_write_b32 a247, v135
    v_accvgpr_read_b32 v216, a76
    v_accvgpr_read_b32 v217, a77
    v_accvgpr_read_b32 v218, a78
    v_accvgpr_read_b32 v219, a79
    v_accvgpr_read_b32 v220, a88
    v_accvgpr_read_b32 v221, a89
    v_accvgpr_read_b32 v222, a90
    v_accvgpr_read_b32 v223, a91
    v_pk_mul_f32 v[216:217], v[216:217], v[194:195]
    v_pk_mul_f32 v[218:219], v[218:219], v[194:195]
    v_pk_mul_f32 v[220:221], v[220:221], v[194:195]
    v_pk_mul_f32 v[222:223], v[222:223], v[194:195]
    v_cvt_pk_bf16_f32 v136, v216, v217
    v_cvt_pk_bf16_f32 v137, v218, v219
    v_cvt_pk_bf16_f32 v138, v220, v221
    v_cvt_pk_bf16_f32 v139, v222, v223
    v_accvgpr_write_b32 a248, v136
    v_accvgpr_write_b32 a249, v137
    v_accvgpr_write_b32 a250, v138
    v_accvgpr_write_b32 a251, v139
    s_nop 1
    s_mov_b32 s6, 1
    s_mov_b32 s7, 1
    s_branch L_unit
L_oc1:
    s_nop 7
    v_accvgpr_read_b32 v192, a192
    v_accvgpr_read_b32 v194, a196
    v_accvgpr_read_b32 v196, a200
    v_rcp_f32 v192, v192
    v_rcp_f32 v194, v194
    v_rcp_f32 v196, v196
    s_nop 0
    v_mov_b32 v193, v192
    v_mov_b32 v195, v194
    v_mov_b32 v197, v196
    .p2align 3
    v_accvgpr_read_b32 v200, a0
    v_accvgpr_read_b32 v201, a1
    v_accvgpr_read_b32 v202, a2
    v_accvgpr_read_b32 v203, a3
    v_accvgpr_read_b32 v204, a12
    v_accvgpr_read_b32 v205, a13
    v_accvgpr_read_b32 v206, a14
    v_accvgpr_read_b32 v207, a15
    v_pk_mul_f32 v[200:201], v[200:201], v[192:193]
    v_pk_mul_f32 v[202:203], v[202:203], v[192:193]
    v_pk_mul_f32 v[204:205], v[204:205], v[192:193]
    v_pk_mul_f32 v[206:207], v[206:207], v[192:193]
    v_cvt_pk_bf16_f32 v96, v200, v201
    v_cvt_pk_bf16_f32 v97, v202, v203
    v_cvt_pk_bf16_f32 v98, v204, v205
    v_cvt_pk_bf16_f32 v99, v206, v207
    v_accvgpr_read_b32 v208, a4
    v_accvgpr_read_b32 v209, a5
    v_accvgpr_read_b32 v210, a6
    v_accvgpr_read_b32 v211, a7
    v_accvgpr_read_b32 v212, a16
    v_accvgpr_read_b32 v213, a17
    v_accvgpr_read_b32 v214, a18
    v_accvgpr_read_b32 v215, a19
    v_pk_mul_f32 v[208:209], v[208:209], v[194:195]
    v_pk_mul_f32 v[210:211], v[210:211], v[194:195]
    v_pk_mul_f32 v[212:213], v[212:213], v[194:195]
    v_pk_mul_f32 v[214:215], v[214:215], v[194:195]
    v_cvt_pk_bf16_f32 v100, v208, v209
    v_cvt_pk_bf16_f32 v101, v210, v211
    v_cvt_pk_bf16_f32 v102, v212, v213
    v_cvt_pk_bf16_f32 v103, v214, v215
    v_accvgpr_read_b32 v216, a8
    v_accvgpr_read_b32 v217, a9
    v_accvgpr_read_b32 v218, a10
    v_accvgpr_read_b32 v219, a11
    v_accvgpr_read_b32 v220, a20
    v_accvgpr_read_b32 v221, a21
    v_accvgpr_read_b32 v222, a22
    v_accvgpr_read_b32 v223, a23
    v_pk_mul_f32 v[216:217], v[216:217], v[196:197]
    v_pk_mul_f32 v[218:219], v[218:219], v[196:197]
    v_pk_mul_f32 v[220:221], v[220:221], v[196:197]
    v_pk_mul_f32 v[222:223], v[222:223], v[196:197]
    v_cvt_pk_bf16_f32 v104, v216, v217
    v_cvt_pk_bf16_f32 v105, v218, v219
    v_cvt_pk_bf16_f32 v106, v220, v221
    v_cvt_pk_bf16_f32 v107, v222, v223
    v_accvgpr_read_b32 v200, a24
    v_accvgpr_read_b32 v201, a25
    v_accvgpr_read_b32 v202, a26
    v_accvgpr_read_b32 v203, a27
    v_accvgpr_read_b32 v204, a36
    v_accvgpr_read_b32 v205, a37
    v_accvgpr_read_b32 v206, a38
    v_accvgpr_read_b32 v207, a39
    v_pk_mul_f32 v[200:201], v[200:201], v[192:193]
    v_pk_mul_f32 v[202:203], v[202:203], v[192:193]
    v_pk_mul_f32 v[204:205], v[204:205], v[192:193]
    v_pk_mul_f32 v[206:207], v[206:207], v[192:193]
    v_cvt_pk_bf16_f32 v108, v200, v201
    v_cvt_pk_bf16_f32 v109, v202, v203
    v_cvt_pk_bf16_f32 v110, v204, v205
    v_cvt_pk_bf16_f32 v111, v206, v207
    v_accvgpr_read_b32 v208, a28
    v_accvgpr_read_b32 v209, a29
    v_accvgpr_read_b32 v210, a30
    v_accvgpr_read_b32 v211, a31
    v_accvgpr_read_b32 v212, a40
    v_accvgpr_read_b32 v213, a41
    v_accvgpr_read_b32 v214, a42
    v_accvgpr_read_b32 v215, a43
    v_pk_mul_f32 v[208:209], v[208:209], v[194:195]
    v_pk_mul_f32 v[210:211], v[210:211], v[194:195]
    v_pk_mul_f32 v[212:213], v[212:213], v[194:195]
    v_pk_mul_f32 v[214:215], v[214:215], v[194:195]
    v_cvt_pk_bf16_f32 v112, v208, v209
    v_cvt_pk_bf16_f32 v113, v210, v211
    v_cvt_pk_bf16_f32 v114, v212, v213
    v_cvt_pk_bf16_f32 v115, v214, v215
    v_accvgpr_read_b32 v216, a32
    v_accvgpr_read_b32 v217, a33
    v_accvgpr_read_b32 v218, a34
    v_accvgpr_read_b32 v219, a35
    v_accvgpr_read_b32 v220, a44
    v_accvgpr_read_b32 v221, a45
    v_accvgpr_read_b32 v222, a46
    v_accvgpr_read_b32 v223, a47
    v_pk_mul_f32 v[216:217], v[216:217], v[196:197]
    v_pk_mul_f32 v[218:219], v[218:219], v[196:197]
    v_pk_mul_f32 v[220:221], v[220:221], v[196:197]
    v_pk_mul_f32 v[222:223], v[222:223], v[196:197]
    v_cvt_pk_bf16_f32 v116, v216, v217
    v_cvt_pk_bf16_f32 v117, v218, v219
    v_cvt_pk_bf16_f32 v118, v220, v221
    v_cvt_pk_bf16_f32 v119, v222, v223
    v_accvgpr_read_b32 v200, a48
    v_accvgpr_read_b32 v201, a49
    v_accvgpr_read_b32 v202, a50
    v_accvgpr_read_b32 v203, a51
    v_accvgpr_read_b32 v204, a60
    v_accvgpr_read_b32 v205, a61
    v_accvgpr_read_b32 v206, a62
    v_accvgpr_read_b32 v207, a63
    v_pk_mul_f32 v[200:201], v[200:201], v[192:193]
    v_pk_mul_f32 v[202:203], v[202:203], v[192:193]
    v_pk_mul_f32 v[204:205], v[204:205], v[192:193]
    v_pk_mul_f32 v[206:207], v[206:207], v[192:193]
    v_cvt_pk_bf16_f32 v120, v200, v201
    v_cvt_pk_bf16_f32 v121, v202, v203
    v_cvt_pk_bf16_f32 v122, v204, v205
    v_cvt_pk_bf16_f32 v123, v206, v207
    v_accvgpr_read_b32 v208, a52
    v_accvgpr_read_b32 v209, a53
    v_accvgpr_read_b32 v210, a54
    v_accvgpr_read_b32 v211, a55
    v_accvgpr_read_b32 v212, a64
    v_accvgpr_read_b32 v213, a65
    v_accvgpr_read_b32 v214, a66
    v_accvgpr_read_b32 v215, a67
    v_pk_mul_f32 v[208:209], v[208:209], v[194:195]
    v_pk_mul_f32 v[210:211], v[210:211], v[194:195]
    v_pk_mul_f32 v[212:213], v[212:213], v[194:195]
    v_pk_mul_f32 v[214:215], v[214:215], v[194:195]
    v_cvt_pk_bf16_f32 v124, v208, v209
    v_cvt_pk_bf16_f32 v125, v210, v211
    v_cvt_pk_bf16_f32 v126, v212, v213
    v_cvt_pk_bf16_f32 v127, v214, v215
    v_accvgpr_read_b32 v216, a56
    v_accvgpr_read_b32 v217, a57
    v_accvgpr_read_b32 v218, a58
    v_accvgpr_read_b32 v219, a59
    v_accvgpr_read_b32 v220, a68
    v_accvgpr_read_b32 v221, a69
    v_accvgpr_read_b32 v222, a70
    v_accvgpr_read_b32 v223, a71
    v_pk_mul_f32 v[216:217], v[216:217], v[196:197]
    v_pk_mul_f32 v[218:219], v[218:219], v[196:197]
    v_pk_mul_f32 v[220:221], v[220:221], v[196:197]
    v_pk_mul_f32 v[222:223], v[222:223], v[196:197]
    v_cvt_pk_bf16_f32 v128, v216, v217
    v_cvt_pk_bf16_f32 v129, v218, v219
    v_cvt_pk_bf16_f32 v130, v220, v221
    v_cvt_pk_bf16_f32 v131, v222, v223
    v_accvgpr_read_b32 v200, a72
    v_accvgpr_read_b32 v201, a73
    v_accvgpr_read_b32 v202, a74
    v_accvgpr_read_b32 v203, a75
    v_accvgpr_read_b32 v204, a84
    v_accvgpr_read_b32 v205, a85
    v_accvgpr_read_b32 v206, a86
    v_accvgpr_read_b32 v207, a87
    v_pk_mul_f32 v[200:201], v[200:201], v[192:193]
    v_pk_mul_f32 v[202:203], v[202:203], v[192:193]
    v_pk_mul_f32 v[204:205], v[204:205], v[192:193]
    v_pk_mul_f32 v[206:207], v[206:207], v[192:193]
    v_cvt_pk_bf16_f32 v132, v200, v201
    v_cvt_pk_bf16_f32 v133, v202, v203
    v_cvt_pk_bf16_f32 v134, v204, v205
    v_cvt_pk_bf16_f32 v135, v206, v207
    v_accvgpr_read_b32 v208, a76
    v_accvgpr_read_b32 v209, a77
    v_accvgpr_read_b32 v210, a78
    v_accvgpr_read_b32 v211, a79
    v_accvgpr_read_b32 v212, a88
    v_accvgpr_read_b32 v213, a89
    v_accvgpr_read_b32 v214, a90
    v_accvgpr_read_b32 v215, a91
    v_pk_mul_f32 v[208:209], v[208:209], v[194:195]
    v_pk_mul_f32 v[210:211], v[210:211], v[194:195]
    v_pk_mul_f32 v[212:213], v[212:213], v[194:195]
    v_pk_mul_f32 v[214:215], v[214:215], v[194:195]
    v_cvt_pk_bf16_f32 v136, v208, v209
    v_cvt_pk_bf16_f32 v137, v210, v211
    v_cvt_pk_bf16_f32 v138, v212, v213
    v_cvt_pk_bf16_f32 v139, v214, v215
    v_accvgpr_read_b32 v216, a80
    v_accvgpr_read_b32 v217, a81
    v_accvgpr_read_b32 v218, a82
    v_accvgpr_read_b32 v219, a83
    v_accvgpr_read_b32 v220, a92
    v_accvgpr_read_b32 v221, a93
    v_accvgpr_read_b32 v222, a94
    v_accvgpr_read_b32 v223, a95
    v_pk_mul_f32 v[216:217], v[216:217], v[196:197]
    v_pk_mul_f32 v[218:219], v[218:219], v[196:197]
    v_pk_mul_f32 v[220:221], v[220:221], v[196:197]
    v_pk_mul_f32 v[222:223], v[222:223], v[196:197]
    v_cvt_pk_bf16_f32 v140, v216, v217
    v_cvt_pk_bf16_f32 v141, v218, v219
    v_cvt_pk_bf16_f32 v142, v220, v221
    v_cvt_pk_bf16_f32 v143, v222, v223
    v_accvgpr_read_b32 v200, a96
    v_accvgpr_read_b32 v201, a97
    v_accvgpr_read_b32 v202, a98
    v_accvgpr_read_b32 v203, a99
    v_accvgpr_read_b32 v204, a108
    v_accvgpr_read_b32 v205, a109
    v_accvgpr_read_b32 v206, a110
    v_accvgpr_read_b32 v207, a111
    v_pk_mul_f32 v[200:201], v[200:201], v[192:193]
    v_pk_mul_f32 v[202:203], v[202:203], v[192:193]
    v_pk_mul_f32 v[204:205], v[204:205], v[192:193]
    v_pk_mul_f32 v[206:207], v[206:207], v[192:193]
    v_cvt_pk_bf16_f32 v144, v200, v201
    v_cvt_pk_bf16_f32 v145, v202, v203
    v_cvt_pk_bf16_f32 v146, v204, v205
    v_cvt_pk_bf16_f32 v147, v206, v207
    v_accvgpr_read_b32 v208, a100
    v_accvgpr_read_b32 v209, a101
    v_accvgpr_read_b32 v210, a102
    v_accvgpr_read_b32 v211, a103
    v_accvgpr_read_b32 v212, a112
    v_accvgpr_read_b32 v213, a113
    v_accvgpr_read_b32 v214, a114
    v_accvgpr_read_b32 v215, a115
    v_pk_mul_f32 v[208:209], v[208:209], v[194:195]
    v_pk_mul_f32 v[210:211], v[210:211], v[194:195]
    v_pk_mul_f32 v[212:213], v[212:213], v[194:195]
    v_pk_mul_f32 v[214:215], v[214:215], v[194:195]
    v_cvt_pk_bf16_f32 v148, v208, v209
    v_cvt_pk_bf16_f32 v149, v210, v211
    v_cvt_pk_bf16_f32 v150, v212, v213
    v_cvt_pk_bf16_f32 v151, v214, v215
    v_accvgpr_read_b32 v216, a104
    v_accvgpr_read_b32 v217, a105
    v_accvgpr_read_b32 v218, a106
    v_accvgpr_read_b32 v219, a107
    v_accvgpr_read_b32 v220, a116
    v_accvgpr_read_b32 v221, a117
    v_accvgpr_read_b32 v222, a118
    v_accvgpr_read_b32 v223, a119
    v_pk_mul_f32 v[216:217], v[216:217], v[196:197]
    v_pk_mul_f32 v[218:219], v[218:219], v[196:197]
    v_pk_mul_f32 v[220:221], v[220:221], v[196:197]
    v_pk_mul_f32 v[222:223], v[222:223], v[196:197]
    v_cvt_pk_bf16_f32 v152, v216, v217
    v_cvt_pk_bf16_f32 v153, v218, v219
    v_cvt_pk_bf16_f32 v154, v220, v221
    v_cvt_pk_bf16_f32 v155, v222, v223
    v_accvgpr_read_b32 v200, a120
    v_accvgpr_read_b32 v201, a121
    v_accvgpr_read_b32 v202, a122
    v_accvgpr_read_b32 v203, a123
    v_accvgpr_read_b32 v204, a132
    v_accvgpr_read_b32 v205, a133
    v_accvgpr_read_b32 v206, a134
    v_accvgpr_read_b32 v207, a135
    v_pk_mul_f32 v[200:201], v[200:201], v[192:193]
    v_pk_mul_f32 v[202:203], v[202:203], v[192:193]
    v_pk_mul_f32 v[204:205], v[204:205], v[192:193]
    v_pk_mul_f32 v[206:207], v[206:207], v[192:193]
    v_cvt_pk_bf16_f32 v156, v200, v201
    v_cvt_pk_bf16_f32 v157, v202, v203
    v_cvt_pk_bf16_f32 v158, v204, v205
    v_cvt_pk_bf16_f32 v159, v206, v207
    v_accvgpr_read_b32 v208, a124
    v_accvgpr_read_b32 v209, a125
    v_accvgpr_read_b32 v210, a126
    v_accvgpr_read_b32 v211, a127
    v_accvgpr_read_b32 v212, a136
    v_accvgpr_read_b32 v213, a137
    v_accvgpr_read_b32 v214, a138
    v_accvgpr_read_b32 v215, a139
    v_pk_mul_f32 v[208:209], v[208:209], v[194:195]
    v_pk_mul_f32 v[210:211], v[210:211], v[194:195]
    v_pk_mul_f32 v[212:213], v[212:213], v[194:195]
    v_pk_mul_f32 v[214:215], v[214:215], v[194:195]
    v_cvt_pk_bf16_f32 v160, v208, v209
    v_cvt_pk_bf16_f32 v161, v210, v211
    v_cvt_pk_bf16_f32 v162, v212, v213
    v_cvt_pk_bf16_f32 v163, v214, v215
    v_accvgpr_read_b32 v216, a128
    v_accvgpr_read_b32 v217, a129
    v_accvgpr_read_b32 v218, a130
    v_accvgpr_read_b32 v219, a131
    v_accvgpr_read_b32 v220, a140
    v_accvgpr_read_b32 v221, a141
    v_accvgpr_read_b32 v222, a142
    v_accvgpr_read_b32 v223, a143
    v_pk_mul_f32 v[216:217], v[216:217], v[196:197]
    v_pk_mul_f32 v[218:219], v[218:219], v[196:197]
    v_pk_mul_f32 v[220:221], v[220:221], v[196:197]
    v_pk_mul_f32 v[222:223], v[222:223], v[196:197]
    v_cvt_pk_bf16_f32 v164, v216, v217
    v_cvt_pk_bf16_f32 v165, v218, v219
    v_cvt_pk_bf16_f32 v166, v220, v221
    v_cvt_pk_bf16_f32 v167, v222, v223
    v_accvgpr_read_b32 v200, a144
    v_accvgpr_read_b32 v201, a145
    v_accvgpr_read_b32 v202, a146
    v_accvgpr_read_b32 v203, a147
    v_accvgpr_read_b32 v204, a156
    v_accvgpr_read_b32 v205, a157
    v_accvgpr_read_b32 v206, a158
    v_accvgpr_read_b32 v207, a159
    v_pk_mul_f32 v[200:201], v[200:201], v[192:193]
    v_pk_mul_f32 v[202:203], v[202:203], v[192:193]
    v_pk_mul_f32 v[204:205], v[204:205], v[192:193]
    v_pk_mul_f32 v[206:207], v[206:207], v[192:193]
    v_cvt_pk_bf16_f32 v168, v200, v201
    v_cvt_pk_bf16_f32 v169, v202, v203
    v_cvt_pk_bf16_f32 v170, v204, v205
    v_cvt_pk_bf16_f32 v171, v206, v207
    v_accvgpr_read_b32 v208, a148
    v_accvgpr_read_b32 v209, a149
    v_accvgpr_read_b32 v210, a150
    v_accvgpr_read_b32 v211, a151
    v_accvgpr_read_b32 v212, a160
    v_accvgpr_read_b32 v213, a161
    v_accvgpr_read_b32 v214, a162
    v_accvgpr_read_b32 v215, a163
    v_pk_mul_f32 v[208:209], v[208:209], v[194:195]
    v_pk_mul_f32 v[210:211], v[210:211], v[194:195]
    v_pk_mul_f32 v[212:213], v[212:213], v[194:195]
    v_pk_mul_f32 v[214:215], v[214:215], v[194:195]
    v_cvt_pk_bf16_f32 v172, v208, v209
    v_cvt_pk_bf16_f32 v173, v210, v211
    v_cvt_pk_bf16_f32 v174, v212, v213
    v_cvt_pk_bf16_f32 v175, v214, v215
    v_accvgpr_read_b32 v216, a152
    v_accvgpr_read_b32 v217, a153
    v_accvgpr_read_b32 v218, a154
    v_accvgpr_read_b32 v219, a155
    v_accvgpr_read_b32 v220, a164
    v_accvgpr_read_b32 v221, a165
    v_accvgpr_read_b32 v222, a166
    v_accvgpr_read_b32 v223, a167
    v_pk_mul_f32 v[216:217], v[216:217], v[196:197]
    v_pk_mul_f32 v[218:219], v[218:219], v[196:197]
    v_pk_mul_f32 v[220:221], v[220:221], v[196:197]
    v_pk_mul_f32 v[222:223], v[222:223], v[196:197]
    v_cvt_pk_bf16_f32 v176, v216, v217
    v_cvt_pk_bf16_f32 v177, v218, v219
    v_cvt_pk_bf16_f32 v178, v220, v221
    v_cvt_pk_bf16_f32 v179, v222, v223
    v_accvgpr_read_b32 v200, a168
    v_accvgpr_read_b32 v201, a169
    v_accvgpr_read_b32 v202, a170
    v_accvgpr_read_b32 v203, a171
    v_accvgpr_read_b32 v204, a180
    v_accvgpr_read_b32 v205, a181
    v_accvgpr_read_b32 v206, a182
    v_accvgpr_read_b32 v207, a183
    v_pk_mul_f32 v[200:201], v[200:201], v[192:193]
    v_pk_mul_f32 v[202:203], v[202:203], v[192:193]
    v_pk_mul_f32 v[204:205], v[204:205], v[192:193]
    v_pk_mul_f32 v[206:207], v[206:207], v[192:193]
    v_cvt_pk_bf16_f32 v180, v200, v201
    v_cvt_pk_bf16_f32 v181, v202, v203
    v_cvt_pk_bf16_f32 v182, v204, v205
    v_cvt_pk_bf16_f32 v183, v206, v207
    v_accvgpr_read_b32 v208, a172
    v_accvgpr_read_b32 v209, a173
    v_accvgpr_read_b32 v210, a174
    v_accvgpr_read_b32 v211, a175
    v_accvgpr_read_b32 v212, a184
    v_accvgpr_read_b32 v213, a185
    v_accvgpr_read_b32 v214, a186
    v_accvgpr_read_b32 v215, a187
    v_pk_mul_f32 v[208:209], v[208:209], v[194:195]
    v_pk_mul_f32 v[210:211], v[210:211], v[194:195]
    v_pk_mul_f32 v[212:213], v[212:213], v[194:195]
    v_pk_mul_f32 v[214:215], v[214:215], v[194:195]
    v_cvt_pk_bf16_f32 v184, v208, v209
    v_cvt_pk_bf16_f32 v185, v210, v211
    v_cvt_pk_bf16_f32 v186, v212, v213
    v_cvt_pk_bf16_f32 v187, v214, v215
    v_accvgpr_read_b32 v216, a176
    v_accvgpr_read_b32 v217, a177
    v_accvgpr_read_b32 v218, a178
    v_accvgpr_read_b32 v219, a179
    v_accvgpr_read_b32 v220, a188
    v_accvgpr_read_b32 v221, a189
    v_accvgpr_read_b32 v222, a190
    v_accvgpr_read_b32 v223, a191
    v_pk_mul_f32 v[216:217], v[216:217], v[196:197]
    v_pk_mul_f32 v[218:219], v[218:219], v[196:197]
    v_pk_mul_f32 v[220:221], v[220:221], v[196:197]
    v_pk_mul_f32 v[222:223], v[222:223], v[196:197]
    v_cvt_pk_bf16_f32 v188, v216, v217
    v_cvt_pk_bf16_f32 v189, v218, v219
    v_cvt_pk_bf16_f32 v190, v220, v221
    v_cvt_pk_bf16_f32 v191, v222, v223
    s_nop 1
L_p4:
    v_lshrrev_b32 v252, 2, v248
    v_lshrrev_b32 v253, 1, v252
    v_and_b32 v253, 3, v253
    v_lshlrev_b32 v253, 1, v253
    v_bfe_u32 v254, v248, 1, 1
    v_xor_b32 v253, v253, v254
    v_lshlrev_b32 v253, 4, v253
    v_lshlrev_b32 v252, 7, v252
    v_add_u32 v252, v252, v253
    v_and_b32 v253, 1, v248
    v_lshlrev_b32 v253, 3, v253
    v_add_u32 v252, v252, v253
    v_xor_b32 v232, 0, v252
    v_add_u32 v232, s34, v232
    v_xor_b32 v233, 32, v252
    v_add_u32 v233, s34, v233
    v_xor_b32 v234, 64, v252
    v_add_u32 v234, s34, v234
    v_xor_b32 v235, 96, v252
    v_add_u32 v235, s34, v235
    s_mov_b32 s36, s34
    s_load_dwordx2 s[12:13], s[0:1], 80
    s_mov_b32 s14, 5505024
    s_mov_b32 s15, 0x00020000
    v_and_b32 v252, 15, v248
    v_lshrrev_b32 v253, 2, v252
    v_lshrrev_b32 v254, 4, v248
    v_cmp_eq_u32 vcc, v253, v254
    v_and_b32 v253, 1, v252
    v_lshlrev_b32 v253, 4, v253
    v_mov_b32 v254, 0x3f80
    v_lshlrev_b32 v254, v253, v254
    v_cndmask_b32 v254, 0, v254, vcc
    v_and_b32 v253, 2, v252
    v_cmp_eq_u32 vcc, 0, v253
    s_nop 1
    v_cndmask_b32 v252, 0, v254, vcc
    v_mov_b32 v255, 0
    v_cndmask_b32 v253, v254, v255, vcc
    v_accvgpr_write_b32 a96, v252
    v_accvgpr_write_b32 a97, v253
    v_accvgpr_write_b32 a98, v255
    v_accvgpr_write_b32 a99, v255
    v_accvgpr_write_b32 a100, v255
    v_accvgpr_write_b32 a101, v255
    v_accvgpr_write_b32 a102, v252
    v_accvgpr_write_b32 a103, v253
    s_cmp_eq_u32 s52, 0
    s_cselect_b32 s71, 0, 0x7f000000
    v_mov_b32 v246, 0x7f000000
    v_mov_b32 v249, s71
    v_cmp_eq_u32 vcc, 0, v248
    s_nop 1
    v_cndmask_b32 v246, v246, v249, vcc
    v_and_b32 v252, 15, v248
    v_mul_u32_u24 v252, 1792, v252
    v_lshrrev_b32 v253, 4, v248
    v_lshlrev_b32 v253, 3, v253
    v_add_u32 v247, v252, v253
    s_mov_b32 s68, s93
    s_lshr_b32 s71, s49, 2
    s_bfe_u32 s70, s49, 0x10001
    s_mul_i32 s66, s74, 1376256
    s_mul_i32 s69, s71, 43008
    s_add_u32 s66, s66, s69
    s_mul_i32 s69, s70, 3072
    s_add_u32 s66, s66, s69
    s_and_b32 s67, s74, 15
    s_mul_i32 s67, s67, 192
    s_mul_i32 s69, s71, 48
    s_add_u32 s67, s67, s69
    s_mul_i32 s67, s67, 1792
    s_lshr_b32 s69, s74, 4
    s_mul_i32 s69, s69, 896
    s_add_u32 s67, s67, s69
    s_lshl_b32 s69, s70, 6
    s_add_u32 s67, s67, s69
    s_mov_b32 s60, 1
    s_mov_b32 s73, 0x7f000000
    s_cmp_eq_u32 s52, 0
    s_cselect_b32 s65, 1, 0
    s_mov_b32 s64, 0
    buffer_load_dword v245, v249, s[76:79], s68 offen sc1
    s_waitcnt lgkmcnt(0)
    s_waitcnt vmcnt(2)
    s_barrier
    ds_read_b64_tr_b16 v[192:193], v232 offset:0
    ds_read_b64_tr_b16 v[194:195], v232 offset:2048
    ds_read_b64_tr_b16 v[196:197], v233 offset:0
    ds_read_b64_tr_b16 v[198:199], v233 offset:2048
    ds_read_b64_tr_b16 v[200:201], v234 offset:0
    ds_read_b64_tr_b16 v[202:203], v234 offset:2048
    ds_read_b64_tr_b16 v[204:205], v235 offset:0
    ds_read_b64_tr_b16 v[206:207], v235 offset:2048
    s_waitcnt lgkmcnt(6)
    v_mfma_f32_16x16x32_bf16 a[0:3], v[192:195], a[208:211], 0
    s_add_u32 s34, s34, 16384
    s_cmp_eq_u32 s34, 163840
    s_cselect_b32 s34, 0, s34
    ds_read_b64_tr_b16 v[208:209], v232 offset:4096
    v_mfma_f32_16x16x32_bf16 a[4:7], v[192:195], a[212:215], 0
    s_sub_u32 s50, s34, s36
    ds_read_b64_tr_b16 v[210:211], v232 offset:6144
    v_mfma_f32_16x16x32_bf16 a[8:11], v[192:195], a[216:219], 0
    s_waitcnt lgkmcnt(6)
    v_mfma_f32_16x16x32_bf16 a[12:15], v[196:199], a[208:211], 0
    s_mov_b32 s36, s34
    ds_read_b64_tr_b16 v[212:213], v233 offset:4096
    v_mfma_f32_16x16x32_bf16 a[16:19], v[196:199], a[212:215], 0
    s_add_u32 m0, s33, s32
    ds_read_b64_tr_b16 v[214:215], v233 offset:6144
    v_mfma_f32_16x16x32_bf16 a[20:23], v[196:199], a[216:219], 0
    s_waitcnt lgkmcnt(6)
    buffer_load_dwordx4 v240, s[16:19], s39 offen offset:0 lds
    v_mfma_f32_16x16x32_bf16 a[24:27], v[200:203], a[208:211], 0
    ds_read_b64_tr_b16 v[216:217], v234 offset:4096
    v_mfma_f32_16x16x32_bf16 a[28:31], v[200:203], a[212:215], 0
    ds_read_b64_tr_b16 v[218:219], v234 offset:6144
    v_mfma_f32_16x16x32_bf16 a[32:35], v[200:203], a[216:219], 0
    s_waitcnt lgkmcnt(6)
    v_mfma_f32_16x16x32_bf16 a[36:39], v[204:207], a[208:211], 0
    ds_read_b64_tr_b16 v[220:221], v235 offset:4096
    v_mfma_f32_16x16x32_bf16 a[40:43], v[204:207], a[212:215], 0
    ds_read_b64_tr_b16 v[222:223], v235 offset:6144
    v_mfma_f32_16x16x32_bf16 a[44:47], v[204:207], a[216:219], 0
    s_waitcnt lgkmcnt(6)
    v_mfma_f32_16x16x32_bf16 a[0:3], v[208:211], a[220:223], a[0:3]
    ds_read_b64_tr_b16 v[192:193], v232 offset:8192
    v_mfma_f32_16x16x32_bf16 a[4:7], v[208:211], a[224:227], a[4:7]
    ds_read_b64_tr_b16 v[194:195], v232 offset:10240
    v_mfma_f32_16x16x32_bf16 a[8:11], v[208:211], a[228:231], a[8:11]
    s_waitcnt lgkmcnt(6)
    buffer_load_dwordx4 v241, s[16:19], s39 offen offset:1024 lds
    v_mfma_f32_16x16x32_bf16 a[12:15], v[212:215], a[220:223], a[12:15]
    ds_read_b64_tr_b16 v[196:197], v233 offset:8192
    v_mfma_f32_16x16x32_bf16 a[16:19], v[212:215], a[224:227], a[16:19]
    ds_read_b64_tr_b16 v[198:199], v233 offset:10240
    v_mfma_f32_16x16x32_bf16 a[20:23], v[212:215], a[228:231], a[20:23]
    s_waitcnt lgkmcnt(6)
    v_mfma_f32_16x16x32_bf16 a[24:27], v[216:219], a[220:223], a[24:27]
    ds_read_b64_tr_b16 v[200:201], v234 offset:8192
    v_mfma_f32_16x16x32_bf16 a[28:31], v[216:219], a[224:227], a[28:31]
    ds_read_b64_tr_b16 v[202:203], v234 offset:10240
    v_mfma_f32_16x16x32_bf16 a[32:35], v[216:219], a[228:231], a[32:35]
    s_waitcnt lgkmcnt(6)
    v_mfma_f32_16x16x32_bf16 a[36:39], v[220:223], a[220:223], a[36:39]
    ds_read_b64_tr_b16 v[204:205], v235 offset:8192
    v_mfma_f32_16x16x32_bf16 a[40:43], v[220:223], a[224:227], a[40:43]
    ds_read_b64_tr_b16 v[206:207], v235 offset:10240
    v_mfma_f32_16x16x32_bf16 a[44:47], v[220:223], a[228:231], a[44:47]
    s_waitcnt lgkmcnt(6)
    v_mfma_f32_16x16x32_bf16 a[0:3], v[192:195], a[232:235], a[0:3]
    ds_read_b64_tr_b16 v[208:209], v232 offset:12288
    v_mfma_f32_16x16x32_bf16 a[4:7], v[192:195], a[236:239], a[4:7]
    ds_read_b64_tr_b16 v[210:211], v232 offset:14336
    v_add_u32 v232, s50, v232
    v_mfma_f32_16x16x32_bf16 a[8:11], v[192:195], a[240:243], a[8:11]
    s_waitcnt lgkmcnt(6)
    buffer_load_dwordx4 v242, s[16:19], s39 offen offset:2048 lds
    v_mfma_f32_16x16x32_bf16 a[12:15], v[196:199], a[232:235], a[12:15]
    ds_read_b64_tr_b16 v[212:213], v233 offset:12288
    v_mfma_f32_16x16x32_bf16 a[16:19], v[196:199], a[236:239], a[16:19]
    ds_read_b64_tr_b16 v[214:215], v233 offset:14336
    v_add_u32 v233, s50, v233
    v_mfma_f32_16x16x32_bf16 a[20:23], v[196:199], a[240:243], a[20:23]
    s_waitcnt lgkmcnt(6)
    v_mfma_f32_16x16x32_bf16 a[24:27], v[200:203], a[232:235], a[24:27]
    ds_read_b64_tr_b16 v[216:217], v234 offset:12288
    v_mfma_f32_16x16x32_bf16 a[28:31], v[200:203], a[236:239], a[28:31]
    ds_read_b64_tr_b16 v[218:219], v234 offset:14336
    v_add_u32 v234, s50, v234
    v_mfma_f32_16x16x32_bf16 a[32:35], v[200:203], a[240:243], a[32:35]
    s_waitcnt lgkmcnt(6)
    v_mfma_f32_16x16x32_bf16 a[36:39], v[204:207], a[232:235], a[36:39]
    ds_read_b64_tr_b16 v[220:221], v235 offset:12288
    v_mfma_f32_16x16x32_bf16 a[40:43], v[204:207], a[236:239], a[40:43]
    ds_read_b64_tr_b16 v[222:223], v235 offset:14336
    v_add_u32 v235, s50, v235
    v_mfma_f32_16x16x32_bf16 a[44:47], v[204:207], a[240:243], a[44:47]
    s_waitcnt lgkmcnt(6)
    s_waitcnt vmcnt(42)
    s_barrier
    buffer_load_dwordx4 v243, s[16:19], s39 offen offset:3072 lds
    v_mfma_f32_16x16x32_bf16 a[0:3], v[208:211], a[244:247], a[0:3]
    s_add_u32 s33, s33, 16384
    s_cmp_eq_u32 s33, 163840
    s_cselect_b32 s33, 0, s33
    ds_read_b64_tr_b16 v[192:193], v232 offset:0
    v_mfma_f32_16x16x32_bf16 a[4:7], v[208:211], a[248:251], a[4:7]
    s_add_u32 s39, s39, s42
    ds_read_b64_tr_b16 v[194:195], v232 offset:2048
    v_mfma_f32_16x16x32_bf16 a[8:11], v[208:211], v[44:47], a[8:11]
    s_waitcnt lgkmcnt(6)
    v_mfma_f32_16x16x32_bf16 a[12:15], v[212:215], a[244:247], a[12:15]
    ds_read_b64_tr_b16 v[196:197], v233 offset:0
    v_mfma_f32_16x16x32_bf16 a[16:19], v[212:215], a[248:251], a[16:19]
    ds_read_b64_tr_b16 v[198:199], v233 offset:2048
    v_mfma_f32_16x16x32_bf16 a[20:23], v[212:215], v[44:47], a[20:23]
    s_waitcnt lgkmcnt(6)
    v_mfma_f32_16x16x32_bf16 a[24:27], v[216:219], a[244:247], a[24:27]
    ds_read_b64_tr_b16 v[200:201], v234 offset:0
    v_mfma_f32_16x16x32_bf16 a[28:31], v[216:219], a[248:251], a[28:31]
    ds_read_b64_tr_b16 v[202:203], v234 offset:2048
    v_mfma_f32_16x16x32_bf16 a[32:35], v[216:219], v[44:47], a[32:35]
    s_waitcnt lgkmcnt(6)
    v_mfma_f32_16x16x32_bf16 a[36:39], v[220:223], a[244:247], a[36:39]
    ds_read_b64_tr_b16 v[204:205], v235 offset:0
    v_mfma_f32_16x16x32_bf16 a[40:43], v[220:223], a[248:251], a[40:43]
    ds_read_b64_tr_b16 v[206:207], v235 offset:2048
    v_mfma_f32_16x16x32_bf16 a[44:47], v[220:223], v[44:47], a[44:47]
    s_waitcnt lgkmcnt(6)
    v_mfma_f32_16x16x32_bf16 a[0:3], v[192:195], v[48:51], a[0:3]
    s_add_u32 s34, s34, 16384
    s_cmp_eq_u32 s34, 163840
    s_cselect_b32 s34, 0, s34
    ds_read_b64_tr_b16 v[208:209], v232 offset:4096
    v_mfma_f32_16x16x32_bf16 a[4:7], v[192:195], v[52:55], a[4:7]
    s_sub_u32 s50, s34, s36
    ds_read_b64_tr_b16 v[210:211], v232 offset:6144
    v_mfma_f32_16x16x32_bf16 a[8:11], v[192:195], v[56:59], a[8:11]
    s_waitcnt lgkmcnt(6)
    v_mfma_f32_16x16x32_bf16 a[12:15], v[196:199], v[48:51], a[12:15]
    s_mov_b32 s36, s34
    ds_read_b64_tr_b16 v[212:213], v233 offset:4096
    v_mfma_f32_16x16x32_bf16 a[16:19], v[196:199], v[52:55], a[16:19]
    s_add_u32 m0, s33, s32
    ds_read_b64_tr_b16 v[214:215], v233 offset:6144
    v_mfma_f32_16x16x32_bf16 a[20:23], v[196:199], v[56:59], a[20:23]
    s_waitcnt lgkmcnt(6)
    buffer_load_dwordx4 v240, s[16:19], s39 offen offset:0 lds
    v_mfma_f32_16x16x32_bf16 a[24:27], v[200:203], v[48:51], a[24:27]
    ds_read_b64_tr_b16 v[216:217], v234 offset:4096
    v_mfma_f32_16x16x32_bf16 a[28:31], v[200:203], v[52:55], a[28:31]
    ds_read_b64_tr_b16 v[218:219], v234 offset:6144
    v_mfma_f32_16x16x32_bf16 a[32:35], v[200:203], v[56:59], a[32:35]
    s_waitcnt lgkmcnt(6)
    v_mfma_f32_16x16x32_bf16 a[36:39], v[204:207], v[48:51], a[36:39]
    ds_read_b64_tr_b16 v[220:221], v235 offset:4096
    v_mfma_f32_16x16x32_bf16 a[40:43], v[204:207], v[52:55], a[40:43]
    ds_read_b64_tr_b16 v[222:223], v235 offset:6144
    v_mfma_f32_16x16x32_bf16 a[44:47], v[204:207], v[56:59], a[44:47]
    s_waitcnt lgkmcnt(6)
    v_mfma_f32_16x16x32_bf16 a[0:3], v[208:211], v[60:63], a[0:3]
    ds_read_b64_tr_b16 v[192:193], v232 offset:8192
    v_mfma_f32_16x16x32_bf16 a[4:7], v[208:211], v[64:67], a[4:7]
    ds_read_b64_tr_b16 v[194:195], v232 offset:10240
    v_mfma_f32_16x16x32_bf16 a[8:11], v[208:211], v[68:71], a[8:11]
    s_waitcnt lgkmcnt(6)
    buffer_load_dwordx4 v241, s[16:19], s39 offen offset:1024 lds
    v_mfma_f32_16x16x32_bf16 a[12:15], v[212:215], v[60:63], a[12:15]
    ds_read_b64_tr_b16 v[196:197], v233 offset:8192
    v_mfma_f32_16x16x32_bf16 a[16:19], v[212:215], v[64:67], a[16:19]
    ds_read_b64_tr_b16 v[198:199], v233 offset:10240
    v_mfma_f32_16x16x32_bf16 a[20:23], v[212:215], v[68:71], a[20:23]
    s_waitcnt lgkmcnt(6)
    v_mfma_f32_16x16x32_bf16 a[24:27], v[216:219], v[60:63], a[24:27]
    ds_read_b64_tr_b16 v[200:201], v234 offset:8192
    v_mfma_f32_16x16x32_bf16 a[28:31], v[216:219], v[64:67], a[28:31]
    ds_read_b64_tr_b16 v[202:203], v234 offset:10240
    v_mfma_f32_16x16x32_bf16 a[32:35], v[216:219], v[68:71], a[32:35]
    s_waitcnt lgkmcnt(6)
    v_mfma_f32_16x16x32_bf16 a[36:39], v[220:223], v[60:63], a[36:39]
    ds_read_b64_tr_b16 v[204:205], v235 offset:8192
    v_mfma_f32_16x16x32_bf16 a[40:43], v[220:223], v[64:67], a[40:43]
    ds_read_b64_tr_b16 v[206:207], v235 offset:10240
    v_mfma_f32_16x16x32_bf16 a[44:47], v[220:223], v[68:71], a[44:47]
    s_waitcnt lgkmcnt(6)
    v_mfma_f32_16x16x32_bf16 a[0:3], v[192:195], v[72:75], a[0:3]
    ds_read_b64_tr_b16 v[208:209], v232 offset:12288
    v_mfma_f32_16x16x32_bf16 a[4:7], v[192:195], v[76:79], a[4:7]
    ds_read_b64_tr_b16 v[210:211], v232 offset:14336
    v_add_u32 v232, s50, v232
    v_mfma_f32_16x16x32_bf16 a[8:11], v[192:195], v[80:83], a[8:11]
    s_waitcnt lgkmcnt(6)
    buffer_load_dwordx4 v242, s[16:19], s39 offen offset:2048 lds
    v_mfma_f32_16x16x32_bf16 a[12:15], v[196:199], v[72:75], a[12:15]
    ds_read_b64_tr_b16 v[212:213], v233 offset:12288
    v_mfma_f32_16x16x32_bf16 a[16:19], v[196:199], v[76:79], a[16:19]
    ds_read_b64_tr_b16 v[214:215], v233 offset:14336
    v_add_u32 v233, s50, v233
    v_mfma_f32_16x16x32_bf16 a[20:23], v[196:199], v[80:83], a[20:23]
    s_waitcnt lgkmcnt(6)
    v_mfma_f32_16x16x32_bf16 a[24:27], v[200:203], v[72:75], a[24:27]
    ds_read_b64_tr_b16 v[216:217], v234 offset:12288
    v_mfma_f32_16x16x32_bf16 a[28:31], v[200:203], v[76:79], a[28:31]
    ds_read_b64_tr_b16 v[218:219], v234 offset:14336
    v_add_u32 v234, s50, v234
    v_mfma_f32_16x16x32_bf16 a[32:35], v[200:203], v[80:83], a[32:35]
    s_waitcnt lgkmcnt(6)
    v_mfma_f32_16x16x32_bf16 a[36:39], v[204:207], v[72:75], a[36:39]
    ds_read_b64_tr_b16 v[220:221], v235 offset:12288
    v_mfma_f32_16x16x32_bf16 a[40:43], v[204:207], v[76:79], a[40:43]
    ds_read_b64_tr_b16 v[222:223], v235 offset:14336
    v_add_u32 v235, s50, v235
    v_mfma_f32_16x16x32_bf16 a[44:47], v[204:207], v[80:83], a[44:47]
    s_waitcnt lgkmcnt(6)
    s_waitcnt vmcnt(7)
    v_readfirstlane_b32 s69, v245
    s_nop 0
    s_lshr_b32 s69, s69, s64
    s_and_b32 s69, s69, 65535
    s_cmp_ge_u32 s69, s65
    s_cbranch_scc0 L_spin0
L_spun0:
    s_barrier
    buffer_load_dwordx4 v243, s[16:19], s39 offen offset:3072 lds
    v_mfma_f32_16x16x32_bf16 a[0:3], v[208:211], v[84:87], a[0:3]
    s_add_u32 s33, s33, 16384
    s_cmp_eq_u32 s33, 163840
    s_cselect_b32 s33, 0, s33
    ds_read_b64_tr_b16 v[192:193], v232 offset:0
    v_mfma_f32_16x16x32_bf16 a[4:7], v[208:211], v[88:91], a[4:7]
    s_add_u32 s39, s39, s42
    ds_read_b64_tr_b16 v[194:195], v232 offset:2048
    v_mfma_f32_16x16x32_bf16 a[8:11], v[208:211], v[92:95], a[8:11]
    s_waitcnt lgkmcnt(6)
    v_mfma_f32_16x16x32_bf16 a[12:15], v[212:215], v[84:87], a[12:15]
    ds_read_b64_tr_b16 v[196:197], v233 offset:0
    v_mfma_f32_16x16x32_bf16 a[16:19], v[212:215], v[88:91], a[16:19]
    ds_read_b64_tr_b16 v[198:199], v233 offset:2048
    v_mfma_f32_16x16x32_bf16 a[20:23], v[212:215], v[92:95], a[20:23]
    s_waitcnt lgkmcnt(6)
    v_mfma_f32_16x16x32_bf16 a[24:27], v[216:219], v[84:87], a[24:27]
    ds_read_b64_tr_b16 v[200:201], v234 offset:0
    v_mfma_f32_16x16x32_bf16 a[28:31], v[216:219], v[88:91], a[28:31]
    ds_read_b64_tr_b16 v[202:203], v234 offset:2048
    v_mfma_f32_16x16x32_bf16 a[32:35], v[216:219], v[92:95], a[32:35]
    s_waitcnt lgkmcnt(6)
    v_mfma_f32_16x16x32_bf16 a[36:39], v[220:223], v[84:87], a[36:39]
    ds_read_b64_tr_b16 v[204:205], v235 offset:0
    v_mfma_f32_16x16x32_bf16 a[40:43], v[220:223], v[88:91], a[40:43]
    ds_read_b64_tr_b16 v[206:207], v235 offset:2048
    v_mfma_f32_16x16x32_bf16 a[44:47], v[220:223], v[92:95], a[44:47]
    s_waitcnt lgkmcnt(6)
    v_mfma_f32_16x16x32_bf16 a[0:3], v[192:195], v[96:99], a[0:3]
    s_add_u32 s34, s34, 16384
    s_cmp_eq_u32 s34, 163840
    s_cselect_b32 s34, 0, s34
    ds_read_b64_tr_b16 v[208:209], v232 offset:4096
    v_mov_b32 v252, -1
    v_mfma_f32_16x16x32_bf16 a[4:7], v[192:195], v[100:103], a[4:7]
    s_sub_u32 s50, s34, s36
    ds_read_b64_tr_b16 v[210:211], v232 offset:6144
    v_mov_b32 v253, -1
    v_mfma_f32_16x16x32_bf16 a[8:11], v[192:195], v[104:107], a[8:11]
    s_waitcnt lgkmcnt(6)
    v_mov_b32 v254, -1
    v_mov_b32 v255, -1
    v_mfma_f32_16x16x32_bf16 a[12:15], v[196:199], v[96:99], a[12:15]
    s_mov_b32 s36, s34
    ds_read_b64_tr_b16 v[212:213], v233 offset:4096
    v_mfma_f32_16x16x32_bf16 a[16:19], v[196:199], v[100:103], a[16:19]
    s_add_u32 m0, s33, s32
    ds_read_b64_tr_b16 v[214:215], v233 offset:6144
    v_mfma_f32_16x16x32_bf16 a[20:23], v[196:199], v[104:107], a[20:23]
    s_waitcnt lgkmcnt(6)
    buffer_load_dwordx4 v240, s[16:19], s39 offen offset:0 lds
    v_mfma_f32_16x16x32_bf16 a[24:27], v[200:203], v[96:99], a[24:27]
    s_add_u32 s55, s48, 36864
    ds_read_b64_tr_b16 v[216:217], v234 offset:4096
    v_mfma_f32_16x16x32_bf16 a[28:31], v[200:203], v[100:103], a[28:31]
    ds_read_b64_tr_b16 v[218:219], v234 offset:6144
    v_mfma_f32_16x16x32_bf16 a[32:35], v[200:203], v[104:107], a[32:35]
    s_waitcnt lgkmcnt(6)
    buffer_store_dwordx4 v[252:255], v250, s[24:27], s55 offen offset:0 sc1
    v_mfma_f32_16x16x32_bf16 a[36:39], v[204:207], v[96:99], a[36:39]
    ds_read_b64_tr_b16 v[220:221], v235 offset:4096
    v_mfma_f32_16x16x32_bf16 a[40:43], v[204:207], v[100:103], a[40:43]
    ds_read_b64_tr_b16 v[222:223], v235 offset:6144
    v_mfma_f32_16x16x32_bf16 a[44:47], v[204:207], v[104:107], a[44:47]
    s_waitcnt lgkmcnt(6)
    buffer_store_dwordx4 v[252:255], v250, s[24:27], s55 offen offset:1024 sc1
    v_mfma_f32_16x16x32_bf16 a[0:3], v[208:211], v[108:111], a[0:3]
    ds_read_b64_tr_b16 v[192:193], v232 offset:8192
    v_mfma_f32_16x16x32_bf16 a[4:7], v[208:211], v[112:115], a[4:7]
    ds_read_b64_tr_b16 v[194:195], v232 offset:10240
    v_mfma_f32_16x16x32_bf16 a[8:11], v[208:211], v[116:119], a[8:11]
    s_waitcnt lgkmcnt(6)
    buffer_load_dwordx4 v241, s[16:19], s39 offen offset:1024 lds
    v_mfma_f32_16x16x32_bf16 a[12:15], v[212:215], v[108:111], a[12:15]
    ds_read_b64_tr_b16 v[196:197], v233 offset:8192
    v_mfma_f32_16x16x32_bf16 a[16:19], v[212:215], v[112:115], a[16:19]
    ds_read_b64_tr_b16 v[198:199], v233 offset:10240
    v_mfma_f32_16x16x32_bf16 a[20:23], v[212:215], v[116:119], a[20:23]
    s_waitcnt lgkmcnt(6)
    buffer_store_dwordx4 v[252:255], v250, s[24:27], s55 offen offset:2048 sc1
    v_mfma_f32_16x16x32_bf16 a[24:27], v[216:219], v[108:111], a[24:27]
    ds_read_b64_tr_b16 v[200:201], v234 offset:8192
    v_mfma_f32_16x16x32_bf16 a[28:31], v[216:219], v[112:115], a[28:31]
    ds_read_b64_tr_b16 v[202:203], v234 offset:10240
    v_mfma_f32_16x16x32_bf16 a[32:35], v[216:219], v[116:119], a[32:35]
    s_waitcnt lgkmcnt(6)
    buffer_store_dwordx4 v[252:255], v250, s[24:27], s55 offen offset:3072 sc1
    v_mfma_f32_16x16x32_bf16 a[36:39], v[220:223], v[108:111], a[36:39]
    s_add_u32 s55, s48, 40960
    ds_read_b64_tr_b16 v[204:205], v235 offset:8192
    v_mfma_f32_16x16x32_bf16 a[40:43], v[220:223], v[112:115], a[40:43]
    ds_read_b64_tr_b16 v[206:207], v235 offset:10240
    v_mfma_f32_16x16x32_bf16 a[44:47], v[220:223], v[116:119], a[44:47]
    s_waitcnt lgkmcnt(6)
    buffer_store_dwordx4 v[252:255], v250, s[24:27], s55 offen offset:0 sc1
    v_mfma_f32_16x16x32_bf16 a[0:3], v[192:195], v[120:123], a[0:3]
    ds_read_b64_tr_b16 v[208:209], v232 offset:12288
    v_mfma_f32_16x16x32_bf16 a[4:7], v[192:195], v[124:127], a[4:7]
    ds_read_b64_tr_b16 v[210:211], v232 offset:14336
    v_add_u32 v232, s50, v232
    v_mfma_f32_16x16x32_bf16 a[8:11], v[192:195], v[128:131], a[8:11]
    s_waitcnt lgkmcnt(6)
    buffer_load_dwordx4 v242, s[16:19], s39 offen offset:2048 lds
    v_mfma_f32_16x16x32_bf16 a[12:15], v[196:199], v[120:123], a[12:15]
    ds_read_b64_tr_b16 v[212:213], v233 offset:12288
    v_mfma_f32_16x16x32_bf16 a[16:19], v[196:199], v[124:127], a[16:19]
    ds_read_b64_tr_b16 v[214:215], v233 offset:14336
    v_add_u32 v233, s50, v233
    v_mfma_f32_16x16x32_bf16 a[20:23], v[196:199], v[128:131], a[20:23]
    s_waitcnt lgkmcnt(6)
    buffer_store_dwordx4 v[252:255], v250, s[24:27], s55 offen offset:1024 sc1
    v_mfma_f32_16x16x32_bf16 a[24:27], v[200:203], v[120:123], a[24:27]
    ds_read_b64_tr_b16 v[216:217], v234 offset:12288
    v_mfma_f32_16x16x32_bf16 a[28:31], v[200:203], v[124:127], a[28:31]
    ds_read_b64_tr_b16 v[218:219], v234 offset:14336
    v_add_u32 v234, s50, v234
    v_mfma_f32_16x16x32_bf16 a[32:35], v[200:203], v[128:131], a[32:35]
    s_waitcnt lgkmcnt(6)
    v_mfma_f32_16x16x32_bf16 a[36:39], v[204:207], v[120:123], a[36:39]
    ds_read_b64_tr_b16 v[220:221], v235 offset:12288
    v_mfma_f32_16x16x32_bf16 a[40:43], v[204:207], v[124:127], a[40:43]
    ds_read_b64_tr_b16 v[222:223], v235 offset:14336
    v_add_u32 v235, s50, v235
    v_mfma_f32_16x16x32_bf16 a[44:47], v[204:207], v[128:131], a[44:47]
    s_waitcnt lgkmcnt(6)
    s_waitcnt vmcnt(47)
    s_barrier
    buffer_load_dwordx4 v243, s[16:19], s39 offen offset:3072 lds
    v_mfma_f32_16x16x32_bf16 a[0:3], v[208:211], v[132:135], a[0:3]
    s_add_u32 s33, s33, 16384
    s_cmp_eq_u32 s33, 163840
    s_cselect_b32 s33, 0, s33
    ds_read_b64_tr_b16 v[192:193], v232 offset:0
    v_mfma_f32_16x16x32_bf16 a[4:7], v[208:211], v[136:139], a[4:7]
    s_add_u32 s39, s39, s42
    ds_read_b64_tr_b16 v[194:195], v232 offset:2048
    v_mfma_f32_16x16x32_bf16 a[8:11], v[208:211], v[140:143], a[8:11]
    s_waitcnt lgkmcnt(6)
    v_mfma_f32_16x16x32_bf16 a[12:15], v[212:215], v[132:135], a[12:15]
    ds_read_b64_tr_b16 v[196:197], v233 offset:0
    v_mfma_f32_16x16x32_bf16 a[16:19], v[212:215], v[136:139], a[16:19]
    ds_read_b64_tr_b16 v[198:199], v233 offset:2048
    v_mfma_f32_16x16x32_bf16 a[20:23], v[212:215], v[140:143], a[20:23]
    s_waitcnt lgkmcnt(6)
    v_mfma_f32_16x16x32_bf16 a[24:27], v[216:219], v[132:135], a[24:27]
    ds_read_b64_tr_b16 v[200:201], v234 offset:0
    v_mfma_f32_16x16x32_bf16 a[28:31], v[216:219], v[136:139], a[28:31]
    ds_read_b64_tr_b16 v[202:203], v234 offset:2048
    v_mfma_f32_16x16x32_bf16 a[32:35], v[216:219], v[140:143], a[32:35]
    s_waitcnt lgkmcnt(6)
    v_mfma_f32_16x16x32_bf16 a[36:39], v[220:223], v[132:135], a[36:39]
    ds_read_b64_tr_b16 v[204:205], v235 offset:0
    v_mfma_f32_16x16x32_bf16 a[40:43], v[220:223], v[136:139], a[40:43]
    ds_read_b64_tr_b16 v[206:207], v235 offset:2048
    v_mfma_f32_16x16x32_bf16 a[44:47], v[220:223], v[140:143], a[44:47]
    s_waitcnt lgkmcnt(6)
    v_mfma_f32_16x16x32_bf16 a[0:3], v[192:195], v[144:147], a[0:3]
    s_add_u32 s34, s34, 16384
    s_cmp_eq_u32 s34, 163840
    s_cselect_b32 s34, 0, s34
    ds_read_b64_tr_b16 v[208:209], v232 offset:4096
    v_mfma_f32_16x16x32_bf16 a[4:7], v[192:195], v[148:151], a[4:7]
    s_sub_u32 s50, s34, s36
    ds_read_b64_tr_b16 v[210:211], v232 offset:6144
    v_mfma_f32_16x16x32_bf16 a[8:11], v[192:195], v[152:155], a[8:11]
    s_waitcnt lgkmcnt(6)
    v_mfma_f32_16x16x32_bf16 a[12:15], v[196:199], v[144:147], a[12:15]
    s_mov_b32 s36, s34
    ds_read_b64_tr_b16 v[212:213], v233 offset:4096
    v_mfma_f32_16x16x32_bf16 a[16:19], v[196:199], v[148:151], a[16:19]
    s_add_u32 m0, s33, s32
    ds_read_b64_tr_b16 v[214:215], v233 offset:6144
    v_mfma_f32_16x16x32_bf16 a[20:23], v[196:199], v[152:155], a[20:23]
    s_waitcnt lgkmcnt(6)
    buffer_load_dwordx4 v240, s[16:19], s39 offen offset:0 lds
    v_mfma_f32_16x16x32_bf16 a[24:27], v[200:203], v[144:147], a[24:27]
    ds_read_b64_tr_b16 v[216:217], v234 offset:4096
    v_mfma_f32_16x16x32_bf16 a[28:31], v[200:203], v[148:151], a[28:31]
    ds_read_b64_tr_b16 v[218:219], v234 offset:6144
    v_mfma_f32_16x16x32_bf16 a[32:35], v[200:203], v[152:155], a[32:35]
    s_waitcnt lgkmcnt(6)
    v_mfma_f32_16x16x32_bf16 a[36:39], v[204:207], v[144:147], a[36:39]
    ds_read_b64_tr_b16 v[220:221], v235 offset:4096
    v_mfma_f32_16x16x32_bf16 a[40:43], v[204:207], v[148:151], a[40:43]
    ds_read_b64_tr_b16 v[222:223], v235 offset:6144
    v_mfma_f32_16x16x32_bf16 a[44:47], v[204:207], v[152:155], a[44:47]
    s_waitcnt lgkmcnt(6)
    v_mfma_f32_16x16x32_bf16 a[0:3], v[208:211], v[156:159], a[0:3]
    ds_read_b64_tr_b16 v[192:193], v232 offset:8192
    v_mfma_f32_16x16x32_bf16 a[4:7], v[208:211], v[160:163], a[4:7]
    ds_read_b64_tr_b16 v[194:195], v232 offset:10240
    v_mfma_f32_16x16x32_bf16 a[8:11], v[208:211], v[164:167], a[8:11]
    s_waitcnt lgkmcnt(6)
    buffer_load_dwordx4 v241, s[16:19], s39 offen offset:1024 lds
    v_mfma_f32_16x16x32_bf16 a[12:15], v[212:215], v[156:159], a[12:15]
    ds_read_b64_tr_b16 v[196:197], v233 offset:8192
    v_mfma_f32_16x16x32_bf16 a[16:19], v[212:215], v[160:163], a[16:19]
    ds_read_b64_tr_b16 v[198:199], v233 offset:10240
    v_mfma_f32_16x16x32_bf16 a[20:23], v[212:215], v[164:167], a[20:23]
    s_waitcnt lgkmcnt(6)
    v_mfma_f32_16x16x32_bf16 a[24:27], v[216:219], v[156:159], a[24:27]
    ds_read_b64_tr_b16 v[200:201], v234 offset:8192
    v_mfma_f32_16x16x32_bf16 a[28:31], v[216:219], v[160:163], a[28:31]
    ds_read_b64_tr_b16 v[202:203], v234 offset:10240
    v_mfma_f32_16x16x32_bf16 a[32:35], v[216:219], v[164:167], a[32:35]
    s_waitcnt lgkmcnt(6)
    v_mfma_f32_16x16x32_bf16 a[36:39], v[220:223], v[156:159], a[36:39]
    ds_read_b64_tr_b16 v[204:205], v235 offset:8192
    v_mfma_f32_16x16x32_bf16 a[40:43], v[220:223], v[160:163], a[40:43]
    ds_read_b64_tr_b16 v[206:207], v235 offset:10240
    v_mfma_f32_16x16x32_bf16 a[44:47], v[220:223], v[164:167], a[44:47]
    s_waitcnt lgkmcnt(6)
    v_mfma_f32_16x16x32_bf16 a[0:3], v[192:195], v[168:171], a[0:3]
    ds_read_b64_tr_b16 v[208:209], v232 offset:12288
    v_mfma_f32_16x16x32_bf16 a[4:7], v[192:195], v[172:175], a[4:7]
    ds_read_b64_tr_b16 v[210:211], v232 offset:14336
    v_add_u32 v232, s50, v232
    v_mfma_f32_16x16x32_bf16 a[8:11], v[192:195], v[176:179], a[8:11]
    s_waitcnt lgkmcnt(6)
    buffer_load_dwordx4 v242, s[16:19], s39 offen offset:2048 lds
    v_mfma_f32_16x16x32_bf16 a[12:15], v[196:199], v[168:171], a[12:15]
    ds_read_b64_tr_b16 v[212:213], v233 offset:12288
    v_mfma_f32_16x16x32_bf16 a[16:19], v[196:199], v[172:175], a[16:19]
    ds_read_b64_tr_b16 v[214:215], v233 offset:14336
    v_add_u32 v233, s50, v233
    v_mfma_f32_16x16x32_bf16 a[20:23], v[196:199], v[176:179], a[20:23]
    s_waitcnt lgkmcnt(6)
    v_mfma_f32_16x16x32_bf16 a[24:27], v[200:203], v[168:171], a[24:27]
    ds_read_b64_tr_b16 v[216:217], v234 offset:12288
    v_mfma_f32_16x16x32_bf16 a[28:31], v[200:203], v[172:175], a[28:31]
    ds_read_b64_tr_b16 v[218:219], v234 offset:14336
    v_add_u32 v234, s50, v234
    v_mfma_f32_16x16x32_bf16 a[32:35], v[200:203], v[176:179], a[32:35]
    s_waitcnt lgkmcnt(6)
    v_mfma_f32_16x16x32_bf16 a[36:39], v[204:207], v[168:171], a[36:39]
    ds_read_b64_tr_b16 v[220:221], v235 offset:12288
    v_mfma_f32_16x16x32_bf16 a[40:43], v[204:207], v[172:175], a[40:43]
    ds_read_b64_tr_b16 v[222:223], v235 offset:14336
    v_add_u32 v235, s50, v235
    v_mfma_f32_16x16x32_bf16 a[44:47], v[204:207], v[176:179], a[44:47]
    s_waitcnt lgkmcnt(6)
    s_waitcnt vmcnt(47)
    s_barrier
    buffer_load_dwordx4 v243, s[16:19], s39 offen offset:3072 lds
    v_mfma_f32_16x16x32_bf16 a[0:3], v[208:211], v[180:183], a[0:3]
    s_add_u32 s33, s33, 16384
    s_cmp_eq_u32 s33, 163840
    s_cselect_b32 s33, 0, s33
    ds_read_b64_tr_b16 v[192:193], v232 offset:0
    v_mfma_f32_16x16x32_bf16 a[4:7], v[208:211], v[184:187], a[4:7]
    s_add_u32 s39, s39, s43
    ds_read_b64_tr_b16 v[194:195], v232 offset:2048
    v_mfma_f32_16x16x32_bf16 a[8:11], v[208:211], v[188:191], a[8:11]
    s_waitcnt lgkmcnt(6)
    v_mfma_f32_16x16x32_bf16 a[12:15], v[212:215], v[180:183], a[12:15]
    ds_read_b64_tr_b16 v[196:197], v233 offset:0
    v_mfma_f32_16x16x32_bf16 a[16:19], v[212:215], v[184:187], a[16:19]
    ds_read_b64_tr_b16 v[198:199], v233 offset:2048
    v_mfma_f32_16x16x32_bf16 a[20:23], v[212:215], v[188:191], a[20:23]
    s_waitcnt lgkmcnt(6)
    v_mfma_f32_16x16x32_bf16 a[24:27], v[216:219], v[180:183], a[24:27]
    ds_read_b64_tr_b16 v[200:201], v234 offset:0
    v_mfma_f32_16x16x32_bf16 a[28:31], v[216:219], v[184:187], a[28:31]
    ds_read_b64_tr_b16 v[202:203], v234 offset:2048
    v_mfma_f32_16x16x32_bf16 a[32:35], v[216:219], v[188:191], a[32:35]
    s_waitcnt lgkmcnt(6)
    v_mfma_f32_16x16x32_bf16 a[36:39], v[220:223], v[180:183], a[36:39]
    ds_read_b64_tr_b16 v[204:205], v235 offset:0
    v_mfma_f32_16x16x32_bf16 a[40:43], v[220:223], v[184:187], a[40:43]
    ds_read_b64_tr_b16 v[206:207], v235 offset:2048
    v_mfma_f32_16x16x32_bf16 a[44:47], v[220:223], v[188:191], a[44:47]
    s_waitcnt lgkmcnt(6)
    s_mov_b32 s31, 2
L_p4l:
    v_mfma_f32_16x16x32_bf16 a[48:51], v[192:195], a[208:211], 0
    s_add_u32 s34, s34, 16384
    s_cmp_eq_u32 s34, 163840
    s_cselect_b32 s34, 0, s34
    ds_read_b64_tr_b16 v[208:209], v232 offset:4096
    v_mfma_f32_16x16x32_bf16 a[52:55], v[192:195], a[212:215], 0
    s_sub_u32 s50, s34, s36
    ds_read_b64_tr_b16 v[210:211], v232 offset:6144
    v_mfma_f32_16x16x32_bf16 a[56:59], v[192:195], a[216:219], 0
    s_waitcnt lgkmcnt(6)
    v_mfma_f32_16x16x32_bf16 a[60:63], v[196:199], a[208:211], 0
    s_mov_b32 s36, s34
    ds_read_b64_tr_b16 v[212:213], v233 offset:4096
    v_mfma_f32_16x16x32_bf16 a[64:67], v[196:199], a[212:215], 0
    s_sub_u32 s71, s60, 2
    ds_read_b64_tr_b16 v[214:215], v233 offset:6144
    v_mfma_f32_16x16x32_bf16 a[68:71], v[196:199], a[216:219], 0
    s_waitcnt lgkmcnt(6)
    v_mfma_f32_16x16x32_bf16 a[72:75], v[200:203], a[208:211], 0
    s_lshl_b32 s71, s71, 2
    ds_read_b64_tr_b16 v[216:217], v234 offset:4096
    v_accvgpr_read_b32 v224, a0
    v_mfma_f32_16x16x32_bf16 a[76:79], v[200:203], a[212:215], 0
    s_lshl_b32 s63, 1, s71
    ds_read_b64_tr_b16 v[218:219], v234 offset:6144
    v_accvgpr_read_b32 v225, a1
    v_mfma_f32_16x16x32_bf16 a[80:83], v[200:203], a[216:219], 0
    s_waitcnt lgkmcnt(6)
    v_accvgpr_read_b32 v226, a2
    v_accvgpr_read_b32 v227, a3
    v_mfma_f32_16x16x32_bf16 a[84:87], v[204:207], a[208:211], 0
    s_cmp_ge_u32 s60, 2
    s_cselect_b32 s63, s63, 0
    ds_read_b64_tr_b16 v[220:221], v235 offset:4096
    v_accvgpr_read_b32 v228, a12
    v_mfma_f32_16x16x32_bf16 a[88:91], v[204:207], a[212:215], 0
    s_sub_u32 s64, s71, 4
    ds_read_b64_tr_b16 v[222:223], v235 offset:6144
    v_accvgpr_read_b32 v229, a13
    v_mfma_f32_16x16x32_bf16 a[92:95], v[204:207], a[216:219], 0
    s_waitcnt lgkmcnt(6)
    v_accvgpr_read_b32 v230, a14
    v_accvgpr_read_b32 v231, a15
    v_mfma_f32_16x16x32_bf16 a[48:51], v[208:211], a[220:223], a[48:51]
    s_and_b32 s64, s64, 31
    ds_read_b64_tr_b16 v[192:193], v232 offset:8192
    v_cvt_pk_bf16_f32 v252, v224, v225
    v_mfma_f32_16x16x32_bf16 a[52:55], v[208:211], a[224:227], a[52:55]
    s_cmp_ge_u32 s60, 3
    s_cselect_b32 s65, 8, 0
    ds_read_b64_tr_b16 v[194:195], v232 offset:10240
    v_cvt_pk_bf16_f32 v253, v226, v227
    v_mfma_f32_16x16x32_bf16 a[56:59], v[208:211], a[228:231], a[56:59]
    s_waitcnt lgkmcnt(6)
    v_cvt_pk_bf16_f32 v254, v228, v229
    v_cvt_pk_bf16_f32 v255, v230, v231
    v_mfma_f32_16x16x32_bf16 a[60:63], v[212:215], a[220:223], a[60:63]
    s_cmp_eq_u32 s52, 0
    s_cselect_b32 s65, s65, 0
    ds_read_b64_tr_b16 v[196:197], v233 offset:8192
    v_mfma_f32_16x16x32_bf16 a[64:67], v[212:215], a[224:227], a[64:67]
    s_add_u32 m0, s33, s32
    ds_read_b64_tr_b16 v[198:199], v233 offset:10240
    v_mfma_f32_16x16x32_bf16 a[68:71], v[212:215], a[228:231], a[68:71]
    s_waitcnt lgkmcnt(6)
    buffer_load_dwordx4 v240, s[16:19], s39 offen offset:0 lds
    v_mfma_f32_16x16x32_bf16 a[72:75], v[216:219], a[220:223], a[72:75]
    s_add_u32 s55, s48, 0
    ds_read_b64_tr_b16 v[200:201], v234 offset:8192
    v_mfma_f32_16x16x32_bf16 a[76:79], v[216:219], a[224:227], a[76:79]
    ds_read_b64_tr_b16 v[202:203], v234 offset:10240
    v_mfma_f32_16x16x32_bf16 a[80:83], v[216:219], a[228:231], a[80:83]
    s_waitcnt lgkmcnt(6)
    buffer_load_dwordx4 v241, s[16:19], s39 offen offset:1024 lds
    v_mfma_f32_16x16x32_bf16 a[84:87], v[220:223], a[220:223], a[84:87]
    ds_read_b64_tr_b16 v[204:205], v235 offset:8192
    v_mfma_f32_16x16x32_bf16 a[88:91], v[220:223], a[224:227], a[88:91]
    ds_read_b64_tr_b16 v[206:207], v235 offset:10240
    v_mfma_f32_16x16x32_bf16 a[92:95], v[220:223], a[228:231], a[92:95]
    s_waitcnt lgkmcnt(6)
    buffer_store_dwordx4 v[252:255], v250, s[24:27], s55 offen sc1
    v_mfma_f32_16x16x32_bf16 a[48:51], v[192:195], a[232:235], a[48:51]
    ds_read_b64_tr_b16 v[208:209], v232 offset:12288
    v_accvgpr_read_b32 v224, a4
    v_mfma_f32_16x16x32_bf16 a[52:55], v[192:195], a[236:239], a[52:55]
    ds_read_b64_tr_b16 v[210:211], v232 offset:14336
    v_add_u32 v232, s50, v232
    v_mfma_f32_16x16x32_bf16 a[56:59], v[192:195], a[240:243], a[56:59]
    s_waitcnt lgkmcnt(6)
    buffer_load_dwordx4 v242, s[16:19], s39 offen offset:2048 lds
    v_mfma_f32_16x16x32_bf16 a[60:63], v[196:199], a[232:235], a[60:63]
    ds_read_b64_tr_b16 v[212:213], v233 offset:12288
    v_accvgpr_read_b32 v225, a5
    v_mfma_f32_16x16x32_bf16 a[64:67], v[196:199], a[236:239], a[64:67]
    ds_read_b64_tr_b16 v[214:215], v233 offset:14336
    v_add_u32 v233, s50, v233
    v_mfma_f32_16x16x32_bf16 a[68:71], v[196:199], a[240:243], a[68:71]
    s_waitcnt lgkmcnt(6)
    v_accvgpr_read_b32 v226, a6
    v_accvgpr_read_b32 v227, a7
    v_mfma_f32_16x16x32_bf16 a[72:75], v[200:203], a[232:235], a[72:75]
    ds_read_b64_tr_b16 v[216:217], v234 offset:12288
    v_accvgpr_read_b32 v228, a16
    v_mfma_f32_16x16x32_bf16 a[76:79], v[200:203], a[236:239], a[76:79]
    ds_read_b64_tr_b16 v[218:219], v234 offset:14336
    v_add_u32 v234, s50, v234
    v_mfma_f32_16x16x32_bf16 a[80:83], v[200:203], a[240:243], a[80:83]
    s_waitcnt lgkmcnt(6)
    v_accvgpr_read_b32 v229, a17
    v_accvgpr_read_b32 v230, a18
    v_mfma_f32_16x16x32_bf16 a[84:87], v[204:207], a[232:235], a[84:87]
    ds_read_b64_tr_b16 v[220:221], v235 offset:12288
    v_accvgpr_read_b32 v231, a19
    v_mfma_f32_16x16x32_bf16 a[88:91], v[204:207], a[236:239], a[88:91]
    ds_read_b64_tr_b16 v[222:223], v235 offset:14336
    v_add_u32 v235, s50, v235
    v_mfma_f32_16x16x32_bf16 a[92:95], v[204:207], a[240:243], a[92:95]
    s_waitcnt lgkmcnt(6)
    s_waitcnt vmcnt(7)
    v_readfirstlane_b32 s69, v245
    s_nop 0
    s_lshr_b32 s69, s69, s64
    s_and_b32 s69, s69, 15
    s_cmp_ge_u32 s69, s65
    s_cbranch_scc0 L_spin1
L_spun1:
    s_barrier
    buffer_load_dwordx4 v243, s[16:19], s39 offen offset:3072 lds
    v_mfma_f32_16x16x32_bf16 a[48:51], v[208:211], a[244:247], a[48:51]
    s_add_u32 s33, s33, 16384
    s_cmp_eq_u32 s33, 163840
    s_cselect_b32 s33, 0, s33
    ds_read_b64_tr_b16 v[192:193], v232 offset:0
    v_cvt_pk_bf16_f32 v236, v224, v225
    v_mfma_f32_16x16x32_bf16 a[52:55], v[208:211], a[248:251], a[52:55]
    s_add_u32 s39, s39, s42
    ds_read_b64_tr_b16 v[194:195], v232 offset:2048
    v_mov_b32 v244, s63
    v_mfma_f32_16x16x32_bf16 a[56:59], v[208:211], v[44:47], a[56:59]
    s_waitcnt lgkmcnt(6)
    v_cvt_pk_bf16_f32 v237, v226, v227
    v_cvt_pk_bf16_f32 v238, v228, v229
    v_mfma_f32_16x16x32_bf16 a[60:63], v[212:215], a[244:247], a[60:63]
    ds_read_b64_tr_b16 v[196:197], v233 offset:0
    v_cvt_pk_bf16_f32 v239, v230, v231
    v_mfma_f32_16x16x32_bf16 a[64:67], v[212:215], a[248:251], a[64:67]
    s_add_u32 s55, s48, 1024
    ds_read_b64_tr_b16 v[198:199], v233 offset:2048
    buffer_atomic_add v244, v246, s[24:27], s75 offen sc1
    v_mfma_f32_16x16x32_bf16 a[68:71], v[212:215], v[44:47], a[68:71]
    s_waitcnt lgkmcnt(6)
    buffer_store_dwordx4 v[236:239], v250, s[24:27], s55 offen sc1
    v_mfma_f32_16x16x32_bf16 a[72:75], v[216:219], a[244:247], a[72:75]
    ds_read_b64_tr_b16 v[200:201], v234 offset:0
    v_accvgpr_read_b32 v224, a8
    v_mfma_f32_16x16x32_bf16 a[76:79], v[216:219], a[248:251], a[76:79]
    ds_read_b64_tr_b16 v[202:203], v234 offset:2048
    v_accvgpr_read_b32 v225, a9
    v_mfma_f32_16x16x32_bf16 a[80:83], v[216:219], v[44:47], a[80:83]
    s_waitcnt lgkmcnt(6)
    v_accvgpr_read_b32 v226, a10
    v_accvgpr_read_b32 v227, a11
    v_mfma_f32_16x16x32_bf16 a[84:87], v[220:223], a[244:247], a[84:87]
    ds_read_b64_tr_b16 v[204:205], v235 offset:0
    v_accvgpr_read_b32 v228, a20
    v_mfma_f32_16x16x32_bf16 a[88:91], v[220:223], a[248:251], a[88:91]
    ds_read_b64_tr_b16 v[206:207], v235 offset:2048
    v_accvgpr_read_b32 v229, a21
    v_mfma_f32_16x16x32_bf16 a[92:95], v[220:223], v[44:47], a[92:95]
    s_waitcnt lgkmcnt(6)
    v_accvgpr_read_b32 v230, a22
    v_accvgpr_read_b32 v231, a23
    v_cvt_pk_bf16_f32 v252, v224, v225
    v_cvt_pk_bf16_f32 v253, v226, v227
    v_cvt_pk_bf16_f32 v254, v228, v229
    v_cvt_pk_bf16_f32 v255, v230, v231
    s_add_u32 s55, s48, 2048
    buffer_store_dwordx4 v[252:255], v250, s[24:27], s55 offen sc1
    s_waitcnt vmcnt(13)
    v_mfma_f32_16x16x32_bf16 v[32:35], a[96:99], v[0:3], 0
    v_mfma_f32_16x16x32_bf16 v[36:39], a[100:103], v[0:3], 0
    v_mfma_f32_16x16x32_bf16 v[32:35], a[96:99], v[4:7], v[32:35]
    v_mfma_f32_16x16x32_bf16 v[36:39], a[100:103], v[4:7], v[36:39]
    v_mfma_f32_16x16x32_bf16 v[32:35], a[96:99], v[8:11], v[32:35]
    v_mfma_f32_16x16x32_bf16 v[36:39], a[100:103], v[8:11], v[36:39]
    v_mfma_f32_16x16x32_bf16 v[32:35], a[96:99], v[12:15], v[32:35]
    v_accvgpr_read_b32 v224, a24
    v_accvgpr_read_b32 v225, a25
    v_mfma_f32_16x16x32_bf16 v[36:39], a[100:103], v[12:15], v[36:39]
    v_accvgpr_read_b32 v226, a26
    v_accvgpr_read_b32 v227, a27
    v_mfma_f32_16x16x32_bf16 v[32:35], a[96:99], v[16:19], v[32:35]
    v_accvgpr_read_b32 v228, a36
    v_accvgpr_read_b32 v229, a37
    v_mfma_f32_16x16x32_bf16 v[36:39], a[100:103], v[16:19], v[36:39]
    v_accvgpr_read_b32 v230, a38
    v_accvgpr_read_b32 v231, a39
    v_mfma_f32_16x16x32_bf16 v[32:35], a[96:99], v[20:23], v[32:35]
    v_cvt_pk_bf16_f32 v236, v224, v225
    v_cvt_pk_bf16_f32 v237, v226, v227
    v_mfma_f32_16x16x32_bf16 v[36:39], a[100:103], v[20:23], v[36:39]
    v_cvt_pk_bf16_f32 v238, v228, v229
    v_cvt_pk_bf16_f32 v239, v230, v231
    v_mfma_f32_16x16x32_bf16 v[32:35], a[96:99], v[24:27], v[32:35]
    s_add_u32 s55, s48, 3072
    buffer_store_dwordx4 v[236:239], v250, s[24:27], s55 offen sc1
    v_mfma_f32_16x16x32_bf16 v[36:39], a[100:103], v[24:27], v[36:39]
    v_accvgpr_read_b32 v224, a28
    v_accvgpr_read_b32 v225, a29
    v_mfma_f32_16x16x32_bf16 v[32:35], a[96:99], v[28:31], v[32:35]
    v_accvgpr_read_b32 v226, a30
    v_accvgpr_read_b32 v227, a31
    v_mfma_f32_16x16x32_bf16 v[36:39], a[100:103], v[28:31], v[36:39]
    v_accvgpr_read_b32 v228, a40
    v_accvgpr_read_b32 v229, a41
    v_mfma_f32_16x16x32_bf16 a[48:51], v[192:195], v[48:51], a[48:51]
    s_add_u32 s34, s34, 16384
    s_cmp_eq_u32 s34, 163840
    s_cselect_b32 s34, 0, s34
    ds_read_b64_tr_b16 v[208:209], v232 offset:4096
    v_accvgpr_read_b32 v230, a42
    v_mfma_f32_16x16x32_bf16 a[52:55], v[192:195], v[52:55], a[52:55]
    s_sub_u32 s50, s34, s36
    ds_read_b64_tr_b16 v[210:211], v232 offset:6144
    v_accvgpr_read_b32 v231, a43
    v_mfma_f32_16x16x32_bf16 a[56:59], v[192:195], v[56:59], a[56:59]
    s_waitcnt lgkmcnt(6)
    v_cvt_pk_bf16_f32 v252, v224, v225
    v_cvt_pk_bf16_f32 v253, v226, v227
    v_mfma_f32_16x16x32_bf16 a[60:63], v[196:199], v[48:51], a[60:63]
    s_mov_b32 s36, s34
    ds_read_b64_tr_b16 v[212:213], v233 offset:4096
    v_cvt_pk_bf16_f32 v254, v228, v229
    v_mfma_f32_16x16x32_bf16 a[64:67], v[196:199], v[52:55], a[64:67]
    s_add_u32 m0, s33, s32
    ds_read_b64_tr_b16 v[214:215], v233 offset:6144
    v_cvt_pk_bf16_f32 v255, v230, v231
    v_mfma_f32_16x16x32_bf16 a[68:71], v[196:199], v[56:59], a[68:71]
    s_waitcnt lgkmcnt(6)
    buffer_load_dwordx4 v240, s[16:19], s39 offen offset:0 lds
    v_mfma_f32_16x16x32_bf16 a[72:75], v[200:203], v[48:51], a[72:75]
    s_add_u32 s55, s48, 4096
    ds_read_b64_tr_b16 v[216:217], v234 offset:4096
    v_mfma_f32_16x16x32_bf16 a[76:79], v[200:203], v[52:55], a[76:79]
    ds_read_b64_tr_b16 v[218:219], v234 offset:6144
    v_mfma_f32_16x16x32_bf16 a[80:83], v[200:203], v[56:59], a[80:83]
    s_waitcnt lgkmcnt(6)
    buffer_store_dwordx4 v[252:255], v250, s[24:27], s55 offen sc1
    v_mfma_f32_16x16x32_bf16 a[84:87], v[204:207], v[48:51], a[84:87]
    ds_read_b64_tr_b16 v[220:221], v235 offset:4096
    v_accvgpr_read_b32 v224, a32
    v_mfma_f32_16x16x32_bf16 a[88:91], v[204:207], v[52:55], a[88:91]
    ds_read_b64_tr_b16 v[222:223], v235 offset:6144
    v_accvgpr_read_b32 v225, a33
    v_mfma_f32_16x16x32_bf16 a[92:95], v[204:207], v[56:59], a[92:95]
    s_waitcnt lgkmcnt(6)
    v_accvgpr_read_b32 v226, a34
    v_accvgpr_read_b32 v227, a35
    v_mfma_f32_16x16x32_bf16 a[48:51], v[208:211], v[60:63], a[48:51]
    ds_read_b64_tr_b16 v[192:193], v232 offset:8192
    v_accvgpr_read_b32 v228, a44
    v_mfma_f32_16x16x32_bf16 a[52:55], v[208:211], v[64:67], a[52:55]
    ds_read_b64_tr_b16 v[194:195], v232 offset:10240
    v_accvgpr_read_b32 v229, a45
    v_mfma_f32_16x16x32_bf16 a[56:59], v[208:211], v[68:71], a[56:59]
    s_waitcnt lgkmcnt(6)
    buffer_load_dwordx4 v241, s[16:19], s39 offen offset:1024 lds
    v_mfma_f32_16x16x32_bf16 a[60:63], v[212:215], v[60:63], a[60:63]
    ds_read_b64_tr_b16 v[196:197], v233 offset:8192
    v_accvgpr_read_b32 v230, a46
    v_mfma_f32_16x16x32_bf16 a[64:67], v[212:215], v[64:67], a[64:67]
    ds_read_b64_tr_b16 v[198:199], v233 offset:10240
    v_accvgpr_read_b32 v231, a47
    v_mfma_f32_16x16x32_bf16 a[68:71], v[212:215], v[68:71], a[68:71]
    s_waitcnt lgkmcnt(6)
    v_cvt_pk_bf16_f32 v236, v224, v225
    v_cvt_pk_bf16_f32 v237, v226, v227
    v_mfma_f32_16x16x32_bf16 a[72:75], v[216:219], v[60:63], a[72:75]
    ds_read_b64_tr_b16 v[200:201], v234 offset:8192
    v_cvt_pk_bf16_f32 v238, v228, v229
    v_mfma_f32_16x16x32_bf16 a[76:79], v[216:219], v[64:67], a[76:79]
    ds_read_b64_tr_b16 v[202:203], v234 offset:10240
    v_cvt_pk_bf16_f32 v239, v230, v231
    v_mfma_f32_16x16x32_bf16 a[80:83], v[216:219], v[68:71], a[80:83]
    s_waitcnt lgkmcnt(6)
    v_cvt_pk_bf16_f32 v40, v32, v33
    v_cvt_pk_bf16_f32 v41, v34, v35
    v_mfma_f32_16x16x32_bf16 a[84:87], v[220:223], v[60:63], a[84:87]
    s_add_u32 s55, s48, 5120
    ds_read_b64_tr_b16 v[204:205], v235 offset:8192
    v_cvt_pk_bf16_f32 v42, v36, v37
    v_mfma_f32_16x16x32_bf16 a[88:91], v[220:223], v[64:67], a[88:91]
    ds_read_b64_tr_b16 v[206:207], v235 offset:10240
    v_cvt_pk_bf16_f32 v43, v38, v39
    v_mfma_f32_16x16x32_bf16 a[92:95], v[220:223], v[68:71], a[92:95]
    s_waitcnt lgkmcnt(6)
    buffer_store_dwordx4 v[236:239], v250, s[24:27], s55 offen sc1
    v_mfma_f32_16x16x32_bf16 a[48:51], v[192:195], v[72:75], a[48:51]
    s_add_u32 s48, s48, 6144
    ds_read_b64_tr_b16 v[208:209], v232 offset:12288
    v_mfma_f32_16x16x32_bf16 a[52:55], v[192:195], v[76:79], a[52:55]
    ds_read_b64_tr_b16 v[210:211], v232 offset:14336
    v_add_u32 v232, s50, v232
    v_mfma_f32_16x16x32_bf16 a[56:59], v[192:195], v[80:83], a[56:59]
    s_waitcnt lgkmcnt(6)
    buffer_load_dwordx4 v242, s[16:19], s39 offen offset:2048 lds
    v_mfma_f32_16x16x32_bf16 a[60:63], v[196:199], v[72:75], a[60:63]
    ds_read_b64_tr_b16 v[212:213], v233 offset:12288
    v_mfma_f32_16x16x32_bf16 a[64:67], v[196:199], v[76:79], a[64:67]
    ds_read_b64_tr_b16 v[214:215], v233 offset:14336
    v_add_u32 v233, s50, v233
    v_mfma_f32_16x16x32_bf16 a[68:71], v[196:199], v[80:83], a[68:71]
    s_waitcnt lgkmcnt(6)
    buffer_store_dwordx2 v[40:41], v247, s[12:15], s73 offen
    v_mfma_f32_16x16x32_bf16 a[72:75], v[200:203], v[72:75], a[72:75]
    ds_read_b64_tr_b16 v[216:217], v234 offset:12288
    v_mfma_f32_16x16x32_bf16 a[76:79], v[200:203], v[76:79], a[76:79]
    ds_read_b64_tr_b16 v[218:219], v234 offset:14336
    v_add_u32 v234, s50, v234
    v_mfma_f32_16x16x32_bf16 a[80:83], v[200:203], v[80:83], a[80:83]
    s_waitcnt lgkmcnt(6)
    buffer_store_dwordx2 v[42:43], v247, s[12:15], s73 offen offset:32
    v_mfma_f32_16x16x32_bf16 a[84:87], v[204:207], v[72:75], a[84:87]
    ds_read_b64_tr_b16 v[220:221], v235 offset:12288
    v_mfma_f32_16x16x32_bf16 a[88:91], v[204:207], v[76:79], a[88:91]
    ds_read_b64_tr_b16 v[222:223], v235 offset:14336
    v_add_u32 v235, s50, v235
    v_mfma_f32_16x16x32_bf16 a[92:95], v[204:207], v[80:83], a[92:95]
    s_waitcnt lgkmcnt(6)
    s_waitcnt vmcnt(56)
    s_barrier
    buffer_load_dwordx4 v243, s[16:19], s39 offen offset:3072 lds
    v_mfma_f32_16x16x32_bf16 a[48:51], v[208:211], v[84:87], a[48:51]
    s_add_u32 s33, s33, 16384
    s_cmp_eq_u32 s33, 163840
    s_cselect_b32 s33, 0, s33
    ds_read_b64_tr_b16 v[192:193], v232 offset:0
    v_mfma_f32_16x16x32_bf16 a[52:55], v[208:211], v[88:91], a[52:55]
    s_add_u32 s39, s39, s42
    ds_read_b64_tr_b16 v[194:195], v232 offset:2048
    v_mfma_f32_16x16x32_bf16 a[56:59], v[208:211], v[92:95], a[56:59]
    s_waitcnt lgkmcnt(6)
    v_mfma_f32_16x16x32_bf16 a[60:63], v[212:215], v[84:87], a[60:63]
    ds_read_b64_tr_b16 v[196:197], v233 offset:0
    v_mfma_f32_16x16x32_bf16 a[64:67], v[212:215], v[88:91], a[64:67]
    ds_read_b64_tr_b16 v[198:199], v233 offset:2048
    v_mfma_f32_16x16x32_bf16 a[68:71], v[212:215], v[92:95], a[68:71]
    s_waitcnt lgkmcnt(6)
    v_mfma_f32_16x16x32_bf16 a[72:75], v[216:219], v[84:87], a[72:75]
    ds_read_b64_tr_b16 v[200:201], v234 offset:0
    v_mfma_f32_16x16x32_bf16 a[76:79], v[216:219], v[88:91], a[76:79]
    ds_read_b64_tr_b16 v[202:203], v234 offset:2048
    v_mfma_f32_16x16x32_bf16 a[80:83], v[216:219], v[92:95], a[80:83]
    s_waitcnt lgkmcnt(6)
    v_mfma_f32_16x16x32_bf16 a[84:87], v[220:223], v[84:87], a[84:87]
    ds_read_b64_tr_b16 v[204:205], v235 offset:0
    v_mfma_f32_16x16x32_bf16 a[88:91], v[220:223], v[88:91], a[88:91]
    ds_read_b64_tr_b16 v[206:207], v235 offset:2048
    v_mfma_f32_16x16x32_bf16 a[92:95], v[220:223], v[92:95], a[92:95]
    s_waitcnt lgkmcnt(6)
    v_mfma_f32_16x16x32_bf16 a[48:51], v[192:195], v[96:99], a[48:51]
    s_add_u32 s34, s34, 16384
    s_cmp_eq_u32 s34, 163840
    s_cselect_b32 s34, 0, s34
    ds_read_b64_tr_b16 v[208:209], v232 offset:4096
    v_mfma_f32_16x16x32_bf16 a[52:55], v[192:195], v[100:103], a[52:55]
    s_sub_u32 s50, s34, s36
    ds_read_b64_tr_b16 v[210:211], v232 offset:6144
    v_mfma_f32_16x16x32_bf16 a[56:59], v[192:195], v[104:107], a[56:59]
    s_waitcnt lgkmcnt(6)
    v_mfma_f32_16x16x32_bf16 a[60:63], v[196:199], v[96:99], a[60:63]
    s_mov_b32 s36, s34
    ds_read_b64_tr_b16 v[212:213], v233 offset:4096
    v_mfma_f32_16x16x32_bf16 a[64:67], v[196:199], v[100:103], a[64:67]
    s_add_u32 m0, s33, s32
    ds_read_b64_tr_b16 v[214:215], v233 offset:6144
    v_mfma_f32_16x16x32_bf16 a[68:71], v[196:199], v[104:107], a[68:71]
    s_waitcnt lgkmcnt(6)
    buffer_load_dwordx4 v240, s[16:19], s39 offen offset:0 lds
    v_mfma_f32_16x16x32_bf16 a[72:75], v[200:203], v[96:99], a[72:75]
    s_sub_u32 s71, s60, 3
    ds_read_b64_tr_b16 v[216:217], v234 offset:4096
    v_mfma_f32_16x16x32_bf16 a[76:79], v[200:203], v[100:103], a[76:79]
    s_sub_u32 s70, s52, s71
    ds_read_b64_tr_b16 v[218:219], v234 offset:6144
    v_mfma_f32_16x16x32_bf16 a[80:83], v[200:203], v[104:107], a[80:83]
    s_waitcnt lgkmcnt(6)
    v_mfma_f32_16x16x32_bf16 a[84:87], v[204:207], v[96:99], a[84:87]
    s_and_b32 s70, s70, 3
    ds_read_b64_tr_b16 v[220:221], v235 offset:4096
    v_mfma_f32_16x16x32_bf16 a[88:91], v[204:207], v[100:103], a[88:91]
    s_mul_i32 s61, s71, 6144
    ds_read_b64_tr_b16 v[222:223], v235 offset:6144
    v_mfma_f32_16x16x32_bf16 a[92:95], v[204:207], v[104:107], a[92:95]
    s_waitcnt lgkmcnt(6)
    v_mfma_f32_16x16x32_bf16 a[48:51], v[208:211], v[108:111], a[48:51]
    s_lshl_b32 s69, s70, 10
    ds_read_b64_tr_b16 v[192:193], v232 offset:8192
    v_mfma_f32_16x16x32_bf16 a[52:55], v[208:211], v[112:115], a[52:55]
    s_add_u32 s61, s61, s69
    ds_read_b64_tr_b16 v[194:195], v232 offset:10240
    v_mfma_f32_16x16x32_bf16 a[56:59], v[208:211], v[116:119], a[56:59]
    s_waitcnt lgkmcnt(6)
    buffer_load_dwordx4 v241, s[16:19], s39 offen offset:1024 lds
    v_mfma_f32_16x16x32_bf16 a[60:63], v[212:215], v[108:111], a[60:63]
    s_add_u32 s61, s61, s66
    ds_read_b64_tr_b16 v[196:197], v233 offset:8192
    v_mfma_f32_16x16x32_bf16 a[64:67], v[212:215], v[112:115], a[64:67]
    s_mul_i32 s62, s70, 28672
    ds_read_b64_tr_b16 v[198:199], v233 offset:10240
    v_mfma_f32_16x16x32_bf16 a[68:71], v[212:215], v[116:119], a[68:71]
    s_waitcnt lgkmcnt(6)
    v_mfma_f32_16x16x32_bf16 a[72:75], v[216:219], v[108:111], a[72:75]
    s_lshl_b32 s69, s71, 7
    ds_read_b64_tr_b16 v[200:201], v234 offset:8192
    v_mfma_f32_16x16x32_bf16 a[76:79], v[216:219], v[112:115], a[76:79]
    s_add_u32 s62, s62, s69
    ds_read_b64_tr_b16 v[202:203], v234 offset:10240
    v_mfma_f32_16x16x32_bf16 a[80:83], v[216:219], v[116:119], a[80:83]
    s_waitcnt lgkmcnt(6)
    v_mfma_f32_16x16x32_bf16 a[84:87], v[220:223], v[108:111], a[84:87]
    s_add_u32 s62, s62, s67
    ds_read_b64_tr_b16 v[204:205], v235 offset:8192
    v_mfma_f32_16x16x32_bf16 a[88:91], v[220:223], v[112:115], a[88:91]
    s_cmp_lt_u32 s70, 3
    s_cselect_b32 s61, s61, 0x7f000000
    s_cselect_b32 s62, s62, 0x7f000000
    ds_read_b64_tr_b16 v[206:207], v235 offset:10240
    v_mfma_f32_16x16x32_bf16 a[92:95], v[220:223], v[116:119], a[92:95]
    s_waitcnt lgkmcnt(6)
    v_mfma_f32_16x16x32_bf16 a[48:51], v[192:195], v[120:123], a[48:51]
    s_cmp_ge_u32 s60, 3
    s_cselect_b32 s61, s61, 0x7f000000
    s_cselect_b32 s62, s62, 0x7f000000
    ds_read_b64_tr_b16 v[208:209], v232 offset:12288
    v_mfma_f32_16x16x32_bf16 a[52:55], v[192:195], v[124:127], a[52:55]
    ds_read_b64_tr_b16 v[210:211], v232 offset:14336
    v_add_u32 v232, s50, v232
    v_mfma_f32_16x16x32_bf16 a[56:59], v[192:195], v[128:131], a[56:59]
    s_waitcnt lgkmcnt(6)
    buffer_load_dwordx4 v242, s[16:19], s39 offen offset:2048 lds
    v_mfma_f32_16x16x32_bf16 a[60:63], v[196:199], v[120:123], a[60:63]
    ds_read_b64_tr_b16 v[212:213], v233 offset:12288
    v_mfma_f32_16x16x32_bf16 a[64:67], v[196:199], v[124:127], a[64:67]
    ds_read_b64_tr_b16 v[214:215], v233 offset:14336
    v_add_u32 v233, s50, v233
    v_mfma_f32_16x16x32_bf16 a[68:71], v[196:199], v[128:131], a[68:71]
    s_waitcnt lgkmcnt(6)
    buffer_load_dwordx4 v[0:3], v250, s[24:27], s61 offen sc1
    v_mfma_f32_16x16x32_bf16 a[72:75], v[200:203], v[120:123], a[72:75]
    s_add_u32 s61, s61, 172032
    ds_read_b64_tr_b16 v[216:217], v234 offset:12288
    v_mfma_f32_16x16x32_bf16 a[76:79], v[200:203], v[124:127], a[76:79]
    ds_read_b64_tr_b16 v[218:219], v234 offset:14336
    v_add_u32 v234, s50, v234
    v_mfma_f32_16x16x32_bf16 a[80:83], v[200:203], v[128:131], a[80:83]
    s_waitcnt lgkmcnt(6)
    buffer_load_dwordx4 v[4:7], v250, s[24:27], s61 offen sc1
    v_mfma_f32_16x16x32_bf16 a[84:87], v[204:207], v[120:123], a[84:87]
    s_add_u32 s61, s61, 172032
    ds_read_b64_tr_b16 v[220:221], v235 offset:12288
    v_mfma_f32_16x16x32_bf16 a[88:91], v[204:207], v[124:127], a[88:91]
    ds_read_b64_tr_b16 v[222:223], v235 offset:14336
    v_add_u32 v235, s50, v235
    v_mfma_f32_16x16x32_bf16 a[92:95], v[204:207], v[128:131], a[92:95]
    s_waitcnt lgkmcnt(6)
    s_waitcnt vmcnt(45)
    s_barrier
    buffer_load_dwordx4 v243, s[16:19], s39 offen offset:3072 lds
    v_mfma_f32_16x16x32_bf16 a[48:51], v[208:211], v[132:135], a[48:51]
    s_add_u32 s33, s33, 16384
    s_cmp_eq_u32 s33, 163840
    s_cselect_b32 s33, 0, s33
    ds_read_b64_tr_b16 v[192:193], v232 offset:0
    v_mfma_f32_16x16x32_bf16 a[52:55], v[208:211], v[136:139], a[52:55]
    s_add_u32 s39, s39, s42
    ds_read_b64_tr_b16 v[194:195], v232 offset:2048
    v_mfma_f32_16x16x32_bf16 a[56:59], v[208:211], v[140:143], a[56:59]
    s_waitcnt lgkmcnt(6)
    buffer_load_dwordx4 v[8:11], v250, s[24:27], s61 offen sc1
    v_mfma_f32_16x16x32_bf16 a[60:63], v[212:215], v[132:135], a[60:63]
    s_add_u32 s61, s61, 172032
    ds_read_b64_tr_b16 v[196:197], v233 offset:0
    v_mfma_f32_16x16x32_bf16 a[64:67], v[212:215], v[136:139], a[64:67]
    ds_read_b64_tr_b16 v[198:199], v233 offset:2048
    v_mfma_f32_16x16x32_bf16 a[68:71], v[212:215], v[140:143], a[68:71]
    s_waitcnt lgkmcnt(6)
    buffer_load_dwordx4 v[12:15], v250, s[24:27], s61 offen sc1
    v_mfma_f32_16x16x32_bf16 a[72:75], v[216:219], v[132:135], a[72:75]
    s_add_u32 s61, s61, 172032
    ds_read_b64_tr_b16 v[200:201], v234 offset:0
    v_mfma_f32_16x16x32_bf16 a[76:79], v[216:219], v[136:139], a[76:79]
    ds_read_b64_tr_b16 v[202:203], v234 offset:2048
    v_mfma_f32_16x16x32_bf16 a[80:83], v[216:219], v[140:143], a[80:83]
    s_waitcnt lgkmcnt(6)
    buffer_load_dwordx4 v[16:19], v250, s[24:27], s61 offen sc1
    v_mfma_f32_16x16x32_bf16 a[84:87], v[220:223], v[132:135], a[84:87]
    s_add_u32 s61, s61, 172032
    ds_read_b64_tr_b16 v[204:205], v235 offset:0
    v_mfma_f32_16x16x32_bf16 a[88:91], v[220:223], v[136:139], a[88:91]
    ds_read_b64_tr_b16 v[206:207], v235 offset:2048
    v_mfma_f32_16x16x32_bf16 a[92:95], v[220:223], v[140:143], a[92:95]
    s_waitcnt lgkmcnt(6)
    buffer_load_dwordx4 v[20:23], v250, s[24:27], s61 offen sc1
    s_add_u32 s61, s61, 172032
    buffer_load_dwordx4 v[24:27], v250, s[24:27], s61 offen sc1
    s_add_u32 s61, s61, 172032
    buffer_load_dwordx4 v[28:31], v250, s[24:27], s61 offen sc1
    s_mov_b32 s73, s62
    v_mfma_f32_16x16x32_bf16 a[48:51], v[192:195], v[144:147], a[48:51]
    s_add_u32 s34, s34, 16384
    s_cmp_eq_u32 s34, 163840
    s_cselect_b32 s34, 0, s34
    ds_read_b64_tr_b16 v[208:209], v232 offset:4096
    v_mfma_f32_16x16x32_bf16 a[52:55], v[192:195], v[148:151], a[52:55]
    s_sub_u32 s50, s34, s36
    ds_read_b64_tr_b16 v[210:211], v232 offset:6144
    v_mfma_f32_16x16x32_bf16 a[56:59], v[192:195], v[152:155], a[56:59]
    s_waitcnt lgkmcnt(6)
    v_mfma_f32_16x16x32_bf16 a[60:63], v[196:199], v[144:147], a[60:63]
    s_mov_b32 s36, s34
    ds_read_b64_tr_b16 v[212:213], v233 offset:4096
    v_mfma_f32_16x16x32_bf16 a[64:67], v[196:199], v[148:151], a[64:67]
    s_add_u32 m0, s33, s32
    ds_read_b64_tr_b16 v[214:215], v233 offset:6144
    v_mfma_f32_16x16x32_bf16 a[68:71], v[196:199], v[152:155], a[68:71]
    s_waitcnt lgkmcnt(6)
    buffer_load_dwordx4 v240, s[16:19], s39 offen offset:0 lds
    v_mfma_f32_16x16x32_bf16 a[72:75], v[200:203], v[144:147], a[72:75]
    ds_read_b64_tr_b16 v[216:217], v234 offset:4096
    v_mfma_f32_16x16x32_bf16 a[76:79], v[200:203], v[148:151], a[76:79]
    ds_read_b64_tr_b16 v[218:219], v234 offset:6144
    v_mfma_f32_16x16x32_bf16 a[80:83], v[200:203], v[152:155], a[80:83]
    s_waitcnt lgkmcnt(6)
    buffer_load_dword v245, v249, s[24:27], s75 offen sc1
    v_mfma_f32_16x16x32_bf16 a[84:87], v[204:207], v[144:147], a[84:87]
    s_add_u32 s60, s60, 1
    ds_read_b64_tr_b16 v[220:221], v235 offset:4096
    v_mfma_f32_16x16x32_bf16 a[88:91], v[204:207], v[148:151], a[88:91]
    ds_read_b64_tr_b16 v[222:223], v235 offset:6144
    v_mfma_f32_16x16x32_bf16 a[92:95], v[204:207], v[152:155], a[92:95]
    s_waitcnt lgkmcnt(6)
    v_mfma_f32_16x16x32_bf16 a[48:51], v[208:211], v[156:159], a[48:51]
    ds_read_b64_tr_b16 v[192:193], v232 offset:8192
    v_mfma_f32_16x16x32_bf16 a[52:55], v[208:211], v[160:163], a[52:55]
    ds_read_b64_tr_b16 v[194:195], v232 offset:10240
    v_mfma_f32_16x16x32_bf16 a[56:59], v[208:211], v[164:167], a[56:59]
    s_waitcnt lgkmcnt(6)
    buffer_load_dwordx4 v241, s[16:19], s39 offen offset:1024 lds
    v_mfma_f32_16x16x32_bf16 a[60:63], v[212:215], v[156:159], a[60:63]
    ds_read_b64_tr_b16 v[196:197], v233 offset:8192
    v_mfma_f32_16x16x32_bf16 a[64:67], v[212:215], v[160:163], a[64:67]
    ds_read_b64_tr_b16 v[198:199], v233 offset:10240
    v_mfma_f32_16x16x32_bf16 a[68:71], v[212:215], v[164:167], a[68:71]
    s_waitcnt lgkmcnt(6)
    v_mfma_f32_16x16x32_bf16 a[72:75], v[216:219], v[156:159], a[72:75]
    ds_read_b64_tr_b16 v[200:201], v234 offset:8192
    v_mfma_f32_16x16x32_bf16 a[76:79], v[216:219], v[160:163], a[76:79]
    ds_read_b64_tr_b16 v[202:203], v234 offset:10240
    v_mfma_f32_16x16x32_bf16 a[80:83], v[216:219], v[164:167], a[80:83]
    s_waitcnt lgkmcnt(6)
    v_mfma_f32_16x16x32_bf16 a[84:87], v[220:223], v[156:159], a[84:87]
    ds_read_b64_tr_b16 v[204:205], v235 offset:8192
    v_mfma_f32_16x16x32_bf16 a[88:91], v[220:223], v[160:163], a[88:91]
    ds_read_b64_tr_b16 v[206:207], v235 offset:10240
    v_mfma_f32_16x16x32_bf16 a[92:95], v[220:223], v[164:167], a[92:95]
    s_waitcnt lgkmcnt(6)
    v_mfma_f32_16x16x32_bf16 a[48:51], v[192:195], v[168:171], a[48:51]
    ds_read_b64_tr_b16 v[208:209], v232 offset:12288
    v_mfma_f32_16x16x32_bf16 a[52:55], v[192:195], v[172:175], a[52:55]
    ds_read_b64_tr_b16 v[210:211], v232 offset:14336
    v_add_u32 v232, s50, v232
    v_mfma_f32_16x16x32_bf16 a[56:59], v[192:195], v[176:179], a[56:59]
    s_waitcnt lgkmcnt(6)
    buffer_load_dwordx4 v242, s[16:19], s39 offen offset:2048 lds
    v_mfma_f32_16x16x32_bf16 a[60:63], v[196:199], v[168:171], a[60:63]
    ds_read_b64_tr_b16 v[212:213], v233 offset:12288
    v_mfma_f32_16x16x32_bf16 a[64:67], v[196:199], v[172:175], a[64:67]
    ds_read_b64_tr_b16 v[214:215], v233 offset:14336
    v_add_u32 v233, s50, v233
    v_mfma_f32_16x16x32_bf16 a[68:71], v[196:199], v[176:179], a[68:71]
    s_waitcnt lgkmcnt(6)
    v_mfma_f32_16x16x32_bf16 a[72:75], v[200:203], v[168:171], a[72:75]
    ds_read_b64_tr_b16 v[216:217], v234 offset:12288
    v_mfma_f32_16x16x32_bf16 a[76:79], v[200:203], v[172:175], a[76:79]
    ds_read_b64_tr_b16 v[218:219], v234 offset:14336
    v_add_u32 v234, s50, v234
    v_mfma_f32_16x16x32_bf16 a[80:83], v[200:203], v[176:179], a[80:83]
    s_waitcnt lgkmcnt(6)
    v_mfma_f32_16x16x32_bf16 a[84:87], v[204:207], v[168:171], a[84:87]
    ds_read_b64_tr_b16 v[220:221], v235 offset:12288
    v_mfma_f32_16x16x32_bf16 a[88:91], v[204:207], v[172:175], a[88:91]
    ds_read_b64_tr_b16 v[222:223], v235 offset:14336
    v_add_u32 v235, s50, v235
    v_mfma_f32_16x16x32_bf16 a[92:95], v[204:207], v[176:179], a[92:95]
    s_waitcnt lgkmcnt(6)
    s_waitcnt vmcnt(51)
    s_barrier
    buffer_load_dwordx4 v243, s[16:19], s39 offen offset:3072 lds
    v_mfma_f32_16x16x32_bf16 a[48:51], v[208:211], v[180:183], a[48:51]
    s_add_u32 s33, s33, 16384
    s_cmp_eq_u32 s33, 163840
    s_cselect_b32 s33, 0, s33
    ds_read_b64_tr_b16 v[192:193], v232 offset:0
    v_mfma_f32_16x16x32_bf16 a[52:55], v[208:211], v[184:187], a[52:55]
    s_add_u32 s39, s39, s43
    ds_read_b64_tr_b16 v[194:195], v232 offset:2048
    v_mfma_f32_16x16x32_bf16 a[56:59], v[208:211], v[188:191], a[56:59]
    s_waitcnt lgkmcnt(6)
    v_mfma_f32_16x16x32_bf16 a[60:63], v[212:215], v[180:183], a[60:63]
    ds_read_b64_tr_b16 v[196:197], v233 offset:0
    v_mfma_f32_16x16x32_bf16 a[64:67], v[212:215], v[184:187], a[64:67]
    ds_read_b64_tr_b16 v[198:199], v233 offset:2048
    v_mfma_f32_16x16x32_bf16 a[68:71], v[212:215], v[188:191], a[68:71]
    s_waitcnt lgkmcnt(6)
    v_mfma_f32_16x16x32_bf16 a[72:75], v[216:219], v[180:183], a[72:75]
    ds_read_b64_tr_b16 v[200:201], v234 offset:0
    v_mfma_f32_16x16x32_bf16 a[76:79], v[216:219], v[184:187], a[76:79]
    ds_read_b64_tr_b16 v[202:203], v234 offset:2048
    v_mfma_f32_16x16x32_bf16 a[80:83], v[216:219], v[188:191], a[80:83]
    s_waitcnt lgkmcnt(6)
    v_mfma_f32_16x16x32_bf16 a[84:87], v[220:223], v[180:183], a[84:87]
    ds_read_b64_tr_b16 v[204:205], v235 offset:0
    v_mfma_f32_16x16x32_bf16 a[88:91], v[220:223], v[184:187], a[88:91]
    ds_read_b64_tr_b16 v[206:207], v235 offset:2048
    v_mfma_f32_16x16x32_bf16 a[92:95], v[220:223], v[188:191], a[92:95]
    s_waitcnt lgkmcnt(6)
    v_mfma_f32_16x16x32_bf16 a[0:3], v[192:195], a[208:211], 0
    s_add_u32 s34, s34, 16384
    s_cmp_eq_u32 s34, 163840
    s_cselect_b32 s34, 0, s34
    ds_read_b64_tr_b16 v[208:209], v232 offset:4096
    v_mfma_f32_16x16x32_bf16 a[4:7], v[192:195], a[212:215], 0
    s_sub_u32 s50, s34, s36
    ds_read_b64_tr_b16 v[210:211], v232 offset:6144
    v_mfma_f32_16x16x32_bf16 a[8:11], v[192:195], a[216:219], 0
    s_waitcnt lgkmcnt(6)
    v_mfma_f32_16x16x32_bf16 a[12:15], v[196:199], a[208:211], 0
    s_mov_b32 s36, s34
    ds_read_b64_tr_b16 v[212:213], v233 offset:4096
    v_mfma_f32_16x16x32_bf16 a[16:19], v[196:199], a[212:215], 0
    s_sub_u32 s71, s60, 2
    ds_read_b64_tr_b16 v[214:215], v233 offset:6144
    v_mfma_f32_16x16x32_bf16 a[20:23], v[196:199], a[216:219], 0
    s_waitcnt lgkmcnt(6)
    v_mfma_f32_16x16x32_bf16 a[24:27], v[200:203], a[208:211], 0
    s_lshl_b32 s71, s71, 2
    ds_read_b64_tr_b16 v[216:217], v234 offset:4096
    v_accvgpr_read_b32 v224, a48
    v_mfma_f32_16x16x32_bf16 a[28:31], v[200:203], a[212:215], 0
    s_lshl_b32 s63, 1, s71
    ds_read_b64_tr_b16 v[218:219], v234 offset:6144
    v_accvgpr_read_b32 v225, a49
    v_mfma_f32_16x16x32_bf16 a[32:35], v[200:203], a[216:219], 0
    s_waitcnt lgkmcnt(6)
    v_accvgpr_read_b32 v226, a50
    v_accvgpr_read_b32 v227, a51
    v_mfma_f32_16x16x32_bf16 a[36:39], v[204:207], a[208:211], 0
    s_cmp_ge_u32 s60, 2
    s_cselect_b32 s63, s63, 0
    ds_read_b64_tr_b16 v[220:221], v235 offset:4096
    v_accvgpr_read_b32 v228, a60
    v_mfma_f32_16x16x32_bf16 a[40:43], v[204:207], a[212:215], 0
    s_sub_u32 s64, s71, 4
    ds_read_b64_tr_b16 v[222:223], v235 offset:6144
    v_accvgpr_read_b32 v229, a61
    v_mfma_f32_16x16x32_bf16 a[44:47], v[204:207], a[216:219], 0
    s_waitcnt lgkmcnt(6)
    v_accvgpr_read_b32 v230, a62
    v_accvgpr_read_b32 v231, a63
    v_mfma_f32_16x16x32_bf16 a[0:3], v[208:211], a[220:223], a[0:3]
    s_and_b32 s64, s64, 31
    ds_read_b64_tr_b16 v[192:193], v232 offset:8192
    v_cvt_pk_bf16_f32 v252, v224, v225
    v_mfma_f32_16x16x32_bf16 a[4:7], v[208:211], a[224:227], a[4:7]
    s_cmp_ge_u32 s60, 3
    s_cselect_b32 s65, 8, 0
    ds_read_b64_tr_b16 v[194:195], v232 offset:10240
    v_cvt_pk_bf16_f32 v253, v226, v227
    v_mfma_f32_16x16x32_bf16 a[8:11], v[208:211], a[228:231], a[8:11]
    s_waitcnt lgkmcnt(6)
    v_cvt_pk_bf16_f32 v254, v228, v229
    v_cvt_pk_bf16_f32 v255, v230, v231
    v_mfma_f32_16x16x32_bf16 a[12:15], v[212:215], a[220:223], a[12:15]
    s_cmp_eq_u32 s52, 0
    s_cselect_b32 s65, s65, 0
    ds_read_b64_tr_b16 v[196:197], v233 offset:8192
    v_mfma_f32_16x16x32_bf16 a[16:19], v[212:215], a[224:227], a[16:19]
    s_add_u32 m0, s33, s32
    ds_read_b64_tr_b16 v[198:199], v233 offset:10240
    v_mfma_f32_16x16x32_bf16 a[20:23], v[212:215], a[228:231], a[20:23]
    s_waitcnt lgkmcnt(6)
    buffer_load_dwordx4 v240, s[16:19], s39 offen offset:0 lds
    v_mfma_f32_16x16x32_bf16 a[24:27], v[216:219], a[220:223], a[24:27]
    s_add_u32 s55, s48, 0
    ds_read_b64_tr_b16 v[200:201], v234 offset:8192
    v_mfma_f32_16x16x32_bf16 a[28:31], v[216:219], a[224:227], a[28:31]
    ds_read_b64_tr_b16 v[202:203], v234 offset:10240
    v_mfma_f32_16x16x32_bf16 a[32:35], v[216:219], a[228:231], a[32:35]
    s_waitcnt lgkmcnt(6)
    buffer_load_dwordx4 v241, s[16:19], s39 offen offset:1024 lds
    v_mfma_f32_16x16x32_bf16 a[36:39], v[220:223], a[220:223], a[36:39]
    ds_read_b64_tr_b16 v[204:205], v235 offset:8192
    v_mfma_f32_16x16x32_bf16 a[40:43], v[220:223], a[224:227], a[40:43]
    ds_read_b64_tr_b16 v[206:207], v235 offset:10240
    v_mfma_f32_16x16x32_bf16 a[44:47], v[220:223], a[228:231], a[44:47]
    s_waitcnt lgkmcnt(6)
    buffer_store_dwordx4 v[252:255], v250, s[24:27], s55 offen sc1
    v_mfma_f32_16x16x32_bf16 a[0:3], v[192:195], a[232:235], a[0:3]
    ds_read_b64_tr_b16 v[208:209], v232 offset:12288
    v_accvgpr_read_b32 v224, a52
    v_mfma_f32_16x16x32_bf16 a[4:7], v[192:195], a[236:239], a[4:7]
    ds_read_b64_tr_b16 v[210:211], v232 offset:14336
    v_add_u32 v232, s50, v232
    v_mfma_f32_16x16x32_bf16 a[8:11], v[192:195], a[240:243], a[8:11]
    s_waitcnt lgkmcnt(6)
    buffer_load_dwordx4 v242, s[16:19], s39 offen offset:2048 lds
    v_mfma_f32_16x16x32_bf16 a[12:15], v[196:199], a[232:235], a[12:15]
    ds_read_b64_tr_b16 v[212:213], v233 offset:12288
    v_accvgpr_read_b32 v225, a53
    v_mfma_f32_16x16x32_bf16 a[16:19], v[196:199], a[236:239], a[16:19]
    ds_read_b64_tr_b16 v[214:215], v233 offset:14336
    v_add_u32 v233, s50, v233
    v_mfma_f32_16x16x32_bf16 a[20:23], v[196:199], a[240:243], a[20:23]
    s_waitcnt lgkmcnt(6)
    v_accvgpr_read_b32 v226, a54
    v_accvgpr_read_b32 v227, a55
    v_mfma_f32_16x16x32_bf16 a[24:27], v[200:203], a[232:235], a[24:27]
    ds_read_b64_tr_b16 v[216:217], v234 offset:12288
    v_accvgpr_read_b32 v228, a64
    v_mfma_f32_16x16x32_bf16 a[28:31], v[200:203], a[236:239], a[28:31]
    ds_read_b64_tr_b16 v[218:219], v234 offset:14336
    v_add_u32 v234, s50, v234
    v_mfma_f32_16x16x32_bf16 a[32:35], v[200:203], a[240:243], a[32:35]
    s_waitcnt lgkmcnt(6)
    v_accvgpr_read_b32 v229, a65
    v_accvgpr_read_b32 v230, a66
    v_mfma_f32_16x16x32_bf16 a[36:39], v[204:207], a[232:235], a[36:39]
    ds_read_b64_tr_b16 v[220:221], v235 offset:12288
    v_accvgpr_read_b32 v231, a67
    v_mfma_f32_16x16x32_bf16 a[40:43], v[204:207], a[236:239], a[40:43]
    ds_read_b64_tr_b16 v[222:223], v235 offset:14336
    v_add_u32 v235, s50, v235
    v_mfma_f32_16x16x32_bf16 a[44:47], v[204:207], a[240:243], a[44:47]
    s_waitcnt lgkmcnt(6)
    s_waitcnt vmcnt(7)
    v_readfirstlane_b32 s69, v245
    s_nop 0
    s_lshr_b32 s69, s69, s64
    s_and_b32 s69, s69, 15
    s_cmp_ge_u32 s69, s65
    s_cbranch_scc0 L_spin2
L_spun2:
    s_barrier
    buffer_load_dwordx4 v243, s[16:19], s39 offen offset:3072 lds
    v_mfma_f32_16x16x32_bf16 a[0:3], v[208:211], a[244:247], a[0:3]
    s_add_u32 s33, s33, 16384
    s_cmp_eq_u32 s33, 163840
    s_cselect_b32 s33, 0, s33
    ds_read_b64_tr_b16 v[192:193], v232 offset:0
    v_cvt_pk_bf16_f32 v236, v224, v225
    v_mfma_f32_16x16x32_bf16 a[4:7], v[208:211], a[248:251], a[4:7]
    s_add_u32 s39, s39, s42
    ds_read_b64_tr_b16 v[194:195], v232 offset:2048
    v_mov_b32 v244, s63
    v_mfma_f32_16x16x32_bf16 a[8:11], v[208:211], v[44:47], a[8:11]
    s_waitcnt lgkmcnt(6)
    v_cvt_pk_bf16_f32 v237, v226, v227
    v_cvt_pk_bf16_f32 v238, v228, v229
    v_mfma_f32_16x16x32_bf16 a[12:15], v[212:215], a[244:247], a[12:15]
    ds_read_b64_tr_b16 v[196:197], v233 offset:0
    v_cvt_pk_bf16_f32 v239, v230, v231
    v_mfma_f32_16x16x32_bf16 a[16:19], v[212:215], a[248:251], a[16:19]
    s_add_u32 s55, s48, 1024
    ds_read_b64_tr_b16 v[198:199], v233 offset:2048
    buffer_atomic_add v244, v246, s[24:27], s75 offen sc1
    v_mfma_f32_16x16x32_bf16 a[20:23], v[212:215], v[44:47], a[20:23]
    s_waitcnt lgkmcnt(6)
    buffer_store_dwordx4 v[236:239], v250, s[24:27], s55 offen sc1
    v_mfma_f32_16x16x32_bf16 a[24:27], v[216:219], a[244:247], a[24:27]
    ds_read_b64_tr_b16 v[200:201], v234 offset:0
    v_accvgpr_read_b32 v224, a56
    v_mfma_f32_16x16x32_bf16 a[28:31], v[216:219], a[248:251], a[28:31]
    ds_read_b64_tr_b16 v[202:203], v234 offset:2048
    v_accvgpr_read_b32 v225, a57
    v_mfma_f32_16x16x32_bf16 a[32:35], v[216:219], v[44:47], a[32:35]
    s_waitcnt lgkmcnt(6)
    v_accvgpr_read_b32 v226, a58
    v_accvgpr_read_b32 v227, a59
    v_mfma_f32_16x16x32_bf16 a[36:39], v[220:223], a[244:247], a[36:39]
    ds_read_b64_tr_b16 v[204:205], v235 offset:0
    v_accvgpr_read_b32 v228, a68
    v_mfma_f32_16x16x32_bf16 a[40:43], v[220:223], a[248:251], a[40:43]
    ds_read_b64_tr_b16 v[206:207], v235 offset:2048
    v_accvgpr_read_b32 v229, a69
    v_mfma_f32_16x16x32_bf16 a[44:47], v[220:223], v[44:47], a[44:47]
    s_waitcnt lgkmcnt(6)
    v_accvgpr_read_b32 v230, a70
    v_accvgpr_read_b32 v231, a71
    v_cvt_pk_bf16_f32 v252, v224, v225
    v_cvt_pk_bf16_f32 v253, v226, v227
    v_cvt_pk_bf16_f32 v254, v228, v229
    v_cvt_pk_bf16_f32 v255, v230, v231
    s_add_u32 s55, s48, 2048
    buffer_store_dwordx4 v[252:255], v250, s[24:27], s55 offen sc1
    s_waitcnt vmcnt(13)
    v_mfma_f32_16x16x32_bf16 v[32:35], a[96:99], v[0:3], 0
    v_mfma_f32_16x16x32_bf16 v[36:39], a[100:103], v[0:3], 0
    v_mfma_f32_16x16x32_bf16 v[32:35], a[96:99], v[4:7], v[32:35]
    v_mfma_f32_16x16x32_bf16 v[36:39], a[100:103], v[4:7], v[36:39]
    v_mfma_f32_16x16x32_bf16 v[32:35], a[96:99], v[8:11], v[32:35]
    v_mfma_f32_16x16x32_bf16 v[36:39], a[100:103], v[8:11], v[36:39]
    v_mfma_f32_16x16x32_bf16 v[32:35], a[96:99], v[12:15], v[32:35]
    v_accvgpr_read_b32 v224, a72
    v_accvgpr_read_b32 v225, a73
    v_mfma_f32_16x16x32_bf16 v[36:39], a[100:103], v[12:15], v[36:39]
    v_accvgpr_read_b32 v226, a74
    v_accvgpr_read_b32 v227, a75
    v_mfma_f32_16x16x32_bf16 v[32:35], a[96:99], v[16:19], v[32:35]
    v_accvgpr_read_b32 v228, a84
    v_accvgpr_read_b32 v229, a85
    v_mfma_f32_16x16x32_bf16 v[36:39], a[100:103], v[16:19], v[36:39]
    v_accvgpr_read_b32 v230, a86
    v_accvgpr_read_b32 v231, a87
    v_mfma_f32_16x16x32_bf16 v[32:35], a[96:99], v[20:23], v[32:35]
    v_cvt_pk_bf16_f32 v236, v224, v225
    v_cvt_pk_bf16_f32 v237, v226, v227
    v_mfma_f32_16x16x32_bf16 v[36:39], a[100:103], v[20:23], v[36:39]
    v_cvt_pk_bf16_f32 v238, v228, v229
    v_cvt_pk_bf16_f32 v239, v230, v231
    v_mfma_f32_16x16x32_bf16 v[32:35], a[96:99], v[24:27], v[32:35]
    s_add_u32 s55, s48, 3072
    buffer_store_dwordx4 v[236:239], v250, s[24:27], s55 offen sc1
    v_mfma_f32_16x16x32_bf16 v[36:39], a[100:103], v[24:27], v[36:39]
    v_accvgpr_read_b32 v224, a76
    v_accvgpr_read_b32 v225, a77
    v_mfma_f32_16x16x32_bf16 v[32:35], a[96:99], v[28:31], v[32:35]
    v_accvgpr_read_b32 v226, a78
    v_accvgpr_read_b32 v227, a79
    v_mfma_f32_16x16x32_bf16 v[36:39], a[100:103], v[28:31], v[36:39]
    v_accvgpr_read_b32 v228, a88
    v_accvgpr_read_b32 v229, a89
    v_mfma_f32_16x16x32_bf16 a[0:3], v[192:195], v[48:51], a[0:3]
    s_add_u32 s34, s34, 16384
    s_cmp_eq_u32 s34, 163840
    s_cselect_b32 s34, 0, s34
    ds_read_b64_tr_b16 v[208:209], v232 offset:4096
    v_accvgpr_read_b32 v230, a90
    v_mfma_f32_16x16x32_bf16 a[4:7], v[192:195], v[52:55], a[4:7]
    s_sub_u32 s50, s34, s36
    ds_read_b64_tr_b16 v[210:211], v232 offset:6144
    v_accvgpr_read_b32 v231, a91
    v_mfma_f32_16x16x32_bf16 a[8:11], v[192:195], v[56:59], a[8:11]
    s_waitcnt lgkmcnt(6)
    v_cvt_pk_bf16_f32 v252, v224, v225
    v_cvt_pk_bf16_f32 v253, v226, v227
    v_mfma_f32_16x16x32_bf16 a[12:15], v[196:199], v[48:51], a[12:15]
    s_mov_b32 s36, s34
    ds_read_b64_tr_b16 v[212:213], v233 offset:4096
    v_cvt_pk_bf16_f32 v254, v228, v229
    v_mfma_f32_16x16x32_bf16 a[16:19], v[196:199], v[52:55], a[16:19]
    s_add_u32 m0, s33, s32
    ds_read_b64_tr_b16 v[214:215], v233 offset:6144
    v_cvt_pk_bf16_f32 v255, v230, v231
    v_mfma_f32_16x16x32_bf16 a[20:23], v[196:199], v[56:59], a[20:23]
    s_waitcnt lgkmcnt(6)
    buffer_load_dwordx4 v240, s[16:19], s39 offen offset:0 lds
    v_mfma_f32_16x16x32_bf16 a[24:27], v[200:203], v[48:51], a[24:27]
    s_add_u32 s55, s48, 4096
    ds_read_b64_tr_b16 v[216:217], v234 offset:4096
    v_mfma_f32_16x16x32_bf16 a[28:31], v[200:203], v[52:55], a[28:31]
    ds_read_b64_tr_b16 v[218:219], v234 offset:6144
    v_mfma_f32_16x16x32_bf16 a[32:35], v[200:203], v[56:59], a[32:35]
    s_waitcnt lgkmcnt(6)
    buffer_store_dwordx4 v[252:255], v250, s[24:27], s55 offen sc1
    v_mfma_f32_16x16x32_bf16 a[36:39], v[204:207], v[48:51], a[36:39]
    ds_read_b64_tr_b16 v[220:221], v235 offset:4096
    v_accvgpr_read_b32 v224, a80
    v_mfma_f32_16x16x32_bf16 a[40:43], v[204:207], v[52:55], a[40:43]
    ds_read_b64_tr_b16 v[222:223], v235 offset:6144
    v_accvgpr_read_b32 v225, a81
    v_mfma_f32_16x16x32_bf16 a[44:47], v[204:207], v[56:59], a[44:47]
    s_waitcnt lgkmcnt(6)
    v_accvgpr_read_b32 v226, a82
    v_accvgpr_read_b32 v227, a83
    v_mfma_f32_16x16x32_bf16 a[0:3], v[208:211], v[60:63], a[0:3]
    ds_read_b64_tr_b16 v[192:193], v232 offset:8192
    v_accvgpr_read_b32 v228, a92
    v_mfma_f32_16x16x32_bf16 a[4:7], v[208:211], v[64:67], a[4:7]
    ds_read_b64_tr_b16 v[194:195], v232 offset:10240
    v_accvgpr_read_b32 v229, a93
    v_mfma_f32_16x16x32_bf16 a[8:11], v[208:211], v[68:71], a[8:11]
    s_waitcnt lgkmcnt(6)
    buffer_load_dwordx4 v241, s[16:19], s39 offen offset:1024 lds
    v_mfma_f32_16x16x32_bf16 a[12:15], v[212:215], v[60:63], a[12:15]
    ds_read_b64_tr_b16 v[196:197], v233 offset:8192
    v_accvgpr_read_b32 v230, a94
    v_mfma_f32_16x16x32_bf16 a[16:19], v[212:215], v[64:67], a[16:19]
    ds_read_b64_tr_b16 v[198:199], v233 offset:10240
    v_accvgpr_read_b32 v231, a95
    v_mfma_f32_16x16x32_bf16 a[20:23], v[212:215], v[68:71], a[20:23]
    s_waitcnt lgkmcnt(6)
    v_cvt_pk_bf16_f32 v236, v224, v225
    v_cvt_pk_bf16_f32 v237, v226, v227
    v_mfma_f32_16x16x32_bf16 a[24:27], v[216:219], v[60:63], a[24:27]
    ds_read_b64_tr_b16 v[200:201], v234 offset:8192
    v_cvt_pk_bf16_f32 v238, v228, v229
    v_mfma_f32_16x16x32_bf16 a[28:31], v[216:219], v[64:67], a[28:31]
    ds_read_b64_tr_b16 v[202:203], v234 offset:10240
    v_cvt_pk_bf16_f32 v239, v230, v231
    v_mfma_f32_16x16x32_bf16 a[32:35], v[216:219], v[68:71], a[32:35]
    s_waitcnt lgkmcnt(6)
    v_cvt_pk_bf16_f32 v40, v32, v33
    v_cvt_pk_bf16_f32 v41, v34, v35
    v_mfma_f32_16x16x32_bf16 a[36:39], v[220:223], v[60:63], a[36:39]
    s_add_u32 s55, s48, 5120
    ds_read_b64_tr_b16 v[204:205], v235 offset:8192
    v_cvt_pk_bf16_f32 v42, v36, v37
    v_mfma_f32_16x16x32_bf16 a[40:43], v[220:223], v[64:67], a[40:43]
    ds_read_b64_tr_b16 v[206:207], v235 offset:10240
    v_cvt_pk_bf16_f32 v43, v38, v39
    v_mfma_f32_16x16x32_bf16 a[44:47], v[220:223], v[68:71], a[44:47]
    s_waitcnt lgkmcnt(6)
    buffer_store_dwordx4 v[236:239], v250, s[24:27], s55 offen sc1
    v_mfma_f32_16x16x32_bf16 a[0:3], v[192:195], v[72:75], a[0:3]
    s_add_u32 s48, s48, 6144
    ds_read_b64_tr_b16 v[208:209], v232 offset:12288
    v_mfma_f32_16x16x32_bf16 a[4:7], v[192:195], v[76:79], a[4:7]
    ds_read_b64_tr_b16 v[210:211], v232 offset:14336
    v_add_u32 v232, s50, v232
    v_mfma_f32_16x16x32_bf16 a[8:11], v[192:195], v[80:83], a[8:11]
    s_waitcnt lgkmcnt(6)
    buffer_load_dwordx4 v242, s[16:19], s39 offen offset:2048 lds
    v_mfma_f32_16x16x32_bf16 a[12:15], v[196:199], v[72:75], a[12:15]
    ds_read_b64_tr_b16 v[212:213], v233 offset:12288
    v_mfma_f32_16x16x32_bf16 a[16:19], v[196:199], v[76:79], a[16:19]
    ds_read_b64_tr_b16 v[214:215], v233 offset:14336
    v_add_u32 v233, s50, v233
    v_mfma_f32_16x16x32_bf16 a[20:23], v[196:199], v[80:83], a[20:23]
    s_waitcnt lgkmcnt(6)
    buffer_store_dwordx2 v[40:41], v247, s[12:15], s73 offen
    v_mfma_f32_16x16x32_bf16 a[24:27], v[200:203], v[72:75], a[24:27]
    ds_read_b64_tr_b16 v[216:217], v234 offset:12288
    v_mfma_f32_16x16x32_bf16 a[28:31], v[200:203], v[76:79], a[28:31]
    ds_read_b64_tr_b16 v[218:219], v234 offset:14336
    v_add_u32 v234, s50, v234
    v_mfma_f32_16x16x32_bf16 a[32:35], v[200:203], v[80:83], a[32:35]
    s_waitcnt lgkmcnt(6)
    buffer_store_dwordx2 v[42:43], v247, s[12:15], s73 offen offset:32
    v_mfma_f32_16x16x32_bf16 a[36:39], v[204:207], v[72:75], a[36:39]
    ds_read_b64_tr_b16 v[220:221], v235 offset:12288
    v_mfma_f32_16x16x32_bf16 a[40:43], v[204:207], v[76:79], a[40:43]
    ds_read_b64_tr_b16 v[222:223], v235 offset:14336
    v_add_u32 v235, s50, v235
    v_mfma_f32_16x16x32_bf16 a[44:47], v[204:207], v[80:83], a[44:47]
    s_waitcnt lgkmcnt(6)
    s_waitcnt vmcnt(54)
    s_barrier
    buffer_load_dwordx4 v243, s[16:19], s39 offen offset:3072 lds
    v_mfma_f32_16x16x32_bf16 a[0:3], v[208:211], v[84:87], a[0:3]
    s_add_u32 s33, s33, 16384
    s_cmp_eq_u32 s33, 163840
    s_cselect_b32 s33, 0, s33
    ds_read_b64_tr_b16 v[192:193], v232 offset:0
    v_mfma_f32_16x16x32_bf16 a[4:7], v[208:211], v[88:91], a[4:7]
    s_add_u32 s39, s39, s42
    ds_read_b64_tr_b16 v[194:195], v232 offset:2048
    v_mfma_f32_16x16x32_bf16 a[8:11], v[208:211], v[92:95], a[8:11]
    s_waitcnt lgkmcnt(6)
    v_mfma_f32_16x16x32_bf16 a[12:15], v[212:215], v[84:87], a[12:15]
    ds_read_b64_tr_b16 v[196:197], v233 offset:0
    v_mfma_f32_16x16x32_bf16 a[16:19], v[212:215], v[88:91], a[16:19]
    ds_read_b64_tr_b16 v[198:199], v233 offset:2048
    v_mfma_f32_16x16x32_bf16 a[20:23], v[212:215], v[92:95], a[20:23]
    s_waitcnt lgkmcnt(6)
    v_mfma_f32_16x16x32_bf16 a[24:27], v[216:219], v[84:87], a[24:27]
    ds_read_b64_tr_b16 v[200:201], v234 offset:0
    v_mfma_f32_16x16x32_bf16 a[28:31], v[216:219], v[88:91], a[28:31]
    ds_read_b64_tr_b16 v[202:203], v234 offset:2048
    v_mfma_f32_16x16x32_bf16 a[32:35], v[216:219], v[92:95], a[32:35]
    s_waitcnt lgkmcnt(6)
    v_mfma_f32_16x16x32_bf16 a[36:39], v[220:223], v[84:87], a[36:39]
    ds_read_b64_tr_b16 v[204:205], v235 offset:0
    v_mfma_f32_16x16x32_bf16 a[40:43], v[220:223], v[88:91], a[40:43]
    ds_read_b64_tr_b16 v[206:207], v235 offset:2048
    v_mfma_f32_16x16x32_bf16 a[44:47], v[220:223], v[92:95], a[44:47]
    s_waitcnt lgkmcnt(6)
    v_mfma_f32_16x16x32_bf16 a[0:3], v[192:195], v[96:99], a[0:3]
    s_add_u32 s34, s34, 16384
    s_cmp_eq_u32 s34, 163840
    s_cselect_b32 s34, 0, s34
    ds_read_b64_tr_b16 v[208:209], v232 offset:4096
    v_mfma_f32_16x16x32_bf16 a[4:7], v[192:195], v[100:103], a[4:7]
    s_sub_u32 s50, s34, s36
    ds_read_b64_tr_b16 v[210:211], v232 offset:6144
    v_mfma_f32_16x16x32_bf16 a[8:11], v[192:195], v[104:107], a[8:11]
    s_waitcnt lgkmcnt(6)
    v_mfma_f32_16x16x32_bf16 a[12:15], v[196:199], v[96:99], a[12:15]
    s_mov_b32 s36, s34
    ds_read_b64_tr_b16 v[212:213], v233 offset:4096
    v_mfma_f32_16x16x32_bf16 a[16:19], v[196:199], v[100:103], a[16:19]
    s_add_u32 m0, s33, s32
    ds_read_b64_tr_b16 v[214:215], v233 offset:6144
    v_mfma_f32_16x16x32_bf16 a[20:23], v[196:199], v[104:107], a[20:23]
    s_waitcnt lgkmcnt(6)
    buffer_load_dwordx4 v240, s[16:19], s39 offen offset:0 lds
    v_mfma_f32_16x16x32_bf16 a[24:27], v[200:203], v[96:99], a[24:27]
    s_sub_u32 s71, s60, 3
    ds_read_b64_tr_b16 v[216:217], v234 offset:4096
    v_mfma_f32_16x16x32_bf16 a[28:31], v[200:203], v[100:103], a[28:31]
    s_sub_u32 s70, s52, s71
    ds_read_b64_tr_b16 v[218:219], v234 offset:6144
    v_mfma_f32_16x16x32_bf16 a[32:35], v[200:203], v[104:107], a[32:35]
    s_waitcnt lgkmcnt(6)
    v_mfma_f32_16x16x32_bf16 a[36:39], v[204:207], v[96:99], a[36:39]
    s_and_b32 s70, s70, 3
    ds_read_b64_tr_b16 v[220:221], v235 offset:4096
    v_mfma_f32_16x16x32_bf16 a[40:43], v[204:207], v[100:103], a[40:43]
    s_mul_i32 s61, s71, 6144
    ds_read_b64_tr_b16 v[222:223], v235 offset:6144
    v_mfma_f32_16x16x32_bf16 a[44:47], v[204:207], v[104:107], a[44:47]
    s_waitcnt lgkmcnt(6)
    v_mfma_f32_16x16x32_bf16 a[0:3], v[208:211], v[108:111], a[0:3]
    s_lshl_b32 s69, s70, 10
    ds_read_b64_tr_b16 v[192:193], v232 offset:8192
    v_mfma_f32_16x16x32_bf16 a[4:7], v[208:211], v[112:115], a[4:7]
    s_add_u32 s61, s61, s69
    ds_read_b64_tr_b16 v[194:195], v232 offset:10240
    v_mfma_f32_16x16x32_bf16 a[8:11], v[208:211], v[116:119], a[8:11]
    s_waitcnt lgkmcnt(6)
    buffer_load_dwordx4 v241, s[16:19], s39 offen offset:1024 lds
    v_mfma_f32_16x16x32_bf16 a[12:15], v[212:215], v[108:111], a[12:15]
    s_add_u32 s61, s61, s66
    ds_read_b64_tr_b16 v[196:197], v233 offset:8192
    v_mfma_f32_16x16x32_bf16 a[16:19], v[212:215], v[112:115], a[16:19]
    s_mul_i32 s62, s70, 28672
    ds_read_b64_tr_b16 v[198:199], v233 offset:10240
    v_mfma_f32_16x16x32_bf16 a[20:23], v[212:215], v[116:119], a[20:23]
    s_waitcnt lgkmcnt(6)
    v_mfma_f32_16x16x32_bf16 a[24:27], v[216:219], v[108:111], a[24:27]
    s_lshl_b32 s69, s71, 7
    ds_read_b64_tr_b16 v[200:201], v234 offset:8192
    v_mfma_f32_16x16x32_bf16 a[28:31], v[216:219], v[112:115], a[28:31]
    s_add_u32 s62, s62, s69
    ds_read_b64_tr_b16 v[202:203], v234 offset:10240
    v_mfma_f32_16x16x32_bf16 a[32:35], v[216:219], v[116:119], a[32:35]
    s_waitcnt lgkmcnt(6)
    v_mfma_f32_16x16x32_bf16 a[36:39], v[220:223], v[108:111], a[36:39]
    s_add_u32 s62, s62, s67
    ds_read_b64_tr_b16 v[204:205], v235 offset:8192
    v_mfma_f32_16x16x32_bf16 a[40:43], v[220:223], v[112:115], a[40:43]
    s_cmp_lt_u32 s70, 3
    s_cselect_b32 s61, s61, 0x7f000000
    s_cselect_b32 s62, s62, 0x7f000000
    ds_read_b64_tr_b16 v[206:207], v235 offset:10240
    v_mfma_f32_16x16x32_bf16 a[44:47], v[220:223], v[116:119], a[44:47]
    s_waitcnt lgkmcnt(6)
    v_mfma_f32_16x16x32_bf16 a[0:3], v[192:195], v[120:123], a[0:3]
    s_cmp_ge_u32 s60, 3
    s_cselect_b32 s61, s61, 0x7f000000
    s_cselect_b32 s62, s62, 0x7f000000
    ds_read_b64_tr_b16 v[208:209], v232 offset:12288
    v_mfma_f32_16x16x32_bf16 a[4:7], v[192:195], v[124:127], a[4:7]
    ds_read_b64_tr_b16 v[210:211], v232 offset:14336
    v_add_u32 v232, s50, v232
    v_mfma_f32_16x16x32_bf16 a[8:11], v[192:195], v[128:131], a[8:11]
    s_waitcnt lgkmcnt(6)
    buffer_load_dwordx4 v242, s[16:19], s39 offen offset:2048 lds
    v_mfma_f32_16x16x32_bf16 a[12:15], v[196:199], v[120:123], a[12:15]
    ds_read_b64_tr_b16 v[212:213], v233 offset:12288
    v_mfma_f32_16x16x32_bf16 a[16:19], v[196:199], v[124:127], a[16:19]
    ds_read_b64_tr_b16 v[214:215], v233 offset:14336
    v_add_u32 v233, s50, v233
    v_mfma_f32_16x16x32_bf16 a[20:23], v[196:199], v[128:131], a[20:23]
    s_waitcnt lgkmcnt(6)
    buffer_load_dwordx4 v[0:3], v250, s[24:27], s61 offen sc1
    v_mfma_f32_16x16x32_bf16 a[24:27], v[200:203], v[120:123], a[24:27]
    s_add_u32 s61, s61, 172032
    ds_read_b64_tr_b16 v[216:217], v234 offset:12288
    v_mfma_f32_16x16x32_bf16 a[28:31], v[200:203], v[124:127], a[28:31]
    ds_read_b64_tr_b16 v[218:219], v234 offset:14336
    v_add_u32 v234, s50, v234
    v_mfma_f32_16x16x32_bf16 a[32:35], v[200:203], v[128:131], a[32:35]
    s_waitcnt lgkmcnt(6)
    buffer_load_dwordx4 v[4:7], v250, s[24:27], s61 offen sc1
    v_mfma_f32_16x16x32_bf16 a[36:39], v[204:207], v[120:123], a[36:39]
    s_add_u32 s61, s61, 172032
    ds_read_b64_tr_b16 v[220:221], v235 offset:12288
    v_mfma_f32_16x16x32_bf16 a[40:43], v[204:207], v[124:127], a[40:43]
    ds_read_b64_tr_b16 v[222:223], v235 offset:14336
    v_add_u32 v235, s50, v235
    v_mfma_f32_16x16x32_bf16 a[44:47], v[204:207], v[128:131], a[44:47]
    s_waitcnt lgkmcnt(6)
    s_waitcnt vmcnt(56)
    s_barrier
    buffer_load_dwordx4 v243, s[16:19], s39 offen offset:3072 lds
    v_mfma_f32_16x16x32_bf16 a[0:3], v[208:211], v[132:135], a[0:3]
    s_add_u32 s33, s33, 16384
    s_cmp_eq_u32 s33, 163840
    s_cselect_b32 s33, 0, s33
    ds_read_b64_tr_b16 v[192:193], v232 offset:0
    v_mfma_f32_16x16x32_bf16 a[4:7], v[208:211], v[136:139], a[4:7]
    s_add_u32 s39, s39, s42
    ds_read_b64_tr_b16 v[194:195], v232 offset:2048
    v_mfma_f32_16x16x32_bf16 a[8:11], v[208:211], v[140:143], a[8:11]
    s_waitcnt lgkmcnt(6)
    buffer_load_dwordx4 v[8:11], v250, s[24:27], s61 offen sc1
    v_mfma_f32_16x16x32_bf16 a[12:15], v[212:215], v[132:135], a[12:15]
    s_add_u32 s61, s61, 172032
    ds_read_b64_tr_b16 v[196:197], v233 offset:0
    v_mfma_f32_16x16x32_bf16 a[16:19], v[212:215], v[136:139], a[16:19]
    ds_read_b64_tr_b16 v[198:199], v233 offset:2048
    v_mfma_f32_16x16x32_bf16 a[20:23], v[212:215], v[140:143], a[20:23]
    s_waitcnt lgkmcnt(6)
    buffer_load_dwordx4 v[12:15], v250, s[24:27], s61 offen sc1
    v_mfma_f32_16x16x32_bf16 a[24:27], v[216:219], v[132:135], a[24:27]
    s_add_u32 s61, s61, 172032
    ds_read_b64_tr_b16 v[200:201], v234 offset:0
    v_mfma_f32_16x16x32_bf16 a[28:31], v[216:219], v[136:139], a[28:31]
    ds_read_b64_tr_b16 v[202:203], v234 offset:2048
    v_mfma_f32_16x16x32_bf16 a[32:35], v[216:219], v[140:143], a[32:35]
    s_waitcnt lgkmcnt(6)
    buffer_load_dwordx4 v[16:19], v250, s[24:27], s61 offen sc1
    v_mfma_f32_16x16x32_bf16 a[36:39], v[220:223], v[132:135], a[36:39]
    s_add_u32 s61, s61, 172032
    ds_read_b64_tr_b16 v[204:205], v235 offset:0
    v_mfma_f32_16x16x32_bf16 a[40:43], v[220:223], v[136:139], a[40:43]
    ds_read_b64_tr_b16 v[206:207], v235 offset:2048
    v_mfma_f32_16x16x32_bf16 a[44:47], v[220:223], v[140:143], a[44:47]
    s_waitcnt lgkmcnt(6)
    buffer_load_dwordx4 v[20:23], v250, s[24:27], s61 offen sc1
    s_add_u32 s61, s61, 172032
    buffer_load_dwordx4 v[24:27], v250, s[24:27], s61 offen sc1
    s_add_u32 s61, s61, 172032
    buffer_load_dwordx4 v[28:31], v250, s[24:27], s61 offen sc1
    s_mov_b32 s73, s62
    v_mfma_f32_16x16x32_bf16 a[0:3], v[192:195], v[144:147], a[0:3]
    s_add_u32 s34, s34, 16384
    s_cmp_eq_u32 s34, 163840
    s_cselect_b32 s34, 0, s34
    ds_read_b64_tr_b16 v[208:209], v232 offset:4096
    v_mfma_f32_16x16x32_bf16 a[4:7], v[192:195], v[148:151], a[4:7]
    s_sub_u32 s50, s34, s36
    ds_read_b64_tr_b16 v[210:211], v232 offset:6144
    v_mfma_f32_16x16x32_bf16 a[8:11], v[192:195], v[152:155], a[8:11]
    s_waitcnt lgkmcnt(6)
    v_mfma_f32_16x16x32_bf16 a[12:15], v[196:199], v[144:147], a[12:15]
    s_mov_b32 s36, s34
    ds_read_b64_tr_b16 v[212:213], v233 offset:4096
    v_mfma_f32_16x16x32_bf16 a[16:19], v[196:199], v[148:151], a[16:19]
    s_add_u32 m0, s33, s32
    ds_read_b64_tr_b16 v[214:215], v233 offset:6144
    v_mfma_f32_16x16x32_bf16 a[20:23], v[196:199], v[152:155], a[20:23]
    s_waitcnt lgkmcnt(6)
    buffer_load_dwordx4 v240, s[16:19], s39 offen offset:0 lds
    v_mfma_f32_16x16x32_bf16 a[24:27], v[200:203], v[144:147], a[24:27]
    ds_read_b64_tr_b16 v[216:217], v234 offset:4096
    v_mfma_f32_16x16x32_bf16 a[28:31], v[200:203], v[148:151], a[28:31]
    ds_read_b64_tr_b16 v[218:219], v234 offset:6144
    v_mfma_f32_16x16x32_bf16 a[32:35], v[200:203], v[152:155], a[32:35]
    s_waitcnt lgkmcnt(6)
    buffer_load_dword v245, v249, s[24:27], s75 offen sc1
    v_mfma_f32_16x16x32_bf16 a[36:39], v[204:207], v[144:147], a[36:39]
    s_add_u32 s60, s60, 1
    ds_read_b64_tr_b16 v[220:221], v235 offset:4096
    v_mfma_f32_16x16x32_bf16 a[40:43], v[204:207], v[148:151], a[40:43]
    ds_read_b64_tr_b16 v[222:223], v235 offset:6144
    v_mfma_f32_16x16x32_bf16 a[44:47], v[204:207], v[152:155], a[44:47]
    s_waitcnt lgkmcnt(6)
    v_mfma_f32_16x16x32_bf16 a[0:3], v[208:211], v[156:159], a[0:3]
    ds_read_b64_tr_b16 v[192:193], v232 offset:8192
    v_mfma_f32_16x16x32_bf16 a[4:7], v[208:211], v[160:163], a[4:7]
    ds_read_b64_tr_b16 v[194:195], v232 offset:10240
    v_mfma_f32_16x16x32_bf16 a[8:11], v[208:211], v[164:167], a[8:11]
    s_waitcnt lgkmcnt(6)
    buffer_load_dwordx4 v241, s[16:19], s39 offen offset:1024 lds
    v_mfma_f32_16x16x32_bf16 a[12:15], v[212:215], v[156:159], a[12:15]
    ds_read_b64_tr_b16 v[196:197], v233 offset:8192
    v_mfma_f32_16x16x32_bf16 a[16:19], v[212:215], v[160:163], a[16:19]
    ds_read_b64_tr_b16 v[198:199], v233 offset:10240
    v_mfma_f32_16x16x32_bf16 a[20:23], v[212:215], v[164:167], a[20:23]
    s_waitcnt lgkmcnt(6)
    v_mfma_f32_16x16x32_bf16 a[24:27], v[216:219], v[156:159], a[24:27]
    ds_read_b64_tr_b16 v[200:201], v234 offset:8192
    v_mfma_f32_16x16x32_bf16 a[28:31], v[216:219], v[160:163], a[28:31]
    ds_read_b64_tr_b16 v[202:203], v234 offset:10240
    v_mfma_f32_16x16x32_bf16 a[32:35], v[216:219], v[164:167], a[32:35]
    s_waitcnt lgkmcnt(6)
    v_mfma_f32_16x16x32_bf16 a[36:39], v[220:223], v[156:159], a[36:39]
    ds_read_b64_tr_b16 v[204:205], v235 offset:8192
    v_mfma_f32_16x16x32_bf16 a[40:43], v[220:223], v[160:163], a[40:43]
    ds_read_b64_tr_b16 v[206:207], v235 offset:10240
    v_mfma_f32_16x16x32_bf16 a[44:47], v[220:223], v[164:167], a[44:47]
    s_waitcnt lgkmcnt(6)
    v_mfma_f32_16x16x32_bf16 a[0:3], v[192:195], v[168:171], a[0:3]
    ds_read_b64_tr_b16 v[208:209], v232 offset:12288
    v_mfma_f32_16x16x32_bf16 a[4:7], v[192:195], v[172:175], a[4:7]
    ds_read_b64_tr_b16 v[210:211], v232 offset:14336
    v_add_u32 v232, s50, v232
    v_mfma_f32_16x16x32_bf16 a[8:11], v[192:195], v[176:179], a[8:11]
    s_waitcnt lgkmcnt(6)
    buffer_load_dwordx4 v242, s[16:19], s39 offen offset:2048 lds
    v_mfma_f32_16x16x32_bf16 a[12:15], v[196:199], v[168:171], a[12:15]
    ds_read_b64_tr_b16 v[212:213], v233 offset:12288
    v_mfma_f32_16x16x32_bf16 a[16:19], v[196:199], v[172:175], a[16:19]
    ds_read_b64_tr_b16 v[214:215], v233 offset:14336
    v_add_u32 v233, s50, v233
    v_mfma_f32_16x16x32_bf16 a[20:23], v[196:199], v[176:179], a[20:23]
    s_waitcnt lgkmcnt(6)
    v_mfma_f32_16x16x32_bf16 a[24:27], v[200:203], v[168:171], a[24:27]
    ds_read_b64_tr_b16 v[216:217], v234 offset:12288
    v_mfma_f32_16x16x32_bf16 a[28:31], v[200:203], v[172:175], a[28:31]
    ds_read_b64_tr_b16 v[218:219], v234 offset:14336
    v_add_u32 v234, s50, v234
    v_mfma_f32_16x16x32_bf16 a[32:35], v[200:203], v[176:179], a[32:35]
    s_waitcnt lgkmcnt(6)
    v_mfma_f32_16x16x32_bf16 a[36:39], v[204:207], v[168:171], a[36:39]
    ds_read_b64_tr_b16 v[220:221], v235 offset:12288
    v_mfma_f32_16x16x32_bf16 a[40:43], v[204:207], v[172:175], a[40:43]
    ds_read_b64_tr_b16 v[222:223], v235 offset:14336
    v_add_u32 v235, s50, v235
    v_mfma_f32_16x16x32_bf16 a[44:47], v[204:207], v[176:179], a[44:47]
    s_waitcnt lgkmcnt(6)
    s_waitcnt vmcnt(62)
    s_barrier
    buffer_load_dwordx4 v243, s[16:19], s39 offen offset:3072 lds
    v_mfma_f32_16x16x32_bf16 a[0:3], v[208:211], v[180:183], a[0:3]
    s_add_u32 s33, s33, 16384
    s_cmp_eq_u32 s33, 163840
    s_cselect_b32 s33, 0, s33
    ds_read_b64_tr_b16 v[192:193], v232 offset:0
    v_mfma_f32_16x16x32_bf16 a[4:7], v[208:211], v[184:187], a[4:7]
    s_add_u32 s39, s39, s43
    ds_read_b64_tr_b16 v[194:195], v232 offset:2048
    v_mfma_f32_16x16x32_bf16 a[8:11], v[208:211], v[188:191], a[8:11]
    s_waitcnt lgkmcnt(6)
    v_mfma_f32_16x16x32_bf16 a[12:15], v[212:215], v[180:183], a[12:15]
    ds_read_b64_tr_b16 v[196:197], v233 offset:0
    v_mfma_f32_16x16x32_bf16 a[16:19], v[212:215], v[184:187], a[16:19]
    ds_read_b64_tr_b16 v[198:199], v233 offset:2048
    v_mfma_f32_16x16x32_bf16 a[20:23], v[212:215], v[188:191], a[20:23]
    s_waitcnt lgkmcnt(6)
    v_mfma_f32_16x16x32_bf16 a[24:27], v[216:219], v[180:183], a[24:27]
    ds_read_b64_tr_b16 v[200:201], v234 offset:0
    v_mfma_f32_16x16x32_bf16 a[28:31], v[216:219], v[184:187], a[28:31]
    ds_read_b64_tr_b16 v[202:203], v234 offset:2048
    v_mfma_f32_16x16x32_bf16 a[32:35], v[216:219], v[188:191], a[32:35]
    s_waitcnt lgkmcnt(6)
    v_mfma_f32_16x16x32_bf16 a[36:39], v[220:223], v[180:183], a[36:39]
    ds_read_b64_tr_b16 v[204:205], v235 offset:0
    v_mfma_f32_16x16x32_bf16 a[40:43], v[220:223], v[184:187], a[40:43]
    ds_read_b64_tr_b16 v[206:207], v235 offset:2048
    v_mfma_f32_16x16x32_bf16 a[44:47], v[220:223], v[188:191], a[44:47]
    s_waitcnt lgkmcnt(6)
    s_sub_u32 s31, s31, 1
    s_cmp_lg_u32 s31, 0
    s_cbranch_scc1 L_p4l
    v_mfma_f32_16x16x32_bf16 a[48:51], v[192:195], a[208:211], 0
    s_add_u32 s34, s34, 16384
    s_cmp_eq_u32 s34, 163840
    s_cselect_b32 s34, 0, s34
    ds_read_b64_tr_b16 v[208:209], v232 offset:4096
    v_mfma_f32_16x16x32_bf16 a[52:55], v[192:195], a[212:215], 0
    s_sub_u32 s50, s34, s36
    ds_read_b64_tr_b16 v[210:211], v232 offset:6144
    v_mfma_f32_16x16x32_bf16 a[56:59], v[192:195], a[216:219], 0
    s_waitcnt lgkmcnt(6)
    v_mfma_f32_16x16x32_bf16 a[60:63], v[196:199], a[208:211], 0
    s_mov_b32 s36, s34
    ds_read_b64_tr_b16 v[212:213], v233 offset:4096
    v_mfma_f32_16x16x32_bf16 a[64:67], v[196:199], a[212:215], 0
    s_sub_u32 s71, s60, 2
    ds_read_b64_tr_b16 v[214:215], v233 offset:6144
    v_mfma_f32_16x16x32_bf16 a[68:71], v[196:199], a[216:219], 0
    s_waitcnt lgkmcnt(6)
    v_mfma_f32_16x16x32_bf16 a[72:75], v[200:203], a[208:211], 0
    s_lshl_b32 s71, s71, 2
    ds_read_b64_tr_b16 v[216:217], v234 offset:4096
    v_accvgpr_read_b32 v224, a0
    v_mfma_f32_16x16x32_bf16 a[76:79], v[200:203], a[212:215], 0
    s_lshl_b32 s63, 1, s71
    ds_read_b64_tr_b16 v[218:219], v234 offset:6144
    v_accvgpr_read_b32 v225, a1
    v_mfma_f32_16x16x32_bf16 a[80:83], v[200:203], a[216:219], 0
    s_waitcnt lgkmcnt(6)
    v_accvgpr_read_b32 v226, a2
    v_accvgpr_read_b32 v227, a3
    v_mfma_f32_16x16x32_bf16 a[84:87], v[204:207], a[208:211], 0
    s_cmp_ge_u32 s60, 2
    s_cselect_b32 s63, s63, 0
    ds_read_b64_tr_b16 v[220:221], v235 offset:4096
    v_accvgpr_read_b32 v228, a12
    v_mfma_f32_16x16x32_bf16 a[88:91], v[204:207], a[212:215], 0
    s_sub_u32 s64, s71, 4
    ds_read_b64_tr_b16 v[222:223], v235 offset:6144
    v_accvgpr_read_b32 v229, a13
    v_mfma_f32_16x16x32_bf16 a[92:95], v[204:207], a[216:219], 0
    s_waitcnt lgkmcnt(6)
    v_accvgpr_read_b32 v230, a14
    v_accvgpr_read_b32 v231, a15
    v_mfma_f32_16x16x32_bf16 a[48:51], v[208:211], a[220:223], a[48:51]
    s_and_b32 s64, s64, 31
    ds_read_b64_tr_b16 v[192:193], v232 offset:8192
    v_cvt_pk_bf16_f32 v252, v224, v225
    v_mfma_f32_16x16x32_bf16 a[52:55], v[208:211], a[224:227], a[52:55]
    s_cmp_ge_u32 s60, 3
    s_cselect_b32 s65, 8, 0
    ds_read_b64_tr_b16 v[194:195], v232 offset:10240
    v_cvt_pk_bf16_f32 v253, v226, v227
    v_mfma_f32_16x16x32_bf16 a[56:59], v[208:211], a[228:231], a[56:59]
    s_waitcnt lgkmcnt(6)
    v_cvt_pk_bf16_f32 v254, v228, v229
    v_cvt_pk_bf16_f32 v255, v230, v231
    v_mfma_f32_16x16x32_bf16 a[60:63], v[212:215], a[220:223], a[60:63]
    s_cmp_eq_u32 s52, 0
    s_cselect_b32 s65, s65, 0
    ds_read_b64_tr_b16 v[196:197], v233 offset:8192
    v_mfma_f32_16x16x32_bf16 a[64:67], v[212:215], a[224:227], a[64:67]
    s_add_u32 s55, s48, 0
    ds_read_b64_tr_b16 v[198:199], v233 offset:10240
    v_mfma_f32_16x16x32_bf16 a[68:71], v[212:215], a[228:231], a[68:71]
    s_waitcnt lgkmcnt(6)
    buffer_store_dwordx4 v[252:255], v250, s[24:27], s55 offen sc1
    v_mfma_f32_16x16x32_bf16 a[72:75], v[216:219], a[220:223], a[72:75]
    ds_read_b64_tr_b16 v[200:201], v234 offset:8192
    v_accvgpr_read_b32 v224, a4
    v_mfma_f32_16x16x32_bf16 a[76:79], v[216:219], a[224:227], a[76:79]
    ds_read_b64_tr_b16 v[202:203], v234 offset:10240
    v_accvgpr_read_b32 v225, a5
    v_mfma_f32_16x16x32_bf16 a[80:83], v[216:219], a[228:231], a[80:83]
    s_waitcnt lgkmcnt(6)
    v_accvgpr_read_b32 v226, a6
    v_accvgpr_read_b32 v227, a7
    v_mfma_f32_16x16x32_bf16 a[84:87], v[220:223], a[220:223], a[84:87]
    ds_read_b64_tr_b16 v[204:205], v235 offset:8192
    v_accvgpr_read_b32 v228, a16
    v_mfma_f32_16x16x32_bf16 a[88:91], v[220:223], a[224:227], a[88:91]
    ds_read_b64_tr_b16 v[206:207], v235 offset:10240
    v_accvgpr_read_b32 v229, a17
    v_mfma_f32_16x16x32_bf16 a[92:95], v[220:223], a[228:231], a[92:95]
    s_waitcnt lgkmcnt(6)
    v_accvgpr_read_b32 v230, a18
    v_accvgpr_read_b32 v231, a19
    v_mfma_f32_16x16x32_bf16 a[48:51], v[192:195], a[232:235], a[48:51]
    ds_read_b64_tr_b16 v[208:209], v232 offset:12288
    v_cvt_pk_bf16_f32 v236, v224, v225
    v_mfma_f32_16x16x32_bf16 a[52:55], v[192:195], a[236:239], a[52:55]
    ds_read_b64_tr_b16 v[210:211], v232 offset:14336
    v_add_u32 v232, s50, v232
    v_mfma_f32_16x16x32_bf16 a[56:59], v[192:195], a[240:243], a[56:59]
    s_waitcnt lgkmcnt(6)
    v_cvt_pk_bf16_f32 v237, v226, v227
    v_cvt_pk_bf16_f32 v238, v228, v229
    v_mfma_f32_16x16x32_bf16 a[60:63], v[196:199], a[232:235], a[60:63]
    ds_read_b64_tr_b16 v[212:213], v233 offset:12288
    v_cvt_pk_bf16_f32 v239, v230, v231
    v_mfma_f32_16x16x32_bf16 a[64:67], v[196:199], a[236:239], a[64:67]
    s_add_u32 s55, s48, 1024
    ds_read_b64_tr_b16 v[214:215], v233 offset:14336
    v_add_u32 v233, s50, v233
    v_mfma_f32_16x16x32_bf16 a[68:71], v[196:199], a[240:243], a[68:71]
    s_waitcnt lgkmcnt(6)
    buffer_store_dwordx4 v[236:239], v250, s[24:27], s55 offen sc1
    v_mfma_f32_16x16x32_bf16 a[72:75], v[200:203], a[232:235], a[72:75]
    ds_read_b64_tr_b16 v[216:217], v234 offset:12288
    v_accvgpr_read_b32 v224, a8
    v_mfma_f32_16x16x32_bf16 a[76:79], v[200:203], a[236:239], a[76:79]
    ds_read_b64_tr_b16 v[218:219], v234 offset:14336
    v_add_u32 v234, s50, v234
    v_mfma_f32_16x16x32_bf16 a[80:83], v[200:203], a[240:243], a[80:83]
    s_waitcnt lgkmcnt(6)
    v_accvgpr_read_b32 v225, a9
    v_accvgpr_read_b32 v226, a10
    v_mfma_f32_16x16x32_bf16 a[84:87], v[204:207], a[232:235], a[84:87]
    ds_read_b64_tr_b16 v[220:221], v235 offset:12288
    v_accvgpr_read_b32 v227, a11
    v_mfma_f32_16x16x32_bf16 a[88:91], v[204:207], a[236:239], a[88:91]
    ds_read_b64_tr_b16 v[222:223], v235 offset:14336
    v_add_u32 v235, s50, v235
    v_mfma_f32_16x16x32_bf16 a[92:95], v[204:207], a[240:243], a[92:95]
    s_waitcnt lgkmcnt(6)
    s_waitcnt vmcnt(5)
    v_readfirstlane_b32 s69, v245
    s_nop 0
    s_lshr_b32 s69, s69, s64
    s_and_b32 s69, s69, 15
    s_cmp_ge_u32 s69, s65
    s_cbranch_scc0 L_spin3
L_spun3:
    s_barrier
    v_accvgpr_read_b32 v228, a20
    v_accvgpr_read_b32 v229, a21
    v_mfma_f32_16x16x32_bf16 a[48:51], v[208:211], a[244:247], a[48:51]
    ds_read_b64_tr_b16 v[192:193], v232 offset:0
    v_accvgpr_read_b32 v230, a22
    v_mfma_f32_16x16x32_bf16 a[52:55], v[208:211], a[248:251], a[52:55]
    ds_read_b64_tr_b16 v[194:195], v232 offset:2048
    v_mov_b32 v244, s63
    v_mfma_f32_16x16x32_bf16 a[56:59], v[208:211], v[44:47], a[56:59]
    s_waitcnt lgkmcnt(6)
    v_accvgpr_read_b32 v231, a23
    v_cvt_pk_bf16_f32 v252, v224, v225
    v_mfma_f32_16x16x32_bf16 a[60:63], v[212:215], a[244:247], a[60:63]
    ds_read_b64_tr_b16 v[196:197], v233 offset:0
    v_cvt_pk_bf16_f32 v253, v226, v227
    v_mfma_f32_16x16x32_bf16 a[64:67], v[212:215], a[248:251], a[64:67]
    ds_read_b64_tr_b16 v[198:199], v233 offset:2048
    buffer_atomic_add v244, v246, s[24:27], s75 offen sc1
    v_mfma_f32_16x16x32_bf16 a[68:71], v[212:215], v[44:47], a[68:71]
    s_waitcnt lgkmcnt(6)
    v_cvt_pk_bf16_f32 v254, v228, v229
    v_cvt_pk_bf16_f32 v255, v230, v231
    v_mfma_f32_16x16x32_bf16 a[72:75], v[216:219], a[244:247], a[72:75]
    s_add_u32 s55, s48, 2048
    ds_read_b64_tr_b16 v[200:201], v234 offset:0
    v_mfma_f32_16x16x32_bf16 a[76:79], v[216:219], a[248:251], a[76:79]
    ds_read_b64_tr_b16 v[202:203], v234 offset:2048
    v_mfma_f32_16x16x32_bf16 a[80:83], v[216:219], v[44:47], a[80:83]
    s_waitcnt lgkmcnt(6)
    buffer_store_dwordx4 v[252:255], v250, s[24:27], s55 offen sc1
    v_mfma_f32_16x16x32_bf16 a[84:87], v[220:223], a[244:247], a[84:87]
    ds_read_b64_tr_b16 v[204:205], v235 offset:0
    v_mfma_f32_16x16x32_bf16 a[88:91], v[220:223], a[248:251], a[88:91]
    ds_read_b64_tr_b16 v[206:207], v235 offset:2048
    v_mfma_f32_16x16x32_bf16 a[92:95], v[220:223], v[44:47], a[92:95]
    s_waitcnt lgkmcnt(6)
    s_waitcnt vmcnt(9)
    v_mfma_f32_16x16x32_bf16 v[32:35], a[96:99], v[0:3], 0
    v_mfma_f32_16x16x32_bf16 v[36:39], a[100:103], v[0:3], 0
    v_mfma_f32_16x16x32_bf16 v[32:35], a[96:99], v[4:7], v[32:35]
    v_mfma_f32_16x16x32_bf16 v[36:39], a[100:103], v[4:7], v[36:39]
    v_mfma_f32_16x16x32_bf16 v[32:35], a[96:99], v[8:11], v[32:35]
    v_mfma_f32_16x16x32_bf16 v[36:39], a[100:103], v[8:11], v[36:39]
    v_mfma_f32_16x16x32_bf16 v[32:35], a[96:99], v[12:15], v[32:35]
    v_accvgpr_read_b32 v224, a24
    v_accvgpr_read_b32 v225, a25
    v_mfma_f32_16x16x32_bf16 v[36:39], a[100:103], v[12:15], v[36:39]
    v_accvgpr_read_b32 v226, a26
    v_accvgpr_read_b32 v227, a27
    v_mfma_f32_16x16x32_bf16 v[32:35], a[96:99], v[16:19], v[32:35]
    v_accvgpr_read_b32 v228, a36
    v_accvgpr_read_b32 v229, a37
    v_mfma_f32_16x16x32_bf16 v[36:39], a[100:103], v[16:19], v[36:39]
    v_accvgpr_read_b32 v230, a38
    v_accvgpr_read_b32 v231, a39
    v_mfma_f32_16x16x32_bf16 v[32:35], a[96:99], v[20:23], v[32:35]
    v_cvt_pk_bf16_f32 v236, v224, v225
    v_cvt_pk_bf16_f32 v237, v226, v227
    v_mfma_f32_16x16x32_bf16 v[36:39], a[100:103], v[20:23], v[36:39]
    v_cvt_pk_bf16_f32 v238, v228, v229
    v_cvt_pk_bf16_f32 v239, v230, v231
    v_mfma_f32_16x16x32_bf16 v[32:35], a[96:99], v[24:27], v[32:35]
    s_add_u32 s55, s48, 3072
    buffer_store_dwordx4 v[236:239], v250, s[24:27], s55 offen sc1
    v_mfma_f32_16x16x32_bf16 v[36:39], a[100:103], v[24:27], v[36:39]
    v_accvgpr_read_b32 v224, a28
    v_accvgpr_read_b32 v225, a29
    v_mfma_f32_16x16x32_bf16 v[32:35], a[96:99], v[28:31], v[32:35]
    v_accvgpr_read_b32 v226, a30
    v_accvgpr_read_b32 v227, a31
    v_mfma_f32_16x16x32_bf16 v[36:39], a[100:103], v[28:31], v[36:39]
    v_accvgpr_read_b32 v228, a40
    v_accvgpr_read_b32 v229, a41
    v_mfma_f32_16x16x32_bf16 a[48:51], v[192:195], v[48:51], a[48:51]
    s_add_u32 s34, s34, 16384
    s_cmp_eq_u32 s34, 163840
    s_cselect_b32 s34, 0, s34
    ds_read_b64_tr_b16 v[208:209], v232 offset:4096
    v_accvgpr_read_b32 v230, a42
    v_mfma_f32_16x16x32_bf16 a[52:55], v[192:195], v[52:55], a[52:55]
    s_sub_u32 s50, s34, s36
    ds_read_b64_tr_b16 v[210:211], v232 offset:6144
    v_accvgpr_read_b32 v231, a43
    v_mfma_f32_16x16x32_bf16 a[56:59], v[192:195], v[56:59], a[56:59]
    s_waitcnt lgkmcnt(6)
    v_cvt_pk_bf16_f32 v252, v224, v225
    v_cvt_pk_bf16_f32 v253, v226, v227
    v_mfma_f32_16x16x32_bf16 a[60:63], v[196:199], v[48:51], a[60:63]
    s_mov_b32 s36, s34
    ds_read_b64_tr_b16 v[212:213], v233 offset:4096
    v_cvt_pk_bf16_f32 v254, v228, v229
    v_mfma_f32_16x16x32_bf16 a[64:67], v[196:199], v[52:55], a[64:67]
    ds_read_b64_tr_b16 v[214:215], v233 offset:6144
    v_cvt_pk_bf16_f32 v255, v230, v231
    v_mfma_f32_16x16x32_bf16 a[68:71], v[196:199], v[56:59], a[68:71]
    s_waitcnt lgkmcnt(6)
    v_mfma_f32_16x16x32_bf16 a[72:75], v[200:203], v[48:51], a[72:75]
    s_add_u32 s55, s48, 4096
    ds_read_b64_tr_b16 v[216:217], v234 offset:4096
    v_mfma_f32_16x16x32_bf16 a[76:79], v[200:203], v[52:55], a[76:79]
    ds_read_b64_tr_b16 v[218:219], v234 offset:6144
    v_mfma_f32_16x16x32_bf16 a[80:83], v[200:203], v[56:59], a[80:83]
    s_waitcnt lgkmcnt(6)
    buffer_store_dwordx4 v[252:255], v250, s[24:27], s55 offen sc1
    v_mfma_f32_16x16x32_bf16 a[84:87], v[204:207], v[48:51], a[84:87]
    ds_read_b64_tr_b16 v[220:221], v235 offset:4096
    v_accvgpr_read_b32 v224, a32
    v_mfma_f32_16x16x32_bf16 a[88:91], v[204:207], v[52:55], a[88:91]
    ds_read_b64_tr_b16 v[222:223], v235 offset:6144
    v_accvgpr_read_b32 v225, a33
    v_mfma_f32_16x16x32_bf16 a[92:95], v[204:207], v[56:59], a[92:95]
    s_waitcnt lgkmcnt(6)
    v_accvgpr_read_b32 v226, a34
    v_accvgpr_read_b32 v227, a35
    v_mfma_f32_16x16x32_bf16 a[48:51], v[208:211], v[60:63], a[48:51]
    ds_read_b64_tr_b16 v[192:193], v232 offset:8192
    v_accvgpr_read_b32 v228, a44
    v_mfma_f32_16x16x32_bf16 a[52:55], v[208:211], v[64:67], a[52:55]
    ds_read_b64_tr_b16 v[194:195], v232 offset:10240
    v_accvgpr_read_b32 v229, a45
    v_mfma_f32_16x16x32_bf16 a[56:59], v[208:211], v[68:71], a[56:59]
    s_waitcnt lgkmcnt(6)
    v_accvgpr_read_b32 v230, a46
    v_accvgpr_read_b32 v231, a47
    v_mfma_f32_16x16x32_bf16 a[60:63], v[212:215], v[60:63], a[60:63]
    ds_read_b64_tr_b16 v[196:197], v233 offset:8192
    v_cvt_pk_bf16_f32 v236, v224, v225
    v_mfma_f32_16x16x32_bf16 a[64:67], v[212:215], v[64:67], a[64:67]
    ds_read_b64_tr_b16 v[198:199], v233 offset:10240
    v_cvt_pk_bf16_f32 v237, v226, v227
    v_mfma_f32_16x16x32_bf16 a[68:71], v[212:215], v[68:71], a[68:71]
    s_waitcnt lgkmcnt(6)
    v_cvt_pk_bf16_f32 v238, v228, v229
    v_cvt_pk_bf16_f32 v239, v230, v231
    v_mfma_f32_16x16x32_bf16 a[72:75], v[216:219], v[60:63], a[72:75]
    s_add_u32 s55, s48, 5120
    ds_read_b64_tr_b16 v[200:201], v234 offset:8192
    v_cvt_pk_bf16_f32 v40, v32, v33
    v_mfma_f32_16x16x32_bf16 a[76:79], v[216:219], v[64:67], a[76:79]
    ds_read_b64_tr_b16 v[202:203], v234 offset:10240
    v_cvt_pk_bf16_f32 v41, v34, v35
    v_mfma_f32_16x16x32_bf16 a[80:83], v[216:219], v[68:71], a[80:83]
    s_waitcnt lgkmcnt(6)
    buffer_store_dwordx4 v[236:239], v250, s[24:27], s55 offen sc1
    v_mfma_f32_16x16x32_bf16 a[84:87], v[220:223], v[60:63], a[84:87]
    s_add_u32 s48, s48, 6144
    ds_read_b64_tr_b16 v[204:205], v235 offset:8192
    v_cvt_pk_bf16_f32 v42, v36, v37
    v_mfma_f32_16x16x32_bf16 a[88:91], v[220:223], v[64:67], a[88:91]
    ds_read_b64_tr_b16 v[206:207], v235 offset:10240
    v_cvt_pk_bf16_f32 v43, v38, v39
    v_mfma_f32_16x16x32_bf16 a[92:95], v[220:223], v[68:71], a[92:95]
    s_waitcnt lgkmcnt(6)
    buffer_store_dwordx2 v[40:41], v247, s[12:15], s73 offen
    v_mfma_f32_16x16x32_bf16 a[48:51], v[192:195], v[72:75], a[48:51]
    ds_read_b64_tr_b16 v[208:209], v232 offset:12288
    v_mfma_f32_16x16x32_bf16 a[52:55], v[192:195], v[76:79], a[52:55]
    ds_read_b64_tr_b16 v[210:211], v232 offset:14336
    v_add_u32 v232, s50, v232
    v_mfma_f32_16x16x32_bf16 a[56:59], v[192:195], v[80:83], a[56:59]
    s_waitcnt lgkmcnt(6)
    buffer_store_dwordx2 v[42:43], v247, s[12:15], s73 offen offset:32
    v_mfma_f32_16x16x32_bf16 a[60:63], v[196:199], v[72:75], a[60:63]
    ds_read_b64_tr_b16 v[212:213], v233 offset:12288
    v_mfma_f32_16x16x32_bf16 a[64:67], v[196:199], v[76:79], a[64:67]
    ds_read_b64_tr_b16 v[214:215], v233 offset:14336
    v_add_u32 v233, s50, v233
    v_mfma_f32_16x16x32_bf16 a[68:71], v[196:199], v[80:83], a[68:71]
    s_waitcnt lgkmcnt(6)
    v_mfma_f32_16x16x32_bf16 a[72:75], v[200:203], v[72:75], a[72:75]
    ds_read_b64_tr_b16 v[216:217], v234 offset:12288
    v_mfma_f32_16x16x32_bf16 a[76:79], v[200:203], v[76:79], a[76:79]
    ds_read_b64_tr_b16 v[218:219], v234 offset:14336
    v_add_u32 v234, s50, v234
    v_mfma_f32_16x16x32_bf16 a[80:83], v[200:203], v[80:83], a[80:83]
    s_waitcnt lgkmcnt(6)
    v_mfma_f32_16x16x32_bf16 a[84:87], v[204:207], v[72:75], a[84:87]
    ds_read_b64_tr_b16 v[220:221], v235 offset:12288
    v_mfma_f32_16x16x32_bf16 a[88:91], v[204:207], v[76:79], a[88:91]
    ds_read_b64_tr_b16 v[222:223], v235 offset:14336
    v_add_u32 v235, s50, v235
    v_mfma_f32_16x16x32_bf16 a[92:95], v[204:207], v[80:83], a[92:95]
    s_waitcnt lgkmcnt(6)
    s_waitcnt vmcnt(54)
    s_barrier
    v_mfma_f32_16x16x32_bf16 a[48:51], v[208:211], v[84:87], a[48:51]
    ds_read_b64_tr_b16 v[192:193], v232 offset:0
    v_mfma_f32_16x16x32_bf16 a[52:55], v[208:211], v[88:91], a[52:55]
    ds_read_b64_tr_b16 v[194:195], v232 offset:2048
    v_mfma_f32_16x16x32_bf16 a[56:59], v[208:211], v[92:95], a[56:59]
    s_waitcnt lgkmcnt(6)
    v_mfma_f32_16x16x32_bf16 a[60:63], v[212:215], v[84:87], a[60:63]
    ds_read_b64_tr_b16 v[196:197], v233 offset:0
    v_mfma_f32_16x16x32_bf16 a[64:67], v[212:215], v[88:91], a[64:67]
    ds_read_b64_tr_b16 v[198:199], v233 offset:2048
    v_mfma_f32_16x16x32_bf16 a[68:71], v[212:215], v[92:95], a[68:71]
    s_waitcnt lgkmcnt(6)
    v_mfma_f32_16x16x32_bf16 a[72:75], v[216:219], v[84:87], a[72:75]
    ds_read_b64_tr_b16 v[200:201], v234 offset:0
    v_mfma_f32_16x16x32_bf16 a[76:79], v[216:219], v[88:91], a[76:79]
    ds_read_b64_tr_b16 v[202:203], v234 offset:2048
    v_mfma_f32_16x16x32_bf16 a[80:83], v[216:219], v[92:95], a[80:83]
    s_waitcnt lgkmcnt(6)
    v_mfma_f32_16x16x32_bf16 a[84:87], v[220:223], v[84:87], a[84:87]
    ds_read_b64_tr_b16 v[204:205], v235 offset:0
    v_mfma_f32_16x16x32_bf16 a[88:91], v[220:223], v[88:91], a[88:91]
    ds_read_b64_tr_b16 v[206:207], v235 offset:2048
    v_mfma_f32_16x16x32_bf16 a[92:95], v[220:223], v[92:95], a[92:95]
    s_waitcnt lgkmcnt(6)
    v_mfma_f32_16x16x32_bf16 a[48:51], v[192:195], v[96:99], a[48:51]
    s_add_u32 s34, s34, 16384
    s_cmp_eq_u32 s34, 163840
    s_cselect_b32 s34, 0, s34
    ds_read_b64_tr_b16 v[208:209], v232 offset:4096
    v_mfma_f32_16x16x32_bf16 a[52:55], v[192:195], v[100:103], a[52:55]
    s_sub_u32 s50, s34, s36
    ds_read_b64_tr_b16 v[210:211], v232 offset:6144
    v_mfma_f32_16x16x32_bf16 a[56:59], v[192:195], v[104:107], a[56:59]
    s_waitcnt lgkmcnt(6)
    v_mfma_f32_16x16x32_bf16 a[60:63], v[196:199], v[96:99], a[60:63]
    s_mov_b32 s36, s34
    ds_read_b64_tr_b16 v[212:213], v233 offset:4096
    v_mfma_f32_16x16x32_bf16 a[64:67], v[196:199], v[100:103], a[64:67]
    s_sub_u32 s71, s60, 3
    ds_read_b64_tr_b16 v[214:215], v233 offset:6144
    v_mfma_f32_16x16x32_bf16 a[68:71], v[196:199], v[104:107], a[68:71]
    s_waitcnt lgkmcnt(6)
    v_mfma_f32_16x16x32_bf16 a[72:75], v[200:203], v[96:99], a[72:75]
    s_sub_u32 s70, s52, s71
    ds_read_b64_tr_b16 v[216:217], v234 offset:4096
    v_mfma_f32_16x16x32_bf16 a[76:79], v[200:203], v[100:103], a[76:79]
    s_and_b32 s70, s70, 3
    ds_read_b64_tr_b16 v[218:219], v234 offset:6144
    v_mfma_f32_16x16x32_bf16 a[80:83], v[200:203], v[104:107], a[80:83]
    s_waitcnt lgkmcnt(6)
    v_mfma_f32_16x16x32_bf16 a[84:87], v[204:207], v[96:99], a[84:87]
    s_mul_i32 s61, s71, 6144
    ds_read_b64_tr_b16 v[220:221], v235 offset:4096
    v_mfma_f32_16x16x32_bf16 a[88:91], v[204:207], v[100:103], a[88:91]
    s_lshl_b32 s69, s70, 10
    ds_read_b64_tr_b16 v[222:223], v235 offset:6144
    v_mfma_f32_16x16x32_bf16 a[92:95], v[204:207], v[104:107], a[92:95]
    s_waitcnt lgkmcnt(6)
    v_mfma_f32_16x16x32_bf16 a[48:51], v[208:211], v[108:111], a[48:51]
    s_add_u32 s61, s61, s69
    ds_read_b64_tr_b16 v[192:193], v232 offset:8192
    v_mfma_f32_16x16x32_bf16 a[52:55], v[208:211], v[112:115], a[52:55]
    s_add_u32 s61, s61, s66
    ds_read_b64_tr_b16 v[194:195], v232 offset:10240
    v_mfma_f32_16x16x32_bf16 a[56:59], v[208:211], v[116:119], a[56:59]
    s_waitcnt lgkmcnt(6)
    v_mfma_f32_16x16x32_bf16 a[60:63], v[212:215], v[108:111], a[60:63]
    s_mul_i32 s62, s70, 28672
    ds_read_b64_tr_b16 v[196:197], v233 offset:8192
    v_mfma_f32_16x16x32_bf16 a[64:67], v[212:215], v[112:115], a[64:67]
    s_lshl_b32 s69, s71, 7
    ds_read_b64_tr_b16 v[198:199], v233 offset:10240
    v_mfma_f32_16x16x32_bf16 a[68:71], v[212:215], v[116:119], a[68:71]
    s_waitcnt lgkmcnt(6)
    v_mfma_f32_16x16x32_bf16 a[72:75], v[216:219], v[108:111], a[72:75]
    s_add_u32 s62, s62, s69
    ds_read_b64_tr_b16 v[200:201], v234 offset:8192
    v_mfma_f32_16x16x32_bf16 a[76:79], v[216:219], v[112:115], a[76:79]
    s_add_u32 s62, s62, s67
    ds_read_b64_tr_b16 v[202:203], v234 offset:10240
    v_mfma_f32_16x16x32_bf16 a[80:83], v[216:219], v[116:119], a[80:83]
    s_waitcnt lgkmcnt(6)
    v_mfma_f32_16x16x32_bf16 a[84:87], v[220:223], v[108:111], a[84:87]
    s_cmp_lt_u32 s70, 3
    s_cselect_b32 s61, s61, 0x7f000000
    s_cselect_b32 s62, s62, 0x7f000000
    ds_read_b64_tr_b16 v[204:205], v235 offset:8192
    v_mfma_f32_16x16x32_bf16 a[88:91], v[220:223], v[112:115], a[88:91]
    s_cmp_ge_u32 s60, 3
    s_cselect_b32 s61, s61, 0x7f000000
    s_cselect_b32 s62, s62, 0x7f000000
    ds_read_b64_tr_b16 v[206:207], v235 offset:10240
    v_mfma_f32_16x16x32_bf16 a[92:95], v[220:223], v[116:119], a[92:95]
    s_waitcnt lgkmcnt(6)
    buffer_load_dwordx4 v[0:3], v250, s[24:27], s61 offen sc1
    v_mfma_f32_16x16x32_bf16 a[48:51], v[192:195], v[120:123], a[48:51]
    s_add_u32 s61, s61, 172032
    ds_read_b64_tr_b16 v[208:209], v232 offset:12288
    v_mfma_f32_16x16x32_bf16 a[52:55], v[192:195], v[124:127], a[52:55]
    ds_read_b64_tr_b16 v[210:211], v232 offset:14336
    v_add_u32 v232, s50, v232
    v_mfma_f32_16x16x32_bf16 a[56:59], v[192:195], v[128:131], a[56:59]
    s_waitcnt lgkmcnt(6)
    buffer_load_dwordx4 v[4:7], v250, s[24:27], s61 offen sc1
    v_mfma_f32_16x16x32_bf16 a[60:63], v[196:199], v[120:123], a[60:63]
    s_add_u32 s61, s61, 172032
    ds_read_b64_tr_b16 v[212:213], v233 offset:12288
    v_mfma_f32_16x16x32_bf16 a[64:67], v[196:199], v[124:127], a[64:67]
    ds_read_b64_tr_b16 v[214:215], v233 offset:14336
    v_add_u32 v233, s50, v233
    v_mfma_f32_16x16x32_bf16 a[68:71], v[196:199], v[128:131], a[68:71]
    s_waitcnt lgkmcnt(6)
    buffer_load_dwordx4 v[8:11], v250, s[24:27], s61 offen sc1
    v_mfma_f32_16x16x32_bf16 a[72:75], v[200:203], v[120:123], a[72:75]
    s_add_u32 s61, s61, 172032
    ds_read_b64_tr_b16 v[216:217], v234 offset:12288
    v_mfma_f32_16x16x32_bf16 a[76:79], v[200:203], v[124:127], a[76:79]
    ds_read_b64_tr_b16 v[218:219], v234 offset:14336
    v_add_u32 v234, s50, v234
    v_mfma_f32_16x16x32_bf16 a[80:83], v[200:203], v[128:131], a[80:83]
    s_waitcnt lgkmcnt(6)
    buffer_load_dwordx4 v[12:15], v250, s[24:27], s61 offen sc1
    v_mfma_f32_16x16x32_bf16 a[84:87], v[204:207], v[120:123], a[84:87]
    s_add_u32 s61, s61, 172032
    ds_read_b64_tr_b16 v[220:221], v235 offset:12288
    v_mfma_f32_16x16x32_bf16 a[88:91], v[204:207], v[124:127], a[88:91]
    ds_read_b64_tr_b16 v[222:223], v235 offset:14336
    v_add_u32 v235, s50, v235
    v_mfma_f32_16x16x32_bf16 a[92:95], v[204:207], v[128:131], a[92:95]
    s_waitcnt lgkmcnt(6)
    s_waitcnt vmcnt(47)
    s_barrier
    buffer_load_dwordx4 v[16:19], v250, s[24:27], s61 offen sc1
    v_mfma_f32_16x16x32_bf16 a[48:51], v[208:211], v[132:135], a[48:51]
    s_add_u32 s61, s61, 172032
    ds_read_b64_tr_b16 v[192:193], v232 offset:0
    v_mfma_f32_16x16x32_bf16 a[52:55], v[208:211], v[136:139], a[52:55]
    ds_read_b64_tr_b16 v[194:195], v232 offset:2048
    v_mfma_f32_16x16x32_bf16 a[56:59], v[208:211], v[140:143], a[56:59]
    s_waitcnt lgkmcnt(6)
    buffer_load_dwordx4 v[20:23], v250, s[24:27], s61 offen sc1
    v_mfma_f32_16x16x32_bf16 a[60:63], v[212:215], v[132:135], a[60:63]
    s_add_u32 s61, s61, 172032
    ds_read_b64_tr_b16 v[196:197], v233 offset:0
    v_mfma_f32_16x16x32_bf16 a[64:67], v[212:215], v[136:139], a[64:67]
    ds_read_b64_tr_b16 v[198:199], v233 offset:2048
    v_mfma_f32_16x16x32_bf16 a[68:71], v[212:215], v[140:143], a[68:71]
    s_waitcnt lgkmcnt(6)
    buffer_load_dwordx4 v[24:27], v250, s[24:27], s61 offen sc1
    v_mfma_f32_16x16x32_bf16 a[72:75], v[216:219], v[132:135], a[72:75]
    s_add_u32 s61, s61, 172032
    ds_read_b64_tr_b16 v[200:201], v234 offset:0
    v_mfma_f32_16x16x32_bf16 a[76:79], v[216:219], v[136:139], a[76:79]
    ds_read_b64_tr_b16 v[202:203], v234 offset:2048
    v_mfma_f32_16x16x32_bf16 a[80:83], v[216:219], v[140:143], a[80:83]
    s_waitcnt lgkmcnt(6)
    buffer_load_dwordx4 v[28:31], v250, s[24:27], s61 offen sc1
    v_mfma_f32_16x16x32_bf16 a[84:87], v[220:223], v[132:135], a[84:87]
    s_mov_b32 s73, s62
    ds_read_b64_tr_b16 v[204:205], v235 offset:0
    v_mfma_f32_16x16x32_bf16 a[88:91], v[220:223], v[136:139], a[88:91]
    ds_read_b64_tr_b16 v[206:207], v235 offset:2048
    v_mfma_f32_16x16x32_bf16 a[92:95], v[220:223], v[140:143], a[92:95]
    s_waitcnt lgkmcnt(6)
    v_mfma_f32_16x16x32_bf16 a[48:51], v[192:195], v[144:147], a[48:51]
    s_add_u32 s34, s34, 16384
    s_cmp_eq_u32 s34, 163840
    s_cselect_b32 s34, 0, s34
    ds_read_b64_tr_b16 v[208:209], v232 offset:4096
    v_mfma_f32_16x16x32_bf16 a[52:55], v[192:195], v[148:151], a[52:55]
    s_sub_u32 s50, s34, s36
    ds_read_b64_tr_b16 v[210:211], v232 offset:6144
    v_mfma_f32_16x16x32_bf16 a[56:59], v[192:195], v[152:155], a[56:59]
    s_waitcnt lgkmcnt(6)
    v_mfma_f32_16x16x32_bf16 a[60:63], v[196:199], v[144:147], a[60:63]
    s_mov_b32 s36, s34
    ds_read_b64_tr_b16 v[212:213], v233 offset:4096
    v_mfma_f32_16x16x32_bf16 a[64:67], v[196:199], v[148:151], a[64:67]
    ds_read_b64_tr_b16 v[214:215], v233 offset:6144
    v_mfma_f32_16x16x32_bf16 a[68:71], v[196:199], v[152:155], a[68:71]
    s_waitcnt lgkmcnt(6)
    buffer_load_dword v245, v249, s[24:27], s75 offen sc1
    v_mfma_f32_16x16x32_bf16 a[72:75], v[200:203], v[144:147], a[72:75]
    s_add_u32 s60, s60, 1
    ds_read_b64_tr_b16 v[216:217], v234 offset:4096
    v_mfma_f32_16x16x32_bf16 a[76:79], v[200:203], v[148:151], a[76:79]
    ds_read_b64_tr_b16 v[218:219], v234 offset:6144
    v_mfma_f32_16x16x32_bf16 a[80:83], v[200:203], v[152:155], a[80:83]
    s_waitcnt lgkmcnt(6)
    v_mfma_f32_16x16x32_bf16 a[84:87], v[204:207], v[144:147], a[84:87]
    ds_read_b64_tr_b16 v[220:221], v235 offset:4096
    v_mfma_f32_16x16x32_bf16 a[88:91], v[204:207], v[148:151], a[88:91]
    ds_read_b64_tr_b16 v[222:223], v235 offset:6144
    v_mfma_f32_16x16x32_bf16 a[92:95], v[204:207], v[152:155], a[92:95]
    s_waitcnt lgkmcnt(6)
    v_mfma_f32_16x16x32_bf16 a[48:51], v[208:211], v[156:159], a[48:51]
    ds_read_b64_tr_b16 v[192:193], v232 offset:8192
    v_mfma_f32_16x16x32_bf16 a[52:55], v[208:211], v[160:163], a[52:55]
    ds_read_b64_tr_b16 v[194:195], v232 offset:10240
    v_mfma_f32_16x16x32_bf16 a[56:59], v[208:211], v[164:167], a[56:59]
    s_waitcnt lgkmcnt(6)
    v_mfma_f32_16x16x32_bf16 a[60:63], v[212:215], v[156:159], a[60:63]
    ds_read_b64_tr_b16 v[196:197], v233 offset:8192
    v_mfma_f32_16x16x32_bf16 a[64:67], v[212:215], v[160:163], a[64:67]
    ds_read_b64_tr_b16 v[198:199], v233 offset:10240
    v_mfma_f32_16x16x32_bf16 a[68:71], v[212:215], v[164:167], a[68:71]
    s_waitcnt lgkmcnt(6)
    v_mfma_f32_16x16x32_bf16 a[72:75], v[216:219], v[156:159], a[72:75]
    ds_read_b64_tr_b16 v[200:201], v234 offset:8192
    v_mfma_f32_16x16x32_bf16 a[76:79], v[216:219], v[160:163], a[76:79]
    ds_read_b64_tr_b16 v[202:203], v234 offset:10240
    v_mfma_f32_16x16x32_bf16 a[80:83], v[216:219], v[164:167], a[80:83]
    s_waitcnt lgkmcnt(6)
    v_mfma_f32_16x16x32_bf16 a[84:87], v[220:223], v[156:159], a[84:87]
    ds_read_b64_tr_b16 v[204:205], v235 offset:8192
    v_mfma_f32_16x16x32_bf16 a[88:91], v[220:223], v[160:163], a[88:91]
    ds_read_b64_tr_b16 v[206:207], v235 offset:10240
    v_mfma_f32_16x16x32_bf16 a[92:95], v[220:223], v[164:167], a[92:95]
    s_waitcnt lgkmcnt(6)
    v_mfma_f32_16x16x32_bf16 a[48:51], v[192:195], v[168:171], a[48:51]
    ds_read_b64_tr_b16 v[208:209], v232 offset:12288
    v_mfma_f32_16x16x32_bf16 a[52:55], v[192:195], v[172:175], a[52:55]
    ds_read_b64_tr_b16 v[210:211], v232 offset:14336
    v_add_u32 v232, s50, v232
    v_mfma_f32_16x16x32_bf16 a[56:59], v[192:195], v[176:179], a[56:59]
    s_waitcnt lgkmcnt(6)
    v_mfma_f32_16x16x32_bf16 a[60:63], v[196:199], v[168:171], a[60:63]
    ds_read_b64_tr_b16 v[212:213], v233 offset:12288
    v_mfma_f32_16x16x32_bf16 a[64:67], v[196:199], v[172:175], a[64:67]
    ds_read_b64_tr_b16 v[214:215], v233 offset:14336
    v_add_u32 v233, s50, v233
    v_mfma_f32_16x16x32_bf16 a[68:71], v[196:199], v[176:179], a[68:71]
    s_waitcnt lgkmcnt(6)
    v_mfma_f32_16x16x32_bf16 a[72:75], v[200:203], v[168:171], a[72:75]
    ds_read_b64_tr_b16 v[216:217], v234 offset:12288
    v_mfma_f32_16x16x32_bf16 a[76:79], v[200:203], v[172:175], a[76:79]
    ds_read_b64_tr_b16 v[218:219], v234 offset:14336
    v_add_u32 v234, s50, v234
    v_mfma_f32_16x16x32_bf16 a[80:83], v[200:203], v[176:179], a[80:83]
    s_waitcnt lgkmcnt(6)
    v_mfma_f32_16x16x32_bf16 a[84:87], v[204:207], v[168:171], a[84:87]
    ds_read_b64_tr_b16 v[220:221], v235 offset:12288
    v_mfma_f32_16x16x32_bf16 a[88:91], v[204:207], v[172:175], a[88:91]
    ds_read_b64_tr_b16 v[222:223], v235 offset:14336
    v_add_u32 v235, s50, v235
    v_mfma_f32_16x16x32_bf16 a[92:95], v[204:207], v[176:179], a[92:95]
    s_waitcnt lgkmcnt(6)
    s_waitcnt vmcnt(47)
    s_barrier
    v_mfma_f32_16x16x32_bf16 a[48:51], v[208:211], v[180:183], a[48:51]
    ds_read_b64_tr_b16 v[192:193], v232 offset:0
    v_mfma_f32_16x16x32_bf16 a[52:55], v[208:211], v[184:187], a[52:55]
    ds_read_b64_tr_b16 v[194:195], v232 offset:2048
    v_mfma_f32_16x16x32_bf16 a[56:59], v[208:211], v[188:191], a[56:59]
    s_waitcnt lgkmcnt(6)
    v_mfma_f32_16x16x32_bf16 a[60:63], v[212:215], v[180:183], a[60:63]
    ds_read_b64_tr_b16 v[196:197], v233 offset:0
    v_mfma_f32_16x16x32_bf16 a[64:67], v[212:215], v[184:187], a[64:67]
    ds_read_b64_tr_b16 v[198:199], v233 offset:2048
    v_mfma_f32_16x16x32_bf16 a[68:71], v[212:215], v[188:191], a[68:71]
    s_waitcnt lgkmcnt(6)
    v_mfma_f32_16x16x32_bf16 a[72:75], v[216:219], v[180:183], a[72:75]
    ds_read_b64_tr_b16 v[200:201], v234 offset:0
    v_mfma_f32_16x16x32_bf16 a[76:79], v[216:219], v[184:187], a[76:79]
    ds_read_b64_tr_b16 v[202:203], v234 offset:2048
    v_mfma_f32_16x16x32_bf16 a[80:83], v[216:219], v[188:191], a[80:83]
    s_waitcnt lgkmcnt(6)
    v_mfma_f32_16x16x32_bf16 a[84:87], v[220:223], v[180:183], a[84:87]
    ds_read_b64_tr_b16 v[204:205], v235 offset:0
    v_mfma_f32_16x16x32_bf16 a[88:91], v[220:223], v[184:187], a[88:91]
    ds_read_b64_tr_b16 v[206:207], v235 offset:2048
    v_mfma_f32_16x16x32_bf16 a[92:95], v[220:223], v[188:191], a[92:95]
    s_waitcnt lgkmcnt(6)
    v_mfma_f32_16x16x32_bf16 a[0:3], v[192:195], a[208:211], 0
    s_add_u32 s34, s34, 16384
    s_cmp_eq_u32 s34, 163840
    s_cselect_b32 s34, 0, s34
    ds_read_b64_tr_b16 v[208:209], v232 offset:4096
    v_mfma_f32_16x16x32_bf16 a[4:7], v[192:195], a[212:215], 0
    s_sub_u32 s50, s34, s36
    ds_read_b64_tr_b16 v[210:211], v232 offset:6144
    v_mfma_f32_16x16x32_bf16 a[8:11], v[192:195], a[216:219], 0
    s_waitcnt lgkmcnt(6)
    v_mfma_f32_16x16x32_bf16 a[12:15], v[196:199], a[208:211], 0
    s_mov_b32 s36, s34
    ds_read_b64_tr_b16 v[212:213], v233 offset:4096
    v_mfma_f32_16x16x32_bf16 a[16:19], v[196:199], a[212:215], 0
    s_sub_u32 s71, s60, 2
    ds_read_b64_tr_b16 v[214:215], v233 offset:6144
    v_mfma_f32_16x16x32_bf16 a[20:23], v[196:199], a[216:219], 0
    s_waitcnt lgkmcnt(6)
    v_mfma_f32_16x16x32_bf16 a[24:27], v[200:203], a[208:211], 0
    s_lshl_b32 s71, s71, 2
    ds_read_b64_tr_b16 v[216:217], v234 offset:4096
    v_accvgpr_read_b32 v224, a48
    v_mfma_f32_16x16x32_bf16 a[28:31], v[200:203], a[212:215], 0
    s_lshl_b32 s63, 1, s71
    ds_read_b64_tr_b16 v[218:219], v234 offset:6144
    v_accvgpr_read_b32 v225, a49
    v_mfma_f32_16x16x32_bf16 a[32:35], v[200:203], a[216:219], 0
    s_waitcnt lgkmcnt(6)
    v_accvgpr_read_b32 v226, a50
    v_accvgpr_read_b32 v227, a51
    v_mfma_f32_16x16x32_bf16 a[36:39], v[204:207], a[208:211], 0
    s_cmp_ge_u32 s60, 2
    s_cselect_b32 s63, s63, 0
    ds_read_b64_tr_b16 v[220:221], v235 offset:4096
    v_accvgpr_read_b32 v228, a60
    v_mfma_f32_16x16x32_bf16 a[40:43], v[204:207], a[212:215], 0
    s_sub_u32 s64, s71, 4
    ds_read_b64_tr_b16 v[222:223], v235 offset:6144
    v_accvgpr_read_b32 v229, a61
    v_mfma_f32_16x16x32_bf16 a[44:47], v[204:207], a[216:219], 0
    s_waitcnt lgkmcnt(6)
    v_accvgpr_read_b32 v230, a62
    v_accvgpr_read_b32 v231, a63
    v_mfma_f32_16x16x32_bf16 a[0:3], v[208:211], a[220:223], a[0:3]
    s_and_b32 s64, s64, 31
    ds_read_b64_tr_b16 v[192:193], v232 offset:8192
    v_cvt_pk_bf16_f32 v252, v224, v225
    v_mfma_f32_16x16x32_bf16 a[4:7], v[208:211], a[224:227], a[4:7]
    s_cmp_ge_u32 s60, 3
    s_cselect_b32 s65, 8, 0
    ds_read_b64_tr_b16 v[194:195], v232 offset:10240
    v_cvt_pk_bf16_f32 v253, v226, v227
    v_mfma_f32_16x16x32_bf16 a[8:11], v[208:211], a[228:231], a[8:11]
    s_waitcnt lgkmcnt(6)
    v_cvt_pk_bf16_f32 v254, v228, v229
    v_cvt_pk_bf16_f32 v255, v230, v231
    v_mfma_f32_16x16x32_bf16 a[12:15], v[212:215], a[220:223], a[12:15]
    s_cmp_eq_u32 s52, 0
    s_cselect_b32 s65, s65, 0
    ds_read_b64_tr_b16 v[196:197], v233 offset:8192
    v_mfma_f32_16x16x32_bf16 a[16:19], v[212:215], a[224:227], a[16:19]
    s_add_u32 s55, s48, 0
    ds_read_b64_tr_b16 v[198:199], v233 offset:10240
    v_mfma_f32_16x16x32_bf16 a[20:23], v[212:215], a[228:231], a[20:23]
    s_waitcnt lgkmcnt(6)
    buffer_store_dwordx4 v[252:255], v250, s[24:27], s55 offen sc1
    v_mfma_f32_16x16x32_bf16 a[24:27], v[216:219], a[220:223], a[24:27]
    ds_read_b64_tr_b16 v[200:201], v234 offset:8192
    v_accvgpr_read_b32 v224, a52
    v_mfma_f32_16x16x32_bf16 a[28:31], v[216:219], a[224:227], a[28:31]
    ds_read_b64_tr_b16 v[202:203], v234 offset:10240
    v_accvgpr_read_b32 v225, a53
    v_mfma_f32_16x16x32_bf16 a[32:35], v[216:219], a[228:231], a[32:35]
    s_waitcnt lgkmcnt(6)
    v_accvgpr_read_b32 v226, a54
    v_accvgpr_read_b32 v227, a55
    v_mfma_f32_16x16x32_bf16 a[36:39], v[220:223], a[220:223], a[36:39]
    ds_read_b64_tr_b16 v[204:205], v235 offset:8192
    v_accvgpr_read_b32 v228, a64
    v_mfma_f32_16x16x32_bf16 a[40:43], v[220:223], a[224:227], a[40:43]
    ds_read_b64_tr_b16 v[206:207], v235 offset:10240
    v_accvgpr_read_b32 v229, a65
    v_mfma_f32_16x16x32_bf16 a[44:47], v[220:223], a[228:231], a[44:47]
    s_waitcnt lgkmcnt(6)
    v_accvgpr_read_b32 v230, a66
    v_accvgpr_read_b32 v231, a67
    v_mfma_f32_16x16x32_bf16 a[0:3], v[192:195], a[232:235], a[0:3]
    ds_read_b64_tr_b16 v[208:209], v232 offset:12288
    v_cvt_pk_bf16_f32 v236, v224, v225
    v_mfma_f32_16x16x32_bf16 a[4:7], v[192:195], a[236:239], a[4:7]
    ds_read_b64_tr_b16 v[210:211], v232 offset:14336
    v_add_u32 v232, s50, v232
    v_mfma_f32_16x16x32_bf16 a[8:11], v[192:195], a[240:243], a[8:11]
    s_waitcnt lgkmcnt(6)
    v_cvt_pk_bf16_f32 v237, v226, v227
    v_cvt_pk_bf16_f32 v238, v228, v229
    v_mfma_f32_16x16x32_bf16 a[12:15], v[196:199], a[232:235], a[12:15]
    ds_read_b64_tr_b16 v[212:213], v233 offset:12288
    v_cvt_pk_bf16_f32 v239, v230, v231
    v_mfma_f32_16x16x32_bf16 a[16:19], v[196:199], a[236:239], a[16:19]
    s_add_u32 s55, s48, 1024
    ds_read_b64_tr_b16 v[214:215], v233 offset:14336
    v_add_u32 v233, s50, v233
    v_mfma_f32_16x16x32_bf16 a[20:23], v[196:199], a[240:243], a[20:23]
    s_waitcnt lgkmcnt(6)
    buffer_store_dwordx4 v[236:239], v250, s[24:27], s55 offen sc1
    v_mfma_f32_16x16x32_bf16 a[24:27], v[200:203], a[232:235], a[24:27]
    ds_read_b64_tr_b16 v[216:217], v234 offset:12288
    v_accvgpr_read_b32 v224, a56
    v_mfma_f32_16x16x32_bf16 a[28:31], v[200:203], a[236:239], a[28:31]
    ds_read_b64_tr_b16 v[218:219], v234 offset:14336
    v_add_u32 v234, s50, v234
    v_mfma_f32_16x16x32_bf16 a[32:35], v[200:203], a[240:243], a[32:35]
    s_waitcnt lgkmcnt(6)
    v_accvgpr_read_b32 v225, a57
    v_accvgpr_read_b32 v226, a58
    v_mfma_f32_16x16x32_bf16 a[36:39], v[204:207], a[232:235], a[36:39]
    ds_read_b64_tr_b16 v[220:221], v235 offset:12288
    v_accvgpr_read_b32 v227, a59
    v_mfma_f32_16x16x32_bf16 a[40:43], v[204:207], a[236:239], a[40:43]
    ds_read_b64_tr_b16 v[222:223], v235 offset:14336
    v_add_u32 v235, s50, v235
    v_mfma_f32_16x16x32_bf16 a[44:47], v[204:207], a[240:243], a[44:47]
    s_waitcnt lgkmcnt(6)
    s_waitcnt vmcnt(2)
    v_readfirstlane_b32 s69, v245
    s_nop 0
    s_lshr_b32 s69, s69, s64
    s_and_b32 s69, s69, 15
    s_cmp_ge_u32 s69, s65
    s_cbranch_scc0 L_spin4
L_spun4:
    s_barrier
    v_accvgpr_read_b32 v228, a68
    v_accvgpr_read_b32 v229, a69
    v_mfma_f32_16x16x32_bf16 a[0:3], v[208:211], a[244:247], a[0:3]
    ds_read_b64_tr_b16 v[192:193], v232 offset:0
    v_accvgpr_read_b32 v230, a70
    v_mfma_f32_16x16x32_bf16 a[4:7], v[208:211], a[248:251], a[4:7]
    ds_read_b64_tr_b16 v[194:195], v232 offset:2048
    v_mov_b32 v244, s63
    v_mfma_f32_16x16x32_bf16 a[8:11], v[208:211], v[44:47], a[8:11]
    s_waitcnt lgkmcnt(6)
    v_accvgpr_read_b32 v231, a71
    v_cvt_pk_bf16_f32 v252, v224, v225
    v_mfma_f32_16x16x32_bf16 a[12:15], v[212:215], a[244:247], a[12:15]
    ds_read_b64_tr_b16 v[196:197], v233 offset:0
    v_cvt_pk_bf16_f32 v253, v226, v227
    v_mfma_f32_16x16x32_bf16 a[16:19], v[212:215], a[248:251], a[16:19]
    ds_read_b64_tr_b16 v[198:199], v233 offset:2048
    buffer_atomic_add v244, v246, s[24:27], s75 offen sc1
    v_mfma_f32_16x16x32_bf16 a[20:23], v[212:215], v[44:47], a[20:23]
    s_waitcnt lgkmcnt(6)
    v_cvt_pk_bf16_f32 v254, v228, v229
    v_cvt_pk_bf16_f32 v255, v230, v231
    v_mfma_f32_16x16x32_bf16 a[24:27], v[216:219], a[244:247], a[24:27]
    s_add_u32 s55, s48, 2048
    ds_read_b64_tr_b16 v[200:201], v234 offset:0
    v_mfma_f32_16x16x32_bf16 a[28:31], v[216:219], a[248:251], a[28:31]
    ds_read_b64_tr_b16 v[202:203], v234 offset:2048
    v_mfma_f32_16x16x32_bf16 a[32:35], v[216:219], v[44:47], a[32:35]
    s_waitcnt lgkmcnt(6)
    buffer_store_dwordx4 v[252:255], v250, s[24:27], s55 offen sc1
    v_mfma_f32_16x16x32_bf16 a[36:39], v[220:223], a[244:247], a[36:39]
    ds_read_b64_tr_b16 v[204:205], v235 offset:0
    v_mfma_f32_16x16x32_bf16 a[40:43], v[220:223], a[248:251], a[40:43]
    ds_read_b64_tr_b16 v[206:207], v235 offset:2048
    v_mfma_f32_16x16x32_bf16 a[44:47], v[220:223], v[44:47], a[44:47]
    s_waitcnt lgkmcnt(6)
    s_waitcnt vmcnt(5)
    v_mfma_f32_16x16x32_bf16 v[32:35], a[96:99], v[0:3], 0
    v_mfma_f32_16x16x32_bf16 v[36:39], a[100:103], v[0:3], 0
    v_mfma_f32_16x16x32_bf16 v[32:35], a[96:99], v[4:7], v[32:35]
    v_mfma_f32_16x16x32_bf16 v[36:39], a[100:103], v[4:7], v[36:39]
    v_mfma_f32_16x16x32_bf16 v[32:35], a[96:99], v[8:11], v[32:35]
    v_mfma_f32_16x16x32_bf16 v[36:39], a[100:103], v[8:11], v[36:39]
    v_mfma_f32_16x16x32_bf16 v[32:35], a[96:99], v[12:15], v[32:35]
    v_accvgpr_read_b32 v224, a72
    v_accvgpr_read_b32 v225, a73
    v_mfma_f32_16x16x32_bf16 v[36:39], a[100:103], v[12:15], v[36:39]
    v_accvgpr_read_b32 v226, a74
    v_accvgpr_read_b32 v227, a75
    v_mfma_f32_16x16x32_bf16 v[32:35], a[96:99], v[16:19], v[32:35]
    v_accvgpr_read_b32 v228, a84
    v_accvgpr_read_b32 v229, a85
    v_mfma_f32_16x16x32_bf16 v[36:39], a[100:103], v[16:19], v[36:39]
    v_accvgpr_read_b32 v230, a86
    v_accvgpr_read_b32 v231, a87
    v_mfma_f32_16x16x32_bf16 v[32:35], a[96:99], v[20:23], v[32:35]
    v_cvt_pk_bf16_f32 v236, v224, v225
    v_cvt_pk_bf16_f32 v237, v226, v227
    v_mfma_f32_16x16x32_bf16 v[36:39], a[100:103], v[20:23], v[36:39]
    v_cvt_pk_bf16_f32 v238, v228, v229
    v_cvt_pk_bf16_f32 v239, v230, v231
    v_mfma_f32_16x16x32_bf16 v[32:35], a[96:99], v[24:27], v[32:35]
    s_add_u32 s55, s48, 3072
    buffer_store_dwordx4 v[236:239], v250, s[24:27], s55 offen sc1
    v_mfma_f32_16x16x32_bf16 v[36:39], a[100:103], v[24:27], v[36:39]
    v_accvgpr_read_b32 v224, a76
    v_accvgpr_read_b32 v225, a77
    v_mfma_f32_16x16x32_bf16 v[32:35], a[96:99], v[28:31], v[32:35]
    v_accvgpr_read_b32 v226, a78
    v_accvgpr_read_b32 v227, a79
    v_mfma_f32_16x16x32_bf16 v[36:39], a[100:103], v[28:31], v[36:39]
    v_accvgpr_read_b32 v228, a88
    v_accvgpr_read_b32 v229, a89
    v_mfma_f32_16x16x32_bf16 a[0:3], v[192:195], v[48:51], a[0:3]
    s_add_u32 s34, s34, 16384
    s_cmp_eq_u32 s34, 163840
    s_cselect_b32 s34, 0, s34
    ds_read_b64_tr_b16 v[208:209], v232 offset:4096
    v_accvgpr_read_b32 v230, a90
    v_mfma_f32_16x16x32_bf16 a[4:7], v[192:195], v[52:55], a[4:7]
    s_sub_u32 s50, s34, s36
    ds_read_b64_tr_b16 v[210:211], v232 offset:6144
    v_accvgpr_read_b32 v231, a91
    v_mfma_f32_16x16x32_bf16 a[8:11], v[192:195], v[56:59], a[8:11]
    s_waitcnt lgkmcnt(6)
    v_cvt_pk_bf16_f32 v252, v224, v225
    v_cvt_pk_bf16_f32 v253, v226, v227
    v_mfma_f32_16x16x32_bf16 a[12:15], v[196:199], v[48:51], a[12:15]
    s_mov_b32 s36, s34
    ds_read_b64_tr_b16 v[212:213], v233 offset:4096
    v_cvt_pk_bf16_f32 v254, v228, v229
    v_mfma_f32_16x16x32_bf16 a[16:19], v[196:199], v[52:55], a[16:19]
    ds_read_b64_tr_b16 v[214:215], v233 offset:6144
    v_cvt_pk_bf16_f32 v255, v230, v231
    v_mfma_f32_16x16x32_bf16 a[20:23], v[196:199], v[56:59], a[20:23]
    s_waitcnt lgkmcnt(6)
    v_mfma_f32_16x16x32_bf16 a[24:27], v[200:203], v[48:51], a[24:27]
    s_add_u32 s55, s48, 4096
    ds_read_b64_tr_b16 v[216:217], v234 offset:4096
    v_mfma_f32_16x16x32_bf16 a[28:31], v[200:203], v[52:55], a[28:31]
    ds_read_b64_tr_b16 v[218:219], v234 offset:6144
    v_mfma_f32_16x16x32_bf16 a[32:35], v[200:203], v[56:59], a[32:35]
    s_waitcnt lgkmcnt(6)
    buffer_store_dwordx4 v[252:255], v250, s[24:27], s55 offen sc1
    v_mfma_f32_16x16x32_bf16 a[36:39], v[204:207], v[48:51], a[36:39]
    ds_read_b64_tr_b16 v[220:221], v235 offset:4096
    v_accvgpr_read_b32 v224, a80
    v_mfma_f32_16x16x32_bf16 a[40:43], v[204:207], v[52:55], a[40:43]
    ds_read_b64_tr_b16 v[222:223], v235 offset:6144
    v_accvgpr_read_b32 v225, a81
    v_mfma_f32_16x16x32_bf16 a[44:47], v[204:207], v[56:59], a[44:47]
    s_waitcnt lgkmcnt(6)
    v_accvgpr_read_b32 v226, a82
    v_accvgpr_read_b32 v227, a83
    v_mfma_f32_16x16x32_bf16 a[0:3], v[208:211], v[60:63], a[0:3]
    ds_read_b64_tr_b16 v[192:193], v232 offset:8192
    v_accvgpr_read_b32 v228, a92
    v_mfma_f32_16x16x32_bf16 a[4:7], v[208:211], v[64:67], a[4:7]
    ds_read_b64_tr_b16 v[194:195], v232 offset:10240
    v_accvgpr_read_b32 v229, a93
    v_mfma_f32_16x16x32_bf16 a[8:11], v[208:211], v[68:71], a[8:11]
    s_waitcnt lgkmcnt(6)
    v_accvgpr_read_b32 v230, a94
    v_accvgpr_read_b32 v231, a95
    v_mfma_f32_16x16x32_bf16 a[12:15], v[212:215], v[60:63], a[12:15]
    ds_read_b64_tr_b16 v[196:197], v233 offset:8192
    v_cvt_pk_bf16_f32 v236, v224, v225
    v_mfma_f32_16x16x32_bf16 a[16:19], v[212:215], v[64:67], a[16:19]
    ds_read_b64_tr_b16 v[198:199], v233 offset:10240
    v_cvt_pk_bf16_f32 v237, v226, v227
    v_mfma_f32_16x16x32_bf16 a[20:23], v[212:215], v[68:71], a[20:23]
    s_waitcnt lgkmcnt(6)
    v_cvt_pk_bf16_f32 v238, v228, v229
    v_cvt_pk_bf16_f32 v239, v230, v231
    v_mfma_f32_16x16x32_bf16 a[24:27], v[216:219], v[60:63], a[24:27]
    s_add_u32 s55, s48, 5120
    ds_read_b64_tr_b16 v[200:201], v234 offset:8192
    v_cvt_pk_bf16_f32 v40, v32, v33
    v_mfma_f32_16x16x32_bf16 a[28:31], v[216:219], v[64:67], a[28:31]
    ds_read_b64_tr_b16 v[202:203], v234 offset:10240
    v_cvt_pk_bf16_f32 v41, v34, v35
    v_mfma_f32_16x16x32_bf16 a[32:35], v[216:219], v[68:71], a[32:35]
    s_waitcnt lgkmcnt(6)
    buffer_store_dwordx4 v[236:239], v250, s[24:27], s55 offen sc1
    v_mfma_f32_16x16x32_bf16 a[36:39], v[220:223], v[60:63], a[36:39]
    s_add_u32 s48, s48, 6144
    ds_read_b64_tr_b16 v[204:205], v235 offset:8192
    v_cvt_pk_bf16_f32 v42, v36, v37
    v_mfma_f32_16x16x32_bf16 a[40:43], v[220:223], v[64:67], a[40:43]
    ds_read_b64_tr_b16 v[206:207], v235 offset:10240
    v_cvt_pk_bf16_f32 v43, v38, v39
    v_mfma_f32_16x16x32_bf16 a[44:47], v[220:223], v[68:71], a[44:47]
    s_waitcnt lgkmcnt(6)
    buffer_store_dwordx2 v[40:41], v247, s[12:15], s73 offen
    v_mfma_f32_16x16x32_bf16 a[0:3], v[192:195], v[72:75], a[0:3]
    ds_read_b64_tr_b16 v[208:209], v232 offset:12288
    v_mfma_f32_16x16x32_bf16 a[4:7], v[192:195], v[76:79], a[4:7]
    ds_read_b64_tr_b16 v[210:211], v232 offset:14336
    v_add_u32 v232, s50, v232
    v_mfma_f32_16x16x32_bf16 a[8:11], v[192:195], v[80:83], a[8:11]
    s_waitcnt lgkmcnt(6)
    buffer_store_dwordx2 v[42:43], v247, s[12:15], s73 offen offset:32
    v_mfma_f32_16x16x32_bf16 a[12:15], v[196:199], v[72:75], a[12:15]
    ds_read_b64_tr_b16 v[212:213], v233 offset:12288
    v_mfma_f32_16x16x32_bf16 a[16:19], v[196:199], v[76:79], a[16:19]
    ds_read_b64_tr_b16 v[214:215], v233 offset:14336
    v_add_u32 v233, s50, v233
    v_mfma_f32_16x16x32_bf16 a[20:23], v[196:199], v[80:83], a[20:23]
    s_waitcnt lgkmcnt(6)
    v_mfma_f32_16x16x32_bf16 a[24:27], v[200:203], v[72:75], a[24:27]
    ds_read_b64_tr_b16 v[216:217], v234 offset:12288
    v_mfma_f32_16x16x32_bf16 a[28:31], v[200:203], v[76:79], a[28:31]
    ds_read_b64_tr_b16 v[218:219], v234 offset:14336
    v_add_u32 v234, s50, v234
    v_mfma_f32_16x16x32_bf16 a[32:35], v[200:203], v[80:83], a[32:35]
    s_waitcnt lgkmcnt(6)
    v_mfma_f32_16x16x32_bf16 a[36:39], v[204:207], v[72:75], a[36:39]
    ds_read_b64_tr_b16 v[220:221], v235 offset:12288
    v_mfma_f32_16x16x32_bf16 a[40:43], v[204:207], v[76:79], a[40:43]
    ds_read_b64_tr_b16 v[222:223], v235 offset:14336
    v_add_u32 v235, s50, v235
    v_mfma_f32_16x16x32_bf16 a[44:47], v[204:207], v[80:83], a[44:47]
    s_waitcnt lgkmcnt(6)
    s_waitcnt vmcnt(38)
    s_barrier
    buffer_load_dword v245, v249, s[24:27], s75 offen sc1
    v_mfma_f32_16x16x32_bf16 a[0:3], v[208:211], v[84:87], a[0:3]
    ds_read_b64_tr_b16 v[192:193], v232 offset:0
    v_mfma_f32_16x16x32_bf16 a[4:7], v[208:211], v[88:91], a[4:7]
    ds_read_b64_tr_b16 v[194:195], v232 offset:2048
    v_mfma_f32_16x16x32_bf16 a[8:11], v[208:211], v[92:95], a[8:11]
    s_waitcnt lgkmcnt(6)
    v_mfma_f32_16x16x32_bf16 a[12:15], v[212:215], v[84:87], a[12:15]
    ds_read_b64_tr_b16 v[196:197], v233 offset:0
    v_mfma_f32_16x16x32_bf16 a[16:19], v[212:215], v[88:91], a[16:19]
    ds_read_b64_tr_b16 v[198:199], v233 offset:2048
    v_mfma_f32_16x16x32_bf16 a[20:23], v[212:215], v[92:95], a[20:23]
    s_waitcnt lgkmcnt(6)
    v_mfma_f32_16x16x32_bf16 a[24:27], v[216:219], v[84:87], a[24:27]
    ds_read_b64_tr_b16 v[200:201], v234 offset:0
    v_mfma_f32_16x16x32_bf16 a[28:31], v[216:219], v[88:91], a[28:31]
    ds_read_b64_tr_b16 v[202:203], v234 offset:2048
    v_mfma_f32_16x16x32_bf16 a[32:35], v[216:219], v[92:95], a[32:35]
    s_waitcnt lgkmcnt(6)
    v_mfma_f32_16x16x32_bf16 a[36:39], v[220:223], v[84:87], a[36:39]
    ds_read_b64_tr_b16 v[204:205], v235 offset:0
    v_mfma_f32_16x16x32_bf16 a[40:43], v[220:223], v[88:91], a[40:43]
    ds_read_b64_tr_b16 v[206:207], v235 offset:2048
    v_mfma_f32_16x16x32_bf16 a[44:47], v[220:223], v[92:95], a[44:47]
    s_waitcnt lgkmcnt(6)
    v_mfma_f32_16x16x32_bf16 a[0:3], v[192:195], v[96:99], a[0:3]
    s_add_u32 s34, s34, 16384
    s_cmp_eq_u32 s34, 163840
    s_cselect_b32 s34, 0, s34
    ds_read_b64_tr_b16 v[208:209], v232 offset:4096
    v_mfma_f32_16x16x32_bf16 a[4:7], v[192:195], v[100:103], a[4:7]
    s_sub_u32 s50, s34, s36
    ds_read_b64_tr_b16 v[210:211], v232 offset:6144
    v_mfma_f32_16x16x32_bf16 a[8:11], v[192:195], v[104:107], a[8:11]
    s_waitcnt lgkmcnt(6)
    v_mfma_f32_16x16x32_bf16 a[12:15], v[196:199], v[96:99], a[12:15]
    s_mov_b32 s36, s34
    ds_read_b64_tr_b16 v[212:213], v233 offset:4096
    v_mfma_f32_16x16x32_bf16 a[16:19], v[196:199], v[100:103], a[16:19]
    s_mov_b32 s64, 16
    ds_read_b64_tr_b16 v[214:215], v233 offset:6144
    v_mfma_f32_16x16x32_bf16 a[20:23], v[196:199], v[104:107], a[20:23]
    s_waitcnt lgkmcnt(6)
    v_mfma_f32_16x16x32_bf16 a[24:27], v[200:203], v[96:99], a[24:27]
    s_cmp_eq_u32 s52, 0
    s_cselect_b32 s65, 8, 0
    ds_read_b64_tr_b16 v[216:217], v234 offset:4096
    v_mfma_f32_16x16x32_bf16 a[28:31], v[200:203], v[100:103], a[28:31]
    s_sub_u32 s71, s60, 3
    ds_read_b64_tr_b16 v[218:219], v234 offset:6144
    v_mfma_f32_16x16x32_bf16 a[32:35], v[200:203], v[104:107], a[32:35]
    s_waitcnt lgkmcnt(6)
    v_mfma_f32_16x16x32_bf16 a[36:39], v[204:207], v[96:99], a[36:39]
    s_sub_u32 s70, s52, s71
    ds_read_b64_tr_b16 v[220:221], v235 offset:4096
    v_mfma_f32_16x16x32_bf16 a[40:43], v[204:207], v[100:103], a[40:43]
    s_and_b32 s70, s70, 3
    ds_read_b64_tr_b16 v[222:223], v235 offset:6144
    v_mfma_f32_16x16x32_bf16 a[44:47], v[204:207], v[104:107], a[44:47]
    s_waitcnt lgkmcnt(6)
    v_mfma_f32_16x16x32_bf16 a[0:3], v[208:211], v[108:111], a[0:3]
    s_mul_i32 s61, s71, 6144
    ds_read_b64_tr_b16 v[192:193], v232 offset:8192
    v_mfma_f32_16x16x32_bf16 a[4:7], v[208:211], v[112:115], a[4:7]
    s_lshl_b32 s69, s70, 10
    ds_read_b64_tr_b16 v[194:195], v232 offset:10240
    v_mfma_f32_16x16x32_bf16 a[8:11], v[208:211], v[116:119], a[8:11]
    s_waitcnt lgkmcnt(6)
    v_mfma_f32_16x16x32_bf16 a[12:15], v[212:215], v[108:111], a[12:15]
    s_add_u32 s61, s61, s69
    ds_read_b64_tr_b16 v[196:197], v233 offset:8192
    v_mfma_f32_16x16x32_bf16 a[16:19], v[212:215], v[112:115], a[16:19]
    s_add_u32 s61, s61, s66
    ds_read_b64_tr_b16 v[198:199], v233 offset:10240
    v_mfma_f32_16x16x32_bf16 a[20:23], v[212:215], v[116:119], a[20:23]
    s_waitcnt lgkmcnt(6)
    v_mfma_f32_16x16x32_bf16 a[24:27], v[216:219], v[108:111], a[24:27]
    s_mul_i32 s62, s70, 28672
    ds_read_b64_tr_b16 v[200:201], v234 offset:8192
    v_mfma_f32_16x16x32_bf16 a[28:31], v[216:219], v[112:115], a[28:31]
    s_lshl_b32 s69, s71, 7
    ds_read_b64_tr_b16 v[202:203], v234 offset:10240
    v_mfma_f32_16x16x32_bf16 a[32:35], v[216:219], v[116:119], a[32:35]
    s_waitcnt lgkmcnt(6)
    v_mfma_f32_16x16x32_bf16 a[36:39], v[220:223], v[108:111], a[36:39]
    s_add_u32 s62, s62, s69
    ds_read_b64_tr_b16 v[204:205], v235 offset:8192
    v_mfma_f32_16x16x32_bf16 a[40:43], v[220:223], v[112:115], a[40:43]
    s_add_u32 s62, s62, s67
    ds_read_b64_tr_b16 v[206:207], v235 offset:10240
    v_mfma_f32_16x16x32_bf16 a[44:47], v[220:223], v[116:119], a[44:47]
    s_waitcnt lgkmcnt(6)
    v_mfma_f32_16x16x32_bf16 a[0:3], v[192:195], v[120:123], a[0:3]
    s_cmp_lt_u32 s70, 3
    s_cselect_b32 s61, s61, 0x7f000000
    s_cselect_b32 s62, s62, 0x7f000000
    ds_read_b64_tr_b16 v[208:209], v232 offset:12288
    v_mfma_f32_16x16x32_bf16 a[4:7], v[192:195], v[124:127], a[4:7]
    s_cmp_ge_u32 s60, 3
    s_cselect_b32 s61, s61, 0x7f000000
    s_cselect_b32 s62, s62, 0x7f000000
    ds_read_b64_tr_b16 v[210:211], v232 offset:14336
    v_add_u32 v232, s50, v232
    v_mfma_f32_16x16x32_bf16 a[8:11], v[192:195], v[128:131], a[8:11]
    s_waitcnt lgkmcnt(6)
    buffer_load_dwordx4 v[0:3], v250, s[24:27], s61 offen sc1
    v_mfma_f32_16x16x32_bf16 a[12:15], v[196:199], v[120:123], a[12:15]
    s_add_u32 s61, s61, 172032
    ds_read_b64_tr_b16 v[212:213], v233 offset:12288
    v_mfma_f32_16x16x32_bf16 a[16:19], v[196:199], v[124:127], a[16:19]
    ds_read_b64_tr_b16 v[214:215], v233 offset:14336
    v_add_u32 v233, s50, v233
    v_mfma_f32_16x16x32_bf16 a[20:23], v[196:199], v[128:131], a[20:23]
    s_waitcnt lgkmcnt(6)
    buffer_load_dwordx4 v[4:7], v250, s[24:27], s61 offen sc1
    v_mfma_f32_16x16x32_bf16 a[24:27], v[200:203], v[120:123], a[24:27]
    s_add_u32 s61, s61, 172032
    ds_read_b64_tr_b16 v[216:217], v234 offset:12288
    v_mfma_f32_16x16x32_bf16 a[28:31], v[200:203], v[124:127], a[28:31]
    ds_read_b64_tr_b16 v[218:219], v234 offset:14336
    v_add_u32 v234, s50, v234
    v_mfma_f32_16x16x32_bf16 a[32:35], v[200:203], v[128:131], a[32:35]
    s_waitcnt lgkmcnt(6)
    buffer_load_dwordx4 v[8:11], v250, s[24:27], s61 offen sc1
    v_mfma_f32_16x16x32_bf16 a[36:39], v[204:207], v[120:123], a[36:39]
    s_add_u32 s61, s61, 172032
    ds_read_b64_tr_b16 v[220:221], v235 offset:12288
    v_mfma_f32_16x16x32_bf16 a[40:43], v[204:207], v[124:127], a[40:43]
    ds_read_b64_tr_b16 v[222:223], v235 offset:14336
    v_add_u32 v235, s50, v235
    v_mfma_f32_16x16x32_bf16 a[44:47], v[204:207], v[128:131], a[44:47]
    s_waitcnt lgkmcnt(6)
    s_waitcnt vmcnt(3)
    v_readfirstlane_b32 s69, v245
    s_nop 0
    s_lshr_b32 s69, s69, s64
    s_and_b32 s69, s69, 15
    s_cmp_ge_u32 s69, s65
    s_cbranch_scc0 L_spin5
L_spun5:
    s_barrier
    buffer_load_dwordx4 v[12:15], v250, s[24:27], s61 offen sc1
    v_mfma_f32_16x16x32_bf16 a[0:3], v[208:211], v[132:135], a[0:3]
    s_add_u32 s61, s61, 172032
    ds_read_b64_tr_b16 v[192:193], v232 offset:0
    v_mfma_f32_16x16x32_bf16 a[4:7], v[208:211], v[136:139], a[4:7]
    ds_read_b64_tr_b16 v[194:195], v232 offset:2048
    v_mov_b32 v244, 0x100000
    v_mfma_f32_16x16x32_bf16 a[8:11], v[208:211], v[140:143], a[8:11]
    s_waitcnt lgkmcnt(6)
    buffer_load_dwordx4 v[16:19], v250, s[24:27], s61 offen sc1
    v_mfma_f32_16x16x32_bf16 a[12:15], v[212:215], v[132:135], a[12:15]
    s_add_u32 s61, s61, 172032
    ds_read_b64_tr_b16 v[196:197], v233 offset:0
    v_mfma_f32_16x16x32_bf16 a[16:19], v[212:215], v[136:139], a[16:19]
    ds_read_b64_tr_b16 v[198:199], v233 offset:2048
    buffer_atomic_add v244, v246, s[24:27], s75 offen sc1
    v_mfma_f32_16x16x32_bf16 a[20:23], v[212:215], v[140:143], a[20:23]
    s_waitcnt lgkmcnt(6)
    buffer_load_dwordx4 v[20:23], v250, s[24:27], s61 offen sc1
    v_mfma_f32_16x16x32_bf16 a[24:27], v[216:219], v[132:135], a[24:27]
    s_add_u32 s61, s61, 172032
    ds_read_b64_tr_b16 v[200:201], v234 offset:0
    v_mfma_f32_16x16x32_bf16 a[28:31], v[216:219], v[136:139], a[28:31]
    ds_read_b64_tr_b16 v[202:203], v234 offset:2048
    v_mfma_f32_16x16x32_bf16 a[32:35], v[216:219], v[140:143], a[32:35]
    s_waitcnt lgkmcnt(6)
    buffer_load_dwordx4 v[24:27], v250, s[24:27], s61 offen sc1
    v_mfma_f32_16x16x32_bf16 a[36:39], v[220:223], v[132:135], a[36:39]
    s_add_u32 s61, s61, 172032
    ds_read_b64_tr_b16 v[204:205], v235 offset:0
    v_mfma_f32_16x16x32_bf16 a[40:43], v[220:223], v[136:139], a[40:43]
    ds_read_b64_tr_b16 v[206:207], v235 offset:2048
    v_mfma_f32_16x16x32_bf16 a[44:47], v[220:223], v[140:143], a[44:47]
    s_waitcnt lgkmcnt(6)
    buffer_load_dwordx4 v[28:31], v250, s[24:27], s61 offen sc1
    s_mov_b32 s73, s62
    v_mfma_f32_16x16x32_bf16 a[0:3], v[192:195], v[144:147], a[0:3]
    s_mov_b32 s71, 4
    ds_read_b64_tr_b16 v[208:209], v232 offset:4096
    v_mfma_f32_16x16x32_bf16 a[4:7], v[192:195], v[148:151], a[4:7]
    s_sub_u32 s70, s52, s71
    ds_read_b64_tr_b16 v[210:211], v232 offset:6144
    v_mfma_f32_16x16x32_bf16 a[8:11], v[192:195], v[152:155], a[8:11]
    s_waitcnt lgkmcnt(6)
    v_mfma_f32_16x16x32_bf16 a[12:15], v[196:199], v[144:147], a[12:15]
    s_and_b32 s70, s70, 3
    ds_read_b64_tr_b16 v[212:213], v233 offset:4096
    v_mfma_f32_16x16x32_bf16 a[16:19], v[196:199], v[148:151], a[16:19]
    s_mul_i32 s61, s71, 6144
    ds_read_b64_tr_b16 v[214:215], v233 offset:6144
    v_mfma_f32_16x16x32_bf16 a[20:23], v[196:199], v[152:155], a[20:23]
    s_waitcnt lgkmcnt(6)
    v_mfma_f32_16x16x32_bf16 a[24:27], v[200:203], v[144:147], a[24:27]
    s_lshl_b32 s69, s70, 10
    ds_read_b64_tr_b16 v[216:217], v234 offset:4096
    v_mfma_f32_16x16x32_bf16 a[28:31], v[200:203], v[148:151], a[28:31]
    s_add_u32 s61, s61, s69
    ds_read_b64_tr_b16 v[218:219], v234 offset:6144
    v_mfma_f32_16x16x32_bf16 a[32:35], v[200:203], v[152:155], a[32:35]
    s_waitcnt lgkmcnt(6)
    v_mfma_f32_16x16x32_bf16 a[36:39], v[204:207], v[144:147], a[36:39]
    s_add_u32 s61, s61, s66
    ds_read_b64_tr_b16 v[220:221], v235 offset:4096
    v_mfma_f32_16x16x32_bf16 a[40:43], v[204:207], v[148:151], a[40:43]
    s_mul_i32 s62, s70, 28672
    ds_read_b64_tr_b16 v[222:223], v235 offset:6144
    v_mfma_f32_16x16x32_bf16 a[44:47], v[204:207], v[152:155], a[44:47]
    s_waitcnt lgkmcnt(6)
    v_mfma_f32_16x16x32_bf16 a[0:3], v[208:211], v[156:159], a[0:3]
    s_lshl_b32 s69, s71, 7
    ds_read_b64_tr_b16 v[192:193], v232 offset:8192
    v_mfma_f32_16x16x32_bf16 a[4:7], v[208:211], v[160:163], a[4:7]
    s_add_u32 s62, s62, s69
    ds_read_b64_tr_b16 v[194:195], v232 offset:10240
    v_mfma_f32_16x16x32_bf16 a[8:11], v[208:211], v[164:167], a[8:11]
    s_waitcnt lgkmcnt(6)
    v_mfma_f32_16x16x32_bf16 a[12:15], v[212:215], v[156:159], a[12:15]
    s_add_u32 s62, s62, s67
    ds_read_b64_tr_b16 v[196:197], v233 offset:8192
    v_mfma_f32_16x16x32_bf16 a[16:19], v[212:215], v[160:163], a[16:19]
    s_cmp_lt_u32 s70, 3
    s_cselect_b32 s61, s61, 0x7f000000
    s_cselect_b32 s62, s62, 0x7f000000
    ds_read_b64_tr_b16 v[198:199], v233 offset:10240
    v_mfma_f32_16x16x32_bf16 a[20:23], v[212:215], v[164:167], a[20:23]
    s_waitcnt lgkmcnt(6)
    v_mfma_f32_16x16x32_bf16 a[24:27], v[216:219], v[156:159], a[24:27]
    s_mov_b32 s82, s62
    ds_read_b64_tr_b16 v[200:201], v234 offset:8192
    v_mfma_f32_16x16x32_bf16 a[28:31], v[216:219], v[160:163], a[28:31]
    ds_read_b64_tr_b16 v[202:203], v234 offset:10240
    v_mfma_f32_16x16x32_bf16 a[32:35], v[216:219], v[164:167], a[32:35]
    s_waitcnt lgkmcnt(6)
    buffer_load_dwordx4 v[44:47], v250, s[24:27], s61 offen sc1
    v_mfma_f32_16x16x32_bf16 a[36:39], v[220:223], v[156:159], a[36:39]
    s_add_u32 s61, s61, 172032
    ds_read_b64_tr_b16 v[204:205], v235 offset:8192
    v_mfma_f32_16x16x32_bf16 a[40:43], v[220:223], v[160:163], a[40:43]
    ds_read_b64_tr_b16 v[206:207], v235 offset:10240
    v_mfma_f32_16x16x32_bf16 a[44:47], v[220:223], v[164:167], a[44:47]
    s_waitcnt lgkmcnt(6)
    buffer_load_dwordx4 v[48:51], v250, s[24:27], s61 offen sc1
    v_mfma_f32_16x16x32_bf16 a[0:3], v[192:195], v[168:171], a[0:3]
    s_add_u32 s61, s61, 172032
    ds_read_b64_tr_b16 v[208:209], v232 offset:12288
    v_mfma_f32_16x16x32_bf16 a[4:7], v[192:195], v[172:175], a[4:7]
    ds_read_b64_tr_b16 v[210:211], v232 offset:14336
    v_mfma_f32_16x16x32_bf16 a[8:11], v[192:195], v[176:179], a[8:11]
    s_waitcnt lgkmcnt(6)
    buffer_load_dwordx4 v[52:55], v250, s[24:27], s61 offen sc1
    v_mfma_f32_16x16x32_bf16 a[12:15], v[196:199], v[168:171], a[12:15]
    s_add_u32 s61, s61, 172032
    ds_read_b64_tr_b16 v[212:213], v233 offset:12288
    v_mfma_f32_16x16x32_bf16 a[16:19], v[196:199], v[172:175], a[16:19]
    ds_read_b64_tr_b16 v[214:215], v233 offset:14336
    v_mfma_f32_16x16x32_bf16 a[20:23], v[196:199], v[176:179], a[20:23]
    s_waitcnt lgkmcnt(6)
    buffer_load_dwordx4 v[56:59], v250, s[24:27], s61 offen sc1
    v_mfma_f32_16x16x32_bf16 a[24:27], v[200:203], v[168:171], a[24:27]
    s_add_u32 s61, s61, 172032
    ds_read_b64_tr_b16 v[216:217], v234 offset:12288
    v_mfma_f32_16x16x32_bf16 a[28:31], v[200:203], v[172:175], a[28:31]
    ds_read_b64_tr_b16 v[218:219], v234 offset:14336
    v_mfma_f32_16x16x32_bf16 a[32:35], v[200:203], v[176:179], a[32:35]
    s_waitcnt lgkmcnt(6)
    buffer_load_dwordx4 v[60:63], v250, s[24:27], s61 offen sc1
    v_mfma_f32_16x16x32_bf16 a[36:39], v[204:207], v[168:171], a[36:39]
    s_add_u32 s61, s61, 172032
    ds_read_b64_tr_b16 v[220:221], v235 offset:12288
    v_mfma_f32_16x16x32_bf16 a[40:43], v[204:207], v[172:175], a[40:43]
    ds_read_b64_tr_b16 v[222:223], v235 offset:14336
    v_mfma_f32_16x16x32_bf16 a[44:47], v[204:207], v[176:179], a[44:47]
    s_waitcnt lgkmcnt(6)
    buffer_load_dwordx4 v[64:67], v250, s[24:27], s61 offen sc1
    v_mfma_f32_16x16x32_bf16 a[0:3], v[208:211], v[180:183], a[0:3]
    s_add_u32 s61, s61, 172032
    buffer_load_dwordx4 v[68:71], v250, s[24:27], s61 offen sc1
    v_mfma_f32_16x16x32_bf16 a[4:7], v[208:211], v[184:187], a[4:7]
    s_add_u32 s61, s61, 172032
    buffer_load_dwordx4 v[72:75], v250, s[24:27], s61 offen sc1
    v_mfma_f32_16x16x32_bf16 a[8:11], v[208:211], v[188:191], a[8:11]
    s_waitcnt lgkmcnt(4)
    v_mfma_f32_16x16x32_bf16 a[12:15], v[212:215], v[180:183], a[12:15]
    v_mfma_f32_16x16x32_bf16 a[16:19], v[212:215], v[184:187], a[16:19]
    v_mfma_f32_16x16x32_bf16 a[20:23], v[212:215], v[188:191], a[20:23]
    s_waitcnt lgkmcnt(2)
    v_mfma_f32_16x16x32_bf16 a[24:27], v[216:219], v[180:183], a[24:27]
    v_mfma_f32_16x16x32_bf16 a[28:31], v[216:219], v[184:187], a[28:31]
    v_mfma_f32_16x16x32_bf16 a[32:35], v[216:219], v[188:191], a[32:35]
    s_waitcnt lgkmcnt(0)
    v_mfma_f32_16x16x32_bf16 a[36:39], v[220:223], v[180:183], a[36:39]
    v_mfma_f32_16x16x32_bf16 a[40:43], v[220:223], v[184:187], a[40:43]
    v_mfma_f32_16x16x32_bf16 a[44:47], v[220:223], v[188:191], a[44:47]
    buffer_load_dword v245, v249, s[24:27], s75 offen sc1
    s_nop 7
    v_accvgpr_read_b32 v224, a0
    v_accvgpr_read_b32 v225, a1
    v_accvgpr_read_b32 v226, a2
    v_accvgpr_read_b32 v227, a3
    v_accvgpr_read_b32 v228, a12
    v_accvgpr_read_b32 v229, a13
    v_accvgpr_read_b32 v230, a14
    v_accvgpr_read_b32 v231, a15
    v_cvt_pk_bf16_f32 v252, v224, v225
    v_cvt_pk_bf16_f32 v253, v226, v227
    v_cvt_pk_bf16_f32 v254, v228, v229
    v_cvt_pk_bf16_f32 v255, v230, v231
    s_add_u32 s55, s48, 0
    buffer_store_dwordx4 v[252:255], v250, s[24:27], s55 offen sc1
    v_accvgpr_read_b32 v224, a4
    v_accvgpr_read_b32 v225, a5
    v_accvgpr_read_b32 v226, a6
    v_accvgpr_read_b32 v227, a7
    v_accvgpr_read_b32 v228, a16
    v_accvgpr_read_b32 v229, a17
    v_accvgpr_read_b32 v230, a18
    v_accvgpr_read_b32 v231, a19
    v_cvt_pk_bf16_f32 v236, v224, v225
    v_cvt_pk_bf16_f32 v237, v226, v227
    v_cvt_pk_bf16_f32 v238, v228, v229
    v_cvt_pk_bf16_f32 v239, v230, v231
    s_add_u32 s55, s48, 1024
    buffer_store_dwordx4 v[236:239], v250, s[24:27], s55 offen sc1
    v_accvgpr_read_b32 v224, a8
    v_accvgpr_read_b32 v225, a9
    v_accvgpr_read_b32 v226, a10
    v_accvgpr_read_b32 v227, a11
    v_accvgpr_read_b32 v228, a20
    v_accvgpr_read_b32 v229, a21
    v_accvgpr_read_b32 v230, a22
    v_accvgpr_read_b32 v231, a23
    v_cvt_pk_bf16_f32 v252, v224, v225
    v_cvt_pk_bf16_f32 v253, v226, v227
    v_cvt_pk_bf16_f32 v254, v228, v229
    v_cvt_pk_bf16_f32 v255, v230, v231
    s_add_u32 s55, s48, 2048
    buffer_store_dwordx4 v[252:255], v250, s[24:27], s55 offen sc1
    v_accvgpr_read_b32 v224, a24
    v_accvgpr_read_b32 v225, a25
    v_accvgpr_read_b32 v226, a26
    v_accvgpr_read_b32 v227, a27
    v_accvgpr_read_b32 v228, a36
    v_accvgpr_read_b32 v229, a37
    v_accvgpr_read_b32 v230, a38
    v_accvgpr_read_b32 v231, a39
    v_cvt_pk_bf16_f32 v236, v224, v225
    v_cvt_pk_bf16_f32 v237, v226, v227
    v_cvt_pk_bf16_f32 v238, v228, v229
    v_cvt_pk_bf16_f32 v239, v230, v231
    s_add_u32 s55, s48, 3072
    buffer_store_dwordx4 v[236:239], v250, s[24:27], s55 offen sc1
    v_accvgpr_read_b32 v224, a28
    v_accvgpr_read_b32 v225, a29
    v_accvgpr_read_b32 v226, a30
    v_accvgpr_read_b32 v227, a31
    v_accvgpr_read_b32 v228, a40
    v_accvgpr_read_b32 v229, a41
    v_accvgpr_read_b32 v230, a42
    v_accvgpr_read_b32 v231, a43
    v_cvt_pk_bf16_f32 v252, v224, v225
    v_cvt_pk_bf16_f32 v253, v226, v227
    v_cvt_pk_bf16_f32 v254, v228, v229
    v_cvt_pk_bf16_f32 v255, v230, v231
    s_add_u32 s55, s48, 4096
    buffer_store_dwordx4 v[252:255], v250, s[24:27], s55 offen sc1
    v_accvgpr_read_b32 v224, a32
    v_accvgpr_read_b32 v225, a33
    v_accvgpr_read_b32 v226, a34
    v_accvgpr_read_b32 v227, a35
    v_accvgpr_read_b32 v228, a44
    v_accvgpr_read_b32 v229, a45
    v_accvgpr_read_b32 v230, a46
    v_accvgpr_read_b32 v231, a47
    v_cvt_pk_bf16_f32 v236, v224, v225
    v_cvt_pk_bf16_f32 v237, v226, v227
    v_cvt_pk_bf16_f32 v238, v228, v229
    v_cvt_pk_bf16_f32 v239, v230, v231
    s_add_u32 s55, s48, 5120
    buffer_store_dwordx4 v[236:239], v250, s[24:27], s55 offen sc1
    s_add_u32 s48, s48, 6144
    s_mov_b32 s64, 20
    s_waitcnt vmcnt(6)
    v_readfirstlane_b32 s69, v245
    s_nop 0
    s_lshr_b32 s69, s69, s64
    s_and_b32 s69, s69, 15
    s_cmp_ge_u32 s69, s65
    s_cbranch_scc0 L_spin6
L_spun6:
    s_barrier
    s_mov_b32 s71, 5
    s_sub_u32 s70, s52, s71
    s_and_b32 s70, s70, 3
    s_mul_i32 s61, s71, 6144
    s_lshl_b32 s69, s70, 10
    s_add_u32 s61, s61, s69
    s_add_u32 s61, s61, s66
    s_mul_i32 s62, s70, 28672
    s_lshl_b32 s69, s71, 7
    s_add_u32 s62, s62, s69
    s_add_u32 s62, s62, s67
    s_cmp_lt_u32 s70, 3
    s_cselect_b32 s61, s61, 0x7f000000
    s_cselect_b32 s62, s62, 0x7f000000
    s_mov_b32 s83, s62
    buffer_load_dwordx4 v[76:79], v250, s[24:27], s61 offen sc1
    s_add_u32 s61, s61, 172032
    buffer_load_dwordx4 v[80:83], v250, s[24:27], s61 offen sc1
    s_add_u32 s61, s61, 172032
    buffer_load_dwordx4 v[84:87], v250, s[24:27], s61 offen sc1
    s_add_u32 s61, s61, 172032
    buffer_load_dwordx4 v[88:91], v250, s[24:27], s61 offen sc1
    s_add_u32 s61, s61, 172032
    buffer_load_dwordx4 v[92:95], v250, s[24:27], s61 offen sc1
    s_add_u32 s61, s61, 172032
    buffer_load_dwordx4 v[96:99], v250, s[24:27], s61 offen sc1
    s_add_u32 s61, s61, 172032
    buffer_load_dwordx4 v[100:103], v250, s[24:27], s61 offen sc1
    s_add_u32 s61, s61, 172032
    buffer_load_dwordx4 v[104:107], v250, s[24:27], s61 offen sc1
    s_mov_b32 s71, 6
    s_sub_u32 s70, s52, s71
    s_and_b32 s70, s70, 3
    s_mul_i32 s61, s71, 6144
    s_lshl_b32 s69, s70, 10
    s_add_u32 s61, s61, s69
    s_add_u32 s61, s61, s66
    s_mul_i32 s62, s70, 28672
    s_lshl_b32 s69, s71, 7
    s_add_u32 s62, s62, s69
    s_add_u32 s62, s62, s67
    s_cmp_lt_u32 s70, 3
    s_cselect_b32 s61, s61, 0x7f000000
    s_cselect_b32 s62, s62, 0x7f000000
    s_mov_b32 s81, s62
    buffer_load_dwordx4 v[108:111], v250, s[24:27], s61 offen sc1
    s_add_u32 s61, s61, 172032
    buffer_load_dwordx4 v[112:115], v250, s[24:27], s61 offen sc1
    s_add_u32 s61, s61, 172032
    buffer_load_dwordx4 v[116:119], v250, s[24:27], s61 offen sc1
    s_add_u32 s61, s61, 172032
    buffer_load_dwordx4 v[120:123], v250, s[24:27], s61 offen sc1
    s_add_u32 s61, s61, 172032
    buffer_load_dwordx4 v[124:127], v250, s[24:27], s61 offen sc1
    s_add_u32 s61, s61, 172032
    buffer_load_dwordx4 v[128:131], v250, s[24:27], s61 offen sc1
    s_add_u32 s61, s61, 172032
    buffer_load_dwordx4 v[132:135], v250, s[24:27], s61 offen sc1
    s_add_u32 s61, s61, 172032
    buffer_load_dwordx4 v[136:139], v250, s[24:27], s61 offen sc1
    s_sub_u32 s59, s61, 1204224
    s_waitcnt vmcnt(31)
    v_mfma_f32_16x16x32_bf16 v[32:35], a[96:99], v[0:3], 0
    v_mfma_f32_16x16x32_bf16 v[36:39], a[100:103], v[0:3], 0
    v_mfma_f32_16x16x32_bf16 v[32:35], a[96:99], v[4:7], v[32:35]
    v_mfma_f32_16x16x32_bf16 v[36:39], a[100:103], v[4:7], v[36:39]
    v_mfma_f32_16x16x32_bf16 v[32:35], a[96:99], v[8:11], v[32:35]
    v_mfma_f32_16x16x32_bf16 v[36:39], a[100:103], v[8:11], v[36:39]
    v_mfma_f32_16x16x32_bf16 v[32:35], a[96:99], v[12:15], v[32:35]
    v_mfma_f32_16x16x32_bf16 v[36:39], a[100:103], v[12:15], v[36:39]
    v_mfma_f32_16x16x32_bf16 v[32:35], a[96:99], v[16:19], v[32:35]
    v_mfma_f32_16x16x32_bf16 v[36:39], a[100:103], v[16:19], v[36:39]
    v_mfma_f32_16x16x32_bf16 v[32:35], a[96:99], v[20:23], v[32:35]
    v_mfma_f32_16x16x32_bf16 v[36:39], a[100:103], v[20:23], v[36:39]
    v_mfma_f32_16x16x32_bf16 v[32:35], a[96:99], v[24:27], v[32:35]
    v_mfma_f32_16x16x32_bf16 v[36:39], a[100:103], v[24:27], v[36:39]
    v_mfma_f32_16x16x32_bf16 v[32:35], a[96:99], v[28:31], v[32:35]
    v_mfma_f32_16x16x32_bf16 v[36:39], a[100:103], v[28:31], v[36:39]
    s_nop 7
    v_cvt_pk_bf16_f32 v40, v32, v33
    v_cvt_pk_bf16_f32 v41, v34, v35
    v_cvt_pk_bf16_f32 v42, v36, v37
    v_cvt_pk_bf16_f32 v43, v38, v39
    buffer_store_dwordx2 v[40:41], v247, s[12:15], s73 offen
    buffer_store_dwordx2 v[42:43], v247, s[12:15], s73 offen offset:32
    s_waitcnt vmcnt(25)
    v_mfma_f32_16x16x32_bf16 v[32:35], a[96:99], v[44:47], 0
    v_mfma_f32_16x16x32_bf16 v[36:39], a[100:103], v[44:47], 0
    v_mfma_f32_16x16x32_bf16 v[32:35], a[96:99], v[48:51], v[32:35]
    v_mfma_f32_16x16x32_bf16 v[36:39], a[100:103], v[48:51], v[36:39]
    v_mfma_f32_16x16x32_bf16 v[32:35], a[96:99], v[52:55], v[32:35]
    v_mfma_f32_16x16x32_bf16 v[36:39], a[100:103], v[52:55], v[36:39]
    v_mfma_f32_16x16x32_bf16 v[32:35], a[96:99], v[56:59], v[32:35]
    v_mfma_f32_16x16x32_bf16 v[36:39], a[100:103], v[56:59], v[36:39]
    v_mfma_f32_16x16x32_bf16 v[32:35], a[96:99], v[60:63], v[32:35]
    v_mfma_f32_16x16x32_bf16 v[36:39], a[100:103], v[60:63], v[36:39]
    v_mfma_f32_16x16x32_bf16 v[32:35], a[96:99], v[64:67], v[32:35]
    v_mfma_f32_16x16x32_bf16 v[36:39], a[100:103], v[64:67], v[36:39]
    v_mfma_f32_16x16x32_bf16 v[32:35], a[96:99], v[68:71], v[32:35]
    v_mfma_f32_16x16x32_bf16 v[36:39], a[100:103], v[68:71], v[36:39]
    v_mfma_f32_16x16x32_bf16 v[32:35], a[96:99], v[72:75], v[32:35]
    v_mfma_f32_16x16x32_bf16 v[36:39], a[100:103], v[72:75], v[36:39]
    s_nop 7
    v_cvt_pk_bf16_f32 v40, v32, v33
    v_cvt_pk_bf16_f32 v41, v34, v35
    v_cvt_pk_bf16_f32 v42, v36, v37
    v_cvt_pk_bf16_f32 v43, v38, v39
    buffer_store_dwordx2 v[40:41], v247, s[12:15], s82 offen
    buffer_store_dwordx2 v[42:43], v247, s[12:15], s82 offen offset:32
    s_waitcnt vmcnt(12)
    v_mfma_f32_16x16x32_bf16 v[32:35], a[96:99], v[76:79], 0
    v_mfma_f32_16x16x32_bf16 v[36:39], a[100:103], v[76:79], 0
    v_mfma_f32_16x16x32_bf16 v[32:35], a[96:99], v[80:83], v[32:35]
    v_mfma_f32_16x16x32_bf16 v[36:39], a[100:103], v[80:83], v[36:39]
    v_mfma_f32_16x16x32_bf16 v[32:35], a[96:99], v[84:87], v[32:35]
    v_mfma_f32_16x16x32_bf16 v[36:39], a[100:103], v[84:87], v[36:39]
    v_mfma_f32_16x16x32_bf16 v[32:35], a[96:99], v[88:91], v[32:35]
    v_mfma_f32_16x16x32_bf16 v[36:39], a[100:103], v[88:91], v[36:39]
    v_mfma_f32_16x16x32_bf16 v[32:35], a[96:99], v[92:95], v[32:35]
    v_mfma_f32_16x16x32_bf16 v[36:39], a[100:103], v[92:95], v[36:39]
    v_mfma_f32_16x16x32_bf16 v[32:35], a[96:99], v[96:99], v[32:35]
    v_mfma_f32_16x16x32_bf16 v[36:39], a[100:103], v[96:99], v[36:39]
    v_mfma_f32_16x16x32_bf16 v[32:35], a[96:99], v[100:103], v[32:35]
    v_mfma_f32_16x16x32_bf16 v[36:39], a[100:103], v[100:103], v[36:39]
    v_mfma_f32_16x16x32_bf16 v[32:35], a[96:99], v[104:107], v[32:35]
    v_mfma_f32_16x16x32_bf16 v[36:39], a[100:103], v[104:107], v[36:39]
    s_nop 7
    v_cvt_pk_bf16_f32 v40, v32, v33
    v_cvt_pk_bf16_f32 v41, v34, v35
    v_cvt_pk_bf16_f32 v42, v36, v37
    v_cvt_pk_bf16_f32 v43, v38, v39
    buffer_store_dwordx2 v[40:41], v247, s[12:15], s83 offen
    buffer_store_dwordx2 v[42:43], v247, s[12:15], s83 offen offset:32
    s_waitcnt vmcnt(6)
    v_max3_u32 v38, v108, v109, v110
    v_max3_u32 v38, v38, v111, v112
    v_max3_u32 v38, v38, v113, v114
    v_max3_u32 v38, v38, v115, v116
    v_max3_u32 v38, v38, v117, v118
    v_max3_u32 v38, v38, v119, v120
    v_max3_u32 v38, v38, v121, v122
    v_max3_u32 v38, v38, v123, v124
    v_max3_u32 v38, v38, v125, v126
    v_max3_u32 v38, v38, v127, v128
    v_max3_u32 v38, v38, v129, v130
    v_max3_u32 v38, v38, v131, v132
    v_max3_u32 v38, v38, v133, v134
    v_max3_u32 v38, v38, v135, v136
    v_max3_u32 v38, v38, v137, v138
    v_max_u32 v38, v38, v139
    v_cmp_eq_u32 vcc, -1, v38
    s_cbranch_vccnz L_retry6
L_ok6:
    v_mfma_f32_16x16x32_bf16 v[32:35], a[96:99], v[108:111], 0
    v_mfma_f32_16x16x32_bf16 v[36:39], a[100:103], v[108:111], 0
    v_mfma_f32_16x16x32_bf16 v[32:35], a[96:99], v[112:115], v[32:35]
    v_mfma_f32_16x16x32_bf16 v[36:39], a[100:103], v[112:115], v[36:39]
    v_mfma_f32_16x16x32_bf16 v[32:35], a[96:99], v[116:119], v[32:35]
    v_mfma_f32_16x16x32_bf16 v[36:39], a[100:103], v[116:119], v[36:39]
    v_mfma_f32_16x16x32_bf16 v[32:35], a[96:99], v[120:123], v[32:35]
    v_mfma_f32_16x16x32_bf16 v[36:39], a[100:103], v[120:123], v[36:39]
    v_mfma_f32_16x16x32_bf16 v[32:35], a[96:99], v[124:127], v[32:35]
    v_mfma_f32_16x16x32_bf16 v[36:39], a[100:103], v[124:127], v[36:39]
    v_mfma_f32_16x16x32_bf16 v[32:35], a[96:99], v[128:131], v[32:35]
    v_mfma_f32_16x16x32_bf16 v[36:39], a[100:103], v[128:131], v[36:39]
    v_mfma_f32_16x16x32_bf16 v[32:35], a[96:99], v[132:135], v[32:35]
    v_mfma_f32_16x16x32_bf16 v[36:39], a[100:103], v[132:135], v[36:39]
    v_mfma_f32_16x16x32_bf16 v[32:35], a[96:99], v[136:139], v[32:35]
    v_mfma_f32_16x16x32_bf16 v[36:39], a[100:103], v[136:139], v[36:39]
    s_nop 7
    v_cvt_pk_bf16_f32 v40, v32, v33
    v_cvt_pk_bf16_f32 v41, v34, v35
    v_cvt_pk_bf16_f32 v42, v36, v37
    v_cvt_pk_bf16_f32 v43, v38, v39
    buffer_store_dwordx2 v[40:41], v247, s[12:15], s81 offen
    buffer_store_dwordx2 v[42:43], v247, s[12:15], s81 offen offset:32
    s_waitcnt vmcnt(0)
    s_waitcnt vmcnt(0)
L_exit:
    s_endpgm
L_stub0:
    s_call_b64 s[28:29], L_rare1
    s_branch L_back0
L_stub1:
    s_call_b64 s[28:29], L_rare0
    s_branch L_back1
L_stub2:
    s_call_b64 s[28:29], L_rare1
    s_branch L_back2
L_stub3:
    s_call_b64 s[28:29], L_rare0
    s_branch L_back3
L_stub4:
    s_call_b64 s[28:29], L_rare1
    s_branch L_back4
L_stub5:
    s_call_b64 s[28:29], L_rare0
    s_branch L_back5
L_stub6:
    s_call_b64 s[28:29], L_rare1
    s_branch L_back6
L_stub7:
    s_call_b64 s[28:29], L_rare0
    s_branch L_back7
L_stub8:
    s_call_b64 s[28:29], L_rare1
    s_branch L_back8
L_spin0:
    s_mov_b32 s71, 0
L_spinl0:
    s_sleep 2
    buffer_load_dword v245, v249, s[76:79], s68 offen sc1
    s_waitcnt vmcnt(0)
    v_readfirstlane_b32 s69, v245
    s_add_u32 s71, s71, 1
    s_lshr_b32 s69, s69, s64
    s_and_b32 s69, s69, 65535
    s_cmp_ge_u32 s69, s65
    s_cbranch_scc1 L_spun0
    s_cmp_lt_u32 s71, 0x200000
    s_cbranch_scc1 L_spinl0
    s_branch L_spun0
L_spin1:
    s_mov_b32 s71, 0
L_spinl1:
    s_sleep 2
    buffer_load_dword v245, v249, s[24:27], s75 offen sc1
    s_waitcnt vmcnt(0)
    v_readfirstlane_b32 s69, v245
    s_add_u32 s71, s71, 1
    s_lshr_b32 s69, s69, s64
    s_and_b32 s69, s69, 15
    s_cmp_ge_u32 s69, s65
    s_cbranch_scc1 L_spun1
    s_cmp_lt_u32 s71, 0x200000
    s_cbranch_scc1 L_spinl1
    s_branch L_spun1
L_spin2:
    s_mov_b32 s71, 0
L_spinl2:
    s_sleep 2
    buffer_load_dword v245, v249, s[24:27], s75 offen sc1
    s_waitcnt vmcnt(0)
    v_readfirstlane_b32 s69, v245
    s_add_u32 s71, s71, 1
    s_lshr_b32 s69, s69, s64
    s_and_b32 s69, s69, 15
    s_cmp_ge_u32 s69, s65
    s_cbranch_scc1 L_spun2
    s_cmp_lt_u32 s71, 0x200000
    s_cbranch_scc1 L_spinl2
    s_branch L_spun2
L_spin3:
    s_mov_b32 s71, 0
L_spinl3:
    s_sleep 2
    buffer_load_dword v245, v249, s[24:27], s75 offen sc1
    s_waitcnt vmcnt(0)
    v_readfirstlane_b32 s69, v245
    s_add_u32 s71, s71, 1
    s_lshr_b32 s69, s69, s64
    s_and_b32 s69, s69, 15
    s_cmp_ge_u32 s69, s65
    s_cbranch_scc1 L_spun3
    s_cmp_lt_u32 s71, 0x200000
    s_cbranch_scc1 L_spinl3
    s_branch L_spun3
L_spin4:
    s_mov_b32 s71, 0
L_spinl4:
    s_sleep 2
    buffer_load_dword v245, v249, s[24:27], s75 offen sc1
    s_waitcnt vmcnt(0)
    v_readfirstlane_b32 s69, v245
    s_add_u32 s71, s71, 1
    s_lshr_b32 s69, s69, s64
    s_and_b32 s69, s69, 15
    s_cmp_ge_u32 s69, s65
    s_cbranch_scc1 L_spun4
    s_cmp_lt_u32 s71, 0x200000
    s_cbranch_scc1 L_spinl4
    s_branch L_spun4
L_spin5:
    s_mov_b32 s71, 0
L_spinl5:
    s_sleep 2
    buffer_load_dword v245, v249, s[24:27], s75 offen sc1
    s_waitcnt vmcnt(0)
    v_readfirstlane_b32 s69, v245
    s_add_u32 s71, s71, 1
    s_lshr_b32 s69, s69, s64
    s_and_b32 s69, s69, 15
    s_cmp_ge_u32 s69, s65
    s_cbranch_scc1 L_spun5
    s_cmp_lt_u32 s71, 0x200000
    s_cbranch_scc1 L_spinl5
    s_branch L_spun5
L_spin6:
    s_mov_b32 s71, 0
L_spinl6:
    s_sleep 2
    buffer_load_dword v245, v249, s[24:27], s75 offen sc1
    s_waitcnt vmcnt(0)
    v_readfirstlane_b32 s69, v245
    s_add_u32 s71, s71, 1
    s_lshr_b32 s69, s69, s64
    s_and_b32 s69, s69, 15
    s_cmp_ge_u32 s69, s65
    s_cbranch_scc1 L_spun6
    s_cmp_lt_u32 s71, 0x200000
    s_cbranch_scc1 L_spinl6
    s_branch L_spun6
L_retry6:
    s_mov_b32 s71, 0
L_retry6l:
    s_mov_b32 s61, s59
    buffer_load_dwordx4 v[108:111], v250, s[24:27], s61 offen sc1
    s_add_u32 s61, s61, 172032
    buffer_load_dwordx4 v[112:115], v250, s[24:27], s61 offen sc1
    s_add_u32 s61, s61, 172032
    buffer_load_dwordx4 v[116:119], v250, s[24:27], s61 offen sc1
    s_add_u32 s61, s61, 172032
    buffer_load_dwordx4 v[120:123], v250, s[24:27], s61 offen sc1
    s_add_u32 s61, s61, 172032
    buffer_load_dwordx4 v[124:127], v250, s[24:27], s61 offen sc1
    s_add_u32 s61, s61, 172032
    buffer_load_dwordx4 v[128:131], v250, s[24:27], s61 offen sc1
    s_add_u32 s61, s61, 172032
    buffer_load_dwordx4 v[132:135], v250, s[24:27], s61 offen sc1
    s_add_u32 s61, s61, 172032
    buffer_load_dwordx4 v[136:139], v250, s[24:27], s61 offen sc1
    s_waitcnt vmcnt(0)
    v_max3_u32 v38, v108, v109, v110
    v_max3_u32 v38, v38, v111, v112
    v_max3_u32 v38, v38, v113, v114
    v_max3_u32 v38, v38, v115, v116
    v_max3_u32 v38, v38, v117, v118
    v_max3_u32 v38, v38, v119, v120
    v_max3_u32 v38, v38, v121, v122
    v_max3_u32 v38, v38, v123, v124
    v_max3_u32 v38, v38, v125, v126
    v_max3_u32 v38, v38, v127, v128
    v_max3_u32 v38, v38, v129, v130
    v_max3_u32 v38, v38, v131, v132
    v_max3_u32 v38, v38, v133, v134
    v_max3_u32 v38, v38, v135, v136
    v_max3_u32 v38, v38, v137, v138
    v_max_u32 v38, v38, v139
    v_cmp_eq_u32 vcc, -1, v38
    s_cbranch_vccz L_ok6
    s_add_u32 s71, s71, 1
    s_cmp_lt_u32 s71, 0x100000
    s_cbranch_scc1 L_retry6l
    s_branch L_ok6
L_rare0:
    s_nop 15
    s_nop 15
    v_max3_f32 v168, v96, v97, v98
    v_max3_f32 v168, v168, v99, v108
    v_max3_f32 v168, v168, v109, v110
    v_max_f32 v168, v168, v111
    v_mov_b32 v169, v168
    s_nop 1
    v_permlane32_swap_b32 v168, v169
    s_nop 1
    v_max_f32 v168, v168, v169
    v_mov_b32 v169, v168
    s_nop 1
    v_permlane16_swap_b32 v168, v169
    s_nop 1
    v_max_f32 v168, v168, v169
    v_add_f32 v168, s51, v168
    v_max_f32 v168, 0, v168
    v_sub_f32 v96, v96, v168
    v_sub_f32 v97, v97, v168
    v_sub_f32 v98, v98, v168
    v_sub_f32 v99, v99, v168
    v_sub_f32 v108, v108, v168
    v_sub_f32 v109, v109, v168
    v_sub_f32 v110, v110, v168
    v_sub_f32 v111, v111, v168
    v_sub_f32 v120, v120, v168
    v_sub_f32 v121, v121, v168
    v_sub_f32 v122, v122, v168
    v_sub_f32 v123, v123, v168
    v_sub_f32 v132, v132, v168
    v_sub_f32 v133, v133, v168
    v_sub_f32 v134, v134, v168
    v_sub_f32 v135, v135, v168
    v_sub_f32 v176, v176, v168
    v_sub_f32 v177, v177, v168
    v_sub_f32 v178, v178, v168
    v_sub_f32 v179, v179, v168
    v_exp_f32_e64 v170, -v168
    s_nop 1
    v_accvgpr_read_b32 v169, a0
    v_mul_f32 v169, v170, v169
    v_accvgpr_write_b32 a0, v169
    v_accvgpr_read_b32 v169, a1
    v_mul_f32 v169, v170, v169
    v_accvgpr_write_b32 a1, v169
    v_accvgpr_read_b32 v169, a2
    v_mul_f32 v169, v170, v169
    v_accvgpr_write_b32 a2, v169
    v_accvgpr_read_b32 v169, a3
    v_mul_f32 v169, v170, v169
    v_accvgpr_write_b32 a3, v169
    v_accvgpr_read_b32 v169, a12
    v_mul_f32 v169, v170, v169
    v_accvgpr_write_b32 a12, v169
    v_accvgpr_read_b32 v169, a13
    v_mul_f32 v169, v170, v169
    v_accvgpr_write_b32 a13, v169
    v_accvgpr_read_b32 v169, a14
    v_mul_f32 v169, v170, v169
    v_accvgpr_write_b32 a14, v169
    v_accvgpr_read_b32 v169, a15
    v_mul_f32 v169, v170, v169
    v_accvgpr_write_b32 a15, v169
    v_accvgpr_read_b32 v169, a24
    v_mul_f32 v169, v170, v169
    v_accvgpr_write_b32 a24, v169
    v_accvgpr_read_b32 v169, a25
    v_mul_f32 v169, v170, v169
    v_accvgpr_write_b32 a25, v169
    v_accvgpr_read_b32 v169, a26
    v_mul_f32 v169, v170, v169
    v_accvgpr_write_b32 a26, v169
    v_accvgpr_read_b32 v169, a27
    v_mul_f32 v169, v170, v169
    v_accvgpr_write_b32 a27, v169
    v_accvgpr_read_b32 v169, a36
    v_mul_f32 v169, v170, v169
    v_accvgpr_write_b32 a36, v169
    v_accvgpr_read_b32 v169, a37
    v_mul_f32 v169, v170, v169
    v_accvgpr_write_b32 a37, v169
    v_accvgpr_read_b32 v169, a38
    v_mul_f32 v169, v170, v169
    v_accvgpr_write_b32 a38, v169
    v_accvgpr_read_b32 v169, a39
    v_mul_f32 v169, v170, v169
    v_accvgpr_write_b32 a39, v169
    v_accvgpr_read_b32 v169, a48
    v_mul_f32 v169, v170, v169
    v_accvgpr_write_b32 a48, v169
    v_accvgpr_read_b32 v169, a49
    v_mul_f32 v169, v170, v169
    v_accvgpr_write_b32 a49, v169
    v_accvgpr_read_b32 v169, a50
    v_mul_f32 v169, v170, v169
    v_accvgpr_write_b32 a50, v169
    v_accvgpr_read_b32 v169, a51
    v_mul_f32 v169, v170, v169
    v_accvgpr_write_b32 a51, v169
    v_accvgpr_read_b32 v169, a60
    v_mul_f32 v169, v170, v169
    v_accvgpr_write_b32 a60, v169
    v_accvgpr_read_b32 v169, a61
    v_mul_f32 v169, v170, v169
    v_accvgpr_write_b32 a61, v169
    v_accvgpr_read_b32 v169, a62
    v_mul_f32 v169, v170, v169
    v_accvgpr_write_b32 a62, v169
    v_accvgpr_read_b32 v169, a63
    v_mul_f32 v169, v170, v169
    v_accvgpr_write_b32 a63, v169
    v_accvgpr_read_b32 v169, a72
    v_mul_f32 v169, v170, v169
    v_accvgpr_write_b32 a72, v169
    v_accvgpr_read_b32 v169, a73
    v_mul_f32 v169, v170, v169
    v_accvgpr_write_b32 a73, v169
    v_accvgpr_read_b32 v169, a74
    v_mul_f32 v169, v170, v169
    v_accvgpr_write_b32 a74, v169
    v_accvgpr_read_b32 v169, a75
    v_mul_f32 v169, v170, v169
    v_accvgpr_write_b32 a75, v169
    v_accvgpr_read_b32 v169, a84
    v_mul_f32 v169, v170, v169
    v_accvgpr_write_b32 a84, v169
    v_accvgpr_read_b32 v169, a85
    v_mul_f32 v169, v170, v169
    v_accvgpr_write_b32 a85, v169
    v_accvgpr_read_b32 v169, a86
    v_mul_f32 v169, v170, v169
    v_accvgpr_write_b32 a86, v169
    v_accvgpr_read_b32 v169, a87
    v_mul_f32 v169, v170, v169
    v_accvgpr_write_b32 a87, v169
    v_accvgpr_read_b32 v169, a96
    v_mul_f32 v169, v170, v169
    v_accvgpr_write_b32 a96, v169
    v_accvgpr_read_b32 v169, a97
    v_mul_f32 v169, v170, v169
    v_accvgpr_write_b32 a97, v169
    v_accvgpr_read_b32 v169, a98
    v_mul_f32 v169, v170, v169
    v_accvgpr_write_b32 a98, v169
    v_accvgpr_read_b32 v169, a99
    v_mul_f32 v169, v170, v169
    v_accvgpr_write_b32 a99, v169
    v_accvgpr_read_b32 v169, a108
    v_mul_f32 v169, v170, v169
    v_accvgpr_write_b32 a108, v169
    v_accvgpr_read_b32 v169, a109
    v_mul_f32 v169, v170, v169
    v_accvgpr_write_b32 a109, v169
    v_accvgpr_read_b32 v169, a110
    v_mul_f32 v169, v170, v169
    v_accvgpr_write_b32 a110, v169
    v_accvgpr_read_b32 v169, a111
    v_mul_f32 v169, v170, v169
    v_accvgpr_write_b32 a111, v169
    v_accvgpr_read_b32 v169, a120
    v_mul_f32 v169, v170, v169
    v_accvgpr_write_b32 a120, v169
    v_accvgpr_read_b32 v169, a121
    v_mul_f32 v169, v170, v169
    v_accvgpr_write_b32 a121, v169
    v_accvgpr_read_b32 v169, a122
    v_mul_f32 v169, v170, v169
    v_accvgpr_write_b32 a122, v169
    v_accvgpr_read_b32 v169, a123
    v_mul_f32 v169, v170, v169
    v_accvgpr_write_b32 a123, v169
    v_accvgpr_read_b32 v169, a132
    v_mul_f32 v169, v170, v169
    v_accvgpr_write_b32 a132, v169
    v_accvgpr_read_b32 v169, a133
    v_mul_f32 v169, v170, v169
    v_accvgpr_write_b32 a133, v169
    v_accvgpr_read_b32 v169, a134
    v_mul_f32 v169, v170, v169
    v_accvgpr_write_b32 a134, v169
    v_accvgpr_read_b32 v169, a135
    v_mul_f32 v169, v170, v169
    v_accvgpr_write_b32 a135, v169
    v_accvgpr_read_b32 v169, a144
    v_mul_f32 v169, v170, v169
    v_accvgpr_write_b32 a144, v169
    v_accvgpr_read_b32 v169, a145
    v_mul_f32 v169, v170, v169
    v_accvgpr_write_b32 a145, v169
    v_accvgpr_read_b32 v169, a146
    v_mul_f32 v169, v170, v169
    v_accvgpr_write_b32 a146, v169
    v_accvgpr_read_b32 v169, a147
    v_mul_f32 v169, v170, v169
    v_accvgpr_write_b32 a147, v169
    v_accvgpr_read_b32 v169, a156
    v_mul_f32 v169, v170, v169
    v_accvgpr_write_b32 a156, v169
    v_accvgpr_read_b32 v169, a157
    v_mul_f32 v169, v170, v169
    v_accvgpr_write_b32 a157, v169
    v_accvgpr_read_b32 v169, a158
    v_mul_f32 v169, v170, v169
    v_accvgpr_write_b32 a158, v169
    v_accvgpr_read_b32 v169, a159
    v_mul_f32 v169, v170, v169
    v_accvgpr_write_b32 a159, v169
    v_accvgpr_read_b32 v169, a168
    v_mul_f32 v169, v170, v169
    v_accvgpr_write_b32 a168, v169
    v_accvgpr_read_b32 v169, a169
    v_mul_f32 v169, v170, v169
    v_accvgpr_write_b32 a169, v169
    v_accvgpr_read_b32 v169, a170
    v_mul_f32 v169, v170, v169
    v_accvgpr_write_b32 a170, v169
    v_accvgpr_read_b32 v169, a171
    v_mul_f32 v169, v170, v169
    v_accvgpr_write_b32 a171, v169
    v_accvgpr_read_b32 v169, a180
    v_mul_f32 v169, v170, v169
    v_accvgpr_write_b32 a180, v169
    v_accvgpr_read_b32 v169, a181
    v_mul_f32 v169, v170, v169
    v_accvgpr_write_b32 a181, v169
    v_accvgpr_read_b32 v169, a182
    v_mul_f32 v169, v170, v169
    v_accvgpr_write_b32 a182, v169
    v_accvgpr_read_b32 v169, a183
    v_mul_f32 v169, v170, v169
    v_accvgpr_write_b32 a183, v169
    v_accvgpr_read_b32 v169, a192
    v_mul_f32 v169, v170, v169
    v_accvgpr_write_b32 a192, v169
    v_accvgpr_read_b32 v169, a193
    v_mul_f32 v169, v170, v169
    v_accvgpr_write_b32 a193, v169
    v_accvgpr_read_b32 v169, a194
    v_mul_f32 v169, v170, v169
    v_accvgpr_write_b32 a194, v169
    v_accvgpr_read_b32 v169, a195
    v_mul_f32 v169, v170, v169
    v_accvgpr_write_b32 a195, v169
    v_exp_f32 v171, v96
    v_exp_f32 v172, v97
    s_nop 1
    v_cvt_pk_bf16_f32 v144, v171, v172
    v_exp_f32 v171, v98
    v_exp_f32 v172, v99
    s_nop 1
    v_cvt_pk_bf16_f32 v145, v171, v172
    v_exp_f32 v171, v108
    v_exp_f32 v172, v109
    s_nop 1
    v_cvt_pk_bf16_f32 v146, v171, v172
    v_exp_f32 v171, v110
    v_exp_f32 v172, v111
    s_nop 1
    v_cvt_pk_bf16_f32 v147, v171, v172
    v_max3_f32 v168, v100, v101, v102
    v_max3_f32 v168, v168, v103, v112
    v_max3_f32 v168, v168, v113, v114
    v_max_f32 v168, v168, v115
    v_mov_b32 v169, v168
    s_nop 1
    v_permlane32_swap_b32 v168, v169
    s_nop 1
    v_max_f32 v168, v168, v169
    v_mov_b32 v169, v168
    s_nop 1
    v_permlane16_swap_b32 v168, v169
    s_nop 1
    v_max_f32 v168, v168, v169
    v_add_f32 v168, s51, v168
    v_max_f32 v168, 0, v168
    v_sub_f32 v100, v100, v168
    v_sub_f32 v101, v101, v168
    v_sub_f32 v102, v102, v168
    v_sub_f32 v103, v103, v168
    v_sub_f32 v112, v112, v168
    v_sub_f32 v113, v113, v168
    v_sub_f32 v114, v114, v168
    v_sub_f32 v115, v115, v168
    v_sub_f32 v124, v124, v168
    v_sub_f32 v125, v125, v168
    v_sub_f32 v126, v126, v168
    v_sub_f32 v127, v127, v168
    v_sub_f32 v136, v136, v168
    v_sub_f32 v137, v137, v168
    v_sub_f32 v138, v138, v168
    v_sub_f32 v139, v139, v168
    v_sub_f32 v180, v180, v168
    v_sub_f32 v181, v181, v168
    v_sub_f32 v182, v182, v168
    v_sub_f32 v183, v183, v168
    v_exp_f32_e64 v170, -v168
    s_nop 1
    v_accvgpr_read_b32 v169, a4
    v_mul_f32 v169, v170, v169
    v_accvgpr_write_b32 a4, v169
    v_accvgpr_read_b32 v169, a5
    v_mul_f32 v169, v170, v169
    v_accvgpr_write_b32 a5, v169
    v_accvgpr_read_b32 v169, a6
    v_mul_f32 v169, v170, v169
    v_accvgpr_write_b32 a6, v169
    v_accvgpr_read_b32 v169, a7
    v_mul_f32 v169, v170, v169
    v_accvgpr_write_b32 a7, v169
    v_accvgpr_read_b32 v169, a16
    v_mul_f32 v169, v170, v169
    v_accvgpr_write_b32 a16, v169
    v_accvgpr_read_b32 v169, a17
    v_mul_f32 v169, v170, v169
    v_accvgpr_write_b32 a17, v169
    v_accvgpr_read_b32 v169, a18
    v_mul_f32 v169, v170, v169
    v_accvgpr_write_b32 a18, v169
    v_accvgpr_read_b32 v169, a19
    v_mul_f32 v169, v170, v169
    v_accvgpr_write_b32 a19, v169
    v_accvgpr_read_b32 v169, a28
    v_mul_f32 v169, v170, v169
    v_accvgpr_write_b32 a28, v169
    v_accvgpr_read_b32 v169, a29
    v_mul_f32 v169, v170, v169
    v_accvgpr_write_b32 a29, v169
    v_accvgpr_read_b32 v169, a30
    v_mul_f32 v169, v170, v169
    v_accvgpr_write_b32 a30, v169
    v_accvgpr_read_b32 v169, a31
    v_mul_f32 v169, v170, v169
    v_accvgpr_write_b32 a31, v169
    v_accvgpr_read_b32 v169, a40
    v_mul_f32 v169, v170, v169
    v_accvgpr_write_b32 a40, v169
    v_accvgpr_read_b32 v169, a41
    v_mul_f32 v169, v170, v169
    v_accvgpr_write_b32 a41, v169
    v_accvgpr_read_b32 v169, a42
    v_mul_f32 v169, v170, v169
    v_accvgpr_write_b32 a42, v169
    v_accvgpr_read_b32 v169, a43
    v_mul_f32 v169, v170, v169
    v_accvgpr_write_b32 a43, v169
    v_accvgpr_read_b32 v169, a52
    v_mul_f32 v169, v170, v169
    v_accvgpr_write_b32 a52, v169
    v_accvgpr_read_b32 v169, a53
    v_mul_f32 v169, v170, v169
    v_accvgpr_write_b32 a53, v169
    v_accvgpr_read_b32 v169, a54
    v_mul_f32 v169, v170, v169
    v_accvgpr_write_b32 a54, v169
    v_accvgpr_read_b32 v169, a55
    v_mul_f32 v169, v170, v169
    v_accvgpr_write_b32 a55, v169
    v_accvgpr_read_b32 v169, a64
    v_mul_f32 v169, v170, v169
    v_accvgpr_write_b32 a64, v169
    v_accvgpr_read_b32 v169, a65
    v_mul_f32 v169, v170, v169
    v_accvgpr_write_b32 a65, v169
    v_accvgpr_read_b32 v169, a66
    v_mul_f32 v169, v170, v169
    v_accvgpr_write_b32 a66, v169
    v_accvgpr_read_b32 v169, a67
    v_mul_f32 v169, v170, v169
    v_accvgpr_write_b32 a67, v169
    v_accvgpr_read_b32 v169, a76
    v_mul_f32 v169, v170, v169
    v_accvgpr_write_b32 a76, v169
    v_accvgpr_read_b32 v169, a77
    v_mul_f32 v169, v170, v169
    v_accvgpr_write_b32 a77, v169
    v_accvgpr_read_b32 v169, a78
    v_mul_f32 v169, v170, v169
    v_accvgpr_write_b32 a78, v169
    v_accvgpr_read_b32 v169, a79
    v_mul_f32 v169, v170, v169
    v_accvgpr_write_b32 a79, v169
    v_accvgpr_read_b32 v169, a88
    v_mul_f32 v169, v170, v169
    v_accvgpr_write_b32 a88, v169
    v_accvgpr_read_b32 v169, a89
    v_mul_f32 v169, v170, v169
    v_accvgpr_write_b32 a89, v169
    v_accvgpr_read_b32 v169, a90
    v_mul_f32 v169, v170, v169
    v_accvgpr_write_b32 a90, v169
    v_accvgpr_read_b32 v169, a91
    v_mul_f32 v169, v170, v169
    v_accvgpr_write_b32 a91, v169
    v_accvgpr_read_b32 v169, a100
    v_mul_f32 v169, v170, v169
    v_accvgpr_write_b32 a100, v169
    v_accvgpr_read_b32 v169, a101
    v_mul_f32 v169, v170, v169
    v_accvgpr_write_b32 a101, v169
    v_accvgpr_read_b32 v169, a102
    v_mul_f32 v169, v170, v169
    v_accvgpr_write_b32 a102, v169
    v_accvgpr_read_b32 v169, a103
    v_mul_f32 v169, v170, v169
    v_accvgpr_write_b32 a103, v169
    v_accvgpr_read_b32 v169, a112
    v_mul_f32 v169, v170, v169
    v_accvgpr_write_b32 a112, v169
    v_accvgpr_read_b32 v169, a113
    v_mul_f32 v169, v170, v169
    v_accvgpr_write_b32 a113, v169
    v_accvgpr_read_b32 v169, a114
    v_mul_f32 v169, v170, v169
    v_accvgpr_write_b32 a114, v169
    v_accvgpr_read_b32 v169, a115
    v_mul_f32 v169, v170, v169
    v_accvgpr_write_b32 a115, v169
    v_accvgpr_read_b32 v169, a124
    v_mul_f32 v169, v170, v169
    v_accvgpr_write_b32 a124, v169
    v_accvgpr_read_b32 v169, a125
    v_mul_f32 v169, v170, v169
    v_accvgpr_write_b32 a125, v169
    v_accvgpr_read_b32 v169, a126
    v_mul_f32 v169, v170, v169
    v_accvgpr_write_b32 a126, v169
    v_accvgpr_read_b32 v169, a127
    v_mul_f32 v169, v170, v169
    v_accvgpr_write_b32 a127, v169
    v_accvgpr_read_b32 v169, a136
    v_mul_f32 v169, v170, v169
    v_accvgpr_write_b32 a136, v169
    v_accvgpr_read_b32 v169, a137
    v_mul_f32 v169, v170, v169
    v_accvgpr_write_b32 a137, v169
    v_accvgpr_read_b32 v169, a138
    v_mul_f32 v169, v170, v169
    v_accvgpr_write_b32 a138, v169
    v_accvgpr_read_b32 v169, a139
    v_mul_f32 v169, v170, v169
    v_accvgpr_write_b32 a139, v169
    v_accvgpr_read_b32 v169, a148
    v_mul_f32 v169, v170, v169
    v_accvgpr_write_b32 a148, v169
    v_accvgpr_read_b32 v169, a149
    v_mul_f32 v169, v170, v169
    v_accvgpr_write_b32 a149, v169
    v_accvgpr_read_b32 v169, a150
    v_mul_f32 v169, v170, v169
    v_accvgpr_write_b32 a150, v169
    v_accvgpr_read_b32 v169, a151
    v_mul_f32 v169, v170, v169
    v_accvgpr_write_b32 a151, v169
    v_accvgpr_read_b32 v169, a160
    v_mul_f32 v169, v170, v169
    v_accvgpr_write_b32 a160, v169
    v_accvgpr_read_b32 v169, a161
    v_mul_f32 v169, v170, v169
    v_accvgpr_write_b32 a161, v169
    v_accvgpr_read_b32 v169, a162
    v_mul_f32 v169, v170, v169
    v_accvgpr_write_b32 a162, v169
    v_accvgpr_read_b32 v169, a163
    v_mul_f32 v169, v170, v169
    v_accvgpr_write_b32 a163, v169
    v_accvgpr_read_b32 v169, a172
    v_mul_f32 v169, v170, v169
    v_accvgpr_write_b32 a172, v169
    v_accvgpr_read_b32 v169, a173
    v_mul_f32 v169, v170, v169
    v_accvgpr_write_b32 a173, v169
    v_accvgpr_read_b32 v169, a174
    v_mul_f32 v169, v170, v169
    v_accvgpr_write_b32 a174, v169
    v_accvgpr_read_b32 v169, a175
    v_mul_f32 v169, v170, v169
    v_accvgpr_write_b32 a175, v169
    v_accvgpr_read_b32 v169, a184
    v_mul_f32 v169, v170, v169
    v_accvgpr_write_b32 a184, v169
    v_accvgpr_read_b32 v169, a185
    v_mul_f32 v169, v170, v169
    v_accvgpr_write_b32 a185, v169
    v_accvgpr_read_b32 v169, a186
    v_mul_f32 v169, v170, v169
    v_accvgpr_write_b32 a186, v169
    v_accvgpr_read_b32 v169, a187
    v_mul_f32 v169, v170, v169
    v_accvgpr_write_b32 a187, v169
    v_accvgpr_read_b32 v169, a196
    v_mul_f32 v169, v170, v169
    v_accvgpr_write_b32 a196, v169
    v_accvgpr_read_b32 v169, a197
    v_mul_f32 v169, v170, v169
    v_accvgpr_write_b32 a197, v169
    v_accvgpr_read_b32 v169, a198
    v_mul_f32 v169, v170, v169
    v_accvgpr_write_b32 a198, v169
    v_accvgpr_read_b32 v169, a199
    v_mul_f32 v169, v170, v169
    v_accvgpr_write_b32 a199, v169
    v_exp_f32 v171, v100
    v_exp_f32 v172, v101
    s_nop 1
    v_cvt_pk_bf16_f32 v148, v171, v172
    v_exp_f32 v171, v102
    v_exp_f32 v172, v103
    s_nop 1
    v_cvt_pk_bf16_f32 v149, v171, v172
    v_exp_f32 v171, v112
    v_exp_f32 v172, v113
    s_nop 1
    v_cvt_pk_bf16_f32 v150, v171, v172
    v_exp_f32 v171, v114
    v_exp_f32 v172, v115
    s_nop 1
    v_cvt_pk_bf16_f32 v151, v171, v172
    v_max3_f32 v168, v104, v105, v106
    v_max3_f32 v168, v168, v107, v116
    v_max3_f32 v168, v168, v117, v118
    v_max_f32 v168, v168, v119
    v_mov_b32 v169, v168
    s_nop 1
    v_permlane32_swap_b32 v168, v169
    s_nop 1
    v_max_f32 v168, v168, v169
    v_mov_b32 v169, v168
    s_nop 1
    v_permlane16_swap_b32 v168, v169
    s_nop 1
    v_max_f32 v168, v168, v169
    v_add_f32 v168, s51, v168
    v_max_f32 v168, 0, v168
    v_sub_f32 v104, v104, v168
    v_sub_f32 v105, v105, v168
    v_sub_f32 v106, v106, v168
    v_sub_f32 v107, v107, v168
    v_sub_f32 v116, v116, v168
    v_sub_f32 v117, v117, v168
    v_sub_f32 v118, v118, v168
    v_sub_f32 v119, v119, v168
    v_sub_f32 v128, v128, v168
    v_sub_f32 v129, v129, v168
    v_sub_f32 v130, v130, v168
    v_sub_f32 v131, v131, v168
    v_sub_f32 v140, v140, v168
    v_sub_f32 v141, v141, v168
    v_sub_f32 v142, v142, v168
    v_sub_f32 v143, v143, v168
    v_sub_f32 v184, v184, v168
    v_sub_f32 v185, v185, v168
    v_sub_f32 v186, v186, v168
    v_sub_f32 v187, v187, v168
    v_exp_f32_e64 v170, -v168
    s_nop 1
    v_accvgpr_read_b32 v169, a8
    v_mul_f32 v169, v170, v169
    v_accvgpr_write_b32 a8, v169
    v_accvgpr_read_b32 v169, a9
    v_mul_f32 v169, v170, v169
    v_accvgpr_write_b32 a9, v169
    v_accvgpr_read_b32 v169, a10
    v_mul_f32 v169, v170, v169
    v_accvgpr_write_b32 a10, v169
    v_accvgpr_read_b32 v169, a11
    v_mul_f32 v169, v170, v169
    v_accvgpr_write_b32 a11, v169
    v_accvgpr_read_b32 v169, a20
    v_mul_f32 v169, v170, v169
    v_accvgpr_write_b32 a20, v169
    v_accvgpr_read_b32 v169, a21
    v_mul_f32 v169, v170, v169
    v_accvgpr_write_b32 a21, v169
    v_accvgpr_read_b32 v169, a22
    v_mul_f32 v169, v170, v169
    v_accvgpr_write_b32 a22, v169
    v_accvgpr_read_b32 v169, a23
    v_mul_f32 v169, v170, v169
    v_accvgpr_write_b32 a23, v169
    v_accvgpr_read_b32 v169, a32
    v_mul_f32 v169, v170, v169
    v_accvgpr_write_b32 a32, v169
    v_accvgpr_read_b32 v169, a33
    v_mul_f32 v169, v170, v169
    v_accvgpr_write_b32 a33, v169
    v_accvgpr_read_b32 v169, a34
    v_mul_f32 v169, v170, v169
    v_accvgpr_write_b32 a34, v169
    v_accvgpr_read_b32 v169, a35
    v_mul_f32 v169, v170, v169
    v_accvgpr_write_b32 a35, v169
    v_accvgpr_read_b32 v169, a44
    v_mul_f32 v169, v170, v169
    v_accvgpr_write_b32 a44, v169
    v_accvgpr_read_b32 v169, a45
    v_mul_f32 v169, v170, v169
    v_accvgpr_write_b32 a45, v169
    v_accvgpr_read_b32 v169, a46
    v_mul_f32 v169, v170, v169
    v_accvgpr_write_b32 a46, v169
    v_accvgpr_read_b32 v169, a47
    v_mul_f32 v169, v170, v169
    v_accvgpr_write_b32 a47, v169
    v_accvgpr_read_b32 v169, a56
    v_mul_f32 v169, v170, v169
    v_accvgpr_write_b32 a56, v169
    v_accvgpr_read_b32 v169, a57
    v_mul_f32 v169, v170, v169
    v_accvgpr_write_b32 a57, v169
    v_accvgpr_read_b32 v169, a58
    v_mul_f32 v169, v170, v169
    v_accvgpr_write_b32 a58, v169
    v_accvgpr_read_b32 v169, a59
    v_mul_f32 v169, v170, v169
    v_accvgpr_write_b32 a59, v169
    v_accvgpr_read_b32 v169, a68
    v_mul_f32 v169, v170, v169
    v_accvgpr_write_b32 a68, v169
    v_accvgpr_read_b32 v169, a69
    v_mul_f32 v169, v170, v169
    v_accvgpr_write_b32 a69, v169
    v_accvgpr_read_b32 v169, a70
    v_mul_f32 v169, v170, v169
    v_accvgpr_write_b32 a70, v169
    v_accvgpr_read_b32 v169, a71
    v_mul_f32 v169, v170, v169
    v_accvgpr_write_b32 a71, v169
    v_accvgpr_read_b32 v169, a80
    v_mul_f32 v169, v170, v169
    v_accvgpr_write_b32 a80, v169
    v_accvgpr_read_b32 v169, a81
    v_mul_f32 v169, v170, v169
    v_accvgpr_write_b32 a81, v169
    v_accvgpr_read_b32 v169, a82
    v_mul_f32 v169, v170, v169
    v_accvgpr_write_b32 a82, v169
    v_accvgpr_read_b32 v169, a83
    v_mul_f32 v169, v170, v169
    v_accvgpr_write_b32 a83, v169
    v_accvgpr_read_b32 v169, a92
    v_mul_f32 v169, v170, v169
    v_accvgpr_write_b32 a92, v169
    v_accvgpr_read_b32 v169, a93
    v_mul_f32 v169, v170, v169
    v_accvgpr_write_b32 a93, v169
    v_accvgpr_read_b32 v169, a94
    v_mul_f32 v169, v170, v169
    v_accvgpr_write_b32 a94, v169
    v_accvgpr_read_b32 v169, a95
    v_mul_f32 v169, v170, v169
    v_accvgpr_write_b32 a95, v169
    v_accvgpr_read_b32 v169, a104
    v_mul_f32 v169, v170, v169
    v_accvgpr_write_b32 a104, v169
    v_accvgpr_read_b32 v169, a105
    v_mul_f32 v169, v170, v169
    v_accvgpr_write_b32 a105, v169
    v_accvgpr_read_b32 v169, a106
    v_mul_f32 v169, v170, v169
    v_accvgpr_write_b32 a106, v169
    v_accvgpr_read_b32 v169, a107
    v_mul_f32 v169, v170, v169
    v_accvgpr_write_b32 a107, v169
    v_accvgpr_read_b32 v169, a116
    v_mul_f32 v169, v170, v169
    v_accvgpr_write_b32 a116, v169
    v_accvgpr_read_b32 v169, a117
    v_mul_f32 v169, v170, v169
    v_accvgpr_write_b32 a117, v169
    v_accvgpr_read_b32 v169, a118
    v_mul_f32 v169, v170, v169
    v_accvgpr_write_b32 a118, v169
    v_accvgpr_read_b32 v169, a119
    v_mul_f32 v169, v170, v169
    v_accvgpr_write_b32 a119, v169
    v_accvgpr_read_b32 v169, a128
    v_mul_f32 v169, v170, v169
    v_accvgpr_write_b32 a128, v169
    v_accvgpr_read_b32 v169, a129
    v_mul_f32 v169, v170, v169
    v_accvgpr_write_b32 a129, v169
    v_accvgpr_read_b32 v169, a130
    v_mul_f32 v169, v170, v169
    v_accvgpr_write_b32 a130, v169
    v_accvgpr_read_b32 v169, a131
    v_mul_f32 v169, v170, v169
    v_accvgpr_write_b32 a131, v169
    v_accvgpr_read_b32 v169, a140
    v_mul_f32 v169, v170, v169
    v_accvgpr_write_b32 a140, v169
    v_accvgpr_read_b32 v169, a141
    v_mul_f32 v169, v170, v169
    v_accvgpr_write_b32 a141, v169
    v_accvgpr_read_b32 v169, a142
    v_mul_f32 v169, v170, v169
    v_accvgpr_write_b32 a142, v169
    v_accvgpr_read_b32 v169, a143
    v_mul_f32 v169, v170, v169
    v_accvgpr_write_b32 a143, v169
    v_accvgpr_read_b32 v169, a152
    v_mul_f32 v169, v170, v169
    v_accvgpr_write_b32 a152, v169
    v_accvgpr_read_b32 v169, a153
    v_mul_f32 v169, v170, v169
    v_accvgpr_write_b32 a153, v169
    v_accvgpr_read_b32 v169, a154
    v_mul_f32 v169, v170, v169
    v_accvgpr_write_b32 a154, v169
    v_accvgpr_read_b32 v169, a155
    v_mul_f32 v169, v170, v169
    v_accvgpr_write_b32 a155, v169
    v_accvgpr_read_b32 v169, a164
    v_mul_f32 v169, v170, v169
    v_accvgpr_write_b32 a164, v169
    v_accvgpr_read_b32 v169, a165
    v_mul_f32 v169, v170, v169
    v_accvgpr_write_b32 a165, v169
    v_accvgpr_read_b32 v169, a166
    v_mul_f32 v169, v170, v169
    v_accvgpr_write_b32 a166, v169
    v_accvgpr_read_b32 v169, a167
    v_mul_f32 v169, v170, v169
    v_accvgpr_write_b32 a167, v169
    v_accvgpr_read_b32 v169, a176
    v_mul_f32 v169, v170, v169
    v_accvgpr_write_b32 a176, v169
    v_accvgpr_read_b32 v169, a177
    v_mul_f32 v169, v170, v169
    v_accvgpr_write_b32 a177, v169
    v_accvgpr_read_b32 v169, a178
    v_mul_f32 v169, v170, v169
    v_accvgpr_write_b32 a178, v169
    v_accvgpr_read_b32 v169, a179
    v_mul_f32 v169, v170, v169
    v_accvgpr_write_b32 a179, v169
    v_accvgpr_read_b32 v169, a188
    v_mul_f32 v169, v170, v169
    v_accvgpr_write_b32 a188, v169
    v_accvgpr_read_b32 v169, a189
    v_mul_f32 v169, v170, v169
    v_accvgpr_write_b32 a189, v169
    v_accvgpr_read_b32 v169, a190
    v_mul_f32 v169, v170, v169
    v_accvgpr_write_b32 a190, v169
    v_accvgpr_read_b32 v169, a191
    v_mul_f32 v169, v170, v169
    v_accvgpr_write_b32 a191, v169
    v_accvgpr_read_b32 v169, a200
    v_mul_f32 v169, v170, v169
    v_accvgpr_write_b32 a200, v169
    v_accvgpr_read_b32 v169, a201
    v_mul_f32 v169, v170, v169
    v_accvgpr_write_b32 a201, v169
    v_accvgpr_read_b32 v169, a202
    v_mul_f32 v169, v170, v169
    v_accvgpr_write_b32 a202, v169
    v_accvgpr_read_b32 v169, a203
    v_mul_f32 v169, v170, v169
    v_accvgpr_write_b32 a203, v169
    v_exp_f32 v171, v104
    v_exp_f32 v172, v105
    s_nop 1
    v_cvt_pk_bf16_f32 v152, v171, v172
    v_exp_f32 v171, v106
    v_exp_f32 v172, v107
    s_nop 1
    v_cvt_pk_bf16_f32 v153, v171, v172
    v_exp_f32 v171, v116
    v_exp_f32 v172, v117
    s_nop 1
    v_cvt_pk_bf16_f32 v154, v171, v172
    v_exp_f32 v171, v118
    v_exp_f32 v172, v119
    s_nop 1
    v_cvt_pk_bf16_f32 v155, v171, v172
    s_nop 7
    s_setpc_b64 s[28:29]
L_rare1:
    s_nop 15
    s_nop 15
    v_max3_f32 v168, v120, v121, v122
    v_max3_f32 v168, v168, v123, v132
    v_max3_f32 v168, v168, v133, v134
    v_max_f32 v168, v168, v135
    v_mov_b32 v169, v168
    s_nop 1
    v_permlane32_swap_b32 v168, v169
    s_nop 1
    v_max_f32 v168, v168, v169
    v_mov_b32 v169, v168
    s_nop 1
    v_permlane16_swap_b32 v168, v169
    s_nop 1
    v_max_f32 v168, v168, v169
    v_add_f32 v168, s51, v168
    v_max_f32 v168, 0, v168
    v_sub_f32 v120, v120, v168
    v_sub_f32 v121, v121, v168
    v_sub_f32 v122, v122, v168
    v_sub_f32 v123, v123, v168
    v_sub_f32 v132, v132, v168
    v_sub_f32 v133, v133, v168
    v_sub_f32 v134, v134, v168
    v_sub_f32 v135, v135, v168
    v_sub_f32 v96, v96, v168
    v_sub_f32 v97, v97, v168
    v_sub_f32 v98, v98, v168
    v_sub_f32 v99, v99, v168
    v_sub_f32 v108, v108, v168
    v_sub_f32 v109, v109, v168
    v_sub_f32 v110, v110, v168
    v_sub_f32 v111, v111, v168
    v_sub_f32 v176, v176, v168
    v_sub_f32 v177, v177, v168
    v_sub_f32 v178, v178, v168
    v_sub_f32 v179, v179, v168
    v_exp_f32_e64 v170, -v168
    s_nop 1
    v_accvgpr_read_b32 v169, a0
    v_mul_f32 v169, v170, v169
    v_accvgpr_write_b32 a0, v169
    v_accvgpr_read_b32 v169, a1
    v_mul_f32 v169, v170, v169
    v_accvgpr_write_b32 a1, v169
    v_accvgpr_read_b32 v169, a2
    v_mul_f32 v169, v170, v169
    v_accvgpr_write_b32 a2, v169
    v_accvgpr_read_b32 v169, a3
    v_mul_f32 v169, v170, v169
    v_accvgpr_write_b32 a3, v169
    v_accvgpr_read_b32 v169, a12
    v_mul_f32 v169, v170, v169
    v_accvgpr_write_b32 a12, v169
    v_accvgpr_read_b32 v169, a13
    v_mul_f32 v169, v170, v169
    v_accvgpr_write_b32 a13, v169
    v_accvgpr_read_b32 v169, a14
    v_mul_f32 v169, v170, v169
    v_accvgpr_write_b32 a14, v169
    v_accvgpr_read_b32 v169, a15
    v_mul_f32 v169, v170, v169
    v_accvgpr_write_b32 a15, v169
    v_accvgpr_read_b32 v169, a24
    v_mul_f32 v169, v170, v169
    v_accvgpr_write_b32 a24, v169
    v_accvgpr_read_b32 v169, a25
    v_mul_f32 v169, v170, v169
    v_accvgpr_write_b32 a25, v169
    v_accvgpr_read_b32 v169, a26
    v_mul_f32 v169, v170, v169
    v_accvgpr_write_b32 a26, v169
    v_accvgpr_read_b32 v169, a27
    v_mul_f32 v169, v170, v169
    v_accvgpr_write_b32 a27, v169
    v_accvgpr_read_b32 v169, a36
    v_mul_f32 v169, v170, v169
    v_accvgpr_write_b32 a36, v169
    v_accvgpr_read_b32 v169, a37
    v_mul_f32 v169, v170, v169
    v_accvgpr_write_b32 a37, v169
    v_accvgpr_read_b32 v169, a38
    v_mul_f32 v169, v170, v169
    v_accvgpr_write_b32 a38, v169
    v_accvgpr_read_b32 v169, a39
    v_mul_f32 v169, v170, v169
    v_accvgpr_write_b32 a39, v169
    v_accvgpr_read_b32 v169, a48
    v_mul_f32 v169, v170, v169
    v_accvgpr_write_b32 a48, v169
    v_accvgpr_read_b32 v169, a49
    v_mul_f32 v169, v170, v169
    v_accvgpr_write_b32 a49, v169
    v_accvgpr_read_b32 v169, a50
    v_mul_f32 v169, v170, v169
    v_accvgpr_write_b32 a50, v169
    v_accvgpr_read_b32 v169, a51
    v_mul_f32 v169, v170, v169
    v_accvgpr_write_b32 a51, v169
    v_accvgpr_read_b32 v169, a60
    v_mul_f32 v169, v170, v169
    v_accvgpr_write_b32 a60, v169
    v_accvgpr_read_b32 v169, a61
    v_mul_f32 v169, v170, v169
    v_accvgpr_write_b32 a61, v169
    v_accvgpr_read_b32 v169, a62
    v_mul_f32 v169, v170, v169
    v_accvgpr_write_b32 a62, v169
    v_accvgpr_read_b32 v169, a63
    v_mul_f32 v169, v170, v169
    v_accvgpr_write_b32 a63, v169
    v_accvgpr_read_b32 v169, a72
    v_mul_f32 v169, v170, v169
    v_accvgpr_write_b32 a72, v169
    v_accvgpr_read_b32 v169, a73
    v_mul_f32 v169, v170, v169
    v_accvgpr_write_b32 a73, v169
    v_accvgpr_read_b32 v169, a74
    v_mul_f32 v169, v170, v169
    v_accvgpr_write_b32 a74, v169
    v_accvgpr_read_b32 v169, a75
    v_mul_f32 v169, v170, v169
    v_accvgpr_write_b32 a75, v169
    v_accvgpr_read_b32 v169, a84
    v_mul_f32 v169, v170, v169
    v_accvgpr_write_b32 a84, v169
    v_accvgpr_read_b32 v169, a85
    v_mul_f32 v169, v170, v169
    v_accvgpr_write_b32 a85, v169
    v_accvgpr_read_b32 v169, a86
    v_mul_f32 v169, v170, v169
    v_accvgpr_write_b32 a86, v169
    v_accvgpr_read_b32 v169, a87
    v_mul_f32 v169, v170, v169
    v_accvgpr_write_b32 a87, v169
    v_accvgpr_read_b32 v169, a96
    v_mul_f32 v169, v170, v169
    v_accvgpr_write_b32 a96, v169
    v_accvgpr_read_b32 v169, a97
    v_mul_f32 v169, v170, v169
    v_accvgpr_write_b32 a97, v169
    v_accvgpr_read_b32 v169, a98
    v_mul_f32 v169, v170, v169
    v_accvgpr_write_b32 a98, v169
    v_accvgpr_read_b32 v169, a99
    v_mul_f32 v169, v170, v169
    v_accvgpr_write_b32 a99, v169
    v_accvgpr_read_b32 v169, a108
    v_mul_f32 v169, v170, v169
    v_accvgpr_write_b32 a108, v169
    v_accvgpr_read_b32 v169, a109
    v_mul_f32 v169, v170, v169
    v_accvgpr_write_b32 a109, v169
    v_accvgpr_read_b32 v169, a110
    v_mul_f32 v169, v170, v169
    v_accvgpr_write_b32 a110, v169
    v_accvgpr_read_b32 v169, a111
    v_mul_f32 v169, v170, v169
    v_accvgpr_write_b32 a111, v169
    v_accvgpr_read_b32 v169, a120
    v_mul_f32 v169, v170, v169
    v_accvgpr_write_b32 a120, v169
    v_accvgpr_read_b32 v169, a121
    v_mul_f32 v169, v170, v169
    v_accvgpr_write_b32 a121, v169
    v_accvgpr_read_b32 v169, a122
    v_mul_f32 v169, v170, v169
    v_accvgpr_write_b32 a122, v169
    v_accvgpr_read_b32 v169, a123
    v_mul_f32 v169, v170, v169
    v_accvgpr_write_b32 a123, v169
    v_accvgpr_read_b32 v169, a132
    v_mul_f32 v169, v170, v169
    v_accvgpr_write_b32 a132, v169
    v_accvgpr_read_b32 v169, a133
    v_mul_f32 v169, v170, v169
    v_accvgpr_write_b32 a133, v169
    v_accvgpr_read_b32 v169, a134
    v_mul_f32 v169, v170, v169
    v_accvgpr_write_b32 a134, v169
    v_accvgpr_read_b32 v169, a135
    v_mul_f32 v169, v170, v169
    v_accvgpr_write_b32 a135, v169
    v_accvgpr_read_b32 v169, a144
    v_mul_f32 v169, v170, v169
    v_accvgpr_write_b32 a144, v169
    v_accvgpr_read_b32 v169, a145
    v_mul_f32 v169, v170, v169
    v_accvgpr_write_b32 a145, v169
    v_accvgpr_read_b32 v169, a146
    v_mul_f32 v169, v170, v169
    v_accvgpr_write_b32 a146, v169
    v_accvgpr_read_b32 v169, a147
    v_mul_f32 v169, v170, v169
    v_accvgpr_write_b32 a147, v169
    v_accvgpr_read_b32 v169, a156
    v_mul_f32 v169, v170, v169
    v_accvgpr_write_b32 a156, v169
    v_accvgpr_read_b32 v169, a157
    v_mul_f32 v169, v170, v169
    v_accvgpr_write_b32 a157, v169
    v_accvgpr_read_b32 v169, a158
    v_mul_f32 v169, v170, v169
    v_accvgpr_write_b32 a158, v169
    v_accvgpr_read_b32 v169, a159
    v_mul_f32 v169, v170, v169
    v_accvgpr_write_b32 a159, v169
    v_accvgpr_read_b32 v169, a168
    v_mul_f32 v169, v170, v169
    v_accvgpr_write_b32 a168, v169
    v_accvgpr_read_b32 v169, a169
    v_mul_f32 v169, v170, v169
    v_accvgpr_write_b32 a169, v169
    v_accvgpr_read_b32 v169, a170
    v_mul_f32 v169, v170, v169
    v_accvgpr_write_b32 a170, v169
    v_accvgpr_read_b32 v169, a171
    v_mul_f32 v169, v170, v169
    v_accvgpr_write_b32 a171, v169
    v_accvgpr_read_b32 v169, a180
    v_mul_f32 v169, v170, v169
    v_accvgpr_write_b32 a180, v169
    v_accvgpr_read_b32 v169, a181
    v_mul_f32 v169, v170, v169
    v_accvgpr_write_b32 a181, v169
    v_accvgpr_read_b32 v169, a182
    v_mul_f32 v169, v170, v169
    v_accvgpr_write_b32 a182, v169
    v_accvgpr_read_b32 v169, a183
    v_mul_f32 v169, v170, v169
    v_accvgpr_write_b32 a183, v169
    v_accvgpr_read_b32 v169, a192
    v_mul_f32 v169, v170, v169
    v_accvgpr_write_b32 a192, v169
    v_accvgpr_read_b32 v169, a193
    v_mul_f32 v169, v170, v169
    v_accvgpr_write_b32 a193, v169
    v_accvgpr_read_b32 v169, a194
    v_mul_f32 v169, v170, v169
    v_accvgpr_write_b32 a194, v169
    v_accvgpr_read_b32 v169, a195
    v_mul_f32 v169, v170, v169
    v_accvgpr_write_b32 a195, v169
    v_exp_f32 v171, v120
    v_exp_f32 v172, v121
    s_nop 1
    v_cvt_pk_bf16_f32 v156, v171, v172
    v_exp_f32 v171, v122
    v_exp_f32 v172, v123
    s_nop 1
    v_cvt_pk_bf16_f32 v157, v171, v172
    v_exp_f32 v171, v132
    v_exp_f32 v172, v133
    s_nop 1
    v_cvt_pk_bf16_f32 v158, v171, v172
    v_exp_f32 v171, v134
    v_exp_f32 v172, v135
    s_nop 1
    v_cvt_pk_bf16_f32 v159, v171, v172
    v_max3_f32 v168, v124, v125, v126
    v_max3_f32 v168, v168, v127, v136
    v_max3_f32 v168, v168, v137, v138
    v_max_f32 v168, v168, v139
    v_mov_b32 v169, v168
    s_nop 1
    v_permlane32_swap_b32 v168, v169
    s_nop 1
    v_max_f32 v168, v168, v169
    v_mov_b32 v169, v168
    s_nop 1
    v_permlane16_swap_b32 v168, v169
    s_nop 1
    v_max_f32 v168, v168, v169
    v_add_f32 v168, s51, v168
    v_max_f32 v168, 0, v168
    v_sub_f32 v124, v124, v168
    v_sub_f32 v125, v125, v168
    v_sub_f32 v126, v126, v168
    v_sub_f32 v127, v127, v168
    v_sub_f32 v136, v136, v168
    v_sub_f32 v137, v137, v168
    v_sub_f32 v138, v138, v168
    v_sub_f32 v139, v139, v168
    v_sub_f32 v100, v100, v168
    v_sub_f32 v101, v101, v168
    v_sub_f32 v102, v102, v168
    v_sub_f32 v103, v103, v168
    v_sub_f32 v112, v112, v168
    v_sub_f32 v113, v113, v168
    v_sub_f32 v114, v114, v168
    v_sub_f32 v115, v115, v168
    v_sub_f32 v180, v180, v168
    v_sub_f32 v181, v181, v168
    v_sub_f32 v182, v182, v168
    v_sub_f32 v183, v183, v168
    v_exp_f32_e64 v170, -v168
    s_nop 1
    v_accvgpr_read_b32 v169, a4
    v_mul_f32 v169, v170, v169
    v_accvgpr_write_b32 a4, v169
    v_accvgpr_read_b32 v169, a5
    v_mul_f32 v169, v170, v169
    v_accvgpr_write_b32 a5, v169
    v_accvgpr_read_b32 v169, a6
    v_mul_f32 v169, v170, v169
    v_accvgpr_write_b32 a6, v169
    v_accvgpr_read_b32 v169, a7
    v_mul_f32 v169, v170, v169
    v_accvgpr_write_b32 a7, v169
    v_accvgpr_read_b32 v169, a16
    v_mul_f32 v169, v170, v169
    v_accvgpr_write_b32 a16, v169
    v_accvgpr_read_b32 v169, a17
    v_mul_f32 v169, v170, v169
    v_accvgpr_write_b32 a17, v169
    v_accvgpr_read_b32 v169, a18
    v_mul_f32 v169, v170, v169
    v_accvgpr_write_b32 a18, v169
    v_accvgpr_read_b32 v169, a19
    v_mul_f32 v169, v170, v169
    v_accvgpr_write_b32 a19, v169
    v_accvgpr_read_b32 v169, a28
    v_mul_f32 v169, v170, v169
    v_accvgpr_write_b32 a28, v169
    v_accvgpr_read_b32 v169, a29
    v_mul_f32 v169, v170, v169
    v_accvgpr_write_b32 a29, v169
    v_accvgpr_read_b32 v169, a30
    v_mul_f32 v169, v170, v169
    v_accvgpr_write_b32 a30, v169
    v_accvgpr_read_b32 v169, a31
    v_mul_f32 v169, v170, v169
    v_accvgpr_write_b32 a31, v169
    v_accvgpr_read_b32 v169, a40
    v_mul_f32 v169, v170, v169
    v_accvgpr_write_b32 a40, v169
    v_accvgpr_read_b32 v169, a41
    v_mul_f32 v169, v170, v169
    v_accvgpr_write_b32 a41, v169
    v_accvgpr_read_b32 v169, a42
    v_mul_f32 v169, v170, v169
    v_accvgpr_write_b32 a42, v169
    v_accvgpr_read_b32 v169, a43
    v_mul_f32 v169, v170, v169
    v_accvgpr_write_b32 a43, v169
    v_accvgpr_read_b32 v169, a52
    v_mul_f32 v169, v170, v169
    v_accvgpr_write_b32 a52, v169
    v_accvgpr_read_b32 v169, a53
    v_mul_f32 v169, v170, v169
    v_accvgpr_write_b32 a53, v169
    v_accvgpr_read_b32 v169, a54
    v_mul_f32 v169, v170, v169
    v_accvgpr_write_b32 a54, v169
    v_accvgpr_read_b32 v169, a55
    v_mul_f32 v169, v170, v169
    v_accvgpr_write_b32 a55, v169
    v_accvgpr_read_b32 v169, a64
    v_mul_f32 v169, v170, v169
    v_accvgpr_write_b32 a64, v169
    v_accvgpr_read_b32 v169, a65
    v_mul_f32 v169, v170, v169
    v_accvgpr_write_b32 a65, v169
    v_accvgpr_read_b32 v169, a66
    v_mul_f32 v169, v170, v169
    v_accvgpr_write_b32 a66, v169
    v_accvgpr_read_b32 v169, a67
    v_mul_f32 v169, v170, v169
    v_accvgpr_write_b32 a67, v169
    v_accvgpr_read_b32 v169, a76
    v_mul_f32 v169, v170, v169
    v_accvgpr_write_b32 a76, v169
    v_accvgpr_read_b32 v169, a77
    v_mul_f32 v169, v170, v169
    v_accvgpr_write_b32 a77, v169
    v_accvgpr_read_b32 v169, a78
    v_mul_f32 v169, v170, v169
    v_accvgpr_write_b32 a78, v169
    v_accvgpr_read_b32 v169, a79
    v_mul_f32 v169, v170, v169
    v_accvgpr_write_b32 a79, v169
    v_accvgpr_read_b32 v169, a88
    v_mul_f32 v169, v170, v169
    v_accvgpr_write_b32 a88, v169
    v_accvgpr_read_b32 v169, a89
    v_mul_f32 v169, v170, v169
    v_accvgpr_write_b32 a89, v169
    v_accvgpr_read_b32 v169, a90
    v_mul_f32 v169, v170, v169
    v_accvgpr_write_b32 a90, v169
    v_accvgpr_read_b32 v169, a91
    v_mul_f32 v169, v170, v169
    v_accvgpr_write_b32 a91, v169
    v_accvgpr_read_b32 v169, a100
    v_mul_f32 v169, v170, v169
    v_accvgpr_write_b32 a100, v169
    v_accvgpr_read_b32 v169, a101
    v_mul_f32 v169, v170, v169
    v_accvgpr_write_b32 a101, v169
    v_accvgpr_read_b32 v169, a102
    v_mul_f32 v169, v170, v169
    v_accvgpr_write_b32 a102, v169
    v_accvgpr_read_b32 v169, a103
    v_mul_f32 v169, v170, v169
    v_accvgpr_write_b32 a103, v169
    v_accvgpr_read_b32 v169, a112
    v_mul_f32 v169, v170, v169
    v_accvgpr_write_b32 a112, v169
    v_accvgpr_read_b32 v169, a113
    v_mul_f32 v169, v170, v169
    v_accvgpr_write_b32 a113, v169
    v_accvgpr_read_b32 v169, a114
    v_mul_f32 v169, v170, v169
    v_accvgpr_write_b32 a114, v169
    v_accvgpr_read_b32 v169, a115
    v_mul_f32 v169, v170, v169
    v_accvgpr_write_b32 a115, v169
    v_accvgpr_read_b32 v169, a124
    v_mul_f32 v169, v170, v169
    v_accvgpr_write_b32 a124, v169
    v_accvgpr_read_b32 v169, a125
    v_mul_f32 v169, v170, v169
    v_accvgpr_write_b32 a125, v169
    v_accvgpr_read_b32 v169, a126
    v_mul_f32 v169, v170, v169
    v_accvgpr_write_b32 a126, v169
    v_accvgpr_read_b32 v169, a127
    v_mul_f32 v169, v170, v169
    v_accvgpr_write_b32 a127, v169
    v_accvgpr_read_b32 v169, a136
    v_mul_f32 v169, v170, v169
    v_accvgpr_write_b32 a136, v169
    v_accvgpr_read_b32 v169, a137
    v_mul_f32 v169, v170, v169
    v_accvgpr_write_b32 a137, v169
    v_accvgpr_read_b32 v169, a138
    v_mul_f32 v169, v170, v169
    v_accvgpr_write_b32 a138, v169
    v_accvgpr_read_b32 v169, a139
    v_mul_f32 v169, v170, v169
    v_accvgpr_write_b32 a139, v169
    v_accvgpr_read_b32 v169, a148
    v_mul_f32 v169, v170, v169
    v_accvgpr_write_b32 a148, v169
    v_accvgpr_read_b32 v169, a149
    v_mul_f32 v169, v170, v169
    v_accvgpr_write_b32 a149, v169
    v_accvgpr_read_b32 v169, a150
    v_mul_f32 v169, v170, v169
    v_accvgpr_write_b32 a150, v169
    v_accvgpr_read_b32 v169, a151
    v_mul_f32 v169, v170, v169
    v_accvgpr_write_b32 a151, v169
    v_accvgpr_read_b32 v169, a160
    v_mul_f32 v169, v170, v169
    v_accvgpr_write_b32 a160, v169
    v_accvgpr_read_b32 v169, a161
    v_mul_f32 v169, v170, v169
    v_accvgpr_write_b32 a161, v169
    v_accvgpr_read_b32 v169, a162
    v_mul_f32 v169, v170, v169
    v_accvgpr_write_b32 a162, v169
    v_accvgpr_read_b32 v169, a163
    v_mul_f32 v169, v170, v169
    v_accvgpr_write_b32 a163, v169
    v_accvgpr_read_b32 v169, a172
    v_mul_f32 v169, v170, v169
    v_accvgpr_write_b32 a172, v169
    v_accvgpr_read_b32 v169, a173
    v_mul_f32 v169, v170, v169
    v_accvgpr_write_b32 a173, v169
    v_accvgpr_read_b32 v169, a174
    v_mul_f32 v169, v170, v169
    v_accvgpr_write_b32 a174, v169
    v_accvgpr_read_b32 v169, a175
    v_mul_f32 v169, v170, v169
    v_accvgpr_write_b32 a175, v169
    v_accvgpr_read_b32 v169, a184
    v_mul_f32 v169, v170, v169
    v_accvgpr_write_b32 a184, v169
    v_accvgpr_read_b32 v169, a185
    v_mul_f32 v169, v170, v169
    v_accvgpr_write_b32 a185, v169
    v_accvgpr_read_b32 v169, a186
    v_mul_f32 v169, v170, v169
    v_accvgpr_write_b32 a186, v169
    v_accvgpr_read_b32 v169, a187
    v_mul_f32 v169, v170, v169
    v_accvgpr_write_b32 a187, v169
    v_accvgpr_read_b32 v169, a196
    v_mul_f32 v169, v170, v169
    v_accvgpr_write_b32 a196, v169
    v_accvgpr_read_b32 v169, a197
    v_mul_f32 v169, v170, v169
    v_accvgpr_write_b32 a197, v169
    v_accvgpr_read_b32 v169, a198
    v_mul_f32 v169, v170, v169
    v_accvgpr_write_b32 a198, v169
    v_accvgpr_read_b32 v169, a199
    v_mul_f32 v169, v170, v169
    v_accvgpr_write_b32 a199, v169
    v_exp_f32 v171, v124
    v_exp_f32 v172, v125
    s_nop 1
    v_cvt_pk_bf16_f32 v160, v171, v172
    v_exp_f32 v171, v126
    v_exp_f32 v172, v127
    s_nop 1
    v_cvt_pk_bf16_f32 v161, v171, v172
    v_exp_f32 v171, v136
    v_exp_f32 v172, v137
    s_nop 1
    v_cvt_pk_bf16_f32 v162, v171, v172
    v_exp_f32 v171, v138
    v_exp_f32 v172, v139
    s_nop 1
    v_cvt_pk_bf16_f32 v163, v171, v172
    v_max3_f32 v168, v128, v129, v130
    v_max3_f32 v168, v168, v131, v140
    v_max3_f32 v168, v168, v141, v142
    v_max_f32 v168, v168, v143
    v_mov_b32 v169, v168
    s_nop 1
    v_permlane32_swap_b32 v168, v169
    s_nop 1
    v_max_f32 v168, v168, v169
    v_mov_b32 v169, v168
    s_nop 1
    v_permlane16_swap_b32 v168, v169
    s_nop 1
    v_max_f32 v168, v168, v169
    v_add_f32 v168, s51, v168
    v_max_f32 v168, 0, v168
    v_sub_f32 v128, v128, v168
    v_sub_f32 v129, v129, v168
    v_sub_f32 v130, v130, v168
    v_sub_f32 v131, v131, v168
    v_sub_f32 v140, v140, v168
    v_sub_f32 v141, v141, v168
    v_sub_f32 v142, v142, v168
    v_sub_f32 v143, v143, v168
    v_sub_f32 v104, v104, v168
    v_sub_f32 v105, v105, v168
    v_sub_f32 v106, v106, v168
    v_sub_f32 v107, v107, v168
    v_sub_f32 v116, v116, v168
    v_sub_f32 v117, v117, v168
    v_sub_f32 v118, v118, v168
    v_sub_f32 v119, v119, v168
    v_sub_f32 v184, v184, v168
    v_sub_f32 v185, v185, v168
    v_sub_f32 v186, v186, v168
    v_sub_f32 v187, v187, v168
    v_exp_f32_e64 v170, -v168
    s_nop 1
    v_accvgpr_read_b32 v169, a8
    v_mul_f32 v169, v170, v169
    v_accvgpr_write_b32 a8, v169
    v_accvgpr_read_b32 v169, a9
    v_mul_f32 v169, v170, v169
    v_accvgpr_write_b32 a9, v169
    v_accvgpr_read_b32 v169, a10
    v_mul_f32 v169, v170, v169
    v_accvgpr_write_b32 a10, v169
    v_accvgpr_read_b32 v169, a11
    v_mul_f32 v169, v170, v169
    v_accvgpr_write_b32 a11, v169
    v_accvgpr_read_b32 v169, a20
    v_mul_f32 v169, v170, v169
    v_accvgpr_write_b32 a20, v169
    v_accvgpr_read_b32 v169, a21
    v_mul_f32 v169, v170, v169
    v_accvgpr_write_b32 a21, v169
    v_accvgpr_read_b32 v169, a22
    v_mul_f32 v169, v170, v169
    v_accvgpr_write_b32 a22, v169
    v_accvgpr_read_b32 v169, a23
    v_mul_f32 v169, v170, v169
    v_accvgpr_write_b32 a23, v169
    v_accvgpr_read_b32 v169, a32
    v_mul_f32 v169, v170, v169
    v_accvgpr_write_b32 a32, v169
    v_accvgpr_read_b32 v169, a33
    v_mul_f32 v169, v170, v169
    v_accvgpr_write_b32 a33, v169
    v_accvgpr_read_b32 v169, a34
    v_mul_f32 v169, v170, v169
    v_accvgpr_write_b32 a34, v169
    v_accvgpr_read_b32 v169, a35
    v_mul_f32 v169, v170, v169
    v_accvgpr_write_b32 a35, v169
    v_accvgpr_read_b32 v169, a44
    v_mul_f32 v169, v170, v169
    v_accvgpr_write_b32 a44, v169
    v_accvgpr_read_b32 v169, a45
    v_mul_f32 v169, v170, v169
    v_accvgpr_write_b32 a45, v169
    v_accvgpr_read_b32 v169, a46
    v_mul_f32 v169, v170, v169
    v_accvgpr_write_b32 a46, v169
    v_accvgpr_read_b32 v169, a47
    v_mul_f32 v169, v170, v169
    v_accvgpr_write_b32 a47, v169
    v_accvgpr_read_b32 v169, a56
    v_mul_f32 v169, v170, v169
    v_accvgpr_write_b32 a56, v169
    v_accvgpr_read_b32 v169, a57
    v_mul_f32 v169, v170, v169
    v_accvgpr_write_b32 a57, v169
    v_accvgpr_read_b32 v169, a58
    v_mul_f32 v169, v170, v169
    v_accvgpr_write_b32 a58, v169
    v_accvgpr_read_b32 v169, a59
    v_mul_f32 v169, v170, v169
    v_accvgpr_write_b32 a59, v169
    v_accvgpr_read_b32 v169, a68
    v_mul_f32 v169, v170, v169
    v_accvgpr_write_b32 a68, v169
    v_accvgpr_read_b32 v169, a69
    v_mul_f32 v169, v170, v169
    v_accvgpr_write_b32 a69, v169
    v_accvgpr_read_b32 v169, a70
    v_mul_f32 v169, v170, v169
    v_accvgpr_write_b32 a70, v169
    v_accvgpr_read_b32 v169, a71
    v_mul_f32 v169, v170, v169
    v_accvgpr_write_b32 a71, v169
    v_accvgpr_read_b32 v169, a80
    v_mul_f32 v169, v170, v169
    v_accvgpr_write_b32 a80, v169
    v_accvgpr_read_b32 v169, a81
    v_mul_f32 v169, v170, v169
    v_accvgpr_write_b32 a81, v169
    v_accvgpr_read_b32 v169, a82
    v_mul_f32 v169, v170, v169
    v_accvgpr_write_b32 a82, v169
    v_accvgpr_read_b32 v169, a83
    v_mul_f32 v169, v170, v169
    v_accvgpr_write_b32 a83, v169
    v_accvgpr_read_b32 v169, a92
    v_mul_f32 v169, v170, v169
    v_accvgpr_write_b32 a92, v169
    v_accvgpr_read_b32 v169, a93
    v_mul_f32 v169, v170, v169
    v_accvgpr_write_b32 a93, v169
    v_accvgpr_read_b32 v169, a94
    v_mul_f32 v169, v170, v169
    v_accvgpr_write_b32 a94, v169
    v_accvgpr_read_b32 v169, a95
    v_mul_f32 v169, v170, v169
    v_accvgpr_write_b32 a95, v169
    v_accvgpr_read_b32 v169, a104
    v_mul_f32 v169, v170, v169
    v_accvgpr_write_b32 a104, v169
    v_accvgpr_read_b32 v169, a105
    v_mul_f32 v169, v170, v169
    v_accvgpr_write_b32 a105, v169
    v_accvgpr_read_b32 v169, a106
    v_mul_f32 v169, v170, v169
    v_accvgpr_write_b32 a106, v169
    v_accvgpr_read_b32 v169, a107
    v_mul_f32 v169, v170, v169
    v_accvgpr_write_b32 a107, v169
    v_accvgpr_read_b32 v169, a116
    v_mul_f32 v169, v170, v169
    v_accvgpr_write_b32 a116, v169
    v_accvgpr_read_b32 v169, a117
    v_mul_f32 v169, v170, v169
    v_accvgpr_write_b32 a117, v169
    v_accvgpr_read_b32 v169, a118
    v_mul_f32 v169, v170, v169
    v_accvgpr_write_b32 a118, v169
    v_accvgpr_read_b32 v169, a119
    v_mul_f32 v169, v170, v169
    v_accvgpr_write_b32 a119, v169
    v_accvgpr_read_b32 v169, a128
    v_mul_f32 v169, v170, v169
    v_accvgpr_write_b32 a128, v169
    v_accvgpr_read_b32 v169, a129
    v_mul_f32 v169, v170, v169
    v_accvgpr_write_b32 a129, v169
    v_accvgpr_read_b32 v169, a130
    v_mul_f32 v169, v170, v169
    v_accvgpr_write_b32 a130, v169
    v_accvgpr_read_b32 v169, a131
    v_mul_f32 v169, v170, v169
    v_accvgpr_write_b32 a131, v169
    v_accvgpr_read_b32 v169, a140
    v_mul_f32 v169, v170, v169
    v_accvgpr_write_b32 a140, v169
    v_accvgpr_read_b32 v169, a141
    v_mul_f32 v169, v170, v169
    v_accvgpr_write_b32 a141, v169
    v_accvgpr_read_b32 v169, a142
    v_mul_f32 v169, v170, v169
    v_accvgpr_write_b32 a142, v169
    v_accvgpr_read_b32 v169, a143
    v_mul_f32 v169, v170, v169
    v_accvgpr_write_b32 a143, v169
    v_accvgpr_read_b32 v169, a152
    v_mul_f32 v169, v170, v169
    v_accvgpr_write_b32 a152, v169
    v_accvgpr_read_b32 v169, a153
    v_mul_f32 v169, v170, v169
    v_accvgpr_write_b32 a153, v169
    v_accvgpr_read_b32 v169, a154
    v_mul_f32 v169, v170, v169
    v_accvgpr_write_b32 a154, v169
    v_accvgpr_read_b32 v169, a155
    v_mul_f32 v169, v170, v169
    v_accvgpr_write_b32 a155, v169
    v_accvgpr_read_b32 v169, a164
    v_mul_f32 v169, v170, v169
    v_accvgpr_write_b32 a164, v169
    v_accvgpr_read_b32 v169, a165
    v_mul_f32 v169, v170, v169
    v_accvgpr_write_b32 a165, v169
    v_accvgpr_read_b32 v169, a166
    v_mul_f32 v169, v170, v169
    v_accvgpr_write_b32 a166, v169
    v_accvgpr_read_b32 v169, a167
    v_mul_f32 v169, v170, v169
    v_accvgpr_write_b32 a167, v169
    v_accvgpr_read_b32 v169, a176
    v_mul_f32 v169, v170, v169
    v_accvgpr_write_b32 a176, v169
    v_accvgpr_read_b32 v169, a177
    v_mul_f32 v169, v170, v169
    v_accvgpr_write_b32 a177, v169
    v_accvgpr_read_b32 v169, a178
    v_mul_f32 v169, v170, v169
    v_accvgpr_write_b32 a178, v169
    v_accvgpr_read_b32 v169, a179
    v_mul_f32 v169, v170, v169
    v_accvgpr_write_b32 a179, v169
    v_accvgpr_read_b32 v169, a188
    v_mul_f32 v169, v170, v169
    v_accvgpr_write_b32 a188, v169
    v_accvgpr_read_b32 v169, a189
    v_mul_f32 v169, v170, v169
    v_accvgpr_write_b32 a189, v169
    v_accvgpr_read_b32 v169, a190
    v_mul_f32 v169, v170, v169
    v_accvgpr_write_b32 a190, v169
    v_accvgpr_read_b32 v169, a191
    v_mul_f32 v169, v170, v169
    v_accvgpr_write_b32 a191, v169
    v_accvgpr_read_b32 v169, a200
    v_mul_f32 v169, v170, v169
    v_accvgpr_write_b32 a200, v169
    v_accvgpr_read_b32 v169, a201
    v_mul_f32 v169, v170, v169
    v_accvgpr_write_b32 a201, v169
    v_accvgpr_read_b32 v169, a202
    v_mul_f32 v169, v170, v169
    v_accvgpr_write_b32 a202, v169
    v_accvgpr_read_b32 v169, a203
    v_mul_f32 v169, v170, v169
    v_accvgpr_write_b32 a203, v169
    v_exp_f32 v171, v128
    v_exp_f32 v172, v129
    s_nop 1
    v_cvt_pk_bf16_f32 v164, v171, v172
    v_exp_f32 v171, v130
    v_exp_f32 v172, v131
    s_nop 1
    v_cvt_pk_bf16_f32 v165, v171, v172
    v_exp_f32 v171, v140
    v_exp_f32 v172, v141
    s_nop 1
    v_cvt_pk_bf16_f32 v166, v171, v172
    v_exp_f32 v171, v142
    v_exp_f32 v172, v143
    s_nop 1
    v_cvt_pk_bf16_f32 v167, v171, v172
    s_nop 7
    s_setpc_b64 s[28:29]
L_codeend:
.section .rodata,"a"
.p2align 6
.amdhsa_kernel concat_heads__mha_block_cached__gqa_block_cached__near_ridge_kernel
  .amdhsa_next_free_vgpr 512
  .amdhsa_next_free_sgpr 100
  .amdhsa_accum_offset 256
  .amdhsa_group_segment_fixed_size 0
  .amdhsa_kernarg_size 104
  .amdhsa_user_sgpr_count 2
  .amdhsa_user_sgpr_kernarg_segment_ptr 1
  .amdhsa_system_sgpr_workgroup_id_x 1
.end_amdhsa_kernel
```
